```python
import torch

def _softmax(x, axis=-1):
    return torch.softmax(x, dim=axis)
def _gelu(x):
    return torch.nn.functional.gelu(x, approximate="tanh")
def _silu(x):
    return torch.nn.functional.silu(x)
def _sigmoid(x):
    return torch.sigmoid(x)
def _layernorm(x, axis=-1, eps=1e-5):
    m = x.mean(dim=axis, keepdim=True)
    v = x.var(dim=axis, keepdim=True, unbiased=False)
    return (x - m) / torch.sqrt(v + eps)
def _scatter_add(tgt, idx, src, axis=0):
    return tgt.clone().index_add_(axis, idx, src)
def _segment_sum(src, seg, n):
    out = torch.zeros((n,) + src.shape[1:], dtype=src.dtype)
    return out.index_add_(0, seg, src)
def _pad(x, pw):
    flat = tuple(v for pair in reversed(pw) for v in pair)
    return torch.nn.functional.pad(x, flat)

kernel_name = 'sequential_preLN__grouped_kv_mqa__glu_gated_geglu__prompt'

def setup_inputs():

    _w = (lambda a: (lambda t: t.to(torch.bfloat16) if t.is_floating_point() else t)(torch.as_tensor(a)))
    def _A_setup():
        B, S, D, H = 1, 2048, 576, 32
        Dh = D // H
        return {
            "x": _w((lambda *s: torch.randn(*s, dtype=torch.bfloat16) * 0.05)(B, S, D)),
            "wq": _w((lambda *s: torch.randn(*s, dtype=torch.bfloat16) * 0.05)(D, H * Dh)),
            "wk": _w((lambda *s: torch.randn(*s, dtype=torch.bfloat16) * 0.05)(D, Dh)),
            "wv": _w((lambda *s: torch.randn(*s, dtype=torch.bfloat16) * 0.05)(D, Dh)),
            "wo": _w((lambda *s: torch.randn(*s, dtype=torch.bfloat16) * 0.05)(H * Dh, D)),
        }
    _A_in = _A_setup()

    def _B_setup():
        B, S, Dm, Df = 1, 2048, 576, 4608
        return {
            "x": _w((lambda *s: torch.randn(*s, dtype=torch.bfloat16) * 0.05)(B, S, Dm)),
            "w_gate": _w((lambda *s: torch.randn(*s, dtype=torch.bfloat16) * 0.8)(Dm, Df) * (Dm ** -0.5)),
            "w_up": _w((lambda *s: torch.randn(*s, dtype=torch.bfloat16) * 0.8)(Dm, Df) * (Dm ** -0.5)),
            "w_down": _w((lambda *s: torch.randn(*s, dtype=torch.bfloat16) * 0.8)(Df, Dm) * (Df ** -0.5)),
        }
    _B_in = _B_setup()

    return {
        "A_x": _A_in["x"],
        "A_wq": _A_in["wq"],
        "A_wk": _A_in["wk"],
        "A_wv": _A_in["wv"],
        "A_wo": _A_in["wo"],
        "B_x": _B_in["x"],
        "B_w_gate": _B_in["w_gate"],
        "B_w_up": _B_in["w_up"],
        "B_w_down": _B_in["w_down"],
    }

def reference(A_x, A_wq, A_wk, A_wv, A_wo, B_x, B_w_gate, B_w_up, B_w_down):
    def _A_ref(x, wq, wk, wv, wo):
        B, S, D = x.shape
        H = 32
        Dh = D // H
        q = (lambda x, *d: x.permute(*d))((x @ wq).reshape(B, S, H, Dh), 0, 2, 1, 3)
        k = x @ wk
        v = x @ wv
        scores = torch.einsum("bhqd,bkd->bhqk", q, k) * (Dh ** -0.5)
        p = _softmax(scores, axis=-1)
        o = torch.einsum("bhqk,bkd->bhqd", p, v)
        return (lambda x, *d: x.permute(*d))(o, 0, 2, 1, 3).reshape(B, S, H * Dh) @ wo

    def _B_ref(x, w_gate, w_up, w_down):
        g = torch.einsum("bsd,df->bsf", x, w_gate)
        u = torch.einsum("bsd,df->bsf", x, w_up)
        h = _gelu(g) * u
        return torch.einsum("bsf,fd->bsd", h, w_down)

    x = A_x
    h = x + _A_ref(_layernorm(x, axis=-1), A_wq, A_wk, A_wv, A_wo)
    h2 = h + _B_ref(_layernorm(h, axis=-1), B_w_gate, B_w_up, B_w_down)
    return h2
```

```asm
; @launch grid=(256,1,1) block=(256,1,1) lds=163840
.amdgcn_target "amdgcn-amd-amdhsa--gfx950"
.text
.p2align 12
.globl sequential_preLN__grouped_kv_mqa__glu_gated_geglu__prompt_kernel
.p2align 8
.type sequential_preLN__grouped_kv_mqa__glu_gated_geglu__prompt_kernel,@function
sequential_preLN__grouped_kv_mqa__glu_gated_geglu__prompt_kernel:
    s_cmp_ge_u32 s2, 256
    s_cbranch_scc1 KF_END
    s_load_dwordx8 s[80:87], s[0:1], 0
    s_load_dwordx2 s[20:21], s[0:1], 88
    v_lshrrev_b32 v176, 6, v0
    v_and_b32 v240, 63, v0
    v_readfirstlane_b32 s32, v176
    s_lshr_b32 s31, s2, 3
    s_and_b32 s48, s2, 7
    s_getpc_b64 s[12:13]
KF_PC:
    s_lshl2_add_u32 s49, s31, s32
    s_lshl_b32 s3, s49, 7
    v_lshl_add_u32 v176, v240, 14, s3
    v_min_u32 v176, CODE_END-KF_PC-4, v176
    s_mov_b64 exec, 31
    global_load_dword v174, v176, s[12:13]
    s_mov_b64 exec, -1
    s_lshr_b32 s4, s2, 5
    s_and_b32 s3, s31, 3
    s_lshl2_add_u32 s5, s48, s3
    s_lshl2_add_u32 s5, s5, s32
    s_mul_i32 s6, s5, 18432
    s_mul_i32 s15, s3, 9
    s_add_u32 s15, s15, 1
    s_lshr_b32 s15, s15, 2
    s_add_u32 s15, s15, s4
    s_cmp_ge_u32 s15, 9
    s_cselect_b32 s3, 9, 0
    s_sub_u32 s15, s15, s3
    s_lshl_b32 s42, s15, 7
    s_add_u32 s42, s42, s6
    s_mul_i32 s14, s15, 73728
    s_lshl_b32 s3, s4, 7
    s_add_u32 s14, s14, s3
    s_add_u32 s14, s14, 128
    s_lshl_b32 s25, s32, 10
    s_mul_i32 s38, s32, 18432
    s_add_u32 s38, s38, 83968
    v_lshlrev_b32 v241, 4, v240
    v_lshrrev_b32 v172, 3, v240
    v_lshrrev_b32 v177, 4, v240
    v_and_b32 v178, 7, v240
    v_xor_b32 v177, v177, v178
    v_mul_u32_u24 v176, 1152, v172
    v_lshl_add_u32 v164, v177, 4, v176
    v_xor_b32 v165, 64, v164
    v_add_u32 v165, 9216, v165
    v_bfe_u32 v176, v240, 1, 2
    v_and_or_b32 v176, v240, 24, v176
    v_lshrrev_b32 v177, 5, v240
    v_lshl_add_u32 v184, v177, 2, v176
    v_and_b32 v185, 16, v241
    s_cmp_ge_u32 s4, 5
    s_cselect_b32 s44, 36, 1152
    s_cselect_b32 s3, 0, s4
    s_lshl_b32 s3, s3, 5
    s_cmp_eq_u32 s4, 7
    s_cselect_b32 s50, 0, 16
    s_cselect_b32 s3, 20, s3
    v_and_b32 v176, s50, v241
    v_mad_u32_u24 v176, v184, s44, v176
    v_add_u32 v179, s3, v176
    s_lshl_b32 s90, s44, 5
    v_cmp_eq_u32 vcc, 0, v185
    s_mov_b32 s18, 2359296
    s_mov_b32 s19, 0x20000
    s_mov_b32 s10, 663552
    s_mov_b32 s11, 0x20000
    s_mov_b32 s62, 663552
    s_mov_b32 s63, 0x20000
    s_mov_b32 s22, 48234496
    s_mov_b32 s23, 0x20000
    s_mov_b32 s89, 0
    s_waitcnt lgkmcnt(0)
    s_mov_b64 s[16:17], s[80:81]
    s_add_u32 m0, s38, 0
    s_nop 0
    buffer_load_dwordx4 v164, s[16:19], s42 offen  lds
    s_add_u32 m0, s38, 1024
    s_nop 0
    buffer_load_dwordx4 v165, s[16:19], s42 offen  lds
    s_cmp_eq_u32 s15, 8
    s_cselect_b32 s3, -64, 8
    s_add_u32 m0, s38, 2048
    s_lshl4_add_u32 s42, s3, s42
    buffer_load_dwordx4 v164, s[16:19], s42 offen  lds
    s_add_u32 m0, s38, 3072
    s_nop 0
    buffer_load_dwordx4 v165, s[16:19], s42 offen  lds
    s_cmp_eq_u32 s15, 7
    s_cselect_b32 s3, -64, 8
    s_add_u32 m0, s38, 4096
    s_lshl4_add_u32 s42, s3, s42
    buffer_load_dwordx4 v164, s[16:19], s42 offen  lds
    s_add_u32 m0, s38, 5120
    s_nop 0
    buffer_load_dwordx4 v165, s[16:19], s42 offen  lds
    s_mov_b64 s[8:9], s[82:83]
    s_load_dwordx2 s[60:61], s[0:1], 32
    s_load_dwordx2 s[64:65], s[0:1], 48
    s_load_dwordx2 s[72:73], s[0:1], 56
    s_load_dwordx2 s[76:77], s[0:1], 64
    s_load_dwordx2 s[26:27], s[0:1], 72
    s_load_dwordx2 s[40:41], s[0:1], 80
    s_add_u32 s58, s20, 46436352
    s_addc_u32 s59, s21, 0
    s_or_b32 s3, s2, s32
    s_cbranch_scc1 K1_NOTAG0
    s_load_dword s91, s[58:59], 0
K1_NOTAG0:
    s_cmp_eq_u32 s4, 6
    s_cselect_b64 s[52:53], s[86:87], s[84:85]
    s_cmp_eq_u32 s4, 5
    s_cselect_b64 s[54:55], s[84:85], s[86:87]
    s_cmp_lt_u32 s4, 5
    s_cselect_b64 s[52:53], s[8:9], s[52:53]
    s_cselect_b64 s[54:55], s[8:9], s[54:55]
    v_mov_b32 v180, s52
    v_mov_b32 v181, s53
    v_mov_b32 v182, s54
    v_mov_b32 v183, s55
    v_cndmask_b32 v180, v182, v180, vcc
    v_cndmask_b32 v181, v183, v181, vcc
    v_add_co_u32 v166, vcc, v180, v179
    s_nop 1
    v_addc_co_u32 v167, vcc, 0, v181, vcc
    s_add_u32 s88, s32, 0
    s_lshl_b32 s3, s88, 10
    s_add_u32 m0, s3, 57344
    s_lshl1_add_u32 s88, s15, s88
    s_cmp_ge_u32 s88, 18
    s_cselect_b32 s3, 18, 0
    s_sub_u32 s88, s88, s3
    s_mul_i32 s88, s88, s90
    v_lshl_add_u64 v[194:195], v[166:167], 0, s[88:89]
    global_load_lds_dwordx4 v[194:195], off
    s_branch K1_MAIN
.p2align 12
K1_MAIN:
    s_min_u32 s50, s2, 161
    s_mul_i32 s52, s50, 57
    s_lshr_b32 s52, s52, 9
    s_mul_i32 s53, s52, 9
    s_sub_u32 s53, s50, s53
    s_lshl2_add_u32 s53, s53, s32
    s_lshl_b32 s54, s52, 5
    v_add_u32 v176, s54, v184
    v_lshrrev_b32 v177, 4, v176
    v_lshl_add_u32 v177, v177, 1, v176
    v_and_b32 v178, 60, v176
    v_lshrrev_b32 v178, 1, v178
    v_and_or_b32 v178, v176, 1, v178
    v_bfe_u32 v179, v176, 1, 1
    v_cmp_gt_u32 vcc, 512, v176
    v_mad_u32_u24 v178, v178, 18, v179
    v_add_u32 v178, 16, v178
    v_cndmask_b32 v177, v178, v177, vcc
    s_movk_i32 s44, 1152
    v_mad_u32_u24 v169, v177, s44, v185
    s_lshl_b32 s54, s53, 5
    s_cmp_ge_u32 s2, 162
    s_cselect_b32 s54, 1073741824, s54
    s_add_u32 m0, s25, 75776
    s_mul_i32 s55, s53, 57
    s_waitcnt lgkmcnt(0)
    buffer_load_dwordx4 v169, s[60:63], s54 offen lds
    s_or_b32 s3, s2, s32
    s_cbranch_scc1 K1_NOTAG
    s_waitcnt lgkmcnt(0)
    s_add_u32 s91, s91, 4
    s_bitset1_b32 s91, 31
    v_mov_b32 v192, 0
    v_mov_b32 v193, s91
    s_mov_b64 exec, 1
    global_store_dword v192, v193, s[40:41] sc1
    global_store_dword v192, v193, s[58:59] sc1
    s_mov_b64 exec, -1
K1_NOTAG:
    s_lshr_b32 s55, s55, 9
    s_mul_i32 s24, s55, 72
    s_add_u32 s24, s24, s53
    s_lshr_b32 s55, s52, 1
    s_mul_i32 s55, s55, 9
    s_add_u32 s24, s24, s55
    s_and_b32 s55, s52, 1
    s_lshl1_add_u32 s24, s24, s55
    s_lshl_b32 s24, s24, 10
    s_add_u32 s24, s24, 2621440
    s_cmp_ge_u32 s2, 162
    s_cselect_b32 s24, 1073741824, s24
    v_and_b32 v176, 6, v172
    v_and_b32 v177, 7, v240
    v_xor_b32 v177, v177, v176
    v_and_b32 v176, 4, v172
    s_and_b32 s53, s32, 1
    s_lshr_b32 s54, s32, 1
    s_lshl2_add_u32 s53, s53, s54
    s_lshl_b32 s53, s53, 2
    v_add3_u32 v176, v176, v172, s53
    v_mul_u32_u24 v176, 1152, v176
    v_lshl_add_u32 v168, v177, 4, v176
    v_bfe_u32 v176, v240, 2, 3
    v_lshrrev_b32 v177, 5, v240
    v_lshlrev_b32 v177, 10, v177
    v_lshl_add_u32 v177, v176, 7, v177
    v_and_b32 v176, 6, v176
    v_lshl_add_u32 v177, v176, 4, v177
    v_and_b32 v176, 3, v240
    v_lshl_add_u32 v170, v176, 3, v177
    s_lshl_b32 s53, s32, 5
    v_xor_b32 v170, s53, v170
    s_mov_b32 s53, 57344
    v_lshl_add_u32 v171, v240, 3, s53
    v_mov_b32 v140, 0x3f803f80
    v_mov_b32 v141, 0x3f803f80
    v_mov_b32 v142, 0x3f803f80
    v_mov_b32 v143, 0x3f803f80
    v_bfe_u32 v176, v240, 1, 3
    v_lshrrev_b32 v177, 4, v240
    v_xor_b32 v176, v176, v177
    v_and_b32 v177, 15, v240
    v_lshlrev_b32 v177, 7, v177
    v_lshl_add_u32 v176, v176, 4, v177
    v_and_b32 v177, 32, v240
    v_add_u32 v177, v177, v241
    s_mul_i32 s55, s32, 1088
    s_xor_b32 s53, s32, 0
    s_mul_i32 s54, s53, 18432
    s_add_u32 s54, s54, 83968
    v_add_u32 v156, s54, v176
    v_xor_b32 v157, 64, v156
    s_mul_i32 s54, s53, 4352
    s_add_u32 s54, s54, s55
    v_add_u32 v196, s54, v177
    s_xor_b32 s53, s32, 1
    s_mul_i32 s54, s53, 18432
    s_add_u32 s54, s54, 83968
    v_add_u32 v158, s54, v176
    v_xor_b32 v159, 64, v158
    s_mul_i32 s54, s53, 4352
    s_add_u32 s54, s54, s55
    v_add_u32 v197, s54, v177
    s_xor_b32 s53, s32, 2
    s_mul_i32 s54, s53, 18432
    s_add_u32 s54, s54, 83968
    v_add_u32 v160, s54, v176
    v_xor_b32 v161, 64, v160
    s_mul_i32 s54, s53, 4352
    s_add_u32 s54, s54, s55
    v_add_u32 v198, s54, v177
    s_xor_b32 s53, s32, 3
    s_mul_i32 s54, s53, 18432
    s_add_u32 s54, s54, 83968
    v_add_u32 v162, s54, v176
    v_xor_b32 v163, 64, v162
    s_mul_i32 s54, s53, 4352
    s_add_u32 s54, s54, s55
    v_add_u32 v199, s54, v177
    v_and_b32 v176, 7, v240
    v_mul_u32_u24 v177, 544, v176
    v_lshl_add_u32 v177, v172, 4, v177
    s_mul_i32 s54, s32, 4352
    v_add_u32 v200, s54, v177
    v_lshlrev_b32 v201, 5, v176
    v_and_b32 v177, 48, v240
    v_lshl_add_u32 v202, s32, 6, v177
    v_lshlrev_b32 v176, 4, v176
    v_mad_u32_u24 v203, v172, s44, v176
    s_add_u32 s53, s25, 79872
    v_mov_b32 v204, s53
    v_bfe_u32 v176, v240, 2, 3
    v_and_b32 v177, 3, v240
    v_mul_u32_u24 v176, 1152, v176
    v_mul_u32_u24 v177, 92, v177
    v_add_u32 v205, v176, v177
    s_mul_i32 s53, s49, 384
    s_min_u32 s53, s53, KF_END-KF_TAIL-256
    s_add_u32 s53, s53, ((KF_TAIL-sequential_preLN__grouped_kv_mqa__glu_gated_geglu__prompt_kernel)&~127)+60-(KF_PC-sequential_preLN__grouped_kv_mqa__glu_gated_geglu__prompt_kernel)
    s_add_u32 s12, s12, s53
    s_addc_u32 s13, s13, 0
    s_mov_b32 s33, 0
    v_lshlrev_b32 v255, 2, v240
    v_lshlrev_b32 v251, 3, v240
    s_mul_i32 s36, s2, 9216
    s_mul_i32 s37, s32, 40960
    s_add_u32 s37, s37, 2359296
    s_lshr_b32 s39, s2, 1
    s_mul_i32 s39, s39, 2048
    s_lshl_b32 s53, s2, 8
    s_add_u32 s39, s39, s53
    s_add_u32 s39, s39, 5767168
    v_accvgpr_write_b32 a241, 0
    v_accvgpr_write_b32 a243, 0
    v_accvgpr_write_b32 a245, 0
    v_accvgpr_write_b32 a247, 0
    v_accvgpr_write_b32 a249, 0
    v_accvgpr_write_b32 a251, 0
    v_accvgpr_write_b32 a253, 0
    v_accvgpr_write_b32 a255, 0
    v_mov_b32 v238, 0
    v_mov_b32 v239, 0
    v_bfe_u32 v176, v240, 2, 2
    v_and_b32 v177, 1, v240
    v_lshl_add_u32 v176, v176, 1, v177
    v_mul_u32_u24 v176, 1152, v176
    v_and_or_b32 v176, v240, 48, v176
    v_and_b32 v177, 2, v240
    v_lshl_add_u32 v224, v177, 29, v176
    s_mul_i32 s7, s32, 288
    s_add_u32 s7, s7, s36
    v_and_b32 v176, 31, v240
    v_lshrrev_b32 v177, 5, v240
    v_lshlrev_b32 v178, 4, v177
    v_lshl_add_u32 v248, v176, 5, v178
    v_and_b32 v182, 16, v240
    v_mad_u32_u24 v248, v182, 48, v248
    v_and_b32 v182, 48, v240
    v_mul_u32_u24 v182, 72, v182
    v_lshl_add_u32 v223, v240, 3, v182
    v_and_b32 v184, 1, v176
    v_cmp_eq_u32 vcc, 1, v184
    v_bfe_u32 v183, v176, 2, 1
    v_add_u32 v183, 16, v183
    v_cndmask_b32 v183, v183, 18, vcc
    v_cmp_gt_u32 vcc, 16, v176
    v_and_b32 v185, 26, v176
    v_mov_b32 v184, 1073741824
    v_cndmask_b32 v182, v183, v176, vcc
    v_cmp_lt_u32 vcc, 16, v185
    v_lshl_add_u32 v182, v182, 5, v178
    v_add_u32 v182, 640, v182
    v_bfe_u32 v179, v240, 2, 3
    v_cndmask_b32 v249, v182, v184, vcc
    v_and_b32 v180, 3, v240
    v_mul_u32_u24 v247, 1152, v179
    v_mad_u32_u24 v247, v180, 36, v247
    v_add_u32 v246, v247, v178
    v_mul_u32_u24 v181, 36, v180
    s_mul_i32 s53, s32, 1280
    s_add_u32 s53, s53, 157696
    v_lshl_add_u32 v182, v179, 5, s53
    v_and_b32 v183, 48, v240
    v_lshl_add_u32 v213, v183, 4, v241
    v_add3_u32 v183, v181, v178, 0
    v_lshrrev_b32 v184, 5, v183
    v_and_or_b32 v183, v183, 31, v182
    v_lshl_add_u32 v206, v184, 8, v183
    v_add3_u32 v183, v181, v178, 4
    v_lshrrev_b32 v184, 5, v183
    v_and_or_b32 v183, v183, 31, v182
    v_lshl_add_u32 v207, v184, 8, v183
    v_add3_u32 v183, v181, v178, 8
    v_lshrrev_b32 v184, 5, v183
    v_and_or_b32 v183, v183, 31, v182
    v_lshl_add_u32 v208, v184, 8, v183
    v_add3_u32 v183, v181, v178, 12
    v_lshrrev_b32 v184, 5, v183
    v_and_or_b32 v183, v183, 31, v182
    v_lshl_add_u32 v209, v184, 8, v183
    v_add_u32 v183, 32, v181
    v_lshrrev_b32 v184, 5, v183
    v_and_or_b32 v183, v183, 31, v182
    v_lshl_add_u32 v210, v184, 8, v183
    s_and_b32 s53, s31, 3
    s_lshr_b32 s54, s31, 2
    s_lshl3_add_u32 s53, s53, s54
    v_and_b32 v176, 7, v240
    v_lshl_add_u32 v176, v176, 5, s53
    s_lshr_b32 s54, s48, 1
    s_lshl_b32 s54, s54, 7
    s_add_u32 s54, s54, 46440448
    v_lshl_add_u32 v212, v176, 9, s54
    v_bfe_u32 v177, v240, 2, 1
    v_lshl_add_u32 v177, v180, 3, v177
    v_and_b32 v178, 24, v240
    v_lshl_add_u32 v177, v178, 2, v177
    s_lshl1_add_u32 s53, s32, 160
    v_cmp_gt_u32 vcc, 24, v240
    v_add_u32 v177, s53, v177
    s_mov_b32 s53, 46403584
    v_cndmask_b32 v176, v176, v177, vcc
    v_lshl_add_u32 v211, v176, 7, s53
    v_lshrrev_b32 v176, 4, v240
    v_and_b32 v177, 15, v240
    v_mul_u32_u24 v176, 4672, v176
    v_lshl_add_u32 v176, v177, 2, v176
    s_mul_i32 s53, s32, 576
    v_add_u32 v225, s53, v176
    v_add_u32 v226, 2336, v225
    v_and_b32 v176, 31, v240
    v_lshrrev_b32 v177, 5, v240
    v_lshl_add_u32 v178, s32, 1, v177
    v_mul_u32_u24 v179, 2336, v178
    v_lshl_add_u32 v227, v176, 5, v179
    s_and_b32 s53, s32, 1
    v_and_b32 v179, 7, v176
    v_xor_b32 v179, s53, v179
    v_lshlrev_b32 v179, 4, v179
    v_lshl_add_u32 v179, v178, 7, v179
    v_lshrrev_b32 v176, 3, v176
    v_lshl_add_u32 v179, v176, 13, v179
    v_add_u32 v228, 18944, v179
    s_lshl_b32 s54, s32, 2
    v_mov_b32 v229, s54
    v_and_b32 v176, 48, v240
    v_add_lshl_u32 v230, v176, v229, 2
    v_lshl_add_u32 v176, v229, 1, v177
    v_lshlrev_b32 v176, 3, v176
    v_add_u32 v231, 18688, v176
    s_lshl_b32 s53, s32, 1
    s_add_u32 s54, s53, 1
    s_max_u32 s53, s53, 1
    v_lshrrev_b32 v176, 3, v240
    v_bfe_u32 v177, v240, 4, 1
    v_and_b32 v178, 7, v240
    v_xor_b32 v177, v177, v178
    v_mul_u32_u24 v176, 1152, v176
    v_lshl_add_u32 v176, v177, 4, v176
    s_and_b32 s55, s53, 3
    s_lshl_b32 s55, s55, 5
    v_xor_b32 v232, s55, v176
    s_add_u32 s53, s53, s48
    s_and_b32 s53, s53, 7
    s_and_b32 s55, s54, 3
    s_lshl_b32 s55, s55, 5
    v_xor_b32 v233, s55, v176
    s_add_u32 s54, s54, s48
    s_and_b32 s54, s54, 7
    v_and_b32 v176, 4, v240
    v_cmp_eq_u32 vcc, 0, v176
    v_mov_b32 v176, s53
    v_mov_b32 v177, s54
    v_cndmask_b32 v176, v177, v176, vcc
    v_and_b32 v177, 3, v240
    v_lshl_add_u32 v176, v176, 2, v177
    s_lshl_b32 s53, s31, 12
    s_add_u32 s53, s53, 46141440
    v_lshl_add_u32 v234, v176, 7, s53
    v_bfe_u32 v176, v240, 1, 3
    v_lshrrev_b32 v177, 4, v240
    v_xor_b32 v176, v176, v177
    v_and_b32 v177, 3, v240
    v_lshlrev_b32 v177, 7, v177
    v_lshl_add_u32 v176, v176, 4, v177
    v_bfe_u32 v177, v240, 2, 2
    v_lshl_add_u32 v176, v177, 10, v176
    v_add_u32 v235, 18944, v176
    v_mov_b32 v236, 0xdddddddd
    v_bfe_u32 v176, v240, 1, 1
    v_mul_u32_u24 v237, 0xaaaa, v176
    v_add_u32 v237, 0x4444, v237
    s_mul_i32 s53, s32, 2560
    s_mul_i32 s43, s32, 10240
    v_add_u32 v242, s53, v241
    v_lshl_add_u32 v243, v240, 3, s53
    v_add_u32 v244, s43, v241
    v_lshl_add_u32 v245, v240, 3, s43
    s_add_u32 s43, s43, 50240
    s_mov_b64 exec, 0
    s_cmp_eq_u32 s32, 0
    s_cbranch_scc1 HOP0_0
    s_cmp_eq_u32 s32, 1
    s_cbranch_scc1 HOP0_1
    s_cmp_eq_u32 s32, 2
    s_cbranch_scc1 HOP0_2
    s_branch HOP0_3
HOP0_1:
HOP0_2:
HOP0_3:
HOPRET0:
    s_mov_b64 exec, -1
    s_add_u32 s88, s32, 4
    s_lshl_b32 s3, s88, 10
    s_add_u32 m0, s3, 57344
    s_lshl1_add_u32 s88, s15, s88
    s_cmp_ge_u32 s88, 18
    s_cselect_b32 s3, 18, 0
    s_sub_u32 s88, s88, s3
    s_mul_i32 s88, s88, s90
    v_lshl_add_u64 v[194:195], v[166:167], 0, s[88:89]
    global_load_lds_dwordx4 v[194:195], off
    s_add_u32 s88, s32, 8
    s_lshl_b32 s3, s88, 10
    s_add_u32 m0, s3, 57344
    s_lshl1_add_u32 s88, s15, s88
    s_cmp_ge_u32 s88, 18
    s_cselect_b32 s3, 18, 0
    s_sub_u32 s88, s88, s3
    s_mul_i32 s88, s88, s90
    v_lshl_add_u64 v[194:195], v[166:167], 0, s[88:89]
    global_load_lds_dwordx4 v[194:195], off
    s_add_u32 s88, s32, 12
    s_lshl_b32 s3, s88, 10
    s_add_u32 m0, s3, 57344
    s_lshl1_add_u32 s88, s15, s88
    s_cmp_ge_u32 s88, 18
    s_cselect_b32 s3, 18, 0
    s_sub_u32 s88, s88, s3
    s_mul_i32 s88, s88, s90
    v_lshl_add_u64 v[194:195], v[166:167], 0, s[88:89]
    global_load_lds_dwordx4 v[194:195], off
    s_add_u32 s88, s32, 16
    s_min_u32 s88, s88, 17
    s_lshl_b32 s3, s88, 10
    s_add_u32 m0, s3, 57344
    s_lshl1_add_u32 s88, s15, s88
    s_cmp_ge_u32 s88, 18
    s_cselect_b32 s3, 18, 0
    s_sub_u32 s88, s88, s3
    s_mul_i32 s88, s88, s90
    v_lshl_add_u64 v[194:195], v[166:167], 0, s[88:89]
    global_load_lds_dwordx4 v[194:195], off
    s_cmp_eq_u32 s15, 6
    s_cselect_b32 s3, -64, 8
    s_add_u32 m0, s38, 6144
    s_lshl4_add_u32 s42, s3, s42
    buffer_load_dwordx4 v164, s[16:19], s42 offen  lds
    s_add_u32 m0, s38, 7168
    s_nop 0
    buffer_load_dwordx4 v165, s[16:19], s42 offen  lds
    s_cmp_eq_u32 s15, 5
    s_cselect_b32 s3, -64, 8
    s_add_u32 m0, s38, 8192
    s_lshl4_add_u32 s42, s3, s42
    buffer_load_dwordx4 v164, s[16:19], s42 offen  lds
    s_add_u32 m0, s38, 9216
    s_nop 0
    buffer_load_dwordx4 v165, s[16:19], s42 offen  lds
    s_cmp_eq_u32 s15, 4
    s_cselect_b32 s3, -64, 8
    s_add_u32 m0, s38, 10240
    s_lshl4_add_u32 s42, s3, s42
    buffer_load_dwordx4 v164, s[16:19], s42 offen  lds
    s_add_u32 m0, s38, 11264
    s_nop 0
    buffer_load_dwordx4 v165, s[16:19], s42 offen  lds
    s_cmp_eq_u32 s15, 3
    s_cselect_b32 s3, -64, 8
    s_add_u32 m0, s38, 12288
    s_lshl4_add_u32 s42, s3, s42
    buffer_load_dwordx4 v164, s[16:19], s42 offen  lds
    s_add_u32 m0, s38, 13312
    s_nop 0
    buffer_load_dwordx4 v165, s[16:19], s42 offen  lds
    s_cmp_eq_u32 s15, 2
    s_cselect_b32 s3, -64, 8
    s_add_u32 m0, s38, 14336
    s_lshl4_add_u32 s42, s3, s42
    buffer_load_dwordx4 v164, s[16:19], s42 offen  lds
    s_add_u32 m0, s38, 15360
    s_nop 0
    buffer_load_dwordx4 v165, s[16:19], s42 offen  lds
    s_cmp_eq_u32 s15, 1
    s_cselect_b32 s3, -64, 8
    s_add_u32 m0, s38, 16384
    s_lshl4_add_u32 s42, s3, s42
    buffer_load_dwordx4 v164, s[16:19], s42 offen  lds
    s_add_u32 m0, s38, 17408
    s_nop 0
    buffer_load_dwordx4 v165, s[16:19], s42 offen  lds
    s_mov_b32 s52, 1048577
    s_mov_b32 s53, 268435712
    s_mov_b32 s54, 2097154
    s_mov_b32 s55, 536871424
    s_mov_b32 s56, 4194308
    s_mov_b32 s57, 1073742848
    s_mov_b32 s58, 8388616
    s_mov_b32 s59, 2147485696
    s_waitcnt vmcnt(12)
    s_barrier
    ds_read_b128 v[0:3], v156 offset:0
    ds_read_b64_tr_b16 v[104:105], v171 offset:0
    ds_read_b64_tr_b16 v[106:107], v171 offset:512
    ds_read_b128 v[4:7], v157 offset:0
    ds_read_b64_tr_b16 v[108:109], v171 offset:1024
    ds_read_b64_tr_b16 v[110:111], v171 offset:1536
    s_waitcnt lgkmcnt(3)
    v_mfma_f32_16x16x32_bf16 v[120:123], v[104:107], v[0:3], 0
    ds_read_b128 v[8:11], v156 offset:2048
    v_mfma_f32_16x16x32_bf16 v[124:127], v[104:107], v[140:143], 0
    ds_read_b64_tr_b16 v[112:113], v171 offset:2048
    v_mfma_f32_16x16x32_bf16 v[136:139], v[0:3], v[0:3], 0
    ds_read_b64_tr_b16 v[114:115], v171 offset:2560
    v_mfma_f32_16x16x32_bf16 v[132:135], v[140:143], v[0:3], 0
    s_add_u32 m0, s25, 0
    s_nop 0
    buffer_load_dwordx4 v168, s[8:11], s14 offen lds
    s_waitcnt lgkmcnt(3)
    v_mfma_f32_16x16x32_bf16 v[120:123], v[108:111], v[4:7], v[120:123]
    ds_read_b128 v[12:15], v157 offset:2048
    v_mfma_f32_16x16x32_bf16 v[124:127], v[108:111], v[140:143], v[124:127]
    ds_read_b64_tr_b16 v[104:105], v171 offset:3072
    v_mfma_f32_16x16x32_bf16 v[136:139], v[4:7], v[4:7], v[136:139]
    ds_read_b64_tr_b16 v[106:107], v171 offset:3584
    v_mfma_f32_16x16x32_bf16 v[132:135], v[140:143], v[4:7], v[132:135]
    s_add_u32 m0, s25, 4096
    s_add_u32 s14, s14, 36864
    buffer_load_dwordx4 v168, s[8:11], s14 offen lds
    s_waitcnt lgkmcnt(3)
    v_mfma_f32_16x16x32_bf16 v[120:123], v[112:115], v[8:11], v[120:123]
    ds_read_b128 v[16:19], v156 offset:4096
    v_mfma_f32_16x16x32_bf16 v[124:127], v[112:115], v[140:143], v[124:127]
    ds_read_b64_tr_b16 v[108:109], v171 offset:4096
    v_mfma_f32_16x16x32_bf16 v[136:139], v[8:11], v[8:11], v[136:139]
    ds_read_b64_tr_b16 v[110:111], v171 offset:4608
    v_mfma_f32_16x16x32_bf16 v[132:135], v[140:143], v[8:11], v[132:135]
    s_cmp_eq_u32 s15, 8
    s_cselect_b32 s3, -663552, 0
    s_add_u32 m0, s25, 8192
    s_add_u32 s14, s14, s3
    s_add_u32 s14, s14, 36864
    buffer_load_dwordx4 v168, s[8:11], s14 offen lds
    s_waitcnt lgkmcnt(3)
    v_mfma_f32_16x16x32_bf16 v[120:123], v[104:107], v[12:15], v[120:123]
    ds_read_b128 v[20:23], v157 offset:4096
    v_mfma_f32_16x16x32_bf16 v[124:127], v[104:107], v[140:143], v[124:127]
    ds_read_b64_tr_b16 v[112:113], v171 offset:5120
    v_mfma_f32_16x16x32_bf16 v[136:139], v[12:15], v[12:15], v[136:139]
    ds_read_b64_tr_b16 v[114:115], v171 offset:5632
    v_mfma_f32_16x16x32_bf16 v[132:135], v[140:143], v[12:15], v[132:135]
    s_add_u32 m0, s25, 12288
    s_add_u32 s14, s14, 36864
    buffer_load_dwordx4 v168, s[8:11], s14 offen lds
    s_waitcnt lgkmcnt(3)
    v_mfma_f32_16x16x32_bf16 v[120:123], v[108:111], v[16:19], v[120:123]
    s_waitcnt vmcnt(14)
    ds_read_b128 v[24:27], v156 offset:6144
    v_mfma_f32_16x16x32_bf16 v[124:127], v[108:111], v[140:143], v[124:127]
    ds_read_b64_tr_b16 v[104:105], v171 offset:6144
    v_mfma_f32_16x16x32_bf16 v[136:139], v[16:19], v[16:19], v[136:139]
    ds_read_b64_tr_b16 v[106:107], v171 offset:6656
    v_mfma_f32_16x16x32_bf16 v[132:135], v[140:143], v[16:19], v[132:135]
    s_cmp_eq_u32 s15, 7
    s_cselect_b32 s3, -663552, 0
    s_add_u32 m0, s25, 16384
    s_add_u32 s14, s14, s3
    s_add_u32 s14, s14, 36864
    buffer_load_dwordx4 v168, s[8:11], s14 offen lds
    s_waitcnt lgkmcnt(3)
    v_mfma_f32_16x16x32_bf16 v[120:123], v[112:115], v[20:23], v[120:123]
    ds_read_b128 v[28:31], v157 offset:6144
    v_mfma_f32_16x16x32_bf16 v[124:127], v[112:115], v[140:143], v[124:127]
    ds_read_b64_tr_b16 v[108:109], v171 offset:7168
    v_mfma_f32_16x16x32_bf16 v[136:139], v[20:23], v[20:23], v[136:139]
    ds_read_b64_tr_b16 v[110:111], v171 offset:7680
    v_mfma_f32_16x16x32_bf16 v[132:135], v[140:143], v[20:23], v[132:135]
    s_add_u32 m0, s25, 20480
    s_add_u32 s14, s14, 36864
    buffer_load_dwordx4 v168, s[8:11], s14 offen lds
    s_waitcnt lgkmcnt(3)
    v_mfma_f32_16x16x32_bf16 v[120:123], v[104:107], v[24:27], v[120:123]
    s_waitcnt vmcnt(14)
    ds_read_b128 v[32:35], v156 offset:8192
    v_mfma_f32_16x16x32_bf16 v[124:127], v[104:107], v[140:143], v[124:127]
    ds_read_b64_tr_b16 v[112:113], v171 offset:8192
    v_mfma_f32_16x16x32_bf16 v[136:139], v[24:27], v[24:27], v[136:139]
    ds_read_b64_tr_b16 v[114:115], v171 offset:8704
    v_mfma_f32_16x16x32_bf16 v[132:135], v[140:143], v[24:27], v[132:135]
    s_cmp_eq_u32 s15, 6
    s_cselect_b32 s3, -663552, 0
    s_add_u32 m0, s25, 24576
    s_add_u32 s14, s14, s3
    s_add_u32 s14, s14, 36864
    buffer_load_dwordx4 v168, s[8:11], s14 offen lds
    s_waitcnt lgkmcnt(3)
    v_mfma_f32_16x16x32_bf16 v[120:123], v[108:111], v[28:31], v[120:123]
    ds_read_b128 v[36:39], v157 offset:8192
    v_mfma_f32_16x16x32_bf16 v[124:127], v[108:111], v[140:143], v[124:127]
    ds_read_b64_tr_b16 v[104:105], v171 offset:9216
    v_mfma_f32_16x16x32_bf16 v[136:139], v[28:31], v[28:31], v[136:139]
    ds_read_b64_tr_b16 v[106:107], v171 offset:9728
    v_mfma_f32_16x16x32_bf16 v[132:135], v[140:143], v[28:31], v[132:135]
    s_add_u32 m0, s25, 28672
    s_add_u32 s14, s14, 36864
    buffer_load_dwordx4 v168, s[8:11], s14 offen lds
    s_waitcnt lgkmcnt(3)
    v_mfma_f32_16x16x32_bf16 v[120:123], v[112:115], v[32:35], v[120:123]
    s_waitcnt vmcnt(14)
    ds_read_b128 v[40:43], v156 offset:10240
    v_mfma_f32_16x16x32_bf16 v[124:127], v[112:115], v[140:143], v[124:127]
    ds_read_b64_tr_b16 v[108:109], v171 offset:10240
    v_mfma_f32_16x16x32_bf16 v[136:139], v[32:35], v[32:35], v[136:139]
    ds_read_b64_tr_b16 v[110:111], v171 offset:10752
    v_mfma_f32_16x16x32_bf16 v[132:135], v[140:143], v[32:35], v[132:135]
    v_add_u32 v176, s25, v171
    ds_read_b64_tr_b16 v[144:145], v176 offset:18432
    ds_read_b64_tr_b16 v[146:147], v176 offset:18944
    s_cmp_eq_u32 s15, 5
    s_cselect_b32 s3, -663552, 0
    s_add_u32 m0, s25, 32768
    s_add_u32 s14, s14, s3
    s_add_u32 s14, s14, 36864
    buffer_load_dwordx4 v168, s[8:11], s14 offen lds
    s_waitcnt lgkmcnt(5)
    v_mfma_f32_16x16x32_bf16 v[120:123], v[104:107], v[36:39], v[120:123]
    ds_read_b128 v[44:47], v157 offset:10240
    v_mfma_f32_16x16x32_bf16 v[124:127], v[104:107], v[140:143], v[124:127]
    ds_read_b64_tr_b16 v[112:113], v171 offset:11264
    v_mfma_f32_16x16x32_bf16 v[136:139], v[36:39], v[36:39], v[136:139]
    ds_read_b64_tr_b16 v[114:115], v171 offset:11776
    v_mfma_f32_16x16x32_bf16 v[132:135], v[140:143], v[36:39], v[132:135]
    s_waitcnt lgkmcnt(5)
    v_mfma_f32_16x16x32_bf16 v[120:123], v[108:111], v[40:43], v[120:123]
    s_waitcnt vmcnt(13)
    ds_read_b128 v[48:51], v156 offset:12288
    v_mfma_f32_16x16x32_bf16 v[124:127], v[108:111], v[140:143], v[124:127]
    ds_read_b64_tr_b16 v[104:105], v171 offset:12288
    v_mfma_f32_16x16x32_bf16 v[136:139], v[40:43], v[40:43], v[136:139]
    ds_read_b64_tr_b16 v[106:107], v171 offset:12800
    v_mfma_f32_16x16x32_bf16 v[132:135], v[140:143], v[40:43], v[132:135]
    s_waitcnt lgkmcnt(3)
    v_mfma_f32_16x16x32_bf16 v[120:123], v[112:115], v[44:47], v[120:123]
    ds_read_b128 v[52:55], v157 offset:12288
    v_mfma_f32_16x16x32_bf16 v[124:127], v[112:115], v[140:143], v[124:127]
    ds_read_b64_tr_b16 v[108:109], v171 offset:13312
    v_mfma_f32_16x16x32_bf16 v[136:139], v[44:47], v[44:47], v[136:139]
    ds_read_b64_tr_b16 v[110:111], v171 offset:13824
    v_mfma_f32_16x16x32_bf16 v[132:135], v[140:143], v[44:47], v[132:135]
    buffer_store_dwordx4 v[144:147], v241, s[20:23], s24 offen sc1
    s_waitcnt lgkmcnt(3)
    v_mfma_f32_16x16x32_bf16 v[120:123], v[104:107], v[48:51], v[120:123]
    s_waitcnt vmcnt(12)
    ds_read_b128 v[56:59], v156 offset:14336
    v_mfma_f32_16x16x32_bf16 v[124:127], v[104:107], v[140:143], v[124:127]
    ds_read_b64_tr_b16 v[112:113], v171 offset:14336
    v_mfma_f32_16x16x32_bf16 v[136:139], v[48:51], v[48:51], v[136:139]
    ds_read_b64_tr_b16 v[114:115], v171 offset:14848
    v_mfma_f32_16x16x32_bf16 v[132:135], v[140:143], v[48:51], v[132:135]
    global_load_dword v173, v238, s[40:41] sc1
    s_waitcnt lgkmcnt(3)
    v_mfma_f32_16x16x32_bf16 v[120:123], v[108:111], v[52:55], v[120:123]
    ds_read_b128 v[60:63], v157 offset:14336
    v_mfma_f32_16x16x32_bf16 v[124:127], v[108:111], v[140:143], v[124:127]
    ds_read_b64_tr_b16 v[104:105], v171 offset:15360
    v_mfma_f32_16x16x32_bf16 v[136:139], v[52:55], v[52:55], v[136:139]
    ds_read_b64_tr_b16 v[106:107], v171 offset:15872
    v_mfma_f32_16x16x32_bf16 v[132:135], v[140:143], v[52:55], v[132:135]
    s_waitcnt lgkmcnt(3)
    v_mfma_f32_16x16x32_bf16 v[120:123], v[112:115], v[56:59], v[120:123]
    s_waitcnt vmcnt(11)
    ds_read_b128 v[64:67], v156 offset:16384
    v_mfma_f32_16x16x32_bf16 v[124:127], v[112:115], v[140:143], v[124:127]
    ds_read_b64_tr_b16 v[108:109], v171 offset:16384
    v_mfma_f32_16x16x32_bf16 v[136:139], v[56:59], v[56:59], v[136:139]
    ds_read_b64_tr_b16 v[110:111], v171 offset:16896
    v_mfma_f32_16x16x32_bf16 v[132:135], v[140:143], v[56:59], v[132:135]
    s_waitcnt lgkmcnt(3)
    v_mfma_f32_16x16x32_bf16 v[120:123], v[104:107], v[60:63], v[120:123]
    ds_read_b128 v[68:71], v157 offset:16384
    v_mfma_f32_16x16x32_bf16 v[124:127], v[104:107], v[140:143], v[124:127]
    ds_read_b64_tr_b16 v[112:113], v171 offset:17408
    v_mfma_f32_16x16x32_bf16 v[136:139], v[60:63], v[60:63], v[136:139]
    ds_read_b64_tr_b16 v[114:115], v171 offset:17920
    v_mfma_f32_16x16x32_bf16 v[132:135], v[140:143], v[60:63], v[132:135]
    s_waitcnt lgkmcnt(3)
    v_mfma_f32_16x16x32_bf16 v[120:123], v[108:111], v[64:67], v[120:123]
    v_mfma_f32_16x16x32_bf16 v[124:127], v[108:111], v[140:143], v[124:127]
    v_mfma_f32_16x16x32_bf16 v[136:139], v[64:67], v[64:67], v[136:139]
    v_mfma_f32_16x16x32_bf16 v[132:135], v[140:143], v[64:67], v[132:135]
    s_waitcnt lgkmcnt(0)
    v_mfma_f32_16x16x32_bf16 v[120:123], v[112:115], v[68:71], v[120:123]
    v_mfma_f32_16x16x32_bf16 v[124:127], v[112:115], v[140:143], v[124:127]
    v_mfma_f32_16x16x32_bf16 v[136:139], v[68:71], v[68:71], v[136:139]
    v_mfma_f32_16x16x32_bf16 v[132:135], v[140:143], v[68:71], v[132:135]
    s_cmp_lt_u32 s4, 5
    s_cselect_b32 s60, 0x3eae1a93, 1.0
    s_movk_i32 s61, 1280
    s_cselect_b32 s61, 2560, s61
    s_mov_b32 s62, 2359296
    s_cselect_b32 s62, 5767168, s62
    s_cselect_b32 s63, s4, 0
    s_mul_i32 s61, s61, s5
    v_cndmask_b32 v177, 0, v136, s[52:53]
    v_cndmask_b32 v177, v177, v137, s[54:55]
    v_cndmask_b32 v177, v177, v138, s[56:57]
    v_cndmask_b32 v177, v177, v139, s[58:59]
    v_mul_f32 v180, 0xbae38e39, v132
    v_mov_b32 v178, v177
    s_lshl_b32 s63, s63, 9
    s_add_u32 s61, s61, s62
    v_permlane32_swap_b32 v177, v178
    v_add_f32 v177, v177, v178
    v_mov_b32 v178, v177
    v_mul_f32 v179, v180, v180
    s_mov_b32 s62, 0x3ae38e39
    v_permlane16_swap_b32 v177, v178
    v_add_f32 v177, v177, v178
    v_fma_f32 v177, v177, s62, -v179
    v_max_f32 v177, 0, v177
    v_add_f32 v177, 0x3727c5ac, v177
    v_rsq_f32 v177, v177
    v_pk_fma_f32 v[120:121], v[124:125], v[180:181], v[120:121] op_sel_hi:[1,0,1]
    v_pk_fma_f32 v[122:123], v[126:127], v[180:181], v[122:123] op_sel_hi:[1,0,1]
    v_mul_f32 v176, s60, v177
    v_mul_f32 v181, 0x3eae1a93, v177
    v_pk_mul_f32 v[120:121], v[120:121], v[176:177] op_sel_hi:[1,0]
    v_pk_mul_f32 v[122:123], v[122:123], v[176:177] op_sel_hi:[1,0]
    v_and_b32 v182, 15, v240
    v_lshrrev_b32 v183, 4, v240
    v_cvt_pk_bf16_f32 v120, v120, v121
    v_cvt_pk_bf16_f32 v121, v122, v123
    s_add_u32 s61, s61, s63
    s_cmp_ge_u32 s4, 6
    s_cbranch_scc1 K1_EV
    v_lshlrev_b32 v184, 3, v183
HOP0_0:
    s_cbranch_execz HOPRET0
    v_lshl_add_u32 v184, v182, 5, v184
    buffer_store_dwordx2 v[120:121], v184, s[20:23], s61 offen sc1
K1_EDONE:
    v_lshl_add_u32 v184, v182, 3, v204
    ds_write_b64 v184, v[180:181] offset:768
    v_lshl_add_u32 v184, v172, 3, v204
    ds_read2_b64 v[188:191], v184 offset0:96 offset1:104
    s_add_u32 m0, s25, 36864
    s_add_u32 s14, s14, 36864
    buffer_load_dwordx4 v168, s[8:11], s14 offen lds
    s_lshl2_add_u32 s38, s2, s32
    s_lshl_b32 s38, s38, 7
    s_add_u32 s38, s38, 46440448
    s_lshl_b32 s53, s4, 7
    s_add_u32 s6, s6, s53
    s_add_u32 s6, s6, 128
    s_add_u32 s5, s6, 9216
    v_lshrrev_b32 v177, 5, v240
    s_cmp_eq_u32 s15, 4
    s_cselect_b32 s3, -663552, 0
    s_add_u32 m0, s25, 40960
    s_add_u32 s14, s14, s3
    s_add_u32 s14, s14, 36864
    buffer_load_dwordx4 v168, s[8:11], s14 offen lds
    v_bfe_u32 v179, v240, 2, 3
    v_and_b32 v180, 3, v240
    v_and_b32 v181, 6, v179
    v_add_u32 v181, v179, v181
    v_lshl_add_u32 v181, v177, 1, v181
    v_lshlrev_b32 v181, 4, v181
    s_lshl_b32 s56, s32, 10
    v_lshl_add_u32 v182, v180, 8, v181
    s_add_u32 m0, s25, 45056
    s_add_u32 s14, s14, 36864
    buffer_load_dwordx4 v168, s[8:11], s14 offen lds
    v_add_u32 v214, s56, v182
    s_lshr_b32 s56, s32, 1
    s_lshl_b32 s56, s56, 8
    s_and_b32 s57, s32, 1
    s_lshl3_add_u32 s56, s57, s56
    v_lshl_add_u32 v182, v180, 1, v181
    v_add_u32 v215, s56, v182
    v_min_u32 v177, 53, v240
    s_cmp_eq_u32 s15, 3
    s_cselect_b32 s3, -663552, 0
    s_add_u32 m0, s25, 49152
    s_add_u32 s14, s14, s3
    s_add_u32 s14, s14, 36864
    buffer_load_dwordx4 v168, s[8:11], s14 offen lds
    v_mul_u32_u24 v178, 43, v177
    v_lshrrev_b32 v178, 7, v178
    v_mad_u32_u24 v177, v178, 6, v177
    s_lshl_b32 s54, s32, 8
    s_add_u32 s53, s54, 46403584
    v_lshl_add_u32 v253, v177, 7, s53
    v_and_b32 v176, 1, v240
    v_lshlrev_b32 v176, 4, v176
    s_add_u32 m0, s25, 53248
    s_add_u32 s14, s14, 36864
    buffer_load_dwordx4 v168, s[8:11], s14 offen lds
    v_mov_b32 v177, 0x3f80
    v_lshlrev_b32 v176, v176, v177
    v_bfe_u32 v177, v240, 1, 3
    v_lshrrev_b32 v178, 4, v240
    v_lshlrev_b32 v178, 2, v178
    v_sub_u32 v177, v177, v178
    v_cmp_eq_u32 s[52:53], 0, v177
    v_cmp_eq_u32 s[54:55], 1, v177
    s_mov_b32 exec_hi, 0
    buffer_load_dword v205, v205, s[16:19], s7 offen
    s_mov_b32 exec_hi, -1
    v_cmp_eq_u32 s[56:57], 2, v177
    v_cmp_eq_u32 s[58:59], 3, v177
    v_cndmask_b32 v184, 0, v176, s[52:53]
    v_cndmask_b32 v185, 0, v176, s[54:55]
    v_cndmask_b32 v186, 0, v176, s[56:57]
    v_cndmask_b32 v187, 0, v176, s[58:59]
    v_cmp_eq_u32 s[52:53], -8, v177
    v_cmp_eq_u32 s[54:55], -7, v177
    v_cmp_eq_u32 s[56:57], -6, v177
    v_cmp_eq_u32 s[58:59], -5, v177
    v_cndmask_b32 v192, 0, v176, s[52:53]
    v_cndmask_b32 v193, 0, v176, s[54:55]
    v_cndmask_b32 v194, 0, v176, s[56:57]
    v_cndmask_b32 v195, 0, v176, s[58:59]
    v_and_b32 v176, 31, v240
    v_lshrrev_b32 v177, 5, v240
    v_lshlrev_b32 v176, 4, v176
    s_movk_i32 s44, 1152
    v_mad_u32_u24 v250, v177, s44, v176
    s_mul_i32 s45, s32, 2304
    s_add_u32 s45, s45, s36
    s_mul_i32 s46, s32, 165888
    s_add_u32 s46, s46, 2621440
    v_lshrrev_b32 v176, 3, v240
    s_waitcnt vmcnt(6)
    v_cmp_eq_u32 vcc, 0, v173
    s_nop 0
    s_cbranch_vccnz KF_TAG_SPIN
KF_TAG_OK:
    v_readfirstlane_b32 s0, v173
    s_lshl_b32 s3, s2, 7
    s_add_u32 s3, s3, 46403584
    s_cmp_eq_u32 s32, 0
    s_cselect_b32 s3, s3, 1073741824
    s_barrier
    s_mov_b32 exec_hi, 0
    buffer_store_dword v173, v255, s[20:23], s3 offen sc1
    s_mov_b64 exec, -1
    s_mov_b32 s1, s0
    s_cmp_eq_u32 s15, 2
    s_cselect_b32 s3, -663552, 0
    s_add_u32 m0, s25, 57344
    s_add_u32 s14, s14, s3
    s_add_u32 s14, s14, 36864
    buffer_load_dwordx4 v168, s[8:11], s14 offen lds
    v_and_b32 v177, 6, v176
    v_and_b32 v178, 7, v240
    v_xor_b32 v178, v178, v177
    v_lshlrev_b32 v178, 4, v178
    v_mad_u32_u24 v220, v176, s44, v178
    v_and_b32 v177, 4, v176
    v_add_u32 v176, v176, v177
    s_movk_i32 s44, 9216
    s_add_u32 m0, s25, 61440
    s_add_u32 s14, s14, 36864
    buffer_load_dwordx4 v168, s[8:11], s14 offen lds
    v_mad_u32_u24 v221, v176, s44, v178
    s_lshl_b32 s47, s32, 14
    s_add_u32 s47, s47, 96256
    v_bfe_u32 v176, v240, 2, 3
    v_lshrrev_b32 v177, 5, v240
    v_lshlrev_b32 v177, 10, v177
    v_lshl_add_u32 v177, v176, 7, v177
    v_and_b32 v176, 6, v176
    s_cmp_eq_u32 s15, 1
    s_cselect_b32 s3, -663552, 0
    s_add_u32 m0, s25, 65536
    s_add_u32 s14, s14, s3
    s_add_u32 s14, s14, 36864
    buffer_load_dwordx4 v168, s[8:11], s14 offen lds
    v_lshl_add_u32 v177, v176, 4, v177
    v_and_b32 v176, 3, v240
    v_lshl_add_u32 v177, v176, 3, v177
    v_xor_b32 v216, 0, v177
    v_add_u32 v216, s47, v216
    v_xor_b32 v217, 32, v177
    v_add_u32 v217, s47, v217
    v_xor_b32 v218, 64, v177
    s_add_u32 m0, s25, 69632
    s_add_u32 s14, s14, 36864
    buffer_load_dwordx4 v168, s[8:11], s14 offen lds
    v_add_u32 v218, s47, v218
    v_xor_b32 v219, 96, v177
    v_add_u32 v219, s47, v219
    s_lshl_b32 s49, s31, 2
    s_add_u32 s49, s49, s32
    s_mul_i32 s50, s48, 1152
    s_mul_i32 s51, s48, 663552
    s_mul_i32 s52, s48, 1990656
    s_add_u32 s52, s52, 10485760
    s_mul_i32 s30, s32, 1024
    s_add_u32 s30, s30, s52
    s_lshl_b32 s28, s48, 9
    s_add_u32 s28, s28, 46137344
    s_lshl_b32 s29, s49, 2
    s_add_u32 s29, s29, s28
    s_mul_i32 s53, s49, 57
    s_lshr_b32 s53, s53, 9
    s_mul_i32 s54, s53, 9
    s_sub_u32 s54, s49, s54
    s_lshl_b32 s55, s54, 7
    s_add_u32 s50, s50, s55
    s_add_u32 s51, s51, s55
    s_lshr_b32 s55, s54, 1
    s_mul_i32 s55, s55, 1024
    s_and_b32 s56, s54, 1
    s_lshl_b32 s56, s56, 2
    s_cmp_eq_u32 s54, 8
    s_cselect_b32 s55, 0, s55
    s_cselect_b32 s56, 8, s56
    s_mov_b32 s96, 147456
    s_cselect_b32 s96, 1024, s96
    s_mov_b32 s99, 73728
    s_cselect_b32 s99, 1024, s99
    s_mov_b32 s97, s96
    s_add_u32 s52, s52, s55
    s_cmp_ge_u32 s49, 126
    s_cselect_b32 s55, 1073741824, 0
    s_add_u32 s50, s50, s55
    s_add_u32 s51, s51, s55
    s_add_u32 s52, s52, s55
    s_mul_i32 s56, s56, 18
    s_add_u32 s56, s56, s53
    s_mul_i32 s57, s56, 4096
    s_add_u32 s58, s57, s52
    s_add_u32 s92, s57, s58
    s_mul_i32 s57, s53, 294912
    s_add_u32 s80, s57, s50
    s_mul_i32 s57, s53, 36864
    s_add_u32 s57, s57, s51
    s_mov_b32 s66, 5308416
    s_mov_b32 s67, 0x20000
    s_mov_b32 s70, 5308416
    s_mov_b32 s71, 0x20000
    s_mov_b32 s74, 5308416
    s_mov_b32 s75, 0x20000
    s_mov_b32 s78, 5308416
    s_mov_b32 s79, 0x20000
    s_cmp_ge_u32 s53, 4
    s_cselect_b32 s68, s72, s64
    s_cselect_b32 s69, s73, s65
    s_cselect_b32 s54, -4, 14
    s_cselect_b32 s55, -7, 28
    s_mul_i32 s54, s54, 294912
    s_add_u32 s81, s80, s54
    s_mul_i32 s55, s55, 4096
    s_add_u32 s93, s92, s55
    s_add_u32 s82, s80, 2949120
    s_add_u32 s94, s92, 86016
    s_sub_u32 s54, s57, 294912
    s_add_u32 s55, s58, 1294336
    s_mov_b32 s86, 146432
    s_mov_b32 s90, 34816
    s_cmp_ge_u32 s53, 8
    s_cselect_b32 s72, s76, s72
    s_cselect_b32 s73, s77, s73
    s_cselect_b32 s82, s54, s82
    s_cselect_b32 s94, s55, s94
    s_cselect_b32 s98, s99, s96
    s_cselect_b32 s86, 8192, s86
    s_cselect_b32 s90, 16384, s90
    s_cselect_b64 s[54:55], -1, 0
    v_cndmask_b32 v222, v221, v220, s[54:55]
    s_add_u32 s83, s57, 221184
    s_add_u32 s95, s58, 1351680
    s_cmp_ge_u32 s53, 12
    s_cselect_b32 s83, 1073741824, s83
    s_cselect_b32 s95, 1073741824, s95
    s_mov_b64 exec, 0
    s_cmp_eq_u32 s32, 0
    s_cbranch_scc1 HOP1_0
    s_cmp_eq_u32 s32, 1
    s_cbranch_scc1 HOP1_1
    s_cmp_eq_u32 s32, 2
    s_cbranch_scc1 HOP1_2
    s_branch HOP1_3
HOPRET1:
    s_mov_b64 exec, -1
    s_waitcnt vmcnt(10)
    s_barrier
    ds_read_b64_tr_b16 v[96:97], v170 offset:0
    ds_read_b64_tr_b16 v[98:99], v170 offset:2048
    ds_read_b128 v[72:75], v158 offset:0
    ds_read_b128 v[76:79], v160 offset:0
    ds_read_b128 v[80:83], v162 offset:0
    ds_read_b64_tr_b16 v[100:101], v170 offset:4096
    ds_read_b64_tr_b16 v[102:103], v170 offset:6144
    ds_read_b128 v[84:87], v159 offset:0
    ds_read_b128 v[88:91], v161 offset:0
    ds_read_b128 v[92:95], v163 offset:0
    s_waitcnt lgkmcnt(5)
    v_mfma_f32_16x16x32_bf16 v[104:107], v[96:99], v[0:3], 0
    ds_read_b64_tr_b16 v[132:133], v170 offset:8192
    v_mfma_f32_16x16x32_bf16 v[128:131], v[96:99], v[140:143], 0
    ds_read_b64_tr_b16 v[134:135], v170 offset:10240
    v_mfma_f32_16x16x32_bf16 v[108:111], v[96:99], v[72:75], 0
    ds_read_b128 v[144:147], v158 offset:2048
    v_mfma_f32_16x16x32_bf16 v[112:115], v[96:99], v[76:79], 0
    ds_read_b128 v[148:151], v160 offset:2048
    v_mfma_f32_16x16x32_bf16 v[116:119], v[96:99], v[80:83], 0
    ds_read_b128 v[152:155], v162 offset:2048
    s_waitcnt lgkmcnt(5)
    v_mfma_f32_16x16x32_bf16 v[104:107], v[100:103], v[4:7], v[104:107]
    ds_read_b64_tr_b16 v[96:97], v170 offset:12288
    v_mfma_f32_16x16x32_bf16 v[128:131], v[100:103], v[140:143], v[128:131]
    ds_read_b64_tr_b16 v[98:99], v170 offset:14336
    v_mfma_f32_16x16x32_bf16 v[108:111], v[100:103], v[84:87], v[108:111]
    ds_read_b128 v[72:75], v159 offset:2048
    v_mfma_f32_16x16x32_bf16 v[112:115], v[100:103], v[88:91], v[112:115]
    ds_read_b128 v[76:79], v161 offset:2048
    v_mfma_f32_16x16x32_bf16 v[116:119], v[100:103], v[92:95], v[116:119]
    ds_read_b128 v[80:83], v163 offset:2048
    s_waitcnt lgkmcnt(5)
    v_mfma_f32_16x16x32_bf16 v[104:107], v[132:135], v[8:11], v[104:107]
    ds_read_b64_tr_b16 v[100:101], v170 offset:16384
    v_mfma_f32_16x16x32_bf16 v[128:131], v[132:135], v[140:143], v[128:131]
    ds_read_b64_tr_b16 v[102:103], v170 offset:18432
    v_mfma_f32_16x16x32_bf16 v[108:111], v[132:135], v[144:147], v[108:111]
    ds_read_b128 v[84:87], v158 offset:4096
    v_mfma_f32_16x16x32_bf16 v[112:115], v[132:135], v[148:151], v[112:115]
    ds_read_b128 v[88:91], v160 offset:4096
    v_mfma_f32_16x16x32_bf16 v[116:119], v[132:135], v[152:155], v[116:119]
    ds_read_b128 v[92:95], v162 offset:4096
    s_waitcnt lgkmcnt(5)
    v_mfma_f32_16x16x32_bf16 v[104:107], v[96:99], v[12:15], v[104:107]
    ds_read_b64_tr_b16 v[132:133], v170 offset:20480
    v_mfma_f32_16x16x32_bf16 v[128:131], v[96:99], v[140:143], v[128:131]
    ds_read_b64_tr_b16 v[134:135], v170 offset:22528
    v_mfma_f32_16x16x32_bf16 v[108:111], v[96:99], v[72:75], v[108:111]
    ds_read_b128 v[144:147], v159 offset:4096
    v_mfma_f32_16x16x32_bf16 v[112:115], v[96:99], v[76:79], v[112:115]
    ds_read_b128 v[148:151], v161 offset:4096
    v_mfma_f32_16x16x32_bf16 v[116:119], v[96:99], v[80:83], v[116:119]
    ds_read_b128 v[152:155], v163 offset:4096
    s_mov_b64 exec, 0x1fffffff
    buffer_load_dword v252, v211, s[20:23], 0 offen sc1
    s_mov_b64 exec, -1
    s_waitcnt lgkmcnt(5)
    v_mfma_f32_16x16x32_bf16 v[104:107], v[100:103], v[16:19], v[104:107]
    ds_read_b64_tr_b16 v[96:97], v170 offset:24576
    v_mfma_f32_16x16x32_bf16 v[128:131], v[100:103], v[140:143], v[128:131]
    ds_read_b64_tr_b16 v[98:99], v170 offset:26624
    v_mfma_f32_16x16x32_bf16 v[108:111], v[100:103], v[84:87], v[108:111]
    ds_read_b128 v[72:75], v158 offset:6144
    v_mfma_f32_16x16x32_bf16 v[112:115], v[100:103], v[88:91], v[112:115]
    ds_read_b128 v[76:79], v160 offset:6144
    v_mfma_f32_16x16x32_bf16 v[116:119], v[100:103], v[92:95], v[116:119]
    ds_read_b128 v[80:83], v162 offset:6144
    s_waitcnt lgkmcnt(5)
    v_mfma_f32_16x16x32_bf16 v[104:107], v[132:135], v[20:23], v[104:107]
    ds_read_b64_tr_b16 v[100:101], v170 offset:28672
    v_mfma_f32_16x16x32_bf16 v[128:131], v[132:135], v[140:143], v[128:131]
    ds_read_b64_tr_b16 v[102:103], v170 offset:30720
    v_mfma_f32_16x16x32_bf16 v[108:111], v[132:135], v[144:147], v[108:111]
    ds_read_b128 v[84:87], v159 offset:6144
    v_mfma_f32_16x16x32_bf16 v[112:115], v[132:135], v[148:151], v[112:115]
    ds_read_b128 v[88:91], v161 offset:6144
    v_mfma_f32_16x16x32_bf16 v[116:119], v[132:135], v[152:155], v[116:119]
    ds_read_b128 v[92:95], v163 offset:6144
    s_waitcnt lgkmcnt(5)
    v_mfma_f32_16x16x32_bf16 v[104:107], v[96:99], v[24:27], v[104:107]
    ds_read_b64_tr_b16 v[132:133], v170 offset:32768
    v_mfma_f32_16x16x32_bf16 v[128:131], v[96:99], v[140:143], v[128:131]
    ds_read_b64_tr_b16 v[134:135], v170 offset:34816
    v_mfma_f32_16x16x32_bf16 v[108:111], v[96:99], v[72:75], v[108:111]
    ds_read_b128 v[144:147], v158 offset:8192
    v_mfma_f32_16x16x32_bf16 v[112:115], v[96:99], v[76:79], v[112:115]
    ds_read_b128 v[148:151], v160 offset:8192
    v_mfma_f32_16x16x32_bf16 v[116:119], v[96:99], v[80:83], v[116:119]
    ds_read_b128 v[152:155], v162 offset:8192
    s_waitcnt lgkmcnt(5)
    v_add_u32 v170, 36864, v170
    v_mfma_f32_16x16x32_bf16 v[104:107], v[100:103], v[28:31], v[104:107]
    ds_read_b64_tr_b16 v[96:97], v170 offset:0
    v_mfma_f32_16x16x32_bf16 v[128:131], v[100:103], v[140:143], v[128:131]
    ds_read_b64_tr_b16 v[98:99], v170 offset:2048
    v_mfma_f32_16x16x32_bf16 v[108:111], v[100:103], v[84:87], v[108:111]
    ds_read_b128 v[72:75], v159 offset:8192
    v_mfma_f32_16x16x32_bf16 v[112:115], v[100:103], v[88:91], v[112:115]
    ds_read_b128 v[76:79], v161 offset:8192
    v_mfma_f32_16x16x32_bf16 v[116:119], v[100:103], v[92:95], v[116:119]
    ds_read_b128 v[80:83], v163 offset:8192
    s_waitcnt lgkmcnt(5)
    s_waitcnt vmcnt(1)
    s_barrier
    v_mfma_f32_16x16x32_bf16 v[104:107], v[132:135], v[32:35], v[104:107]
    ds_read_b64_tr_b16 v[100:101], v170 offset:4096
    v_mfma_f32_16x16x32_bf16 v[128:131], v[132:135], v[140:143], v[128:131]
    ds_read_b64_tr_b16 v[102:103], v170 offset:6144
    v_mfma_f32_16x16x32_bf16 v[108:111], v[132:135], v[144:147], v[108:111]
    ds_read_b128 v[84:87], v158 offset:10240
    v_mfma_f32_16x16x32_bf16 v[112:115], v[132:135], v[148:151], v[112:115]
    ds_read_b128 v[88:91], v160 offset:10240
    v_mfma_f32_16x16x32_bf16 v[116:119], v[132:135], v[152:155], v[116:119]
    ds_read_b128 v[92:95], v162 offset:10240
    s_waitcnt lgkmcnt(5)
    v_mfma_f32_16x16x32_bf16 v[104:107], v[96:99], v[36:39], v[104:107]
    ds_read_b64_tr_b16 v[132:133], v170 offset:8192
    v_mfma_f32_16x16x32_bf16 v[128:131], v[96:99], v[140:143], v[128:131]
    ds_read_b64_tr_b16 v[134:135], v170 offset:10240
    v_mfma_f32_16x16x32_bf16 v[108:111], v[96:99], v[72:75], v[108:111]
    ds_read_b128 v[144:147], v159 offset:10240
    v_mfma_f32_16x16x32_bf16 v[112:115], v[96:99], v[76:79], v[112:115]
    ds_read_b128 v[148:151], v161 offset:10240
    v_mfma_f32_16x16x32_bf16 v[116:119], v[96:99], v[80:83], v[116:119]
    ds_read_b128 v[152:155], v163 offset:10240
    s_mov_b64 exec, 0x1fffffff
    s_waitcnt vmcnt(0)
    v_cmp_ne_u32 vcc, s1, v252
    s_nop 0
    s_cbranch_vccnz KF_SQ_SPIN
KF_SQ_OK:
    s_mov_b64 exec, -1
    s_mul_i32 s3, s32, 1280
    s_add_u32 m0, s3, 157696
    s_add_u32 s3, s39, 1024
    buffer_load_dwordx4 v213, s[20:23], s39 offen lds
    s_mov_b64 exec, 0xffff
    buffer_load_dwordx4 v213, s[20:23], s3 offen offset:1024 lds
    s_mov_b64 exec, -1
    s_add_u32 s40, s37, 0
    buffer_load_dwordx2 a[192:193], v223, s[20:23], s40 offen offset:512
    buffer_load_dwordx4 a[0:3], v248, s[20:23], s40 offen offset:0
    s_waitcnt lgkmcnt(5)
    v_mfma_f32_16x16x32_bf16 v[104:107], v[100:103], v[40:43], v[104:107]
    ds_read_b64_tr_b16 v[96:97], v170 offset:12288
    v_mfma_f32_16x16x32_bf16 v[128:131], v[100:103], v[140:143], v[128:131]
    ds_read_b64_tr_b16 v[98:99], v170 offset:14336
    v_mfma_f32_16x16x32_bf16 v[108:111], v[100:103], v[84:87], v[108:111]
    ds_read_b128 v[72:75], v158 offset:12288
    v_mfma_f32_16x16x32_bf16 v[112:115], v[100:103], v[88:91], v[112:115]
    ds_read_b128 v[76:79], v160 offset:12288
    v_mfma_f32_16x16x32_bf16 v[116:119], v[100:103], v[92:95], v[116:119]
    ds_read_b128 v[80:83], v162 offset:12288
    buffer_load_dwordx4 a[4:7], v248, s[20:23], s40 offen offset:2560
    s_add_u32 s41, s37, 5120
    buffer_load_dwordx2 a[194:195], v223, s[20:23], s41 offen offset:512
    s_waitcnt lgkmcnt(5)
    v_mfma_f32_16x16x32_bf16 v[104:107], v[132:135], v[44:47], v[104:107]
    ds_read_b64_tr_b16 v[100:101], v170 offset:16384
    v_mfma_f32_16x16x32_bf16 v[128:131], v[132:135], v[140:143], v[128:131]
    ds_read_b64_tr_b16 v[102:103], v170 offset:18432
    v_mfma_f32_16x16x32_bf16 v[108:111], v[132:135], v[144:147], v[108:111]
    ds_read_b128 v[84:87], v159 offset:12288
    v_mfma_f32_16x16x32_bf16 v[112:115], v[132:135], v[148:151], v[112:115]
    ds_read_b128 v[88:91], v161 offset:12288
    v_mfma_f32_16x16x32_bf16 v[116:119], v[132:135], v[152:155], v[116:119]
    ds_read_b128 v[92:95], v163 offset:12288
    buffer_load_dwordx4 a[8:11], v248, s[20:23], s41 offen offset:0
    buffer_load_dwordx4 a[12:15], v248, s[20:23], s41 offen offset:2560
    s_waitcnt lgkmcnt(5)
    v_mfma_f32_16x16x32_bf16 v[104:107], v[96:99], v[48:51], v[104:107]
    ds_read_b64_tr_b16 v[132:133], v170 offset:20480
    v_mfma_f32_16x16x32_bf16 v[128:131], v[96:99], v[140:143], v[128:131]
    ds_read_b64_tr_b16 v[134:135], v170 offset:22528
    v_mfma_f32_16x16x32_bf16 v[108:111], v[96:99], v[72:75], v[108:111]
    ds_read_b128 v[144:147], v158 offset:14336
    v_mfma_f32_16x16x32_bf16 v[112:115], v[96:99], v[76:79], v[112:115]
    ds_read_b128 v[148:151], v160 offset:14336
    v_mfma_f32_16x16x32_bf16 v[116:119], v[96:99], v[80:83], v[116:119]
    ds_read_b128 v[152:155], v162 offset:14336
    buffer_load_dwordx4 a[64:67], v249, s[20:23], s40 offen offset:0
    buffer_load_dwordx4 a[68:71], v249, s[20:23], s40 offen offset:1280
    s_waitcnt lgkmcnt(5)
    v_mfma_f32_16x16x32_bf16 v[104:107], v[100:103], v[52:55], v[104:107]
    ds_read_b64_tr_b16 v[96:97], v170 offset:24576
    v_mfma_f32_16x16x32_bf16 v[128:131], v[100:103], v[140:143], v[128:131]
    ds_read_b64_tr_b16 v[98:99], v170 offset:26624
    v_mfma_f32_16x16x32_bf16 v[108:111], v[100:103], v[84:87], v[108:111]
    ds_read_b128 v[72:75], v159 offset:14336
    v_mfma_f32_16x16x32_bf16 v[112:115], v[100:103], v[88:91], v[112:115]
    ds_read_b128 v[76:79], v161 offset:14336
    v_mfma_f32_16x16x32_bf16 v[116:119], v[100:103], v[92:95], v[116:119]
    ds_read_b128 v[80:83], v163 offset:14336
    buffer_load_dwordx4 a[72:75], v249, s[20:23], s40 offen offset:2560
    buffer_load_dwordx4 a[76:79], v249, s[20:23], s40 offen offset:3840
    s_waitcnt lgkmcnt(5)
    v_mfma_f32_16x16x32_bf16 v[104:107], v[132:135], v[56:59], v[104:107]
    ds_read_b64_tr_b16 v[100:101], v170 offset:28672
    v_mfma_f32_16x16x32_bf16 v[128:131], v[132:135], v[140:143], v[128:131]
    ds_read_b64_tr_b16 v[102:103], v170 offset:30720
    v_mfma_f32_16x16x32_bf16 v[108:111], v[132:135], v[144:147], v[108:111]
    ds_read_b128 v[84:87], v158 offset:16384
    v_mfma_f32_16x16x32_bf16 v[112:115], v[132:135], v[148:151], v[112:115]
    ds_read_b128 v[88:91], v160 offset:16384
    v_mfma_f32_16x16x32_bf16 v[116:119], v[132:135], v[152:155], v[116:119]
    ds_read_b128 v[92:95], v162 offset:16384
    s_add_u32 s40, s37, 10240
    buffer_load_dwordx2 a[196:197], v223, s[20:23], s40 offen offset:512
    buffer_load_dwordx4 a[16:19], v248, s[20:23], s40 offen offset:0
    s_waitcnt lgkmcnt(5)
    v_mfma_f32_16x16x32_bf16 v[104:107], v[96:99], v[60:63], v[104:107]
    ds_read_b64_tr_b16 v[132:133], v170 offset:32768
    v_mfma_f32_16x16x32_bf16 v[128:131], v[96:99], v[140:143], v[128:131]
    ds_read_b64_tr_b16 v[134:135], v170 offset:34816
    v_mfma_f32_16x16x32_bf16 v[108:111], v[96:99], v[72:75], v[108:111]
    ds_read_b128 v[144:147], v159 offset:16384
    v_mfma_f32_16x16x32_bf16 v[112:115], v[96:99], v[76:79], v[112:115]
    ds_read_b128 v[148:151], v161 offset:16384
    v_mfma_f32_16x16x32_bf16 v[116:119], v[96:99], v[80:83], v[116:119]
    ds_read_b128 v[152:155], v163 offset:16384
    buffer_load_dwordx4 a[20:23], v248, s[20:23], s40 offen offset:2560
    buffer_load_dwordx4 a[80:83], v249, s[20:23], s41 offen offset:0
    s_waitcnt lgkmcnt(5)
    v_mfma_f32_16x16x32_bf16 v[104:107], v[100:103], v[64:67], v[104:107]
    v_mfma_f32_16x16x32_bf16 v[128:131], v[100:103], v[140:143], v[128:131]
    v_mfma_f32_16x16x32_bf16 v[108:111], v[100:103], v[84:87], v[108:111]
    v_mfma_f32_16x16x32_bf16 v[112:115], v[100:103], v[88:91], v[112:115]
    v_mfma_f32_16x16x32_bf16 v[116:119], v[100:103], v[92:95], v[116:119]
    buffer_load_dwordx4 a[84:87], v249, s[20:23], s41 offen offset:1280
    buffer_load_dwordx4 a[88:91], v249, s[20:23], s41 offen offset:2560
    s_waitcnt lgkmcnt(0)
    v_mfma_f32_16x16x32_bf16 v[104:107], v[132:135], v[68:71], v[104:107]
    v_mfma_f32_16x16x32_bf16 v[128:131], v[132:135], v[140:143], v[128:131]
    v_mfma_f32_16x16x32_bf16 v[108:111], v[132:135], v[144:147], v[108:111]
    v_mfma_f32_16x16x32_bf16 v[112:115], v[132:135], v[148:151], v[112:115]
    v_mfma_f32_16x16x32_bf16 v[116:119], v[132:135], v[152:155], v[116:119]
    buffer_load_dwordx4 a[92:95], v249, s[20:23], s41 offen offset:3840
    s_add_u32 s41, s37, 15360
    buffer_load_dwordx2 a[198:199], v223, s[20:23], s41 offen offset:512
    s_nop 0
    ds_write_b128 v196, v[104:107]
    ds_write_b128 v202, v[128:131] offset:17408
    ds_write_b128 v197, v[108:111]
    ds_write_b128 v198, v[112:115]
    ds_write_b128 v199, v[116:119]
    buffer_load_dwordx4 a[24:27], v248, s[20:23], s41 offen offset:0
    buffer_load_dwordx4 a[28:31], v248, s[20:23], s41 offen offset:2560
    buffer_load_dwordx4 a[96:99], v249, s[20:23], s40 offen offset:0
    s_waitcnt lgkmcnt(0)
    s_barrier
    ds_read_b128 v[148:151], v201 offset:17408
    ds_read_b128 v[152:155], v201 offset:17424
    ds_read_b128 v[32:35], v200 offset:0
    ds_read_b128 v[36:39], v200 offset:256
    ds_read_b128 v[40:43], v200 offset:128
    ds_read_b128 v[44:47], v200 offset:384
    buffer_load_dwordx4 a[100:103], v249, s[20:23], s40 offen offset:1280
    buffer_load_dwordx4 a[104:107], v249, s[20:23], s40 offen offset:2560
    buffer_load_dwordx4 a[108:111], v249, s[20:23], s40 offen offset:3840
    s_waitcnt lgkmcnt(3)
    v_pk_fma_f32 v[32:33], v[148:149], v[188:189], v[32:33] op_sel_hi:[1,0,1]
    v_pk_fma_f32 v[34:35], v[150:151], v[188:189], v[34:35] op_sel_hi:[1,0,1]
    s_waitcnt lgkmcnt(2)
    v_pk_fma_f32 v[36:37], v[152:153], v[188:189], v[36:37] op_sel_hi:[1,0,1]
    v_pk_fma_f32 v[38:39], v[154:155], v[188:189], v[38:39] op_sel_hi:[1,0,1]
    v_pk_mul_f32 v[32:33], v[32:33], v[188:189] op_sel:[0,1] op_sel_hi:[1,1]
    v_pk_mul_f32 v[34:35], v[34:35], v[188:189] op_sel:[0,1] op_sel_hi:[1,1]
    v_pk_mul_f32 v[36:37], v[36:37], v[188:189] op_sel:[0,1] op_sel_hi:[1,1]
    v_pk_mul_f32 v[38:39], v[38:39], v[188:189] op_sel:[0,1] op_sel_hi:[1,1]
    v_cvt_pk_bf16_f32 v72, v32, v33
    v_cvt_pk_bf16_f32 v73, v34, v35
    v_cvt_pk_bf16_f32 v74, v36, v37
    v_cvt_pk_bf16_f32 v75, v38, v39
    buffer_store_dwordx4 v[72:75], v203, s[20:23], s6 offen sc1
    s_waitcnt lgkmcnt(1)
    v_pk_fma_f32 v[40:41], v[148:149], v[190:191], v[40:41] op_sel_hi:[1,0,1]
    v_pk_fma_f32 v[42:43], v[150:151], v[190:191], v[42:43] op_sel_hi:[1,0,1]
    s_waitcnt lgkmcnt(0)
    v_pk_fma_f32 v[44:45], v[152:153], v[190:191], v[44:45] op_sel_hi:[1,0,1]
    v_pk_fma_f32 v[46:47], v[154:155], v[190:191], v[46:47] op_sel_hi:[1,0,1]
    v_pk_mul_f32 v[40:41], v[40:41], v[190:191] op_sel:[0,1] op_sel_hi:[1,1]
    v_pk_mul_f32 v[42:43], v[42:43], v[190:191] op_sel:[0,1] op_sel_hi:[1,1]
    v_pk_mul_f32 v[44:45], v[44:45], v[190:191] op_sel:[0,1] op_sel_hi:[1,1]
    v_pk_mul_f32 v[46:47], v[46:47], v[190:191] op_sel:[0,1] op_sel_hi:[1,1]
    v_cvt_pk_bf16_f32 v76, v40, v41
    v_cvt_pk_bf16_f32 v77, v42, v43
    v_cvt_pk_bf16_f32 v78, v44, v45
    v_cvt_pk_bf16_f32 v79, v46, v47
    buffer_store_dwordx4 v[76:79], v203, s[20:23], s5 offen sc1
    s_add_u32 s40, s37, 20480
    buffer_load_dwordx2 a[200:201], v223, s[20:23], s40 offen offset:512
    buffer_load_dwordx4 a[32:35], v248, s[20:23], s40 offen offset:0
    buffer_load_dwordx4 a[36:39], v248, s[20:23], s40 offen offset:2560
    buffer_load_dwordx4 a[112:115], v249, s[20:23], s41 offen offset:0
    s_waitcnt vmcnt(30)
KF_START:
    ds_read_b32 a208, v206
    ds_read_b32 a209, v207
    ds_read_b32 a210, v208
    ds_read_b32 a211, v209
    ds_read_b32 a240, v210
    s_mov_b64 s[34:35], 0
    v_mfma_f32_32x32x4bf16_1k v[128:159], v[238:239], v[238:239], 0
    s_waitcnt vmcnt(29) lgkmcnt(0)
    v_mfma_f32_32x32x4bf16_1k v[0:31], a[192:193], a[240:241], 0
    s_waitcnt vmcnt(28)
    s_nop 15
    s_nop 0
    v_mfma_f32_32x32x16_bf16 v[0:15], a[0:3], a[208:211], v[0:15]
    s_waitcnt vmcnt(27)
    v_mfma_f32_32x32x16_bf16 v[16:31], a[4:7], a[208:211], v[16:31]
    s_nop 9
    v_exp_f32 v0, v0
    v_exp_f32 v1, v1
    buffer_load_dwordx4 a[116:119], v249, s[20:23], s41 offen offset:1280
    v_exp_f32 v2, v2
    v_exp_f32 v3, v3
    v_exp_f32 v4, v4
    s_waitcnt vmcnt(27)
    v_mfma_f32_32x32x4bf16_1k v[32:63], a[194:195], a[240:241], 0
    v_exp_f32 v5, v5
    v_exp_f32 v6, v6
    v_exp_f32 v7, v7
    v_exp_f32 v8, v8
    v_exp_f32 v9, v9
    v_exp_f32 v10, v10
    v_exp_f32 v11, v11
    v_exp_f32 v12, v12
    s_waitcnt vmcnt(24)
    v_smfmac_f32_32x32x32_bf16 v[128:143], a[64:67], v[0:7], v236
    buffer_load_dwordx4 a[120:123], v249, s[20:23], s41 offen offset:2560
    buffer_load_dwordx4 a[124:127], v249, s[20:23], s41 offen offset:3840
    s_add_u32 s41, s37, 25600
    v_exp_f32 v13, v13
    v_exp_f32 v14, v14
    v_exp_f32 v15, v15
    v_exp_f32 v16, v16
    v_exp_f32 v17, v17
    s_waitcnt vmcnt(25)
    v_smfmac_f32_32x32x32_bf16 v[128:143], a[68:71], v[8:15], v236
    s_waitcnt vmcnt(7)
    v_mov_b32 v252, s1
    s_mov_b32 exec_hi, 0
    buffer_store_dword v252, v255, s[20:23], s38 offen sc1
    s_mov_b64 exec, -1
    v_exp_f32 v18, v18
    v_exp_f32 v19, v19
    v_exp_f32 v20, v20
    v_mfma_f32_32x32x16_bf16 v[32:47], a[8:11], a[208:211], v[32:47]
    buffer_load_dwordx2 a[202:203], v223, s[20:23], s41 offen offset:512
    v_exp_f32 v21, v21
    v_exp_f32 v22, v22
    v_exp_f32 v23, v23
    v_mfma_f32_32x32x16_bf16 v[48:63], a[12:15], a[208:211], v[48:63]
    buffer_load_dwordx4 a[40:43], v248, s[20:23], s41 offen offset:0
    buffer_load_dwordx4 a[44:47], v248, s[20:23], s41 offen offset:2560
    v_exp_f32 v24, v24
    v_exp_f32 v25, v25
    v_exp_f32 v26, v26
    v_smfmac_f32_32x32x32_bf16 v[128:143], a[72:75], v[16:23], v236
    buffer_load_dwordx4 a[128:131], v249, s[20:23], s40 offen offset:0
    v_exp_f32 v27, v27
    v_exp_f32 v28, v28
    v_exp_f32 v29, v29
    v_exp_f32 v30, v30
    v_exp_f32 v31, v31
    v_exp_f32 v32, v32
    v_exp_f32 v33, v33
    v_smfmac_f32_32x32x32_bf16 v[128:143], a[76:79], v[24:31], v236
HOP1_0:
    s_cbranch_execz HOP1_4
    buffer_load_dwordx4 a[132:135], v249, s[20:23], s40 offen offset:1280
    buffer_load_dwordx4 a[136:139], v249, s[20:23], s40 offen offset:2560
    v_exp_f32 v34, v34
    v_exp_f32 v35, v35
    v_exp_f32 v36, v36
    v_mfma_f32_32x32x4bf16_1k v[0:31], a[196:197], a[240:241], 0
    v_exp_f32 v37, v37
    v_exp_f32 v38, v38
    v_exp_f32 v39, v39
    v_exp_f32 v40, v40
    v_exp_f32 v41, v41
    v_exp_f32 v42, v42
    v_exp_f32 v43, v43
    v_exp_f32 v44, v44
    v_smfmac_f32_32x32x32_bf16 v[128:143], a[80:83], v[32:39], v236
    buffer_load_dwordx4 a[140:143], v249, s[20:23], s40 offen offset:3840
    s_add_u32 s40, s37, 30720
    v_exp_f32 v45, v45
    v_exp_f32 v46, v46
    v_exp_f32 v47, v47
    v_exp_f32 v48, v48
    v_exp_f32 v49, v49
    v_smfmac_f32_32x32x32_bf16 v[128:143], a[84:87], v[40:47], v236
    buffer_load_dwordx2 a[204:205], v223, s[20:23], s40 offen offset:512
    buffer_load_dwordx4 a[48:51], v248, s[20:23], s40 offen offset:0
    v_exp_f32 v50, v50
    v_exp_f32 v51, v51
    v_exp_f32 v52, v52
    v_mfma_f32_32x32x16_bf16 v[0:15], a[16:19], a[208:211], v[0:15]
    buffer_load_dwordx4 a[52:55], v248, s[20:23], s40 offen offset:2560
    v_exp_f32 v53, v53
    v_exp_f32 v54, v54
    v_exp_f32 v55, v55
    v_mfma_f32_32x32x16_bf16 v[16:31], a[20:23], a[208:211], v[16:31]
    buffer_load_dwordx4 a[144:147], v249, s[20:23], s41 offen offset:0
    buffer_load_dwordx4 a[148:151], v249, s[20:23], s41 offen offset:1280
    v_exp_f32 v56, v56
    v_exp_f32 v57, v57
    v_exp_f32 v58, v58
    v_smfmac_f32_32x32x32_bf16 v[128:143], a[88:91], v[48:55], v236
    buffer_load_dwordx4 a[152:155], v249, s[20:23], s41 offen offset:2560
    v_exp_f32 v59, v59
    v_exp_f32 v60, v60
    v_exp_f32 v61, v61
    v_exp_f32 v62, v62
    v_exp_f32 v63, v63
    v_exp_f32 v0, v0
    v_exp_f32 v1, v1
    v_smfmac_f32_32x32x32_bf16 v[128:143], a[92:95], v[56:63], v236
    buffer_load_dwordx4 a[156:159], v249, s[20:23], s41 offen offset:3840
    s_add_u32 s41, s37, 35840
    buffer_load_dwordx2 a[206:207], v223, s[20:23], s41 offen offset:512
    v_exp_f32 v2, v2
    v_exp_f32 v3, v3
    v_exp_f32 v4, v4
    v_mfma_f32_32x32x4bf16_1k v[32:63], a[198:199], a[240:241], 0
    v_exp_f32 v5, v5
    v_exp_f32 v6, v6
    v_exp_f32 v7, v7
    v_exp_f32 v8, v8
    v_exp_f32 v9, v9
    v_exp_f32 v10, v10
    v_exp_f32 v11, v11
    v_exp_f32 v12, v12
    v_smfmac_f32_32x32x32_bf16 v[128:143], a[96:99], v[0:7], v236
    buffer_load_dwordx4 a[56:59], v248, s[20:23], s41 offen offset:0
    v_exp_f32 v13, v13
    v_exp_f32 v14, v14
    v_exp_f32 v15, v15
    v_exp_f32 v16, v16
    v_exp_f32 v17, v17
    v_smfmac_f32_32x32x32_bf16 v[128:143], a[100:103], v[8:15], v236
    buffer_load_dwordx4 a[60:63], v248, s[20:23], s41 offen offset:2560
    buffer_load_dwordx4 a[160:163], v249, s[20:23], s40 offen offset:0
    v_exp_f32 v18, v18
    v_exp_f32 v19, v19
    v_exp_f32 v20, v20
    v_mfma_f32_32x32x16_bf16 v[32:47], a[24:27], a[208:211], v[32:47]
    buffer_load_dwordx4 a[164:167], v249, s[20:23], s40 offen offset:1280
    v_exp_f32 v21, v21
    v_exp_f32 v22, v22
    v_exp_f32 v23, v23
    v_mfma_f32_32x32x16_bf16 v[48:63], a[28:31], a[208:211], v[48:63]
    buffer_load_dwordx4 a[168:171], v249, s[20:23], s40 offen offset:2560
    buffer_load_dwordx4 a[172:175], v249, s[20:23], s40 offen offset:3840
    v_exp_f32 v24, v24
    v_exp_f32 v25, v25
    v_exp_f32 v26, v26
    v_smfmac_f32_32x32x32_bf16 v[128:143], a[104:107], v[16:23], v236
    buffer_load_dwordx4 a[176:179], v249, s[20:23], s41 offen offset:0
    v_exp_f32 v27, v27
    v_exp_f32 v28, v28
    v_exp_f32 v29, v29
    v_exp_f32 v30, v30
    v_exp_f32 v31, v31
    v_exp_f32 v32, v32
    v_exp_f32 v33, v33
    v_smfmac_f32_32x32x32_bf16 v[128:143], a[108:111], v[24:31], v236
    s_mov_b64 exec, 0xff
    buffer_load_dword v252, v212, s[20:23], 0 offen sc1
    s_mov_b64 exec, -1
    v_exp_f32 v34, v34
    v_exp_f32 v35, v35
    v_exp_f32 v36, v36
    s_waitcnt vmcnt(30)
    v_mfma_f32_32x32x4bf16_1k v[0:31], a[200:201], a[240:241], 0
    v_exp_f32 v37, v37
    v_exp_f32 v38, v38
    v_exp_f32 v39, v39
    v_exp_f32 v40, v40
    v_exp_f32 v41, v41
    v_exp_f32 v42, v42
    v_exp_f32 v43, v43
    v_exp_f32 v44, v44
    s_waitcnt vmcnt(27)
    v_smfmac_f32_32x32x32_bf16 v[128:143], a[112:115], v[32:39], v236
    buffer_load_dwordx4 a[180:183], v249, s[20:23], s41 offen offset:1280
    buffer_load_dwordx4 a[184:187], v249, s[20:23], s41 offen offset:2560
    v_exp_f32 v45, v45
    v_exp_f32 v46, v46
    v_exp_f32 v47, v47
    v_exp_f32 v48, v48
    v_exp_f32 v49, v49
    s_waitcnt vmcnt(28)
    v_smfmac_f32_32x32x32_bf16 v[128:143], a[116:119], v[40:47], v236
    buffer_load_dwordx4 a[188:191], v249, s[20:23], s41 offen offset:3840
    v_exp_f32 v50, v50
    v_exp_f32 v51, v51
    v_exp_f32 v52, v52
    v_mfma_f32_32x32x16_bf16 v[0:15], a[32:35], a[208:211], v[0:15]
    buffer_load_dwordx4 v[160:163], v224, s[16:19], s7 offen offset:0
    v_exp_f32 v53, v53
    v_exp_f32 v54, v54
    v_exp_f32 v55, v55
    v_mfma_f32_32x32x16_bf16 v[16:31], a[36:39], a[208:211], v[16:31]
    buffer_load_dwordx4 v[164:167], v224, s[16:19], s7 offen offset:64
    v_exp_f32 v56, v56
    v_exp_f32 v57, v57
    v_exp_f32 v58, v58
    s_waitcnt vmcnt(30)
    v_smfmac_f32_32x32x32_bf16 v[128:143], a[120:123], v[48:55], v236
    s_waitcnt vmcnt(21)
    v_exp_f32 v59, v59
    v_exp_f32 v60, v60
    v_exp_f32 v61, v61
    v_exp_f32 v62, v62
    v_exp_f32 v63, v63
    v_exp_f32 v0, v0
    v_exp_f32 v1, v1
    v_smfmac_f32_32x32x32_bf16 v[128:143], a[124:127], v[56:63], v236
    buffer_load_dwordx4 v[168:171], v224, s[16:19], s7 offen offset:128
    v_exp_f32 v2, v2
    v_exp_f32 v3, v3
    v_exp_f32 v4, v4
    v_mfma_f32_32x32x4bf16_1k v[32:63], a[202:203], a[240:241], 0
    v_exp_f32 v5, v5
    v_exp_f32 v6, v6
    v_exp_f32 v7, v7
    v_exp_f32 v8, v8
    v_exp_f32 v9, v9
    v_exp_f32 v10, v10
    v_exp_f32 v11, v11
    v_exp_f32 v12, v12
    v_smfmac_f32_32x32x32_bf16 v[128:143], a[128:131], v[0:7], v236
    buffer_load_dwordx4 v[172:175], v224, s[16:19], s7 offen offset:192
    v_exp_f32 v13, v13
    v_exp_f32 v14, v14
    v_exp_f32 v15, v15
    v_exp_f32 v16, v16
    v_exp_f32 v17, v17
    v_smfmac_f32_32x32x32_bf16 v[128:143], a[132:135], v[8:15], v236
    buffer_load_dwordx4 v[176:179], v224, s[16:19], s7 offen offset:256
    v_exp_f32 v18, v18
    v_exp_f32 v19, v19
    v_exp_f32 v20, v20
    v_mfma_f32_32x32x16_bf16 v[32:47], a[40:43], a[208:211], v[32:47]
    v_exp_f32 v21, v21
    v_exp_f32 v22, v22
    v_exp_f32 v23, v23
    v_mfma_f32_32x32x16_bf16 v[48:63], a[44:47], a[208:211], v[48:63]
    v_exp_f32 v24, v24
    v_exp_f32 v25, v25
    v_exp_f32 v26, v26
    v_smfmac_f32_32x32x32_bf16 v[128:143], a[136:139], v[16:23], v236
    s_waitcnt vmcnt(17)
    v_exp_f32 v27, v27
    v_exp_f32 v28, v28
    v_exp_f32 v29, v29
    v_exp_f32 v30, v30
    v_exp_f32 v31, v31
    v_exp_f32 v32, v32
    v_exp_f32 v33, v33
    v_smfmac_f32_32x32x32_bf16 v[128:143], a[140:143], v[24:31], v236
    s_mov_b64 exec, 0xff
    s_waitcnt vmcnt(8)
    v_cmp_ne_u32 vcc, s1, v252
    s_nop 0
    s_cbranch_vccnz KF_SL_SPIN
KF_SL_OK:
    s_mov_b64 exec, -1
    v_exp_f32 v34, v34
    v_exp_f32 v35, v35
    v_exp_f32 v36, v36
    v_mfma_f32_32x32x4bf16_1k v[0:31], a[204:205], a[240:241], 0
    v_exp_f32 v37, v37
    v_exp_f32 v38, v38
    v_exp_f32 v39, v39
    v_exp_f32 v40, v40
    v_exp_f32 v41, v41
    v_exp_f32 v42, v42
    v_exp_f32 v43, v43
    v_exp_f32 v44, v44
    v_smfmac_f32_32x32x32_bf16 v[128:143], a[144:147], v[32:39], v236
    buffer_load_dword a242, v247, s[20:23], s36 offen offset:176
    v_exp_f32 v45, v45
    v_exp_f32 v46, v46
    v_exp_f32 v47, v47
    v_exp_f32 v48, v48
    v_exp_f32 v49, v49
    v_smfmac_f32_32x32x32_bf16 v[128:143], a[148:151], v[40:47], v236
    buffer_load_dwordx4 a[212:215], v246, s[20:23], s36 offen offset:144
    v_exp_f32 v50, v50
    v_exp_f32 v51, v51
    v_exp_f32 v52, v52
    v_mfma_f32_32x32x16_bf16 v[0:15], a[48:51], a[208:211], v[0:15]
    buffer_load_dword v205, v253, s[20:23], 0 offen sc1
    v_exp_f32 v53, v53
    v_exp_f32 v54, v54
    v_exp_f32 v55, v55
    v_mfma_f32_32x32x16_bf16 v[16:31], a[52:55], a[208:211], v[16:31]
    buffer_load_dword a244, v247, s[20:23], s36 offen offset:320
    v_exp_f32 v56, v56
    v_exp_f32 v57, v57
    v_exp_f32 v58, v58
    v_smfmac_f32_32x32x32_bf16 v[128:143], a[152:155], v[48:55], v236
    v_exp_f32 v59, v59
    v_exp_f32 v60, v60
    v_exp_f32 v61, v61
    v_exp_f32 v62, v62
    v_exp_f32 v63, v63
    v_exp_f32 v0, v0
    v_exp_f32 v1, v1
    v_smfmac_f32_32x32x32_bf16 v[128:143], a[156:159], v[56:63], v236
    buffer_load_dwordx4 a[216:219], v246, s[20:23], s36 offen offset:288
    v_exp_f32 v2, v2
    v_exp_f32 v3, v3
    v_exp_f32 v4, v4
    v_mfma_f32_32x32x4bf16_1k v[32:63], a[206:207], a[240:241], 0
    v_exp_f32 v5, v5
    v_exp_f32 v6, v6
    v_exp_f32 v7, v7
    v_exp_f32 v8, v8
    v_exp_f32 v9, v9
    v_exp_f32 v10, v10
    v_exp_f32 v11, v11
    v_exp_f32 v12, v12
    v_smfmac_f32_32x32x32_bf16 v[128:143], a[160:163], v[0:7], v236
    v_exp_f32 v13, v13
    v_exp_f32 v14, v14
    v_exp_f32 v15, v15
    v_exp_f32 v16, v16
    v_exp_f32 v17, v17
    v_smfmac_f32_32x32x32_bf16 v[128:143], a[164:167], v[8:15], v236
    buffer_load_dword a246, v247, s[20:23], s36 offen offset:464
    v_exp_f32 v18, v18
    v_exp_f32 v19, v19
    v_exp_f32 v20, v20
    v_mfma_f32_32x32x16_bf16 v[32:47], a[56:59], a[208:211], v[32:47]
    v_exp_f32 v21, v21
    v_exp_f32 v22, v22
    v_exp_f32 v23, v23
    v_mfma_f32_32x32x16_bf16 v[48:63], a[60:63], a[208:211], v[48:63]
    v_exp_f32 v24, v24
    v_exp_f32 v25, v25
    v_exp_f32 v26, v26
    v_smfmac_f32_32x32x32_bf16 v[128:143], a[168:171], v[16:23], v236
    s_waitcnt vmcnt(11)
    v_exp_f32 v27, v27
    v_exp_f32 v28, v28
    v_exp_f32 v29, v29
    v_exp_f32 v30, v30
    v_exp_f32 v31, v31
    v_exp_f32 v32, v32
    v_exp_f32 v33, v33
    v_smfmac_f32_32x32x32_bf16 v[128:143], a[172:175], v[24:31], v236
    s_barrier
    v_exp_f32 v34, v34
    v_exp_f32 v35, v35
    v_exp_f32 v36, v36
    s_waitcnt vmcnt(5)
    v_mfma_f32_32x32x4bf16_1k v[0:31], a[192:193], a[242:243], 0
    v_exp_f32 v37, v37
    v_exp_f32 v38, v38
    v_exp_f32 v39, v39
    v_exp_f32 v40, v40
    v_exp_f32 v41, v41
    v_exp_f32 v42, v42
    v_exp_f32 v43, v43
    v_exp_f32 v44, v44
    v_smfmac_f32_32x32x32_bf16 v[128:143], a[176:179], v[32:39], v236
    buffer_load_dwordx4 a[220:223], v246, s[20:23], s36 offen offset:432
    v_exp_f32 v45, v45
    v_exp_f32 v46, v46
    v_exp_f32 v47, v47
    v_exp_f32 v48, v48
    v_exp_f32 v49, v49
    v_smfmac_f32_32x32x32_bf16 v[128:143], a[180:183], v[40:47], v236
    v_exp_f32 v50, v50
    v_exp_f32 v51, v51
    v_exp_f32 v52, v52
    s_waitcnt vmcnt(5)
    v_mfma_f32_32x32x16_bf16 v[0:15], a[0:3], a[212:215], v[0:15]
    buffer_load_dword a248, v247, s[20:23], s36 offen offset:608
    v_exp_f32 v53, v53
    v_exp_f32 v54, v54
    v_exp_f32 v55, v55
    v_mfma_f32_32x32x16_bf16 v[16:31], a[4:7], a[212:215], v[16:31]
    v_exp_f32 v56, v56
    v_exp_f32 v57, v57
    v_exp_f32 v58, v58
    v_smfmac_f32_32x32x32_bf16 v[128:143], a[184:187], v[48:55], v236
    v_exp_f32 v59, v59
    v_exp_f32 v60, v60
    v_exp_f32 v61, v61
    v_exp_f32 v62, v62
    v_exp_f32 v63, v63
    v_exp_f32 v0, v0
    v_exp_f32 v1, v1
    v_smfmac_f32_32x32x32_bf16 v[128:143], a[188:191], v[56:63], v236
    buffer_load_dwordx4 a[224:227], v246, s[20:23], s36 offen offset:576
    v_exp_f32 v2, v2
    v_exp_f32 v3, v3
    v_exp_f32 v4, v4
    v_mfma_f32_32x32x4bf16_1k v[32:63], a[194:195], a[242:243], 0
    v_exp_f32 v5, v5
    v_exp_f32 v6, v6
    v_exp_f32 v7, v7
    v_exp_f32 v8, v8
    v_exp_f32 v9, v9
    v_exp_f32 v10, v10
    v_exp_f32 v11, v11
    v_exp_f32 v12, v12
    v_smfmac_f32_32x32x32_bf16 v[144:159], a[64:67], v[0:7], v236
    ds_write_b128 v242, v[128:131] offset:0
    v_exp_f32 v13, v13
    v_exp_f32 v14, v14
    v_exp_f32 v15, v15
    v_exp_f32 v16, v16
    v_exp_f32 v17, v17
    v_smfmac_f32_32x32x32_bf16 v[144:159], a[68:71], v[8:15], v236
    ds_write_b128 v242, v[132:135] offset:1024
    v_exp_f32 v18, v18
    v_exp_f32 v19, v19
    v_exp_f32 v20, v20
    v_mfma_f32_32x32x16_bf16 v[32:47], a[8:11], a[212:215], v[32:47]
    ds_write_b64 v243, v[136:137] offset:2048
    v_exp_f32 v21, v21
    v_exp_f32 v22, v22
    v_exp_f32 v23, v23
    v_mfma_f32_32x32x16_bf16 v[48:63], a[12:15], a[212:215], v[48:63]
    s_add_u32 m0, s47, 0
    v_exp_f32 v24, v24
    v_exp_f32 v25, v25
    v_exp_f32 v26, v26
    v_smfmac_f32_32x32x32_bf16 v[144:159], a[72:75], v[16:23], v236
    buffer_load_dword a250, v247, s[20:23], s36 offen offset:752
    v_exp_f32 v27, v27
    v_exp_f32 v28, v28
    v_exp_f32 v29, v29
    v_exp_f32 v30, v30
    v_exp_f32 v31, v31
    v_exp_f32 v32, v32
    v_exp_f32 v33, v33
    v_smfmac_f32_32x32x32_bf16 v[144:159], a[76:79], v[24:31], v236
    buffer_load_dwordx4 v221, s[64:67], s80 offen offset:0 nt lds
    v_exp_f32 v34, v34
    v_exp_f32 v35, v35
    v_exp_f32 v36, v36
    v_mfma_f32_32x32x4bf16_1k v[0:31], a[196:197], a[242:243], 0
    v_exp_f32 v37, v37
    v_exp_f32 v38, v38
    v_exp_f32 v39, v39
    v_exp_f32 v40, v40
    v_exp_f32 v41, v41
    v_exp_f32 v42, v42
    v_exp_f32 v43, v43
    v_exp_f32 v44, v44
    v_smfmac_f32_32x32x32_bf16 v[144:159], a[80:83], v[32:39], v236
    s_add_u32 s54, s80, 146432
    v_exp_f32 v45, v45
    v_exp_f32 v46, v46
    v_exp_f32 v47, v47
    v_exp_f32 v48, v48
    v_exp_f32 v49, v49
    v_smfmac_f32_32x32x32_bf16 v[144:159], a[84:87], v[40:47], v236
    s_waitcnt lgkmcnt(0)
    v_exp_f32 v50, v50
    v_exp_f32 v51, v51
    v_exp_f32 v52, v52
    v_mfma_f32_32x32x16_bf16 v[0:15], a[16:19], a[212:215], v[0:15]
    s_waitcnt vmcnt(8)
    v_cmp_ne_u32 vcc, s1, v205
    s_nop 0
    s_cbranch_vccnz KF_SW_SPIN
KF_SW_OK:
    v_exp_f32 v53, v53
    v_exp_f32 v54, v54
    v_exp_f32 v55, v55
    v_mfma_f32_32x32x16_bf16 v[16:31], a[20:23], a[212:215], v[16:31]
    buffer_load_dwordx4 a[228:231], v246, s[20:23], s36 offen offset:720
    v_exp_f32 v56, v56
    v_exp_f32 v57, v57
    v_exp_f32 v58, v58
    v_smfmac_f32_32x32x32_bf16 v[144:159], a[88:91], v[48:55], v236
    buffer_load_dwordx4 v221, s[64:67], s54 offen offset:1024 nt lds
    v_exp_f32 v59, v59
    v_exp_f32 v60, v60
    v_exp_f32 v61, v61
    v_mfma_f32_32x32x8bf16_1k v[128:143], v[238:239], v[238:239], 0
    v_exp_f32 v62, v62
    v_exp_f32 v63, v63
    v_exp_f32 v0, v0
    v_exp_f32 v1, v1
    v_smfmac_f32_32x32x32_bf16 v[144:159], a[92:95], v[56:63], v236
    s_add_u32 s54, s80, 34816
    v_exp_f32 v2, v2
    v_exp_f32 v3, v3
    v_exp_f32 v4, v4
    v_mfma_f32_32x32x4bf16_1k v[32:63], a[198:199], a[242:243], 0
    v_exp_f32 v5, v5
    v_exp_f32 v6, v6
    v_exp_f32 v7, v7
    v_exp_f32 v8, v8
    v_exp_f32 v9, v9
    v_exp_f32 v10, v10
    v_exp_f32 v11, v11
    v_exp_f32 v12, v12
    v_smfmac_f32_32x32x32_bf16 v[144:159], a[96:99], v[0:7], v236
    buffer_load_dword a252, v247, s[20:23], s36 offen offset:896
    v_exp_f32 v13, v13
    v_exp_f32 v14, v14
    v_exp_f32 v15, v15
    v_exp_f32 v16, v16
    v_exp_f32 v17, v17
    v_smfmac_f32_32x32x32_bf16 v[144:159], a[100:103], v[8:15], v236
    v_exp_f32 v18, v18
    v_exp_f32 v19, v19
    v_exp_f32 v20, v20
    v_mfma_f32_32x32x16_bf16 v[32:47], a[24:27], a[212:215], v[32:47]
    buffer_load_dwordx4 v221, s[64:67], s54 offen offset:2048 nt lds
    v_exp_f32 v21, v21
    v_exp_f32 v22, v22
    v_exp_f32 v23, v23
    v_mfma_f32_32x32x16_bf16 v[48:63], a[28:31], a[212:215], v[48:63]
    s_add_u32 s54, s54, 146432
    v_exp_f32 v24, v24
    v_exp_f32 v25, v25
    v_exp_f32 v26, v26
    v_smfmac_f32_32x32x32_bf16 v[144:159], a[104:107], v[16:23], v236
    buffer_load_dwordx4 a[232:235], v246, s[20:23], s36 offen offset:864
    v_exp_f32 v27, v27
    v_exp_f32 v28, v28
    v_exp_f32 v29, v29
    v_exp_f32 v30, v30
    v_exp_f32 v31, v31
    v_exp_f32 v32, v32
    v_exp_f32 v33, v33
    v_smfmac_f32_32x32x32_bf16 v[144:159], a[108:111], v[24:31], v236
    buffer_load_dword a254, v247, s[20:23], s36 offen offset:1040
    v_exp_f32 v34, v34
    v_exp_f32 v35, v35
    v_exp_f32 v36, v36
    v_mfma_f32_32x32x4bf16_1k v[0:31], a[200:201], a[242:243], 0
    v_exp_f32 v37, v37
    v_exp_f32 v38, v38
    v_exp_f32 v39, v39
    v_exp_f32 v40, v40
    v_exp_f32 v41, v41
    v_exp_f32 v42, v42
    v_exp_f32 v43, v43
    v_exp_f32 v44, v44
    v_smfmac_f32_32x32x32_bf16 v[144:159], a[112:115], v[32:39], v236
    buffer_load_dwordx4 v221, s[64:67], s54 offen offset:3072 nt lds
    v_exp_f32 v45, v45
    v_exp_f32 v46, v46
    v_exp_f32 v47, v47
    v_mfma_f32_16x16x32_bf16 v[64:67], v[160:163], v[184:187], 0
    s_add_u32 m0, s47, 4096
    v_exp_f32 v48, v48
    v_exp_f32 v49, v49
    v_smfmac_f32_32x32x32_bf16 v[144:159], a[116:119], v[40:47], v236
    buffer_load_dwordx4 a[236:239], v246, s[20:23], s36 offen offset:1008
    v_exp_f32 v50, v50
    v_exp_f32 v51, v51
    v_exp_f32 v52, v52
    v_mfma_f32_32x32x16_bf16 v[0:15], a[32:35], a[212:215], v[0:15]
    v_exp_f32 v53, v53
    v_exp_f32 v54, v54
    v_exp_f32 v55, v55
    v_mfma_f32_32x32x16_bf16 v[16:31], a[36:39], a[212:215], v[16:31]
    v_exp_f32 v56, v56
    v_exp_f32 v57, v57
    v_exp_f32 v58, v58
    v_smfmac_f32_32x32x32_bf16 v[144:159], a[120:123], v[48:55], v236
    v_exp_f32 v59, v59
    v_exp_f32 v60, v60
    v_exp_f32 v61, v61
    v_mfma_f32_16x16x32_bf16 v[68:71], v[160:163], v[192:195], 0
    v_exp_f32 v62, v62
    v_exp_f32 v63, v63
    v_exp_f32 v0, v0
    v_exp_f32 v1, v1
    v_smfmac_f32_32x32x32_bf16 v[144:159], a[124:127], v[56:63], v236
    buffer_load_dwordx4 v221, s[68:71], s81 offen offset:0 nt lds
    v_exp_f32 v2, v2
    v_exp_f32 v3, v3
    v_exp_f32 v4, v4
    v_mfma_f32_32x32x4bf16_1k v[32:63], a[202:203], a[242:243], 0
    v_mov_b32 v248, v214
    v_mov_b32 v249, v215
    v_exp_f32 v5, v5
    v_exp_f32 v6, v6
    v_exp_f32 v7, v7
    v_exp_f32 v8, v8
    v_exp_f32 v9, v9
    v_exp_f32 v10, v10
    v_exp_f32 v11, v11
    v_exp_f32 v12, v12
    v_smfmac_f32_32x32x32_bf16 v[144:159], a[128:131], v[0:7], v236
    s_add_u32 s54, s81, 146432
    v_exp_f32 v13, v13
    v_exp_f32 v14, v14
    v_exp_f32 v15, v15
    v_mfma_f32_16x16x32_bf16 v[72:75], v[164:167], v[184:187], 0
    v_exp_f32 v16, v16
    v_exp_f32 v17, v17
    v_smfmac_f32_32x32x32_bf16 v[144:159], a[132:135], v[8:15], v236
    v_exp_f32 v18, v18
    v_exp_f32 v19, v19
    v_exp_f32 v20, v20
    v_mfma_f32_32x32x16_bf16 v[32:47], a[40:43], a[212:215], v[32:47]
    v_exp_f32 v21, v21
    v_exp_f32 v22, v22
    v_exp_f32 v23, v23
    v_mfma_f32_32x32x16_bf16 v[48:63], a[44:47], a[212:215], v[48:63]
    v_exp_f32 v24, v24
    v_exp_f32 v25, v25
    v_exp_f32 v26, v26
    v_smfmac_f32_32x32x32_bf16 v[144:159], a[136:139], v[16:23], v236
    buffer_load_dwordx4 v221, s[68:71], s54 offen offset:1024 nt lds
    v_exp_f32 v27, v27
    v_exp_f32 v28, v28
    v_exp_f32 v29, v29
    v_mfma_f32_16x16x32_bf16 v[76:79], v[164:167], v[192:195], 0
    s_add_u32 s54, s81, 34816
    v_exp_f32 v30, v30
    v_exp_f32 v31, v31
    v_exp_f32 v32, v32
    v_exp_f32 v33, v33
    v_smfmac_f32_32x32x32_bf16 v[144:159], a[140:143], v[24:31], v236
    v_exp_f32 v34, v34
    v_exp_f32 v35, v35
    v_exp_f32 v36, v36
    v_mfma_f32_32x32x4bf16_1k v[0:31], a[204:205], a[242:243], 0
    v_exp_f32 v37, v37
    v_exp_f32 v38, v38
    v_exp_f32 v39, v39
    v_exp_f32 v40, v40
    v_exp_f32 v41, v41
    v_exp_f32 v42, v42
    v_exp_f32 v43, v43
    v_exp_f32 v44, v44
    v_smfmac_f32_32x32x32_bf16 v[144:159], a[144:147], v[32:39], v236
    v_exp_f32 v45, v45
    v_exp_f32 v46, v46
    v_exp_f32 v47, v47
    v_mfma_f32_16x16x32_bf16 v[80:83], v[168:171], v[184:187], 0
    v_exp_f32 v48, v48
    v_exp_f32 v49, v49
    v_smfmac_f32_32x32x32_bf16 v[144:159], a[148:151], v[40:47], v236
    v_exp_f32 v50, v50
    v_exp_f32 v51, v51
    v_exp_f32 v52, v52
    v_mfma_f32_32x32x16_bf16 v[0:15], a[48:51], a[212:215], v[0:15]
    buffer_load_dwordx4 v221, s[68:71], s54 offen offset:2048 nt lds
    v_exp_f32 v53, v53
    v_exp_f32 v54, v54
    v_exp_f32 v55, v55
    v_mfma_f32_32x32x16_bf16 v[16:31], a[52:55], a[212:215], v[16:31]
    s_add_u32 s54, s54, 146432
    v_exp_f32 v56, v56
    v_exp_f32 v57, v57
    v_exp_f32 v58, v58
    v_smfmac_f32_32x32x32_bf16 v[144:159], a[152:155], v[48:55], v236
    v_exp_f32 v59, v59
    v_exp_f32 v60, v60
    v_exp_f32 v61, v61
    v_mfma_f32_16x16x32_bf16 v[84:87], v[168:171], v[192:195], 0
    v_exp_f32 v62, v62
    v_exp_f32 v63, v63
    v_exp_f32 v0, v0
    v_exp_f32 v1, v1
    v_smfmac_f32_32x32x32_bf16 v[144:159], a[156:159], v[56:63], v236
    v_exp_f32 v2, v2
    v_exp_f32 v3, v3
    v_exp_f32 v4, v4
    v_mfma_f32_32x32x4bf16_1k v[32:63], a[206:207], a[242:243], 0
    v_exp_f32 v5, v5
    v_exp_f32 v6, v6
    v_exp_f32 v7, v7
    v_exp_f32 v8, v8
    v_exp_f32 v9, v9
    v_exp_f32 v10, v10
    v_exp_f32 v11, v11
    v_exp_f32 v12, v12
    v_smfmac_f32_32x32x32_bf16 v[144:159], a[160:163], v[0:7], v236
    buffer_load_dwordx4 v221, s[68:71], s54 offen offset:3072 nt lds
    v_exp_f32 v13, v13
    v_exp_f32 v14, v14
    v_exp_f32 v15, v15
    v_mfma_f32_16x16x32_bf16 v[88:91], v[172:175], v[184:187], 0
    s_add_u32 m0, s47, 8192
    v_exp_f32 v16, v16
    v_exp_f32 v17, v17
    v_smfmac_f32_32x32x32_bf16 v[144:159], a[164:167], v[8:15], v236
    v_exp_f32 v18, v18
    v_exp_f32 v19, v19
    v_exp_f32 v20, v20
    v_mfma_f32_32x32x16_bf16 v[32:47], a[56:59], a[212:215], v[32:47]
    v_exp_f32 v21, v21
    v_exp_f32 v22, v22
    v_exp_f32 v23, v23
    v_mfma_f32_32x32x16_bf16 v[48:63], a[60:63], a[212:215], v[48:63]
    v_exp_f32 v24, v24
    v_exp_f32 v25, v25
    v_exp_f32 v26, v26
    v_smfmac_f32_32x32x32_bf16 v[144:159], a[168:171], v[16:23], v236
    s_waitcnt vmcnt(18)
    v_exp_f32 v27, v27
    v_exp_f32 v28, v28
    v_exp_f32 v29, v29
    v_mfma_f32_16x16x32_bf16 v[92:95], v[172:175], v[192:195], 0
    v_exp_f32 v30, v30
    v_exp_f32 v31, v31
    v_exp_f32 v32, v32
    v_exp_f32 v33, v33
    v_smfmac_f32_32x32x32_bf16 v[144:159], a[172:175], v[24:31], v236
    buffer_load_dwordx4 v222, s[72:75], s82 offen offset:0 nt lds
    v_exp_f32 v34, v34
    v_exp_f32 v35, v35
    v_exp_f32 v36, v36
    v_mfma_f32_32x32x4bf16_1k v[0:31], a[192:193], a[244:245], 0
    v_exp_f32 v37, v37
    v_exp_f32 v38, v38
    v_exp_f32 v39, v39
    v_exp_f32 v40, v40
    v_exp_f32 v41, v41
    v_exp_f32 v42, v42
    v_exp_f32 v43, v43
    v_exp_f32 v44, v44
    v_smfmac_f32_32x32x32_bf16 v[144:159], a[176:179], v[32:39], v236
    s_add_u32 s54, s82, s86
    v_exp_f32 v45, v45
    v_exp_f32 v46, v46
    v_exp_f32 v47, v47
    v_mfma_f32_16x16x32_bf16 v[96:99], v[176:179], v[184:187], 0
    v_exp_f32 v48, v48
    v_exp_f32 v49, v49
    v_smfmac_f32_32x32x32_bf16 v[144:159], a[180:183], v[40:47], v236
    v_exp_f32 v50, v50
    v_exp_f32 v51, v51
    v_exp_f32 v52, v52
    v_mfma_f32_32x32x16_bf16 v[0:15], a[0:3], a[216:219], v[0:15]
    v_exp_f32 v53, v53
    v_exp_f32 v54, v54
    v_exp_f32 v55, v55
    v_mfma_f32_32x32x16_bf16 v[16:31], a[4:7], a[216:219], v[16:31]
    v_exp_f32 v56, v56
    v_exp_f32 v57, v57
    v_exp_f32 v58, v58
    v_smfmac_f32_32x32x32_bf16 v[144:159], a[184:187], v[48:55], v236
    buffer_load_dwordx4 v222, s[72:75], s54 offen offset:1024 nt lds
    v_exp_f32 v59, v59
    v_exp_f32 v60, v60
    v_exp_f32 v61, v61
    v_exp_f32 v62, v62
    v_exp_f32 v63, v63
    v_exp_f32 v0, v0
    v_exp_f32 v1, v1
    v_smfmac_f32_32x32x32_bf16 v[144:159], a[188:191], v[56:63], v236
    s_add_u32 s54, s82, s90
    v_exp_f32 v2, v2
    v_exp_f32 v3, v3
    v_exp_f32 v4, v4
    v_mfma_f32_32x32x4bf16_1k v[32:63], a[194:195], a[244:245], 0
    v_exp_f32 v5, v5
    v_exp_f32 v6, v6
    v_exp_f32 v7, v7
    v_exp_f32 v8, v8
    v_exp_f32 v9, v9
    v_exp_f32 v10, v10
    v_exp_f32 v11, v11
    v_exp_f32 v12, v12
    v_smfmac_f32_32x32x32_bf16 v[128:143], a[64:67], v[0:7], v236
    ds_write_b128 v242, v[144:147] offset:10240
    v_exp_f32 v13, v13
    v_exp_f32 v14, v14
    v_exp_f32 v15, v15
    v_exp_f32 v16, v16
    v_exp_f32 v17, v17
    v_smfmac_f32_32x32x32_bf16 v[128:143], a[68:71], v[8:15], v236
    ds_write_b128 v242, v[148:151] offset:11264
    v_exp_f32 v18, v18
    v_exp_f32 v19, v19
    v_exp_f32 v20, v20
    v_mfma_f32_32x32x16_bf16 v[32:47], a[8:11], a[216:219], v[32:47]
    ds_write_b64 v243, v[152:153] offset:12288
    v_exp_f32 v21, v21
    v_exp_f32 v22, v22
    v_exp_f32 v23, v23
    v_mfma_f32_32x32x16_bf16 v[48:63], a[12:15], a[216:219], v[48:63]
    buffer_load_dwordx4 v222, s[72:75], s54 offen offset:2048 nt lds
    v_exp_f32 v24, v24
    v_exp_f32 v25, v25
    v_exp_f32 v26, v26
    v_smfmac_f32_32x32x32_bf16 v[128:143], a[72:75], v[16:23], v236
    s_add_u32 s54, s54, s86
    v_exp_f32 v27, v27
    v_exp_f32 v28, v28
    v_exp_f32 v29, v29
    v_exp_f32 v30, v30
    v_exp_f32 v31, v31
    v_exp_f32 v32, v32
    v_exp_f32 v33, v33
    v_smfmac_f32_32x32x32_bf16 v[128:143], a[76:79], v[24:31], v236
    v_exp_f32 v34, v34
    v_exp_f32 v35, v35
    v_exp_f32 v36, v36
    v_mfma_f32_32x32x4bf16_1k v[0:31], a[196:197], a[244:245], 0
    v_exp_f32 v37, v37
    v_exp_f32 v38, v38
    v_exp_f32 v39, v39
    v_exp_f32 v40, v40
    v_exp_f32 v41, v41
    v_exp_f32 v42, v42
    v_exp_f32 v43, v43
    v_exp_f32 v44, v44
    v_smfmac_f32_32x32x32_bf16 v[128:143], a[80:83], v[32:39], v236
    buffer_load_dwordx4 v222, s[72:75], s54 offen offset:3072 nt lds
    v_exp_f32 v45, v45
    v_exp_f32 v46, v46
    v_exp_f32 v47, v47
    v_exp_f32 v48, v48
    v_exp_f32 v49, v49
    v_smfmac_f32_32x32x32_bf16 v[128:143], a[84:87], v[40:47], v236
    s_waitcnt lgkmcnt(0)
    v_exp_f32 v50, v50
    v_exp_f32 v51, v51
    v_exp_f32 v52, v52
    v_mfma_f32_32x32x16_bf16 v[0:15], a[16:19], a[216:219], v[0:15]
    s_add_u32 m0, s47, 12288
    v_exp_f32 v53, v53
    v_exp_f32 v54, v54
    v_exp_f32 v55, v55
    v_mfma_f32_32x32x16_bf16 v[16:31], a[20:23], a[216:219], v[16:31]
    v_exp_f32 v56, v56
    v_exp_f32 v57, v57
    v_exp_f32 v58, v58
    v_smfmac_f32_32x32x32_bf16 v[128:143], a[88:91], v[48:55], v236
    v_exp_f32 v59, v59
    v_exp_f32 v60, v60
    v_exp_f32 v61, v61
    v_mfma_f32_32x32x8bf16_1k v[144:159], v[238:239], v[238:239], 0
    v_exp_f32 v62, v62
    v_exp_f32 v63, v63
    v_exp_f32 v0, v0
    v_exp_f32 v1, v1
    v_smfmac_f32_32x32x32_bf16 v[128:143], a[92:95], v[56:63], v236
    buffer_load_dwordx4 v220, s[76:79], s83 offen offset:0 nt lds
    v_exp_f32 v2, v2
    v_exp_f32 v3, v3
    v_exp_f32 v4, v4
    v_mfma_f32_32x32x4bf16_1k v[32:63], a[198:199], a[244:245], 0
    v_exp_f32 v5, v5
    v_exp_f32 v6, v6
    v_exp_f32 v7, v7
    v_exp_f32 v8, v8
    v_exp_f32 v9, v9
    v_exp_f32 v10, v10
    v_exp_f32 v11, v11
    v_exp_f32 v12, v12
    v_smfmac_f32_32x32x32_bf16 v[128:143], a[96:99], v[0:7], v236
    s_add_u32 s54, s83, 8192
    v_exp_f32 v13, v13
    v_exp_f32 v14, v14
    v_exp_f32 v15, v15
    v_exp_f32 v16, v16
    v_exp_f32 v17, v17
    v_smfmac_f32_32x32x32_bf16 v[128:143], a[100:103], v[8:15], v236
    v_exp_f32 v18, v18
    v_exp_f32 v19, v19
    v_exp_f32 v20, v20
    v_mfma_f32_32x32x16_bf16 v[32:47], a[24:27], a[216:219], v[32:47]
    v_exp_f32 v21, v21
    v_exp_f32 v22, v22
    v_exp_f32 v23, v23
    v_mfma_f32_32x32x16_bf16 v[48:63], a[28:31], a[216:219], v[48:63]
    v_exp_f32 v24, v24
    v_exp_f32 v25, v25
    v_exp_f32 v26, v26
    v_smfmac_f32_32x32x32_bf16 v[128:143], a[104:107], v[16:23], v236
HOP1_1:
    s_cbranch_execz HOPRET1
    buffer_load_dwordx4 v220, s[76:79], s54 offen offset:1024 nt lds
    v_exp_f32 v27, v27
    v_exp_f32 v28, v28
    v_exp_f32 v29, v29
    v_exp_f32 v30, v30
    v_exp_f32 v31, v31
    v_exp_f32 v32, v32
    v_exp_f32 v33, v33
    v_smfmac_f32_32x32x32_bf16 v[128:143], a[108:111], v[24:31], v236
    s_add_u32 s54, s83, 16384
    v_exp_f32 v34, v34
    v_exp_f32 v35, v35
    v_exp_f32 v36, v36
    v_mfma_f32_32x32x4bf16_1k v[0:31], a[200:201], a[244:245], 0
    v_exp_f32 v37, v37
    v_exp_f32 v38, v38
    v_exp_f32 v39, v39
    v_exp_f32 v40, v40
    v_exp_f32 v41, v41
    v_exp_f32 v42, v42
    v_exp_f32 v43, v43
    v_exp_f32 v44, v44
    v_smfmac_f32_32x32x32_bf16 v[128:143], a[112:115], v[32:39], v236
    v_exp_f32 v45, v45
    v_exp_f32 v46, v46
    v_exp_f32 v47, v47
    v_exp_f32 v48, v48
    v_exp_f32 v49, v49
    v_smfmac_f32_32x32x32_bf16 v[128:143], a[116:119], v[40:47], v236
    v_exp_f32 v50, v50
    v_exp_f32 v51, v51
    v_exp_f32 v52, v52
    v_mfma_f32_32x32x16_bf16 v[0:15], a[32:35], a[216:219], v[0:15]
    buffer_load_dwordx4 v220, s[76:79], s54 offen offset:2048 nt lds
    v_exp_f32 v53, v53
    v_exp_f32 v54, v54
    v_exp_f32 v55, v55
    v_mfma_f32_32x32x16_bf16 v[16:31], a[36:39], a[216:219], v[16:31]
    s_add_u32 s54, s54, 8192
    v_exp_f32 v56, v56
    v_exp_f32 v57, v57
    v_exp_f32 v58, v58
    v_smfmac_f32_32x32x32_bf16 v[128:143], a[120:123], v[48:55], v236
    v_exp_f32 v59, v59
    v_exp_f32 v60, v60
    v_exp_f32 v61, v61
    v_exp_f32 v62, v62
    v_exp_f32 v63, v63
    v_exp_f32 v0, v0
    v_exp_f32 v1, v1
    v_smfmac_f32_32x32x32_bf16 v[128:143], a[124:127], v[56:63], v236
    v_exp_f32 v2, v2
    v_exp_f32 v3, v3
    v_exp_f32 v4, v4
    v_mfma_f32_32x32x4bf16_1k v[32:63], a[202:203], a[244:245], 0
    v_exp_f32 v5, v5
    v_exp_f32 v6, v6
    v_exp_f32 v7, v7
    v_exp_f32 v8, v8
    v_exp_f32 v9, v9
    v_exp_f32 v10, v10
    v_exp_f32 v11, v11
    v_exp_f32 v12, v12
    v_smfmac_f32_32x32x32_bf16 v[128:143], a[128:131], v[0:7], v236
    buffer_load_dwordx4 v220, s[76:79], s54 offen offset:3072 nt lds
    v_exp_f32 v13, v13
    v_exp_f32 v14, v14
    v_exp_f32 v15, v15
    v_exp_f32 v16, v16
    v_exp_f32 v17, v17
    v_smfmac_f32_32x32x32_bf16 v[128:143], a[132:135], v[8:15], v236
    s_add_u32 s53, s46, 0
    v_exp_f32 v18, v18
    v_exp_f32 v19, v19
    v_exp_f32 v20, v20
    v_mfma_f32_32x32x16_bf16 v[32:47], a[40:43], a[216:219], v[32:47]
    v_exp_f32 v21, v21
    v_exp_f32 v22, v22
    v_exp_f32 v23, v23
    v_mfma_f32_32x32x16_bf16 v[48:63], a[44:47], a[216:219], v[48:63]
    s_add_u32 s59, s46, 143360
    v_exp_f32 v24, v24
    v_exp_f32 v25, v25
    v_exp_f32 v26, v26
    v_smfmac_f32_32x32x32_bf16 v[128:143], a[136:139], v[16:23], v236
    s_add_u32 m0, s43, 0
    v_exp_f32 v27, v27
    v_exp_f32 v28, v28
    v_exp_f32 v29, v29
    v_exp_f32 v30, v30
    v_exp_f32 v31, v31
    v_exp_f32 v32, v32
    v_exp_f32 v33, v33
    v_smfmac_f32_32x32x32_bf16 v[128:143], a[140:143], v[24:31], v236
    buffer_load_dwordx4 v241, s[20:23], s59 offen offset:0 lds
    v_exp_f32 v34, v34
    v_exp_f32 v35, v35
    v_exp_f32 v36, v36
    v_mfma_f32_32x32x4bf16_1k v[0:31], a[204:205], a[244:245], 0
    v_exp_f32 v37, v37
    v_exp_f32 v38, v38
    v_exp_f32 v39, v39
    v_exp_f32 v40, v40
    v_exp_f32 v41, v41
    v_exp_f32 v42, v42
    v_exp_f32 v43, v43
    v_exp_f32 v44, v44
    v_smfmac_f32_32x32x32_bf16 v[128:143], a[144:147], v[32:39], v236
    buffer_load_dwordx4 v241, s[20:23], s59 offen offset:1024 lds
    v_exp_f32 v45, v45
    v_exp_f32 v46, v46
    v_exp_f32 v47, v47
    v_exp_f32 v48, v48
    v_exp_f32 v49, v49
    v_smfmac_f32_32x32x32_bf16 v[128:143], a[148:151], v[40:47], v236
    buffer_load_dwordx4 v[168:171], v241, s[20:23], s53 offen offset:0 sc1
    v_exp_f32 v50, v50
    v_exp_f32 v51, v51
    v_exp_f32 v52, v52
    v_mfma_f32_32x32x16_bf16 v[0:15], a[48:51], a[216:219], v[0:15]
    buffer_load_dwordx4 v[172:175], v241, s[20:23], s53 offen offset:1024 sc1
    v_exp_f32 v53, v53
    v_exp_f32 v54, v54
    v_exp_f32 v55, v55
    v_mfma_f32_32x32x16_bf16 v[16:31], a[52:55], a[216:219], v[16:31]
    v_exp_f32 v56, v56
    v_exp_f32 v57, v57
    v_exp_f32 v58, v58
    v_smfmac_f32_32x32x32_bf16 v[128:143], a[152:155], v[48:55], v236
    buffer_load_dwordx4 v[176:179], v241, s[20:23], s53 offen offset:2048 sc1
    buffer_load_dwordx4 v[180:183], v241, s[20:23], s53 offen offset:3072 sc1
    v_exp_f32 v59, v59
    v_exp_f32 v60, v60
    v_exp_f32 v61, v61
    s_add_u32 s53, s46, 4096
    v_exp_f32 v62, v62
    v_exp_f32 v63, v63
    v_exp_f32 v0, v0
    v_exp_f32 v1, v1
    v_smfmac_f32_32x32x32_bf16 v[128:143], a[156:159], v[56:63], v236
    buffer_load_dwordx4 v241, s[20:23], s59 offen offset:2048 lds
    v_exp_f32 v2, v2
    v_exp_f32 v3, v3
    v_exp_f32 v4, v4
    v_mfma_f32_32x32x4bf16_1k v[32:63], a[206:207], a[244:245], 0
    v_exp_f32 v5, v5
    v_exp_f32 v6, v6
    v_exp_f32 v7, v7
    v_exp_f32 v8, v8
    v_exp_f32 v9, v9
    v_exp_f32 v10, v10
    v_exp_f32 v11, v11
    v_exp_f32 v12, v12
    v_smfmac_f32_32x32x32_bf16 v[128:143], a[160:163], v[0:7], v236
    buffer_load_dwordx4 v241, s[20:23], s59 offen offset:3072 lds
    v_exp_f32 v13, v13
    v_exp_f32 v14, v14
    v_exp_f32 v15, v15
    v_exp_f32 v16, v16
    v_exp_f32 v17, v17
    v_smfmac_f32_32x32x32_bf16 v[128:143], a[164:167], v[8:15], v236
    buffer_load_dwordx4 v[184:187], v241, s[20:23], s53 offen offset:0 sc1
    v_exp_f32 v18, v18
    v_exp_f32 v19, v19
    v_exp_f32 v20, v20
    v_mfma_f32_32x32x16_bf16 v[32:47], a[56:59], a[216:219], v[32:47]
    buffer_load_dwordx4 v[188:191], v241, s[20:23], s53 offen offset:1024 sc1
    v_exp_f32 v21, v21
    v_exp_f32 v22, v22
    v_exp_f32 v23, v23
    v_mfma_f32_32x32x16_bf16 v[48:63], a[60:63], a[216:219], v[48:63]
    s_add_u32 s59, s46, 147456
    v_exp_f32 v24, v24
    v_exp_f32 v25, v25
    v_exp_f32 v26, v26
    v_smfmac_f32_32x32x32_bf16 v[128:143], a[168:171], v[16:23], v236
    s_waitcnt vmcnt(34)
    v_exp_f32 v27, v27
    v_exp_f32 v28, v28
    v_exp_f32 v29, v29
    v_exp_f32 v30, v30
    v_exp_f32 v31, v31
    v_exp_f32 v32, v32
    v_exp_f32 v33, v33
    v_smfmac_f32_32x32x32_bf16 v[128:143], a[172:175], v[24:31], v236
    s_add_u32 m0, s43, 4096
    v_exp_f32 v34, v34
    v_exp_f32 v35, v35
    v_exp_f32 v36, v36
    v_mfma_f32_32x32x4bf16_1k v[0:31], a[192:193], a[246:247], 0
    v_exp_f32 v37, v37
    v_exp_f32 v38, v38
    v_exp_f32 v39, v39
    v_exp_f32 v40, v40
    v_exp_f32 v41, v41
    v_exp_f32 v42, v42
    v_exp_f32 v43, v43
    v_exp_f32 v44, v44
    v_smfmac_f32_32x32x32_bf16 v[128:143], a[176:179], v[32:39], v236
    buffer_load_dwordx4 v241, s[20:23], s59 offen offset:0 lds
    v_exp_f32 v45, v45
    v_exp_f32 v46, v46
    v_exp_f32 v47, v47
    v_exp_f32 v48, v48
    v_exp_f32 v49, v49
    v_smfmac_f32_32x32x32_bf16 v[128:143], a[180:183], v[40:47], v236
    buffer_load_dwordx4 v241, s[20:23], s59 offen offset:1024 lds
    v_exp_f32 v50, v50
    v_exp_f32 v51, v51
    v_exp_f32 v52, v52
    v_mfma_f32_32x32x16_bf16 v[0:15], a[0:3], a[220:223], v[0:15]
    buffer_load_dwordx4 v[192:195], v241, s[20:23], s53 offen offset:2048 sc1
    v_exp_f32 v53, v53
    v_exp_f32 v54, v54
    v_exp_f32 v55, v55
    v_mfma_f32_32x32x16_bf16 v[16:31], a[4:7], a[220:223], v[16:31]
    buffer_load_dwordx4 v[196:199], v241, s[20:23], s53 offen offset:3072 sc1
    v_exp_f32 v56, v56
    v_exp_f32 v57, v57
    v_exp_f32 v58, v58
    v_smfmac_f32_32x32x32_bf16 v[128:143], a[184:187], v[48:55], v236
    s_add_u32 s53, s46, 8192
    v_exp_f32 v59, v59
    v_exp_f32 v60, v60
    v_exp_f32 v61, v61
    buffer_load_dwordx4 v[200:203], v241, s[20:23], s53 offen offset:0 sc1
    buffer_load_dwordx4 v[204:207], v241, s[20:23], s53 offen offset:1024 sc1
    v_exp_f32 v62, v62
    v_exp_f32 v63, v63
    v_exp_f32 v0, v0
    v_exp_f32 v1, v1
    v_smfmac_f32_32x32x32_bf16 v[128:143], a[188:191], v[56:63], v236
    buffer_load_dwordx4 v241, s[20:23], s59 offen offset:2048 lds
    v_exp_f32 v2, v2
    v_exp_f32 v3, v3
    v_exp_f32 v4, v4
    v_mfma_f32_32x32x4bf16_1k v[32:63], a[194:195], a[246:247], 0
    buffer_load_dwordx4 v241, s[20:23], s59 offen offset:3072 lds
    v_exp_f32 v5, v5
    v_exp_f32 v6, v6
    v_exp_f32 v7, v7
    v_exp_f32 v8, v8
    v_exp_f32 v9, v9
    v_exp_f32 v10, v10
    v_exp_f32 v11, v11
    v_exp_f32 v12, v12
    v_smfmac_f32_32x32x32_bf16 v[144:159], a[64:67], v[0:7], v236
    ds_write_b128 v242, v[128:131] offset:20480
    v_exp_f32 v13, v13
    v_exp_f32 v14, v14
    v_exp_f32 v15, v15
    v_exp_f32 v16, v16
    v_exp_f32 v17, v17
    v_smfmac_f32_32x32x32_bf16 v[144:159], a[68:71], v[8:15], v236
    ds_write_b128 v242, v[132:135] offset:21504
    v_exp_f32 v18, v18
    v_exp_f32 v19, v19
    v_exp_f32 v20, v20
    v_mfma_f32_32x32x16_bf16 v[32:47], a[8:11], a[220:223], v[32:47]
    ds_write_b64 v243, v[136:137] offset:22528
    buffer_load_dwordx4 v[208:211], v241, s[20:23], s53 offen offset:2048 sc1
    buffer_load_dwordx4 v[212:215], v241, s[20:23], s53 offen offset:3072 sc1
    s_add_u32 s53, s46, 12288
    v_exp_f32 v21, v21
    v_exp_f32 v22, v22
    v_exp_f32 v23, v23
    v_mfma_f32_32x32x16_bf16 v[48:63], a[12:15], a[220:223], v[48:63]
    s_add_u32 s59, s46, 151552
    v_exp_f32 v24, v24
    v_exp_f32 v25, v25
    v_exp_f32 v26, v26
    v_smfmac_f32_32x32x32_bf16 v[144:159], a[72:75], v[16:23], v236
    s_add_u32 m0, s43, 8192
    v_exp_f32 v27, v27
    v_exp_f32 v28, v28
    v_exp_f32 v29, v29
    v_exp_f32 v30, v30
    v_exp_f32 v31, v31
    v_exp_f32 v32, v32
    v_exp_f32 v33, v33
    v_smfmac_f32_32x32x32_bf16 v[144:159], a[76:79], v[24:31], v236
    buffer_load_dwordx4 v241, s[20:23], s59 offen offset:0 lds
    buffer_load_dwordx4 a[208:211], v241, s[20:23], s53 offen offset:0 sc1
    buffer_load_dwordx4 a[212:215], v241, s[20:23], s53 offen offset:1024 sc1
    v_exp_f32 v34, v34
    v_exp_f32 v35, v35
    v_exp_f32 v36, v36
    v_mfma_f32_32x32x4bf16_1k v[0:31], a[196:197], a[246:247], 0
    buffer_load_dwordx4 v241, s[20:23], s59 offen offset:1024 lds
    v_exp_f32 v37, v37
    v_exp_f32 v38, v38
    v_exp_f32 v39, v39
    v_exp_f32 v40, v40
    v_exp_f32 v41, v41
    v_exp_f32 v42, v42
    v_exp_f32 v43, v43
    v_exp_f32 v44, v44
    v_smfmac_f32_32x32x32_bf16 v[144:159], a[80:83], v[32:39], v236
    s_waitcnt vmcnt(24)
    v_exp_f32 v45, v45
    v_exp_f32 v46, v46
    v_exp_f32 v47, v47
    v_exp_f32 v48, v48
    v_exp_f32 v49, v49
    v_smfmac_f32_32x32x32_bf16 v[144:159], a[84:87], v[40:47], v236
    s_waitcnt lgkmcnt(0)
    v_exp_f32 v50, v50
    v_exp_f32 v51, v51
    v_exp_f32 v52, v52
    v_mfma_f32_32x32x16_bf16 v[0:15], a[16:19], a[220:223], v[0:15]
    ds_read_b64_tr_b16 v[160:161], v216 offset:0
    v_exp_f32 v53, v53
    v_exp_f32 v54, v54
    v_exp_f32 v55, v55
    v_mfma_f32_32x32x16_bf16 v[16:31], a[20:23], a[220:223], v[16:31]
    ds_read_b64_tr_b16 v[162:163], v216 offset:2048
    v_exp_f32 v56, v56
    v_exp_f32 v57, v57
    v_exp_f32 v58, v58
    v_smfmac_f32_32x32x32_bf16 v[144:159], a[88:91], v[48:55], v236
    ds_read_b64_tr_b16 v[164:165], v217 offset:0
    v_exp_f32 v59, v59
    v_exp_f32 v60, v60
    v_exp_f32 v61, v61
    v_mfma_f32_32x32x8bf16_1k v[128:143], v[238:239], v[238:239], 0
    v_exp_f32 v62, v62
    v_exp_f32 v63, v63
    v_exp_f32 v0, v0
    v_exp_f32 v1, v1
    v_smfmac_f32_32x32x32_bf16 v[144:159], a[92:95], v[56:63], v236
    ds_read_b64_tr_b16 v[166:167], v217 offset:2048
    v_exp_f32 v2, v2
    v_exp_f32 v3, v3
    v_exp_f32 v4, v4
    v_mfma_f32_32x32x4bf16_1k v[32:63], a[198:199], a[246:247], 0
    v_exp_f32 v5, v5
    v_exp_f32 v6, v6
    v_exp_f32 v7, v7
    v_exp_f32 v8, v8
    v_exp_f32 v9, v9
    v_exp_f32 v10, v10
    v_exp_f32 v11, v11
    v_exp_f32 v12, v12
    v_smfmac_f32_32x32x32_bf16 v[144:159], a[96:99], v[0:7], v236
    s_waitcnt lgkmcnt(0)
    v_exp_f32 v13, v13
    v_exp_f32 v14, v14
    v_exp_f32 v15, v15
    v_exp_f32 v16, v16
    v_exp_f32 v17, v17
    v_smfmac_f32_32x32x32_bf16 v[144:159], a[100:103], v[8:15], v236
    buffer_store_dwordx4 v[160:163], v241, s[20:23], s92 offen sc1
    v_exp_f32 v18, v18
    v_exp_f32 v19, v19
    v_exp_f32 v20, v20
    v_mfma_f32_32x32x16_bf16 v[32:47], a[24:27], a[220:223], v[32:47]
    s_add_u32 s55, s92, s96
    v_exp_f32 v21, v21
    v_exp_f32 v22, v22
    v_exp_f32 v23, v23
    v_mfma_f32_32x32x16_bf16 v[48:63], a[28:31], a[220:223], v[48:63]
    v_exp_f32 v24, v24
    v_exp_f32 v25, v25
    v_exp_f32 v26, v26
    v_smfmac_f32_32x32x32_bf16 v[144:159], a[104:107], v[16:23], v236
    buffer_store_dwordx4 v[164:167], v241, s[20:23], s55 offen sc1
    v_exp_f32 v27, v27
    v_exp_f32 v28, v28
    v_exp_f32 v29, v29
    v_exp_f32 v30, v30
    v_exp_f32 v31, v31
    v_exp_f32 v32, v32
    v_exp_f32 v33, v33
    v_smfmac_f32_32x32x32_bf16 v[144:159], a[108:111], v[24:31], v236
    ds_read_b64_tr_b16 v[160:161], v218 offset:0
    v_exp_f32 v34, v34
    v_exp_f32 v35, v35
    v_exp_f32 v36, v36
    v_mfma_f32_32x32x4bf16_1k v[0:31], a[200:201], a[246:247], 0
    v_exp_f32 v37, v37
    v_exp_f32 v38, v38
    v_exp_f32 v39, v39
    v_exp_f32 v40, v40
    v_exp_f32 v41, v41
    v_exp_f32 v42, v42
    v_exp_f32 v43, v43
    v_exp_f32 v44, v44
    v_smfmac_f32_32x32x32_bf16 v[144:159], a[112:115], v[32:39], v236
    ds_read_b64_tr_b16 v[162:163], v218 offset:2048
    v_exp_f32 v45, v45
    v_exp_f32 v46, v46
    v_exp_f32 v47, v47
    v_exp_f32 v48, v48
    v_exp_f32 v49, v49
    v_smfmac_f32_32x32x32_bf16 v[144:159], a[116:119], v[40:47], v236
    ds_read_b64_tr_b16 v[164:165], v219 offset:0
    v_exp_f32 v50, v50
    v_exp_f32 v51, v51
    v_exp_f32 v52, v52
    v_mfma_f32_32x32x16_bf16 v[0:15], a[32:35], a[220:223], v[0:15]
    ds_read_b64_tr_b16 v[166:167], v219 offset:2048
    v_exp_f32 v53, v53
    v_exp_f32 v54, v54
    v_exp_f32 v55, v55
    v_mfma_f32_32x32x16_bf16 v[16:31], a[36:39], a[220:223], v[16:31]
    s_add_u32 s55, s55, s96
    v_exp_f32 v56, v56
    v_exp_f32 v57, v57
    v_exp_f32 v58, v58
    v_smfmac_f32_32x32x32_bf16 v[144:159], a[120:123], v[48:55], v236
    s_add_u32 s59, s46, 153600
    s_add_u32 m0, s47, 0
    v_exp_f32 v59, v59
    v_exp_f32 v60, v60
    v_exp_f32 v61, v61
    v_exp_f32 v62, v62
    v_exp_f32 v63, v63
    v_exp_f32 v0, v0
    v_exp_f32 v1, v1
    v_smfmac_f32_32x32x32_bf16 v[144:159], a[124:127], v[56:63], v236
    s_waitcnt lgkmcnt(0)
    v_exp_f32 v2, v2
    v_exp_f32 v3, v3
    v_exp_f32 v4, v4
    v_mfma_f32_32x32x4bf16_1k v[32:63], a[202:203], a[246:247], 0
    buffer_load_dwordx4 v241, s[20:23], s59 offen offset:0 lds
    v_exp_f32 v5, v5
    v_exp_f32 v6, v6
    v_exp_f32 v7, v7
    v_exp_f32 v8, v8
    v_exp_f32 v9, v9
    v_exp_f32 v10, v10
    v_exp_f32 v11, v11
    v_exp_f32 v12, v12
    v_smfmac_f32_32x32x32_bf16 v[144:159], a[128:131], v[0:7], v236
    buffer_store_dwordx4 v[160:163], v241, s[20:23], s55 offen sc1
    buffer_load_dwordx4 v241, s[20:23], s59 offen offset:1024 lds
    v_exp_f32 v13, v13
    v_exp_f32 v14, v14
    v_exp_f32 v15, v15
    buffer_load_dwordx4 v241, s[20:23], s59 offen offset:2048 lds
    v_exp_f32 v16, v16
    v_exp_f32 v17, v17
    v_smfmac_f32_32x32x32_bf16 v[144:159], a[132:135], v[8:15], v236
    s_add_u32 s55, s55, s96
    buffer_load_dwordx4 v241, s[20:23], s59 offen offset:3072 lds
    v_exp_f32 v18, v18
    v_exp_f32 v19, v19
    v_exp_f32 v20, v20
    v_mfma_f32_32x32x16_bf16 v[32:47], a[40:43], a[220:223], v[32:47]
    buffer_store_dwordx4 v[164:167], v241, s[20:23], s55 offen sc1
    v_exp_f32 v21, v21
    v_exp_f32 v22, v22
    v_exp_f32 v23, v23
    v_mfma_f32_32x32x16_bf16 v[48:63], a[44:47], a[220:223], v[48:63]
    ds_read_b64_tr_b16 v[160:161], v216 offset:4096
    v_exp_f32 v24, v24
    v_exp_f32 v25, v25
    v_exp_f32 v26, v26
    v_smfmac_f32_32x32x32_bf16 v[144:159], a[136:139], v[16:23], v236
    ds_read_b64_tr_b16 v[162:163], v216 offset:6144
    v_exp_f32 v27, v27
    v_exp_f32 v28, v28
    v_exp_f32 v29, v29
    v_exp_f32 v30, v30
    v_exp_f32 v31, v31
    v_exp_f32 v32, v32
    v_exp_f32 v33, v33
    v_smfmac_f32_32x32x32_bf16 v[144:159], a[140:143], v[24:31], v236
    ds_read_b64_tr_b16 v[164:165], v217 offset:4096
    v_exp_f32 v34, v34
    v_exp_f32 v35, v35
    v_exp_f32 v36, v36
    v_mfma_f32_32x32x4bf16_1k v[0:31], a[204:205], a[246:247], 0
    v_exp_f32 v37, v37
    v_exp_f32 v38, v38
    v_exp_f32 v39, v39
    v_exp_f32 v40, v40
    v_exp_f32 v41, v41
    v_exp_f32 v42, v42
    v_exp_f32 v43, v43
    v_exp_f32 v44, v44
    v_smfmac_f32_32x32x32_bf16 v[144:159], a[144:147], v[32:39], v236
    ds_read_b64_tr_b16 v[166:167], v217 offset:6144
    v_exp_f32 v45, v45
    v_exp_f32 v46, v46
    v_exp_f32 v47, v47
    v_exp_f32 v48, v48
    v_exp_f32 v49, v49
    v_smfmac_f32_32x32x32_bf16 v[144:159], a[148:151], v[40:47], v236
    s_waitcnt lgkmcnt(0)
    v_exp_f32 v50, v50
    v_exp_f32 v51, v51
    v_exp_f32 v52, v52
    v_mfma_f32_32x32x16_bf16 v[0:15], a[48:51], a[220:223], v[0:15]
    buffer_store_dwordx4 v[160:163], v241, s[20:23], s93 offen sc1
    v_exp_f32 v53, v53
    v_exp_f32 v54, v54
    v_exp_f32 v55, v55
    v_mfma_f32_32x32x16_bf16 v[16:31], a[52:55], a[220:223], v[16:31]
    s_add_u32 s55, s93, s97
    v_exp_f32 v56, v56
    v_exp_f32 v57, v57
    v_exp_f32 v58, v58
    v_smfmac_f32_32x32x32_bf16 v[144:159], a[152:155], v[48:55], v236
    buffer_store_dwordx4 v[164:167], v241, s[20:23], s55 offen sc1
    v_exp_f32 v59, v59
    v_exp_f32 v60, v60
    v_exp_f32 v61, v61
    v_exp_f32 v62, v62
    v_exp_f32 v63, v63
    v_exp_f32 v0, v0
    v_exp_f32 v1, v1
    v_smfmac_f32_32x32x32_bf16 v[144:159], a[156:159], v[56:63], v236
    ds_read_b64_tr_b16 v[160:161], v218 offset:4096
    v_exp_f32 v2, v2
    v_exp_f32 v3, v3
    v_exp_f32 v4, v4
    v_mfma_f32_32x32x4bf16_1k v[32:63], a[206:207], a[246:247], 0
    v_exp_f32 v5, v5
    v_exp_f32 v6, v6
    v_exp_f32 v7, v7
    v_exp_f32 v8, v8
    v_exp_f32 v9, v9
    v_exp_f32 v10, v10
    v_exp_f32 v11, v11
    v_exp_f32 v12, v12
    v_smfmac_f32_32x32x32_bf16 v[144:159], a[160:163], v[0:7], v236
    ds_read_b64_tr_b16 v[162:163], v218 offset:6144
    v_exp_f32 v13, v13
    v_exp_f32 v14, v14
    v_exp_f32 v15, v15
    v_exp_f32 v16, v16
    v_exp_f32 v17, v17
    v_smfmac_f32_32x32x32_bf16 v[144:159], a[164:167], v[8:15], v236
    ds_read_b64_tr_b16 v[164:165], v219 offset:4096
    v_exp_f32 v18, v18
    v_exp_f32 v19, v19
    v_exp_f32 v20, v20
    v_mfma_f32_32x32x16_bf16 v[32:47], a[56:59], a[220:223], v[32:47]
    ds_read_b64_tr_b16 v[166:167], v219 offset:6144
    v_exp_f32 v21, v21
    v_exp_f32 v22, v22
    v_exp_f32 v23, v23
    v_mfma_f32_32x32x16_bf16 v[48:63], a[60:63], a[220:223], v[48:63]
    s_add_u32 s55, s55, s97
    v_exp_f32 v24, v24
    v_exp_f32 v25, v25
    v_exp_f32 v26, v26
    v_smfmac_f32_32x32x32_bf16 v[144:159], a[168:171], v[16:23], v236
    s_add_u32 s59, s46, 157696
    s_add_u32 m0, s47, 4096
    v_exp_f32 v27, v27
    v_exp_f32 v28, v28
    v_exp_f32 v29, v29
    v_exp_f32 v30, v30
    v_exp_f32 v31, v31
    v_exp_f32 v32, v32
    v_exp_f32 v33, v33
    v_smfmac_f32_32x32x32_bf16 v[144:159], a[172:175], v[24:31], v236
    s_waitcnt lgkmcnt(0)
    buffer_load_dwordx4 a[216:219], v241, s[20:23], s53 offen offset:2048 sc1
    buffer_load_dwordx4 a[220:223], v241, s[20:23], s53 offen offset:3072 sc1
    v_exp_f32 v34, v34
    v_exp_f32 v35, v35
    v_exp_f32 v36, v36
    v_mfma_f32_32x32x4bf16_1k v[0:31], a[192:193], a[248:249], 0
    buffer_load_dwordx4 v241, s[20:23], s59 offen offset:0 lds
    v_exp_f32 v37, v37
    v_exp_f32 v38, v38
    v_exp_f32 v39, v39
    v_exp_f32 v40, v40
    v_exp_f32 v41, v41
    v_exp_f32 v42, v42
    v_exp_f32 v43, v43
    v_exp_f32 v44, v44
    v_smfmac_f32_32x32x32_bf16 v[144:159], a[176:179], v[32:39], v236
    buffer_store_dwordx4 v[160:163], v241, s[20:23], s55 offen sc1
    buffer_load_dwordx4 v241, s[20:23], s59 offen offset:1024 lds
    v_exp_f32 v45, v45
    v_exp_f32 v46, v46
    v_exp_f32 v47, v47
    buffer_load_dwordx4 v241, s[20:23], s59 offen offset:2048 lds
    v_exp_f32 v48, v48
    v_exp_f32 v49, v49
    v_smfmac_f32_32x32x32_bf16 v[144:159], a[180:183], v[40:47], v236
    s_add_u32 s55, s55, s97
    buffer_load_dwordx4 v241, s[20:23], s59 offen offset:3072 lds
    v_exp_f32 v50, v50
    v_exp_f32 v51, v51
    v_exp_f32 v52, v52
    v_mfma_f32_32x32x16_bf16 v[0:15], a[0:3], a[224:227], v[0:15]
    buffer_store_dwordx4 v[164:167], v241, s[20:23], s55 offen sc1
    v_exp_f32 v53, v53
    v_exp_f32 v54, v54
    v_exp_f32 v55, v55
    v_mfma_f32_32x32x16_bf16 v[16:31], a[4:7], a[224:227], v[16:31]
    ds_read_b64_tr_b16 v[160:161], v216 offset:8192
    v_exp_f32 v56, v56
    v_exp_f32 v57, v57
    v_exp_f32 v58, v58
    v_smfmac_f32_32x32x32_bf16 v[144:159], a[184:187], v[48:55], v236
    ds_read_b64_tr_b16 v[162:163], v216 offset:10240
    v_exp_f32 v59, v59
    v_exp_f32 v60, v60
    v_exp_f32 v61, v61
    v_exp_f32 v62, v62
    v_exp_f32 v63, v63
    v_exp_f32 v0, v0
    v_exp_f32 v1, v1
    v_smfmac_f32_32x32x32_bf16 v[144:159], a[188:191], v[56:63], v236
    ds_read_b64_tr_b16 v[164:165], v217 offset:8192
    ds_read_b64_tr_b16 v[166:167], v217 offset:10240
    v_exp_f32 v2, v2
    v_exp_f32 v3, v3
    v_exp_f32 v4, v4
    v_mfma_f32_32x32x4bf16_1k v[32:63], a[194:195], a[248:249], 0
    v_exp_f32 v5, v5
    v_exp_f32 v6, v6
    v_exp_f32 v7, v7
    v_exp_f32 v8, v8
    v_exp_f32 v9, v9
    v_exp_f32 v10, v10
    v_exp_f32 v11, v11
    v_exp_f32 v12, v12
    v_smfmac_f32_32x32x32_bf16 v[128:143], a[64:67], v[0:7], v236
    ds_write_b128 v242, v[144:147] offset:30720
    v_exp_f32 v13, v13
    v_exp_f32 v14, v14
    v_exp_f32 v15, v15
    v_exp_f32 v16, v16
    v_exp_f32 v17, v17
    v_smfmac_f32_32x32x32_bf16 v[128:143], a[68:71], v[8:15], v236
    ds_write_b128 v242, v[148:151] offset:31744
    v_exp_f32 v18, v18
    v_exp_f32 v19, v19
    v_exp_f32 v20, v20
    v_mfma_f32_32x32x16_bf16 v[32:47], a[8:11], a[224:227], v[32:47]
    ds_write_b64 v243, v[152:153] offset:32768
    v_exp_f32 v21, v21
    v_exp_f32 v22, v22
    v_exp_f32 v23, v23
    v_mfma_f32_32x32x16_bf16 v[48:63], a[12:15], a[224:227], v[48:63]
    s_waitcnt lgkmcnt(3)
    buffer_store_dwordx4 v[160:163], v241, s[20:23], s94 offen sc1
    s_add_u32 s55, s94, s98
    v_exp_f32 v24, v24
    v_exp_f32 v25, v25
    v_exp_f32 v26, v26
    v_smfmac_f32_32x32x32_bf16 v[128:143], a[72:75], v[16:23], v236
    s_waitcnt lgkmcnt(0)
    s_barrier
    ds_read_b128 v[108:111], v244 offset:0
    ds_read_b128 v[112:115], v244 offset:1024
    ds_read_b64 v[116:117], v245 offset:2048
    buffer_store_dwordx4 v[164:167], v241, s[20:23], s55 offen sc1
    ds_read_b64_tr_b16 v[160:161], v218 offset:8192
    ds_read_b64_tr_b16 v[162:163], v218 offset:10240
    ds_read_b64_tr_b16 v[164:165], v219 offset:8192
    ds_read_b64_tr_b16 v[166:167], v219 offset:10240
    s_add_u32 s55, s55, s98
    v_exp_f32 v27, v27
    v_exp_f32 v28, v28
    v_exp_f32 v29, v29
    v_exp_f32 v30, v30
    v_exp_f32 v31, v31
    s_add_u32 s59, s46, 161792
    s_add_u32 m0, s47, 8192
    v_exp_f32 v32, v32
    v_exp_f32 v33, v33
    v_smfmac_f32_32x32x32_bf16 v[128:143], a[76:79], v[24:31], v236
    ds_read_b128 v[118:121], v244 offset:2560
    ds_read_b128 v[122:125], v244 offset:3584
    ds_read_b64 v[126:127], v245 offset:4608
    v_exp_f32 v34, v34
    v_exp_f32 v35, v35
    v_exp_f32 v36, v36
    v_mfma_f32_32x32x4bf16_1k v[0:31], a[196:197], a[248:249], 0
    v_exp_f32 v37, v37
    v_exp_f32 v38, v38
    v_exp_f32 v39, v39
    v_exp_f32 v40, v40
    v_exp_f32 v41, v41
    v_exp_f32 v42, v42
    v_exp_f32 v43, v43
    v_exp_f32 v44, v44
    v_smfmac_f32_32x32x32_bf16 v[128:143], a[80:83], v[32:39], v236
    s_waitcnt lgkmcnt(3)
    v_exp_f32 v45, v45
    v_exp_f32 v46, v46
    v_exp_f32 v47, v47
    buffer_load_dwordx4 v241, s[20:23], s59 offen offset:0 lds
    v_exp_f32 v48, v48
    v_exp_f32 v49, v49
    v_smfmac_f32_32x32x32_bf16 v[128:143], a[84:87], v[40:47], v236
    s_waitcnt lgkmcnt(0)
    v_add_f32 v108, v108, v118
    v_add_f32 v109, v109, v119
    v_add_f32 v110, v110, v120
    v_add_f32 v111, v111, v121
    v_add_f32 v112, v112, v122
    v_add_f32 v113, v113, v123
    v_add_f32 v114, v114, v124
    v_add_f32 v115, v115, v125
    v_add_f32 v116, v116, v126
    v_add_f32 v117, v117, v127
    ds_read_b128 v[118:121], v244 offset:5120
    ds_read_b128 v[122:125], v244 offset:6144
    ds_read_b64 v[126:127], v245 offset:7168
    buffer_load_dwordx4 v241, s[20:23], s59 offen offset:1024 lds
    v_exp_f32 v50, v50
    v_exp_f32 v51, v51
    v_exp_f32 v52, v52
    v_mfma_f32_32x32x16_bf16 v[0:15], a[16:19], a[224:227], v[0:15]
    buffer_store_dwordx4 v[160:163], v241, s[20:23], s55 offen sc1
    buffer_load_dwordx4 v241, s[20:23], s59 offen offset:2048 lds
    v_exp_f32 v53, v53
    v_exp_f32 v54, v54
    v_exp_f32 v55, v55
    v_mfma_f32_32x32x16_bf16 v[16:31], a[20:23], a[224:227], v[16:31]
    s_add_u32 s55, s55, s98
    buffer_load_dwordx4 v241, s[20:23], s59 offen offset:3072 lds
    v_exp_f32 v56, v56
    v_exp_f32 v57, v57
    v_exp_f32 v58, v58
    v_smfmac_f32_32x32x32_bf16 v[128:143], a[88:91], v[48:55], v236
    s_waitcnt lgkmcnt(0)
    v_add_f32 v108, v108, v118
    v_add_f32 v109, v109, v119
    v_add_f32 v110, v110, v120
    v_add_f32 v111, v111, v121
    v_add_f32 v112, v112, v122
    v_add_f32 v113, v113, v123
    v_add_f32 v114, v114, v124
    v_add_f32 v115, v115, v125
    v_add_f32 v116, v116, v126
    v_add_f32 v117, v117, v127
    ds_read_b128 v[118:121], v244 offset:7680
    ds_read_b128 v[122:125], v244 offset:8704
    ds_read_b64 v[126:127], v245 offset:9728
    v_exp_f32 v59, v59
    v_exp_f32 v60, v60
    v_exp_f32 v61, v61
    v_mfma_f32_32x32x8bf16_1k v[144:159], v[238:239], v[238:239], 0
    v_exp_f32 v62, v62
    v_exp_f32 v63, v63
    v_exp_f32 v0, v0
    v_exp_f32 v1, v1
    v_smfmac_f32_32x32x32_bf16 v[128:143], a[92:95], v[56:63], v236
    s_waitcnt lgkmcnt(0)
    v_add_f32 v108, v108, v118
    v_add_f32 v109, v109, v119
    v_add_f32 v110, v110, v120
    v_add_f32 v111, v111, v121
    v_add_f32 v112, v112, v122
    v_add_f32 v113, v113, v123
    v_add_f32 v114, v114, v124
    v_add_f32 v115, v115, v125
    v_add_f32 v116, v116, v126
    v_add_f32 v117, v117, v127
    v_rcp_f32 v118, v117
    v_maximum3_f32 v121, abs(v108), abs(v109), abs(v110)
    v_maximum3_f32 v121, abs(v111), abs(v112), v121
    v_maximum3_f32 v121, abs(v113), abs(v114), v121
    v_maximum3_f32 v121, abs(v115), abs(v116), v121
    v_fma_f32 v120, 0, v121, v117
    v_subrev_u32 v120, 0x2b800000, v120
    v_cmp_le_u32 vcc, 0x46000000, v120
    v_mul_f32 v108, v118, v108
    v_mul_f32 v109, v118, v109
    v_mul_f32 v110, v118, v110
    v_mul_f32 v111, v118, v111
    v_mul_f32 v112, v118, v112
    v_mul_f32 v113, v118, v113
    v_mul_f32 v114, v118, v114
    v_mul_f32 v115, v118, v115
    v_mul_f32 v116, v118, v116
    s_or_b64 s[34:35], s[34:35], vcc
    v_cvt_pk_bf16_f32 v108, v108, v109
    v_cvt_pk_bf16_f32 v109, v110, v111
    v_cvt_pk_bf16_f32 v110, v112, v113
    v_cvt_pk_bf16_f32 v111, v114, v115
    v_cvt_pk_bf16_f32 v116, v116, v116
    v_exp_f32 v2, v2
    v_exp_f32 v3, v3
    v_exp_f32 v4, v4
    v_mfma_f32_32x32x4bf16_1k v[32:63], a[198:199], a[248:249], 0
    v_exp_f32 v5, v5
    v_exp_f32 v6, v6
    v_exp_f32 v7, v7
    v_exp_f32 v8, v8
    v_exp_f32 v9, v9
    v_exp_f32 v10, v10
    v_exp_f32 v11, v11
    v_exp_f32 v12, v12
    v_smfmac_f32_32x32x32_bf16 v[128:143], a[96:99], v[0:7], v236
HOP1_2:
    s_cbranch_execz HOPRET1
    ds_write_b128 v248, v[108:111] offset:40960
    v_exp_f32 v13, v13
    v_exp_f32 v14, v14
    v_exp_f32 v15, v15
    v_exp_f32 v16, v16
    v_exp_f32 v17, v17
    v_smfmac_f32_32x32x32_bf16 v[128:143], a[100:103], v[8:15], v236
    ds_write_b16 v249, v116 offset:49152
    v_exp_f32 v18, v18
    v_exp_f32 v19, v19
    v_exp_f32 v20, v20
    v_mfma_f32_32x32x16_bf16 v[32:47], a[24:27], a[224:227], v[32:47]
    buffer_store_dwordx4 v[164:167], v241, s[20:23], s55 offen sc1
    v_exp_f32 v21, v21
    v_exp_f32 v22, v22
    v_exp_f32 v23, v23
    v_mfma_f32_32x32x16_bf16 v[48:63], a[28:31], a[224:227], v[48:63]
    s_waitcnt lgkmcnt(0)
    s_barrier
    ds_read_b128 v[100:103], v241 offset:40960
    v_exp_f32 v24, v24
    v_exp_f32 v25, v25
    v_exp_f32 v26, v26
    v_smfmac_f32_32x32x32_bf16 v[128:143], a[104:107], v[16:23], v236
    ds_read_b64_tr_b16 v[160:161], v216 offset:12288
    v_exp_f32 v27, v27
    v_exp_f32 v28, v28
    v_exp_f32 v29, v29
    v_exp_f32 v30, v30
    v_exp_f32 v31, v31
    v_exp_f32 v32, v32
    v_exp_f32 v33, v33
    v_smfmac_f32_32x32x32_bf16 v[128:143], a[108:111], v[24:31], v236
    ds_read_b64_tr_b16 v[162:163], v216 offset:14336
    v_exp_f32 v34, v34
    v_exp_f32 v35, v35
    v_exp_f32 v36, v36
    v_mfma_f32_32x32x4bf16_1k v[0:31], a[200:201], a[248:249], 0
    v_exp_f32 v37, v37
    v_exp_f32 v38, v38
    v_exp_f32 v39, v39
    v_exp_f32 v40, v40
    v_exp_f32 v41, v41
    v_exp_f32 v42, v42
    v_exp_f32 v43, v43
    v_exp_f32 v44, v44
    v_smfmac_f32_32x32x32_bf16 v[128:143], a[112:115], v[32:39], v236
    ds_read_b64_tr_b16 v[164:165], v217 offset:12288
    v_exp_f32 v45, v45
    v_exp_f32 v46, v46
    v_exp_f32 v47, v47
    v_exp_f32 v48, v48
    v_exp_f32 v49, v49
    v_smfmac_f32_32x32x32_bf16 v[128:143], a[116:119], v[40:47], v236
    ds_read_b64_tr_b16 v[166:167], v217 offset:14336
    v_exp_f32 v50, v50
    v_exp_f32 v51, v51
    v_exp_f32 v52, v52
    v_mfma_f32_32x32x16_bf16 v[0:15], a[32:35], a[224:227], v[0:15]
    v_exp_f32 v53, v53
    v_exp_f32 v54, v54
    v_exp_f32 v55, v55
    v_mfma_f32_32x32x16_bf16 v[16:31], a[36:39], a[224:227], v[16:31]
    s_waitcnt lgkmcnt(0)
    buffer_store_dwordx4 v[160:163], v241, s[20:23], s95 offen sc1
    v_exp_f32 v56, v56
    v_exp_f32 v57, v57
    v_exp_f32 v58, v58
    v_smfmac_f32_32x32x32_bf16 v[128:143], a[120:123], v[48:55], v236
    s_waitcnt vmcnt(45)
    s_add_u32 s53, s46, 16384
    v_exp_f32 v59, v59
    v_exp_f32 v60, v60
    v_exp_f32 v61, v61
    v_exp_f32 v62, v62
    v_exp_f32 v63, v63
    v_exp_f32 v0, v0
    v_exp_f32 v1, v1
    v_smfmac_f32_32x32x32_bf16 v[128:143], a[124:127], v[56:63], v236
    s_add_u32 s55, s95, s99
    v_exp_f32 v2, v2
    v_exp_f32 v3, v3
    v_exp_f32 v4, v4
    v_mfma_f32_32x32x4bf16_1k v[32:63], a[202:203], a[248:249], 0
    v_exp_f32 v5, v5
    v_exp_f32 v6, v6
    v_exp_f32 v7, v7
    v_exp_f32 v8, v8
    v_exp_f32 v9, v9
    v_exp_f32 v10, v10
    v_exp_f32 v11, v11
    v_exp_f32 v12, v12
    v_smfmac_f32_32x32x32_bf16 v[128:143], a[128:131], v[0:7], v236
    buffer_store_dwordx4 v[164:167], v241, s[20:23], s55 offen sc1
    v_exp_f32 v13, v13
    v_exp_f32 v14, v14
    v_exp_f32 v15, v15
    v_smfmac_f32_16x16x64_bf16 v[64:67], v[100:103], v[168:175], v237
    ds_read_b64_tr_b16 v[160:161], v218 offset:12288
    buffer_load_dwordx4 v[168:171], v241, s[20:23], s53 offen offset:0 sc1
    buffer_load_dwordx4 v[172:175], v241, s[20:23], s53 offen offset:1024 sc1
    v_exp_f32 v16, v16
    v_exp_f32 v17, v17
    v_smfmac_f32_32x32x32_bf16 v[128:143], a[132:135], v[8:15], v236
    ds_read_b64_tr_b16 v[162:163], v218 offset:14336
    v_exp_f32 v18, v18
    v_exp_f32 v19, v19
    v_exp_f32 v20, v20
    v_mfma_f32_32x32x16_bf16 v[32:47], a[40:43], a[224:227], v[32:47]
    ds_read_b64_tr_b16 v[164:165], v219 offset:12288
    v_exp_f32 v21, v21
    v_exp_f32 v22, v22
    v_exp_f32 v23, v23
    v_mfma_f32_32x32x16_bf16 v[48:63], a[44:47], a[224:227], v[48:63]
    ds_read_b64_tr_b16 v[166:167], v219 offset:14336
    v_exp_f32 v24, v24
    v_exp_f32 v25, v25
    v_exp_f32 v26, v26
    v_smfmac_f32_32x32x32_bf16 v[128:143], a[136:139], v[16:23], v236
    s_waitcnt vmcnt(40)
    v_exp_f32 v27, v27
    v_exp_f32 v28, v28
    v_exp_f32 v29, v29
    v_smfmac_f32_16x16x64_bf16 v[68:71], v[100:103], v[176:183], v237
    s_add_u32 s55, s55, s99
    buffer_load_dwordx4 v[176:179], v241, s[20:23], s53 offen offset:2048 sc1
    buffer_load_dwordx4 v[180:183], v241, s[20:23], s53 offen offset:3072 sc1
    s_add_u32 s53, s46, 20480
    v_exp_f32 v30, v30
    v_exp_f32 v31, v31
    v_exp_f32 v32, v32
    v_exp_f32 v33, v33
    v_smfmac_f32_32x32x32_bf16 v[128:143], a[140:143], v[24:31], v236
    s_waitcnt lgkmcnt(0)
    v_exp_f32 v34, v34
    v_exp_f32 v35, v35
    v_exp_f32 v36, v36
    v_mfma_f32_32x32x4bf16_1k v[0:31], a[204:205], a[248:249], 0
    v_exp_f32 v37, v37
    v_exp_f32 v38, v38
    v_exp_f32 v39, v39
    v_exp_f32 v40, v40
    v_exp_f32 v41, v41
    v_exp_f32 v42, v42
    v_exp_f32 v43, v43
    v_exp_f32 v44, v44
    v_smfmac_f32_32x32x32_bf16 v[128:143], a[144:147], v[32:39], v236
    buffer_store_dwordx4 v[160:163], v241, s[20:23], s55 offen sc1
    v_exp_f32 v45, v45
    v_exp_f32 v46, v46
    v_exp_f32 v47, v47
    v_smfmac_f32_16x16x64_bf16 v[72:75], v[100:103], v[184:191], v237
    ds_read_b128 v[104:107], v241 offset:41984
    v_exp_f32 v48, v48
    v_exp_f32 v49, v49
    v_smfmac_f32_32x32x32_bf16 v[128:143], a[148:151], v[40:47], v236
    s_add_u32 s55, s55, s99
    v_exp_f32 v50, v50
    v_exp_f32 v51, v51
    v_exp_f32 v52, v52
    v_mfma_f32_32x32x16_bf16 v[0:15], a[48:51], a[224:227], v[0:15]
    buffer_store_dwordx4 v[164:167], v241, s[20:23], s55 offen sc1
    v_exp_f32 v53, v53
    v_exp_f32 v54, v54
    v_exp_f32 v55, v55
    v_mfma_f32_32x32x16_bf16 v[16:31], a[52:55], a[224:227], v[16:31]
    buffer_load_dwordx4 v[184:187], v241, s[20:23], s53 offen offset:0 sc1
    v_exp_f32 v56, v56
    v_exp_f32 v57, v57
    v_exp_f32 v58, v58
    v_smfmac_f32_32x32x32_bf16 v[128:143], a[152:155], v[48:55], v236
    s_waitcnt vmcnt(39)
    v_exp_f32 v59, v59
    v_exp_f32 v60, v60
    v_exp_f32 v61, v61
    v_smfmac_f32_16x16x64_bf16 v[76:79], v[100:103], v[192:199], v237
    buffer_load_dwordx4 v[188:191], v241, s[20:23], s53 offen offset:1024 sc1
    v_exp_f32 v62, v62
    v_exp_f32 v63, v63
    v_exp_f32 v0, v0
    v_exp_f32 v1, v1
    v_smfmac_f32_32x32x32_bf16 v[128:143], a[156:159], v[56:63], v236
    buffer_load_dwordx4 v[192:195], v241, s[20:23], s53 offen offset:2048 sc1
    v_exp_f32 v2, v2
    v_exp_f32 v3, v3
    v_exp_f32 v4, v4
    v_mfma_f32_32x32x4bf16_1k v[32:63], a[206:207], a[248:249], 0
    v_exp_f32 v5, v5
    v_exp_f32 v6, v6
    v_exp_f32 v7, v7
    v_exp_f32 v8, v8
    v_exp_f32 v9, v9
    v_exp_f32 v10, v10
    v_exp_f32 v11, v11
    v_exp_f32 v12, v12
    v_smfmac_f32_32x32x32_bf16 v[128:143], a[160:163], v[0:7], v236
    buffer_load_dwordx4 v[196:199], v241, s[20:23], s53 offen offset:3072 sc1
    v_exp_f32 v13, v13
    v_exp_f32 v14, v14
    v_exp_f32 v15, v15
    v_smfmac_f32_16x16x64_bf16 v[80:83], v[100:103], v[200:207], v237
    s_add_u32 s53, s46, 24576
    v_exp_f32 v16, v16
    v_exp_f32 v17, v17
    v_smfmac_f32_32x32x32_bf16 v[128:143], a[164:167], v[8:15], v236
    buffer_load_dwordx4 v[200:203], v241, s[20:23], s53 offen offset:0 sc1
    v_exp_f32 v18, v18
    v_exp_f32 v19, v19
    v_exp_f32 v20, v20
    v_mfma_f32_32x32x16_bf16 v[32:47], a[56:59], a[224:227], v[32:47]
    buffer_load_dwordx4 v[204:207], v241, s[20:23], s53 offen offset:1024 sc1
    v_exp_f32 v21, v21
    v_exp_f32 v22, v22
    v_exp_f32 v23, v23
    v_mfma_f32_32x32x16_bf16 v[48:63], a[60:63], a[224:227], v[48:63]
    buffer_load_dwordx4 v[160:163], v241, s[20:23], s53 offen offset:2048 sc1
    v_exp_f32 v24, v24
    v_exp_f32 v25, v25
    v_exp_f32 v26, v26
    v_smfmac_f32_32x32x32_bf16 v[128:143], a[168:171], v[16:23], v236
    s_waitcnt vmcnt(29)
    v_exp_f32 v27, v27
    v_exp_f32 v28, v28
    v_exp_f32 v29, v29
    v_smfmac_f32_16x16x64_bf16 v[84:87], v[100:103], v[208:215], v237
    buffer_load_dwordx4 v[164:167], v241, s[20:23], s53 offen offset:3072 sc1
    v_exp_f32 v30, v30
    v_exp_f32 v31, v31
    v_exp_f32 v32, v32
    v_exp_f32 v33, v33
    v_smfmac_f32_32x32x32_bf16 v[128:143], a[172:175], v[24:31], v236
    s_add_u32 s53, s46, 28672
    v_exp_f32 v34, v34
    v_exp_f32 v35, v35
    v_exp_f32 v36, v36
    v_mfma_f32_32x32x4bf16_1k v[0:31], a[192:193], a[250:251], 0
    v_exp_f32 v37, v37
    v_exp_f32 v38, v38
    v_exp_f32 v39, v39
    v_exp_f32 v40, v40
    v_exp_f32 v41, v41
    v_exp_f32 v42, v42
    v_exp_f32 v43, v43
    v_exp_f32 v44, v44
    v_smfmac_f32_32x32x32_bf16 v[128:143], a[176:179], v[32:39], v236
    buffer_load_dwordx4 v[216:219], v241, s[20:23], s53 offen offset:0 sc1
    v_exp_f32 v45, v45
    v_exp_f32 v46, v46
    v_exp_f32 v47, v47
    v_smfmac_f32_16x16x64_bf16 v[88:91], v[100:103], a[208:215], v237
    buffer_load_dwordx4 v[220:223], v241, s[20:23], s53 offen offset:1024 sc1
    v_exp_f32 v48, v48
    v_exp_f32 v49, v49
    v_smfmac_f32_32x32x32_bf16 v[128:143], a[180:183], v[40:47], v236
    buffer_load_dwordx4 v[208:211], v241, s[20:23], s53 offen offset:2048 sc1
    v_exp_f32 v50, v50
    v_exp_f32 v51, v51
    v_exp_f32 v52, v52
    v_mfma_f32_32x32x16_bf16 v[0:15], a[0:3], a[228:231], v[0:15]
    buffer_load_dwordx4 v[212:215], v241, s[20:23], s53 offen offset:3072 sc1
    v_exp_f32 v53, v53
    v_exp_f32 v54, v54
    v_exp_f32 v55, v55
    v_mfma_f32_32x32x16_bf16 v[16:31], a[4:7], a[228:231], v[16:31]
    s_add_u32 s53, s46, 32768
    v_exp_f32 v56, v56
    v_exp_f32 v57, v57
    v_exp_f32 v58, v58
    v_smfmac_f32_32x32x32_bf16 v[128:143], a[184:187], v[48:55], v236
    s_waitcnt vmcnt(14) lgkmcnt(0)
    v_exp_f32 v59, v59
    v_exp_f32 v60, v60
    v_exp_f32 v61, v61
    v_smfmac_f32_16x16x64_bf16 v[92:95], v[100:103], a[216:223], v237
    buffer_load_dwordx4 a[208:211], v241, s[20:23], s53 offen offset:0 sc1
    v_exp_f32 v62, v62
    v_exp_f32 v63, v63
    v_exp_f32 v0, v0
    v_exp_f32 v1, v1
    v_smfmac_f32_32x32x32_bf16 v[128:143], a[188:191], v[56:63], v236
    buffer_load_dwordx4 a[212:215], v241, s[20:23], s53 offen offset:1024 sc1
    buffer_load_dwordx4 a[216:219], v241, s[20:23], s53 offen offset:2048 sc1
    buffer_load_dwordx4 a[220:223], v241, s[20:23], s53 offen offset:3072 sc1
    s_add_u32 s53, s46, 36864
    v_exp_f32 v2, v2
    v_exp_f32 v3, v3
    v_exp_f32 v4, v4
    v_mfma_f32_32x32x4bf16_1k v[32:63], a[194:195], a[250:251], 0
    v_exp_f32 v5, v5
    v_exp_f32 v6, v6
    v_exp_f32 v7, v7
    v_exp_f32 v8, v8
    v_exp_f32 v9, v9
    v_exp_f32 v10, v10
    v_exp_f32 v11, v11
    v_exp_f32 v12, v12
    v_smfmac_f32_32x32x32_bf16 v[144:159], a[64:67], v[0:7], v236
    ds_write_b128 v242, v[128:131] offset:0
    v_exp_f32 v13, v13
    v_exp_f32 v14, v14
    v_exp_f32 v15, v15
    v_smfmac_f32_16x16x64_bf16 v[96:99], v[100:103], v[168:175], v237
    ds_write_b128 v242, v[132:135] offset:1024
    v_exp_f32 v16, v16
    v_exp_f32 v17, v17
    v_smfmac_f32_32x32x32_bf16 v[144:159], a[68:71], v[8:15], v236
    ds_write_b64 v243, v[136:137] offset:2048
    v_exp_f32 v18, v18
    v_exp_f32 v19, v19
    v_exp_f32 v20, v20
    v_mfma_f32_32x32x16_bf16 v[32:47], a[8:11], a[228:231], v[32:47]
    buffer_load_dwordx4 v[168:171], v241, s[20:23], s53 offen offset:0 sc1
    v_exp_f32 v21, v21
    v_exp_f32 v22, v22
    v_exp_f32 v23, v23
    v_mfma_f32_32x32x16_bf16 v[48:63], a[12:15], a[228:231], v[48:63]
    buffer_load_dwordx4 v[172:175], v241, s[20:23], s53 offen offset:1024 sc1
    v_exp_f32 v24, v24
    v_exp_f32 v25, v25
    v_exp_f32 v26, v26
    v_smfmac_f32_32x32x32_bf16 v[144:159], a[72:75], v[16:23], v236
    s_waitcnt vmcnt(16)
    v_exp_f32 v27, v27
    v_exp_f32 v28, v28
    v_exp_f32 v29, v29
    v_smfmac_f32_16x16x64_bf16 v[64:67], v[104:107], v[176:183], v237
    buffer_load_dwordx4 v[176:179], v241, s[20:23], s53 offen offset:2048 sc1
    v_exp_f32 v30, v30
    v_exp_f32 v31, v31
    v_exp_f32 v32, v32
    v_exp_f32 v33, v33
    v_smfmac_f32_32x32x32_bf16 v[144:159], a[76:79], v[24:31], v236
    buffer_load_dwordx4 v[180:183], v241, s[20:23], s53 offen offset:3072 sc1
    v_exp_f32 v34, v34
    v_exp_f32 v35, v35
    v_exp_f32 v36, v36
    v_mfma_f32_32x32x4bf16_1k v[0:31], a[196:197], a[250:251], 0
    v_exp_f32 v37, v37
    v_exp_f32 v38, v38
    v_exp_f32 v39, v39
    v_exp_f32 v40, v40
    v_exp_f32 v41, v41
    v_exp_f32 v42, v42
    v_exp_f32 v43, v43
    v_exp_f32 v44, v44
    v_smfmac_f32_32x32x32_bf16 v[144:159], a[80:83], v[32:39], v236
    s_add_u32 s53, s46, 40960
    v_exp_f32 v45, v45
    v_exp_f32 v46, v46
    v_exp_f32 v47, v47
    v_smfmac_f32_16x16x64_bf16 v[68:71], v[104:107], v[184:191], v237
    buffer_load_dwordx4 v[184:187], v241, s[20:23], s53 offen offset:0 sc1
    v_exp_f32 v48, v48
    v_exp_f32 v49, v49
    v_smfmac_f32_32x32x32_bf16 v[144:159], a[84:87], v[40:47], v236
    s_waitcnt lgkmcnt(0)
    v_exp_f32 v50, v50
    v_exp_f32 v51, v51
    v_exp_f32 v52, v52
    v_mfma_f32_32x32x16_bf16 v[0:15], a[16:19], a[228:231], v[0:15]
    buffer_load_dwordx4 v[188:191], v241, s[20:23], s53 offen offset:1024 sc1
    v_exp_f32 v53, v53
    v_exp_f32 v54, v54
    v_exp_f32 v55, v55
    v_mfma_f32_32x32x16_bf16 v[16:31], a[20:23], a[228:231], v[16:31]
    v_exp_f32 v56, v56
    v_exp_f32 v57, v57
    v_exp_f32 v58, v58
    v_smfmac_f32_32x32x32_bf16 v[144:159], a[88:91], v[48:55], v236
    s_waitcnt vmcnt(16)
    v_exp_f32 v59, v59
    v_exp_f32 v60, v60
    v_exp_f32 v61, v61
    v_mfma_f32_32x32x8bf16_1k v[128:143], v[238:239], v[238:239], 0
    v_exp_f32 v62, v62
    v_exp_f32 v63, v63
    v_exp_f32 v0, v0
    v_exp_f32 v1, v1
    v_smfmac_f32_32x32x32_bf16 v[144:159], a[92:95], v[56:63], v236
    v_mov_b32 v252, s1
    s_mov_b64 exec, 1
    buffer_store_dword v252, off, s[20:23], s29 sc1
    s_mov_b64 exec, -1
    v_exp_f32 v2, v2
    v_exp_f32 v3, v3
    v_exp_f32 v4, v4
    v_mfma_f32_32x32x4bf16_1k v[32:63], a[198:199], a[250:251], 0
    v_exp_f32 v5, v5
    v_exp_f32 v6, v6
    v_exp_f32 v7, v7
    v_exp_f32 v8, v8
    v_exp_f32 v9, v9
    v_exp_f32 v10, v10
    v_exp_f32 v11, v11
    v_exp_f32 v12, v12
    v_smfmac_f32_32x32x32_bf16 v[144:159], a[96:99], v[0:7], v236
    v_exp_f32 v13, v13
    v_exp_f32 v14, v14
    v_exp_f32 v15, v15
    v_smfmac_f32_16x16x64_bf16 v[72:75], v[104:107], v[192:199], v237
    ds_read_b128 v[100:103], v241 offset:43008
    v_exp_f32 v16, v16
    v_exp_f32 v17, v17
    v_smfmac_f32_32x32x32_bf16 v[144:159], a[100:103], v[8:15], v236
    buffer_load_dwordx4 v[192:195], v241, s[20:23], s53 offen offset:2048 sc1
    v_exp_f32 v18, v18
    v_exp_f32 v19, v19
    v_exp_f32 v20, v20
    v_mfma_f32_32x32x16_bf16 v[32:47], a[24:27], a[228:231], v[32:47]
    buffer_load_dwordx4 v[196:199], v241, s[20:23], s53 offen offset:3072 sc1
    v_exp_f32 v21, v21
    v_exp_f32 v22, v22
    v_exp_f32 v23, v23
    v_mfma_f32_32x32x16_bf16 v[48:63], a[28:31], a[228:231], v[48:63]
    s_add_u32 s53, s46, 45056
    v_exp_f32 v24, v24
    v_exp_f32 v25, v25
    v_exp_f32 v26, v26
    v_smfmac_f32_32x32x32_bf16 v[144:159], a[104:107], v[16:23], v236
    s_waitcnt vmcnt(15)
    v_exp_f32 v27, v27
    v_exp_f32 v28, v28
    v_exp_f32 v29, v29
    v_smfmac_f32_16x16x64_bf16 v[76:79], v[104:107], v[200:207], v237
    buffer_load_dwordx4 v[200:203], v241, s[20:23], s53 offen offset:0 sc1
    v_exp_f32 v30, v30
    v_exp_f32 v31, v31
    v_exp_f32 v32, v32
    v_exp_f32 v33, v33
    v_smfmac_f32_32x32x32_bf16 v[144:159], a[108:111], v[24:31], v236
    buffer_load_dwordx4 v[204:207], v241, s[20:23], s53 offen offset:1024 sc1
    v_exp_f32 v34, v34
    v_exp_f32 v35, v35
    v_exp_f32 v36, v36
    v_mfma_f32_32x32x4bf16_1k v[0:31], a[200:201], a[250:251], 0
    v_exp_f32 v37, v37
    v_exp_f32 v38, v38
    v_exp_f32 v39, v39
    v_exp_f32 v40, v40
    v_exp_f32 v41, v41
    v_exp_f32 v42, v42
    v_exp_f32 v43, v43
    v_exp_f32 v44, v44
    v_smfmac_f32_32x32x32_bf16 v[144:159], a[112:115], v[32:39], v236
    v_exp_f32 v45, v45
    v_exp_f32 v46, v46
    v_exp_f32 v47, v47
    v_smfmac_f32_16x16x64_bf16 v[80:83], v[104:107], v[160:167], v237
    buffer_load_dwordx4 v[160:163], v241, s[20:23], s53 offen offset:2048 sc1
    v_exp_f32 v48, v48
    v_exp_f32 v49, v49
    v_smfmac_f32_32x32x32_bf16 v[144:159], a[116:119], v[40:47], v236
    buffer_load_dwordx4 v[164:167], v241, s[20:23], s53 offen offset:3072 sc1
    v_exp_f32 v50, v50
    v_exp_f32 v51, v51
    v_exp_f32 v52, v52
    v_mfma_f32_32x32x16_bf16 v[0:15], a[32:35], a[228:231], v[0:15]
    s_add_u32 s53, s46, 49152
    v_exp_f32 v53, v53
    v_exp_f32 v54, v54
    v_exp_f32 v55, v55
    v_mfma_f32_32x32x16_bf16 v[16:31], a[36:39], a[228:231], v[16:31]
    v_exp_f32 v56, v56
    v_exp_f32 v57, v57
    v_exp_f32 v58, v58
    v_smfmac_f32_32x32x32_bf16 v[144:159], a[120:123], v[48:55], v236
    s_waitcnt vmcnt(15)
    v_exp_f32 v59, v59
    v_exp_f32 v60, v60
    v_exp_f32 v61, v61
    v_smfmac_f32_16x16x64_bf16 v[84:87], v[104:107], v[216:223], v237
    buffer_load_dwordx4 v[216:219], v241, s[20:23], s53 offen offset:0 sc1
    buffer_load_dwordx4 v[220:223], v241, s[20:23], s53 offen offset:1024 sc1
    v_exp_f32 v62, v62
    v_exp_f32 v63, v63
    v_exp_f32 v0, v0
    v_exp_f32 v1, v1
    v_smfmac_f32_32x32x32_bf16 v[144:159], a[124:127], v[56:63], v236
    v_mov_b32 v108, -1
    v_mov_b32 v109, -1
    v_mov_b32 v110, -1
    v_mov_b32 v111, -1
    v_exp_f32 v2, v2
    v_exp_f32 v3, v3
    v_exp_f32 v4, v4
    v_mfma_f32_32x32x4bf16_1k v[32:63], a[202:203], a[250:251], 0
    v_exp_f32 v5, v5
    v_exp_f32 v6, v6
    v_exp_f32 v7, v7
    v_exp_f32 v8, v8
    v_exp_f32 v9, v9
    v_exp_f32 v10, v10
    v_exp_f32 v11, v11
    v_exp_f32 v12, v12
    v_smfmac_f32_32x32x32_bf16 v[144:159], a[128:131], v[0:7], v236
    s_mul_i32 s60, s2, 73728
    v_exp_f32 v13, v13
    v_exp_f32 v14, v14
    v_exp_f32 v15, v15
    v_smfmac_f32_16x16x64_bf16 v[88:91], v[104:107], v[208:215], v237
    s_mul_i32 s61, s32, 18432
    v_exp_f32 v16, v16
    v_exp_f32 v17, v17
    v_smfmac_f32_32x32x32_bf16 v[144:159], a[132:135], v[8:15], v236
    s_add_u32 s60, s60, s61
    v_exp_f32 v18, v18
    v_exp_f32 v19, v19
    v_exp_f32 v20, v20
    v_mfma_f32_32x32x16_bf16 v[32:47], a[40:43], a[228:231], v[32:47]
    s_add_u32 s60, s60, 27275264
    v_exp_f32 v21, v21
    v_exp_f32 v22, v22
    v_exp_f32 v23, v23
    v_mfma_f32_32x32x16_bf16 v[48:63], a[44:47], a[228:231], v[48:63]
    buffer_load_dwordx4 v[208:211], v241, s[20:23], s53 offen offset:2048 sc1
    v_exp_f32 v24, v24
    v_exp_f32 v25, v25
    v_exp_f32 v26, v26
    v_smfmac_f32_32x32x32_bf16 v[144:159], a[136:139], v[16:23], v236
    s_waitcnt vmcnt(14) lgkmcnt(0)
    v_exp_f32 v27, v27
    v_exp_f32 v28, v28
    v_exp_f32 v29, v29
    v_smfmac_f32_16x16x64_bf16 v[92:95], v[104:107], a[208:215], v237
    buffer_load_dwordx4 v[212:215], v241, s[20:23], s53 offen offset:3072 sc1
    v_exp_f32 v30, v30
    v_exp_f32 v31, v31
    v_exp_f32 v32, v32
    v_exp_f32 v33, v33
    v_smfmac_f32_32x32x32_bf16 v[144:159], a[140:143], v[24:31], v236
    s_add_u32 s53, s46, 53248
    v_exp_f32 v34, v34
    v_exp_f32 v35, v35
    v_exp_f32 v36, v36
    v_mfma_f32_32x32x4bf16_1k v[0:31], a[204:205], a[250:251], 0
    v_exp_f32 v37, v37
    v_exp_f32 v38, v38
    v_exp_f32 v39, v39
    v_exp_f32 v40, v40
    v_exp_f32 v41, v41
    v_exp_f32 v42, v42
    v_exp_f32 v43, v43
    v_exp_f32 v44, v44
    v_smfmac_f32_32x32x32_bf16 v[144:159], a[144:147], v[32:39], v236
    buffer_load_dwordx4 a[208:211], v241, s[20:23], s53 offen offset:0 sc1
    v_exp_f32 v45, v45
    v_exp_f32 v46, v46
    v_exp_f32 v47, v47
    v_smfmac_f32_16x16x64_bf16 v[96:99], v[104:107], a[216:223], v237
    buffer_load_dwordx4 a[212:215], v241, s[20:23], s53 offen offset:1024 sc1
    v_exp_f32 v48, v48
    v_exp_f32 v49, v49
    v_smfmac_f32_32x32x32_bf16 v[144:159], a[148:151], v[40:47], v236
    buffer_load_dwordx4 a[216:219], v241, s[20:23], s53 offen offset:2048 sc1
    v_exp_f32 v50, v50
    v_exp_f32 v51, v51
    v_exp_f32 v52, v52
    v_mfma_f32_32x32x16_bf16 v[0:15], a[48:51], a[228:231], v[0:15]
    buffer_load_dwordx4 a[220:223], v241, s[20:23], s53 offen offset:3072 sc1
    v_exp_f32 v53, v53
    v_exp_f32 v54, v54
    v_exp_f32 v55, v55
    v_mfma_f32_32x32x16_bf16 v[16:31], a[52:55], a[228:231], v[16:31]
    s_add_u32 s53, s46, 57344
    v_exp_f32 v56, v56
    v_exp_f32 v57, v57
    v_exp_f32 v58, v58
    v_smfmac_f32_32x32x32_bf16 v[144:159], a[152:155], v[48:55], v236
    s_waitcnt vmcnt(15)
    v_exp_f32 v59, v59
    v_exp_f32 v60, v60
    v_exp_f32 v61, v61
    v_smfmac_f32_16x16x64_bf16 v[64:67], v[100:103], v[168:175], v237
    buffer_load_dwordx4 v[168:171], v241, s[20:23], s53 offen offset:0 sc1
    v_exp_f32 v62, v62
    v_exp_f32 v63, v63
    v_exp_f32 v0, v0
    v_exp_f32 v1, v1
    v_smfmac_f32_32x32x32_bf16 v[144:159], a[156:159], v[56:63], v236
    buffer_load_dwordx4 v[172:175], v241, s[20:23], s53 offen offset:1024 sc1
    v_exp_f32 v2, v2
    v_exp_f32 v3, v3
    v_exp_f32 v4, v4
    v_mfma_f32_32x32x4bf16_1k v[32:63], a[206:207], a[250:251], 0
    v_exp_f32 v5, v5
    v_exp_f32 v6, v6
    v_exp_f32 v7, v7
    v_exp_f32 v8, v8
    v_exp_f32 v9, v9
    v_exp_f32 v10, v10
    v_exp_f32 v11, v11
    v_exp_f32 v12, v12
    v_smfmac_f32_32x32x32_bf16 v[144:159], a[160:163], v[0:7], v236
    v_exp_f32 v13, v13
    v_exp_f32 v14, v14
    v_exp_f32 v15, v15
    v_smfmac_f32_16x16x64_bf16 v[68:71], v[100:103], v[176:183], v237
    buffer_load_dwordx4 v[176:179], v241, s[20:23], s53 offen offset:2048 sc1
    v_exp_f32 v16, v16
    v_exp_f32 v17, v17
    v_smfmac_f32_32x32x32_bf16 v[144:159], a[164:167], v[8:15], v236
    buffer_load_dwordx4 v[180:183], v241, s[20:23], s53 offen offset:3072 sc1
    v_exp_f32 v18, v18
    v_exp_f32 v19, v19
    v_exp_f32 v20, v20
    v_mfma_f32_32x32x16_bf16 v[32:47], a[56:59], a[228:231], v[32:47]
    s_add_u32 s53, s46, 61440
    v_exp_f32 v21, v21
    v_exp_f32 v22, v22
    v_exp_f32 v23, v23
    v_mfma_f32_32x32x16_bf16 v[48:63], a[60:63], a[228:231], v[48:63]
    v_exp_f32 v24, v24
    v_exp_f32 v25, v25
    v_exp_f32 v26, v26
    v_smfmac_f32_32x32x32_bf16 v[144:159], a[168:171], v[16:23], v236
    s_waitcnt vmcnt(14)
    v_exp_f32 v27, v27
    v_exp_f32 v28, v28
    v_exp_f32 v29, v29
    v_smfmac_f32_16x16x64_bf16 v[72:75], v[100:103], v[184:191], v237
    ds_read_b128 v[104:107], v241 offset:44032
    v_exp_f32 v30, v30
    v_exp_f32 v31, v31
    v_exp_f32 v32, v32
    v_exp_f32 v33, v33
    v_smfmac_f32_32x32x32_bf16 v[144:159], a[172:175], v[24:31], v236
    buffer_load_dwordx2 v[252:253], v251, s[20:23], s28 offen sc1
    v_exp_f32 v34, v34
    v_exp_f32 v35, v35
    v_exp_f32 v36, v36
    v_mfma_f32_32x32x4bf16_1k v[0:31], a[192:193], a[252:253], 0
    v_exp_f32 v37, v37
    v_exp_f32 v38, v38
    v_exp_f32 v39, v39
    v_exp_f32 v40, v40
    v_exp_f32 v41, v41
    v_exp_f32 v42, v42
    v_exp_f32 v43, v43
    v_exp_f32 v44, v44
    v_smfmac_f32_32x32x32_bf16 v[144:159], a[176:179], v[32:39], v236
    buffer_load_dwordx4 v[184:187], v241, s[20:23], s53 offen offset:0 sc1
    v_exp_f32 v45, v45
    v_exp_f32 v46, v46
    v_exp_f32 v47, v47
    v_smfmac_f32_16x16x64_bf16 v[76:79], v[100:103], v[192:199], v237
    buffer_load_dwordx4 v[188:191], v241, s[20:23], s53 offen offset:1024 sc1
    v_exp_f32 v48, v48
    v_exp_f32 v49, v49
    v_smfmac_f32_32x32x32_bf16 v[144:159], a[180:183], v[40:47], v236
    buffer_load_dwordx4 a[224:227], v241, s[20:23], s53 offen offset:2048 sc1
    v_exp_f32 v50, v50
    v_exp_f32 v51, v51
    v_exp_f32 v52, v52
    v_mfma_f32_32x32x16_bf16 v[0:15], a[0:3], a[232:235], v[0:15]
    buffer_store_dwordx4 v[108:111], v241, s[20:23], s60 offen offset:0 sc1
    v_exp_f32 v53, v53
    v_exp_f32 v54, v54
    v_exp_f32 v55, v55
    v_mfma_f32_32x32x16_bf16 v[16:31], a[4:7], a[232:235], v[16:31]
    buffer_load_dwordx4 a[228:231], v241, s[20:23], s53 offen offset:3072 sc1
    v_exp_f32 v56, v56
    v_exp_f32 v57, v57
    v_exp_f32 v58, v58
    v_smfmac_f32_32x32x32_bf16 v[144:159], a[184:187], v[48:55], v236
    s_waitcnt vmcnt(16)
    v_exp_f32 v59, v59
    v_exp_f32 v60, v60
    v_exp_f32 v61, v61
    v_smfmac_f32_16x16x64_bf16 v[80:83], v[100:103], v[200:207], v237
    s_add_u32 s53, s46, 65536
    v_exp_f32 v62, v62
    v_exp_f32 v63, v63
    v_exp_f32 v0, v0
    v_exp_f32 v1, v1
    v_smfmac_f32_32x32x32_bf16 v[144:159], a[188:191], v[56:63], v236
    buffer_load_dwordx4 v[192:195], v241, s[20:23], s53 offen offset:0 sc1
    buffer_load_dwordx4 v[196:199], v241, s[20:23], s53 offen offset:1024 sc1
    buffer_load_dwordx4 v[200:203], v241, s[20:23], s53 offen offset:2048 sc1
    buffer_load_dwordx4 v[204:207], v241, s[20:23], s53 offen offset:3072 sc1
    s_add_u32 s53, s46, 69632
    v_exp_f32 v2, v2
    v_exp_f32 v3, v3
    v_exp_f32 v4, v4
    v_mfma_f32_32x32x4bf16_1k v[32:63], a[194:195], a[252:253], 0
    v_exp_f32 v5, v5
    v_exp_f32 v6, v6
    v_exp_f32 v7, v7
    v_exp_f32 v8, v8
    v_exp_f32 v9, v9
    v_exp_f32 v10, v10
    v_exp_f32 v11, v11
    v_exp_f32 v12, v12
    v_smfmac_f32_32x32x32_bf16 v[128:143], a[64:67], v[0:7], v236
    ds_write_b128 v242, v[144:147] offset:10240
    v_exp_f32 v13, v13
    v_exp_f32 v14, v14
    v_exp_f32 v15, v15
    v_smfmac_f32_16x16x64_bf16 v[84:87], v[100:103], v[160:167], v237
    ds_write_b128 v242, v[148:151] offset:11264
    v_exp_f32 v16, v16
    v_exp_f32 v17, v17
    v_smfmac_f32_32x32x32_bf16 v[128:143], a[68:71], v[8:15], v236
    ds_write_b64 v243, v[152:153] offset:12288
    v_exp_f32 v18, v18
    v_exp_f32 v19, v19
    v_exp_f32 v20, v20
    v_mfma_f32_32x32x16_bf16 v[32:47], a[8:11], a[232:235], v[32:47]
    buffer_load_dwordx4 v[160:163], v241, s[20:23], s53 offen offset:0 sc1
    v_exp_f32 v21, v21
    v_exp_f32 v22, v22
    v_exp_f32 v23, v23
    v_mfma_f32_32x32x16_bf16 v[48:63], a[12:15], a[232:235], v[48:63]
    buffer_load_dwordx4 v[164:167], v241, s[20:23], s53 offen offset:1024 sc1
    v_exp_f32 v24, v24
    v_exp_f32 v25, v25
    v_exp_f32 v26, v26
    v_smfmac_f32_32x32x32_bf16 v[128:143], a[72:75], v[16:23], v236
    s_waitcnt vmcnt(20)
    v_exp_f32 v27, v27
    v_exp_f32 v28, v28
    v_exp_f32 v29, v29
    v_smfmac_f32_16x16x64_bf16 v[88:91], v[100:103], v[216:223], v237
    buffer_load_dwordx4 v[216:219], v241, s[20:23], s53 offen offset:2048 sc1
    v_exp_f32 v30, v30
    v_exp_f32 v31, v31
    v_exp_f32 v32, v32
    v_exp_f32 v33, v33
    v_smfmac_f32_32x32x32_bf16 v[128:143], a[76:79], v[24:31], v236
    buffer_load_dwordx4 v[220:223], v241, s[20:23], s53 offen offset:3072 sc1
    v_exp_f32 v34, v34
    v_exp_f32 v35, v35
    v_exp_f32 v36, v36
    v_mfma_f32_32x32x4bf16_1k v[0:31], a[192:193], a[254:255], 0
    v_exp_f32 v37, v37
    v_exp_f32 v38, v38
    v_exp_f32 v39, v39
    v_exp_f32 v40, v40
    v_exp_f32 v41, v41
    v_exp_f32 v42, v42
    v_exp_f32 v43, v43
    v_exp_f32 v44, v44
    v_smfmac_f32_32x32x32_bf16 v[128:143], a[80:83], v[32:39], v236
    v_exp_f32 v45, v45
    v_exp_f32 v46, v46
    v_exp_f32 v47, v47
    v_smfmac_f32_16x16x64_bf16 v[92:95], v[100:103], v[208:215], v237
    v_exp_f32 v48, v48
    v_exp_f32 v49, v49
    v_smfmac_f32_32x32x32_bf16 v[128:143], a[84:87], v[40:47], v236
    s_waitcnt lgkmcnt(0)
    v_exp_f32 v50, v50
    v_exp_f32 v51, v51
    v_exp_f32 v52, v52
    v_mfma_f32_32x32x16_bf16 v[0:15], a[0:3], a[236:239], v[0:15]
    s_add_u32 s53, s46, 73728
    v_exp_f32 v53, v53
    v_exp_f32 v54, v54
    v_exp_f32 v55, v55
    v_mfma_f32_32x32x16_bf16 v[16:31], a[4:7], a[236:239], v[16:31]
    v_exp_f32 v56, v56
    v_exp_f32 v57, v57
    v_exp_f32 v58, v58
    v_smfmac_f32_32x32x32_bf16 v[128:143], a[88:91], v[48:55], v236
    s_waitcnt vmcnt(18)
    v_exp_f32 v59, v59
    v_exp_f32 v60, v60
    v_exp_f32 v61, v61
    v_mfma_f32_32x32x8bf16_1k v[144:159], v[238:239], v[238:239], 0
    v_exp_f32 v62, v62
    v_exp_f32 v63, v63
    v_exp_f32 v0, v0
    v_exp_f32 v1, v1
    v_smfmac_f32_32x32x32_bf16 v[128:143], a[92:95], v[56:63], v236
    buffer_load_dwordx4 v[208:211], v241, s[20:23], s53 offen offset:0 sc1
    v_exp_f32 v2, v2
    v_exp_f32 v3, v3
    v_exp_f32 v4, v4
    v_mfma_f32_32x32x4bf16_1k v[32:63], a[194:195], a[254:255], 0
HOP1_3:
    s_cbranch_execz HOPRET1
    v_exp_f32 v5, v5
    v_exp_f32 v6, v6
    v_exp_f32 v7, v7
    v_exp_f32 v8, v8
    v_exp_f32 v9, v9
    v_exp_f32 v10, v10
    v_exp_f32 v11, v11
    v_exp_f32 v12, v12
    v_smfmac_f32_32x32x32_bf16 v[144:159], a[64:67], v[0:7], v236
    buffer_load_dwordx4 v[212:215], v241, s[20:23], s53 offen offset:1024 sc1
    v_exp_f32 v13, v13
    v_exp_f32 v14, v14
    v_exp_f32 v15, v15
    v_smfmac_f32_16x16x64_bf16 v[96:99], v[100:103], a[208:215], v237
    v_exp_f32 v16, v16
    v_exp_f32 v17, v17
    v_smfmac_f32_32x32x32_bf16 v[144:159], a[68:71], v[8:15], v236
    buffer_load_dwordx4 a[0:3], v241, s[20:23], s53 offen offset:2048 sc1
    v_exp_f32 v18, v18
    v_exp_f32 v19, v19
    v_exp_f32 v20, v20
    v_mfma_f32_32x32x16_bf16 v[32:47], a[8:11], a[236:239], v[32:47]
    buffer_store_dwordx4 v[108:111], v241, s[20:23], s60 offen offset:1024 sc1
    v_exp_f32 v21, v21
    v_exp_f32 v22, v22
    v_exp_f32 v23, v23
    v_mfma_f32_32x32x16_bf16 v[48:63], a[12:15], a[236:239], v[48:63]
    buffer_load_dwordx4 a[4:7], v241, s[20:23], s53 offen offset:3072 sc1
    v_exp_f32 v24, v24
    v_exp_f32 v25, v25
    v_exp_f32 v26, v26
    v_smfmac_f32_32x32x32_bf16 v[144:159], a[72:75], v[16:23], v236
    s_waitcnt vmcnt(19)
    v_exp_f32 v27, v27
    v_exp_f32 v28, v28
    v_exp_f32 v29, v29
    v_smfmac_f32_16x16x64_bf16 v[64:67], v[104:107], a[216:223], v237
    s_add_u32 s53, s46, 77824
    v_exp_f32 v30, v30
    v_exp_f32 v31, v31
    v_exp_f32 v32, v32
    v_exp_f32 v33, v33
    v_smfmac_f32_32x32x32_bf16 v[144:159], a[76:79], v[24:31], v236
    s_waitcnt vmcnt(18)
    v_cmp_ne_u64 vcc, s[0:1], v[252:253]
    s_nop 0
    s_cbranch_vccnz KF_S0_SPIN
KF_S0_OK:
    v_exp_f32 v34, v34
    v_exp_f32 v35, v35
    v_exp_f32 v36, v36
    v_mfma_f32_32x32x4bf16_1k v[0:31], a[196:197], a[252:253], 0
    v_exp_f32 v37, v37
    v_exp_f32 v38, v38
    v_exp_f32 v39, v39
    v_exp_f32 v40, v40
    v_exp_f32 v41, v41
    v_exp_f32 v42, v42
    v_exp_f32 v43, v43
    v_exp_f32 v44, v44
    v_smfmac_f32_32x32x32_bf16 v[144:159], a[80:83], v[32:39], v236
    buffer_load_dwordx4 a[208:211], v241, s[20:23], s53 offen offset:0 sc1
    v_exp_f32 v45, v45
    v_exp_f32 v46, v46
    v_exp_f32 v47, v47
    v_smfmac_f32_16x16x64_bf16 v[68:71], v[104:107], v[168:175], v237
    buffer_load_dwordx4 a[212:215], v241, s[20:23], s53 offen offset:1024 sc1
    v_exp_f32 v48, v48
    v_exp_f32 v49, v49
    v_smfmac_f32_32x32x32_bf16 v[144:159], a[84:87], v[40:47], v236
    buffer_load_dwordx4 a[64:67], v241, s[20:23], s53 offen offset:2048 sc1
    v_exp_f32 v50, v50
    v_exp_f32 v51, v51
    v_exp_f32 v52, v52
    v_mfma_f32_32x32x16_bf16 v[0:15], a[16:19], a[232:235], v[0:15]
    buffer_load_dwordx4 a[68:71], v241, s[20:23], s53 offen offset:3072 sc1
    v_exp_f32 v53, v53
    v_exp_f32 v54, v54
    v_exp_f32 v55, v55
    v_mfma_f32_32x32x16_bf16 v[16:31], a[20:23], a[232:235], v[16:31]
    s_add_u32 s53, s46, 81920
    v_exp_f32 v56, v56
    v_exp_f32 v57, v57
    v_exp_f32 v58, v58
    v_smfmac_f32_32x32x32_bf16 v[144:159], a[88:91], v[48:55], v236
    s_waitcnt vmcnt(17)
    v_exp_f32 v59, v59
    v_exp_f32 v60, v60
    v_exp_f32 v61, v61
    v_smfmac_f32_16x16x64_bf16 v[72:75], v[104:107], v[176:183], v237
    buffer_load_dwordx4 a[8:11], v241, s[20:23], s53 offen offset:0 sc1
    v_exp_f32 v62, v62
    v_exp_f32 v63, v63
    v_exp_f32 v0, v0
    v_exp_f32 v1, v1
    v_smfmac_f32_32x32x32_bf16 v[144:159], a[92:95], v[56:63], v236
    buffer_load_dwordx4 a[12:15], v241, s[20:23], s53 offen offset:1024 sc1
    v_exp_f32 v2, v2
    v_exp_f32 v3, v3
    v_exp_f32 v4, v4
    v_mfma_f32_32x32x4bf16_1k v[32:63], a[196:197], a[254:255], 0
    v_exp_f32 v5, v5
    v_exp_f32 v6, v6
    v_exp_f32 v7, v7
    v_exp_f32 v8, v8
    v_exp_f32 v9, v9
    v_exp_f32 v10, v10
    v_exp_f32 v11, v11
    v_exp_f32 v12, v12
    v_smfmac_f32_32x32x32_bf16 v[128:143], a[96:99], v[0:7], v236
    buffer_load_dwordx4 a[216:219], v241, s[20:23], s53 offen offset:2048 sc1
    v_exp_f32 v13, v13
    v_exp_f32 v14, v14
    v_exp_f32 v15, v15
    v_smfmac_f32_16x16x64_bf16 v[76:79], v[104:107], v[184:191], v237
    buffer_load_dwordx4 a[220:223], v241, s[20:23], s53 offen offset:3072 sc1
    v_exp_f32 v16, v16
    v_exp_f32 v17, v17
    v_smfmac_f32_32x32x32_bf16 v[128:143], a[100:103], v[8:15], v236
    s_add_u32 s53, s46, 86016
    v_exp_f32 v18, v18
    v_exp_f32 v19, v19
    v_exp_f32 v20, v20
    v_mfma_f32_32x32x16_bf16 v[32:47], a[16:19], a[236:239], v[32:47]
    buffer_load_dwordx4 a[72:75], v241, s[20:23], s53 offen offset:0 sc1
    v_exp_f32 v21, v21
    v_exp_f32 v22, v22
    v_exp_f32 v23, v23
    v_mfma_f32_32x32x16_bf16 v[48:63], a[20:23], a[236:239], v[48:63]
    buffer_load_dwordx4 a[76:79], v241, s[20:23], s53 offen offset:1024 sc1
    v_exp_f32 v24, v24
    v_exp_f32 v25, v25
    v_exp_f32 v26, v26
    v_smfmac_f32_32x32x32_bf16 v[128:143], a[104:107], v[16:23], v236
    s_waitcnt vmcnt(19)
    v_exp_f32 v27, v27
    v_exp_f32 v28, v28
    v_exp_f32 v29, v29
    v_smfmac_f32_16x16x64_bf16 v[80:83], v[104:107], a[224:231], v237
    buffer_load_dwordx4 v[168:171], v241, s[20:23], s53 offen offset:2048 sc1
    buffer_load_dwordx4 v[172:175], v241, s[20:23], s53 offen offset:3072 sc1
    s_add_u32 s53, s46, 90112
    v_exp_f32 v30, v30
    v_exp_f32 v31, v31
    v_exp_f32 v32, v32
    v_exp_f32 v33, v33
    v_smfmac_f32_32x32x32_bf16 v[128:143], a[108:111], v[24:31], v236
    s_load_dwordx2 s[62:63], s[12:13], 0
    v_exp_f32 v34, v34
    v_exp_f32 v35, v35
    v_exp_f32 v36, v36
    v_mfma_f32_32x32x4bf16_1k v[0:31], a[198:199], a[252:253], 0
    v_exp_f32 v37, v37
    v_exp_f32 v38, v38
    v_exp_f32 v39, v39
    v_exp_f32 v40, v40
    v_exp_f32 v41, v41
    v_exp_f32 v42, v42
    v_exp_f32 v43, v43
    v_exp_f32 v44, v44
    v_smfmac_f32_32x32x32_bf16 v[144:159], a[96:99], v[32:39], v236
    s_load_dwordx2 s[62:63], s[12:13], 128
    v_exp_f32 v45, v45
    v_exp_f32 v46, v46
    v_exp_f32 v47, v47
    v_smfmac_f32_16x16x64_bf16 v[84:87], v[104:107], v[192:199], v237
    s_load_dwordx2 s[62:63], s[12:13], 256
    v_exp_f32 v48, v48
    v_exp_f32 v49, v49
    v_smfmac_f32_32x32x32_bf16 v[144:159], a[100:103], v[40:47], v236
    buffer_load_dwordx4 a[80:83], v241, s[20:23], s53 offen offset:0 sc1
    v_exp_f32 v50, v50
    v_exp_f32 v51, v51
    v_exp_f32 v52, v52
    v_mfma_f32_32x32x16_bf16 v[0:15], a[24:27], a[232:235], v[0:15]
    buffer_store_dwordx4 v[108:111], v241, s[20:23], s60 offen offset:2048 sc1
    v_exp_f32 v53, v53
    v_exp_f32 v54, v54
    v_exp_f32 v55, v55
    v_mfma_f32_32x32x16_bf16 v[16:31], a[28:31], a[232:235], v[16:31]
    buffer_load_dwordx4 a[84:87], v241, s[20:23], s53 offen offset:1024 sc1
    v_exp_f32 v56, v56
    v_exp_f32 v57, v57
    v_exp_f32 v58, v58
    v_smfmac_f32_32x32x32_bf16 v[144:159], a[104:107], v[48:55], v236
    s_waitcnt vmcnt(20)
    v_exp_f32 v59, v59
    v_exp_f32 v60, v60
    v_exp_f32 v61, v61
    v_smfmac_f32_16x16x64_bf16 v[88:91], v[104:107], v[200:207], v237
    buffer_load_dwordx4 v[176:179], v241, s[20:23], s53 offen offset:2048 sc1
    v_exp_f32 v62, v62
    v_exp_f32 v63, v63
    v_exp_f32 v0, v0
    v_exp_f32 v1, v1
    v_smfmac_f32_32x32x32_bf16 v[144:159], a[108:111], v[56:63], v236
    buffer_load_dwordx4 v[180:183], v241, s[20:23], s53 offen offset:3072 sc1
    v_exp_f32 v2, v2
    v_exp_f32 v3, v3
    v_exp_f32 v4, v4
    v_mfma_f32_32x32x4bf16_1k v[32:63], a[198:199], a[254:255], 0
    v_exp_f32 v5, v5
    v_exp_f32 v6, v6
    v_exp_f32 v7, v7
    v_exp_f32 v8, v8
    v_exp_f32 v9, v9
    v_exp_f32 v10, v10
    v_exp_f32 v11, v11
    v_exp_f32 v12, v12
    v_smfmac_f32_32x32x32_bf16 v[128:143], a[112:115], v[0:7], v236
    s_add_u32 s53, s46, 94208
    v_exp_f32 v13, v13
    v_exp_f32 v14, v14
    v_exp_f32 v15, v15
    v_smfmac_f32_16x16x64_bf16 v[92:95], v[104:107], v[160:167], v237
    buffer_load_dwordx4 a[88:91], v241, s[20:23], s53 offen offset:0 sc1
    v_exp_f32 v16, v16
    v_exp_f32 v17, v17
    v_smfmac_f32_32x32x32_bf16 v[128:143], a[116:119], v[8:15], v236
    buffer_load_dwordx4 a[92:95], v241, s[20:23], s53 offen offset:1024 sc1
    v_exp_f32 v18, v18
    v_exp_f32 v19, v19
    v_exp_f32 v20, v20
    v_mfma_f32_32x32x16_bf16 v[32:47], a[24:27], a[236:239], v[32:47]
    buffer_load_dwordx4 v[184:187], v241, s[20:23], s53 offen offset:2048 sc1
    v_exp_f32 v21, v21
    v_exp_f32 v22, v22
    v_exp_f32 v23, v23
    v_mfma_f32_32x32x16_bf16 v[48:63], a[28:31], a[236:239], v[48:63]
    buffer_load_dwordx4 v[188:191], v241, s[20:23], s53 offen offset:3072 sc1
    v_exp_f32 v24, v24
    v_exp_f32 v25, v25
    v_exp_f32 v26, v26
    v_smfmac_f32_32x32x32_bf16 v[128:143], a[120:123], v[16:23], v236
    s_add_u32 s53, s46, 98304
    v_exp_f32 v27, v27
    v_exp_f32 v28, v28
    v_exp_f32 v29, v29
    v_smfmac_f32_16x16x64_bf16 v[96:99], v[104:107], v[216:223], v237
    buffer_load_dwordx4 a[16:19], v241, s[20:23], s53 offen offset:0 sc1
    v_exp_f32 v30, v30
    v_exp_f32 v31, v31
    v_exp_f32 v32, v32
    v_exp_f32 v33, v33
    v_smfmac_f32_32x32x32_bf16 v[128:143], a[124:127], v[24:31], v236
    buffer_load_dwordx4 a[20:23], v241, s[20:23], s53 offen offset:1024 sc1
    v_exp_f32 v34, v34
    v_exp_f32 v35, v35
    v_exp_f32 v36, v36
    v_mfma_f32_32x32x4bf16_1k v[0:31], a[200:201], a[252:253], 0
    v_exp_f32 v37, v37
    v_exp_f32 v38, v38
    v_exp_f32 v39, v39
    v_exp_f32 v40, v40
    v_exp_f32 v41, v41
    v_exp_f32 v42, v42
    v_exp_f32 v43, v43
    v_exp_f32 v44, v44
    v_smfmac_f32_32x32x32_bf16 v[144:159], a[112:115], v[32:39], v236
    buffer_load_dwordx4 a[224:227], v241, s[20:23], s53 offen offset:2048 sc1
    v_exp_f32 v45, v45
    v_exp_f32 v46, v46
    v_exp_f32 v47, v47
    v_exp_f32 v48, v48
    v_exp_f32 v49, v49
    v_smfmac_f32_32x32x32_bf16 v[144:159], a[116:119], v[40:47], v236
    buffer_load_dwordx4 a[228:231], v241, s[20:23], s53 offen offset:3072 sc1
    v_exp_f32 v50, v50
    v_exp_f32 v51, v51
    v_exp_f32 v52, v52
    v_mfma_f32_32x32x16_bf16 v[0:15], a[32:35], a[232:235], v[0:15]
    s_add_u32 s53, s46, 102400
    v_exp_f32 v53, v53
    v_exp_f32 v54, v54
    v_exp_f32 v55, v55
    v_mfma_f32_32x32x16_bf16 v[16:31], a[36:39], a[232:235], v[16:31]
    buffer_load_dwordx4 v[192:195], v241, s[20:23], s53 offen offset:0 sc1
    v_exp_f32 v56, v56
    v_exp_f32 v57, v57
    v_exp_f32 v58, v58
    v_smfmac_f32_32x32x32_bf16 v[144:159], a[120:123], v[48:55], v236
    buffer_load_dwordx4 v[196:199], v241, s[20:23], s53 offen offset:1024 sc1
    v_exp_f32 v59, v59
    v_exp_f32 v60, v60
    v_exp_f32 v61, v61
    v_exp_f32 v62, v62
    v_exp_f32 v63, v63
    v_exp_f32 v0, v0
    v_exp_f32 v1, v1
    v_smfmac_f32_32x32x32_bf16 v[144:159], a[124:127], v[56:63], v236
    buffer_load_dwordx4 a[96:99], v241, s[20:23], s53 offen offset:2048 sc1
    v_exp_f32 v2, v2
    v_exp_f32 v3, v3
    v_exp_f32 v4, v4
    v_mfma_f32_32x32x4bf16_1k v[32:63], a[200:201], a[254:255], 0
    v_exp_f32 v5, v5
    v_exp_f32 v6, v6
    v_exp_f32 v7, v7
    v_exp_f32 v8, v8
    v_exp_f32 v9, v9
    v_exp_f32 v10, v10
    v_exp_f32 v11, v11
    v_exp_f32 v12, v12
    v_smfmac_f32_32x32x32_bf16 v[128:143], a[128:131], v[0:7], v236
    buffer_load_dwordx4 a[100:103], v241, s[20:23], s53 offen offset:3072 sc1
    v_exp_f32 v13, v13
    v_exp_f32 v14, v14
    v_exp_f32 v15, v15
    v_exp_f32 v16, v16
    v_exp_f32 v17, v17
    v_smfmac_f32_32x32x32_bf16 v[128:143], a[132:135], v[8:15], v236
    s_add_u32 s53, s46, 106496
    v_exp_f32 v18, v18
    v_exp_f32 v19, v19
    v_exp_f32 v20, v20
    v_mfma_f32_32x32x16_bf16 v[32:47], a[32:35], a[236:239], v[32:47]
    buffer_store_dwordx4 v[108:111], v241, s[20:23], s60 offen offset:3072 sc1
    v_exp_f32 v21, v21
    v_exp_f32 v22, v22
    v_exp_f32 v23, v23
    v_mfma_f32_32x32x16_bf16 v[48:63], a[36:39], a[236:239], v[48:63]
    s_add_u32 s60, s60, 4096
    v_exp_f32 v24, v24
    v_exp_f32 v25, v25
    v_exp_f32 v26, v26
    v_smfmac_f32_32x32x32_bf16 v[128:143], a[136:139], v[16:23], v236
    buffer_load_dwordx4 v[200:203], v241, s[20:23], s53 offen offset:0 sc1
    v_exp_f32 v27, v27
    v_exp_f32 v28, v28
    v_exp_f32 v29, v29
    v_exp_f32 v30, v30
    v_exp_f32 v31, v31
    v_exp_f32 v32, v32
    v_exp_f32 v33, v33
    v_smfmac_f32_32x32x32_bf16 v[128:143], a[140:143], v[24:31], v236
    buffer_load_dwordx4 v[204:207], v241, s[20:23], s53 offen offset:1024 sc1
    v_exp_f32 v34, v34
    v_exp_f32 v35, v35
    v_exp_f32 v36, v36
    v_mfma_f32_32x32x4bf16_1k v[0:31], a[202:203], a[252:253], 0
    v_exp_f32 v37, v37
    v_exp_f32 v38, v38
    v_exp_f32 v39, v39
    v_exp_f32 v40, v40
    v_exp_f32 v41, v41
    v_exp_f32 v42, v42
    v_exp_f32 v43, v43
    v_exp_f32 v44, v44
    v_smfmac_f32_32x32x32_bf16 v[144:159], a[128:131], v[32:39], v236
    buffer_load_dwordx4 a[104:107], v241, s[20:23], s53 offen offset:2048 sc1
    v_exp_f32 v45, v45
    v_exp_f32 v46, v46
    v_exp_f32 v47, v47
    v_exp_f32 v48, v48
    v_exp_f32 v49, v49
    v_smfmac_f32_32x32x32_bf16 v[144:159], a[132:135], v[40:47], v236
    buffer_load_dwordx4 a[108:111], v241, s[20:23], s53 offen offset:3072 sc1
    v_exp_f32 v50, v50
    v_exp_f32 v51, v51
    v_exp_f32 v52, v52
    v_mfma_f32_32x32x16_bf16 v[0:15], a[40:43], a[232:235], v[0:15]
    s_add_u32 s53, s46, 110592
    v_exp_f32 v53, v53
    v_exp_f32 v54, v54
    v_exp_f32 v55, v55
    v_mfma_f32_32x32x16_bf16 v[16:31], a[44:47], a[232:235], v[16:31]
    buffer_load_dwordx4 v[160:163], v241, s[20:23], s53 offen offset:0 sc1
    v_exp_f32 v56, v56
    v_exp_f32 v57, v57
    v_exp_f32 v58, v58
    v_smfmac_f32_32x32x32_bf16 v[144:159], a[136:139], v[48:55], v236
    buffer_load_dwordx4 v[164:167], v241, s[20:23], s53 offen offset:1024 sc1
    v_exp_f32 v59, v59
    v_exp_f32 v60, v60
    v_exp_f32 v61, v61
    v_exp_f32 v62, v62
    v_exp_f32 v63, v63
    v_exp_f32 v0, v0
    v_exp_f32 v1, v1
    v_smfmac_f32_32x32x32_bf16 v[144:159], a[140:143], v[56:63], v236
    buffer_load_dwordx4 a[24:27], v241, s[20:23], s53 offen offset:2048 sc1
    v_exp_f32 v2, v2
    v_exp_f32 v3, v3
    v_exp_f32 v4, v4
    v_mfma_f32_32x32x4bf16_1k v[32:63], a[202:203], a[254:255], 0
    v_exp_f32 v5, v5
    v_exp_f32 v6, v6
    v_exp_f32 v7, v7
    v_exp_f32 v8, v8
    v_exp_f32 v9, v9
    v_exp_f32 v10, v10
    v_exp_f32 v11, v11
    v_exp_f32 v12, v12
    v_smfmac_f32_32x32x32_bf16 v[128:143], a[144:147], v[0:7], v236
    buffer_load_dwordx4 a[28:31], v241, s[20:23], s53 offen offset:3072 sc1
    v_exp_f32 v13, v13
    v_exp_f32 v14, v14
    v_exp_f32 v15, v15
    v_exp_f32 v16, v16
    v_exp_f32 v17, v17
    v_smfmac_f32_32x32x32_bf16 v[128:143], a[148:151], v[8:15], v236
    s_add_u32 s53, s46, 114688
    v_exp_f32 v18, v18
    v_exp_f32 v19, v19
    v_exp_f32 v20, v20
    v_mfma_f32_32x32x16_bf16 v[32:47], a[40:43], a[236:239], v[32:47]
    buffer_load_dwordx4 v[216:219], v241, s[20:23], s53 offen offset:0 sc1
    v_exp_f32 v21, v21
    v_exp_f32 v22, v22
    v_exp_f32 v23, v23
    v_mfma_f32_32x32x16_bf16 v[48:63], a[44:47], a[236:239], v[48:63]
    buffer_load_dwordx4 v[220:223], v241, s[20:23], s53 offen offset:1024 sc1
    v_exp_f32 v24, v24
    v_exp_f32 v25, v25
    v_exp_f32 v26, v26
    v_smfmac_f32_32x32x32_bf16 v[128:143], a[152:155], v[16:23], v236
    buffer_load_dwordx4 a[112:115], v241, s[20:23], s53 offen offset:2048 sc1
    v_exp_f32 v27, v27
    v_exp_f32 v28, v28
    v_exp_f32 v29, v29
    v_exp_f32 v30, v30
    v_exp_f32 v31, v31
    v_exp_f32 v32, v32
    v_exp_f32 v33, v33
    v_smfmac_f32_32x32x32_bf16 v[128:143], a[156:159], v[24:31], v236
    buffer_load_dwordx4 a[116:119], v241, s[20:23], s53 offen offset:3072 sc1
    v_exp_f32 v34, v34
    v_exp_f32 v35, v35
    v_exp_f32 v36, v36
    v_mfma_f32_32x32x4bf16_1k v[0:31], a[204:205], a[252:253], 0
    v_exp_f32 v37, v37
    v_exp_f32 v38, v38
    v_exp_f32 v39, v39
    v_exp_f32 v40, v40
    v_exp_f32 v41, v41
    v_exp_f32 v42, v42
    v_exp_f32 v43, v43
    v_exp_f32 v44, v44
    v_smfmac_f32_32x32x32_bf16 v[144:159], a[144:147], v[32:39], v236
    s_add_u32 s53, s46, 118784
    v_exp_f32 v45, v45
    v_exp_f32 v46, v46
    v_exp_f32 v47, v47
    v_exp_f32 v48, v48
    v_exp_f32 v49, v49
    v_smfmac_f32_32x32x32_bf16 v[144:159], a[148:151], v[40:47], v236
    buffer_load_dwordx4 a[120:123], v241, s[20:23], s53 offen offset:0 sc1
    v_exp_f32 v50, v50
    v_exp_f32 v51, v51
    v_exp_f32 v52, v52
    v_mfma_f32_32x32x16_bf16 v[0:15], a[48:51], a[232:235], v[0:15]
    buffer_load_dwordx4 a[124:127], v241, s[20:23], s53 offen offset:1024 sc1
    v_exp_f32 v53, v53
    v_exp_f32 v54, v54
    v_exp_f32 v55, v55
    v_mfma_f32_32x32x16_bf16 v[16:31], a[52:55], a[232:235], v[16:31]
    buffer_store_dwordx4 v[108:111], v241, s[20:23], s60 offen offset:0 sc1
    v_exp_f32 v56, v56
    v_exp_f32 v57, v57
    v_exp_f32 v58, v58
    v_smfmac_f32_32x32x32_bf16 v[144:159], a[152:155], v[48:55], v236
    buffer_load_dwordx4 a[32:35], v241, s[20:23], s53 offen offset:2048 sc1
    v_exp_f32 v59, v59
    v_exp_f32 v60, v60
    v_exp_f32 v61, v61
    v_exp_f32 v62, v62
    v_exp_f32 v63, v63
    v_exp_f32 v0, v0
    v_exp_f32 v1, v1
    v_smfmac_f32_32x32x32_bf16 v[144:159], a[156:159], v[56:63], v236
    buffer_load_dwordx4 a[36:39], v241, s[20:23], s53 offen offset:3072 sc1
    v_exp_f32 v2, v2
    v_exp_f32 v3, v3
    v_exp_f32 v4, v4
    v_mfma_f32_32x32x4bf16_1k v[32:63], a[204:205], a[254:255], 0
    v_exp_f32 v5, v5
    v_exp_f32 v6, v6
    v_exp_f32 v7, v7
    v_exp_f32 v8, v8
    v_exp_f32 v9, v9
    v_exp_f32 v10, v10
    v_exp_f32 v11, v11
    v_exp_f32 v12, v12
    v_smfmac_f32_32x32x32_bf16 v[128:143], a[160:163], v[0:7], v236
    s_add_u32 s53, s46, 122880
    v_exp_f32 v13, v13
    v_exp_f32 v14, v14
    v_exp_f32 v15, v15
    v_exp_f32 v16, v16
    v_exp_f32 v17, v17
    v_smfmac_f32_32x32x32_bf16 v[128:143], a[164:167], v[8:15], v236
    buffer_load_dwordx4 a[128:131], v241, s[20:23], s53 offen offset:0 sc1
    v_exp_f32 v18, v18
    v_exp_f32 v19, v19
    v_exp_f32 v20, v20
    v_mfma_f32_32x32x16_bf16 v[32:47], a[48:51], a[236:239], v[32:47]
    buffer_load_dwordx4 a[132:135], v241, s[20:23], s53 offen offset:1024 sc1
    v_exp_f32 v21, v21
    v_exp_f32 v22, v22
    v_exp_f32 v23, v23
    v_mfma_f32_32x32x16_bf16 v[48:63], a[52:55], a[236:239], v[48:63]
    buffer_load_dwordx4 a[136:139], v241, s[20:23], s53 offen offset:2048 sc1
    v_exp_f32 v24, v24
    v_exp_f32 v25, v25
    v_exp_f32 v26, v26
    v_smfmac_f32_32x32x32_bf16 v[128:143], a[168:171], v[16:23], v236
    buffer_load_dwordx4 a[140:143], v241, s[20:23], s53 offen offset:3072 sc1
    v_exp_f32 v27, v27
    v_exp_f32 v28, v28
    v_exp_f32 v29, v29
    v_exp_f32 v30, v30
    v_exp_f32 v31, v31
    v_exp_f32 v32, v32
    v_exp_f32 v33, v33
    v_smfmac_f32_32x32x32_bf16 v[128:143], a[172:175], v[24:31], v236
    s_add_u32 s53, s46, 126976
    v_exp_f32 v34, v34
    v_exp_f32 v35, v35
    v_exp_f32 v36, v36
    v_mfma_f32_32x32x4bf16_1k v[0:31], a[206:207], a[252:253], 0
    v_exp_f32 v37, v37
    v_exp_f32 v38, v38
    v_exp_f32 v39, v39
    v_exp_f32 v40, v40
    v_exp_f32 v41, v41
    v_exp_f32 v42, v42
    v_exp_f32 v43, v43
    v_exp_f32 v44, v44
    v_smfmac_f32_32x32x32_bf16 v[144:159], a[160:163], v[32:39], v236
    buffer_load_dwordx4 a[40:43], v241, s[20:23], s53 offen offset:0 sc1
    v_exp_f32 v45, v45
    v_exp_f32 v46, v46
    v_exp_f32 v47, v47
    v_exp_f32 v48, v48
    v_exp_f32 v49, v49
    v_smfmac_f32_32x32x32_bf16 v[144:159], a[164:167], v[40:47], v236
    buffer_load_dwordx4 a[44:47], v241, s[20:23], s53 offen offset:1024 sc1
    v_exp_f32 v50, v50
    v_exp_f32 v51, v51
    v_exp_f32 v52, v52
    v_mfma_f32_32x32x16_bf16 v[0:15], a[56:59], a[232:235], v[0:15]
    buffer_load_dwordx4 a[144:147], v241, s[20:23], s53 offen offset:2048 sc1
    v_exp_f32 v53, v53
    v_exp_f32 v54, v54
    v_exp_f32 v55, v55
    v_mfma_f32_32x32x16_bf16 v[16:31], a[60:63], a[232:235], v[16:31]
    buffer_load_dwordx4 a[148:151], v241, s[20:23], s53 offen offset:3072 sc1
    v_exp_f32 v56, v56
    v_exp_f32 v57, v57
    v_exp_f32 v58, v58
    v_smfmac_f32_32x32x32_bf16 v[144:159], a[168:171], v[48:55], v236
    s_add_u32 s53, s46, 131072
    v_exp_f32 v59, v59
    v_exp_f32 v60, v60
    v_exp_f32 v61, v61
    v_exp_f32 v62, v62
    v_exp_f32 v63, v63
    v_exp_f32 v0, v0
    v_exp_f32 v1, v1
    v_smfmac_f32_32x32x32_bf16 v[144:159], a[172:175], v[56:63], v236
    buffer_load_dwordx4 a[152:155], v241, s[20:23], s53 offen offset:0 sc1
    v_exp_f32 v2, v2
    v_exp_f32 v3, v3
    v_exp_f32 v4, v4
    v_mfma_f32_32x32x4bf16_1k v[32:63], a[206:207], a[254:255], 0
    v_exp_f32 v5, v5
    v_exp_f32 v6, v6
    v_exp_f32 v7, v7
    v_exp_f32 v8, v8
    v_exp_f32 v9, v9
    v_exp_f32 v10, v10
    v_exp_f32 v11, v11
    v_exp_f32 v12, v12
    v_smfmac_f32_32x32x32_bf16 v[128:143], a[176:179], v[0:7], v236
    buffer_load_dwordx4 a[156:159], v241, s[20:23], s53 offen offset:1024 sc1
    v_exp_f32 v13, v13
    v_exp_f32 v14, v14
    v_exp_f32 v15, v15
    v_exp_f32 v16, v16
    v_exp_f32 v17, v17
    v_smfmac_f32_32x32x32_bf16 v[128:143], a[180:183], v[8:15], v236
    buffer_load_dwordx4 a[48:51], v241, s[20:23], s53 offen offset:2048 sc1
    v_exp_f32 v18, v18
    v_exp_f32 v19, v19
    v_exp_f32 v20, v20
    v_mfma_f32_32x32x16_bf16 v[32:47], a[56:59], a[236:239], v[32:47]
    s_waitcnt vmcnt(62)
    buffer_load_dwordx4 a[52:55], v241, s[20:23], s53 offen offset:3072 sc1
    v_exp_f32 v21, v21
    v_exp_f32 v22, v22
    v_exp_f32 v23, v23
    v_mfma_f32_32x32x16_bf16 v[48:63], a[60:63], a[236:239], v[48:63]
    s_waitcnt vmcnt(62)
    buffer_store_dwordx4 v[108:111], v241, s[20:23], s60 offen offset:1024 sc1
    v_exp_f32 v24, v24
    v_exp_f32 v25, v25
    v_exp_f32 v26, v26
    v_smfmac_f32_32x32x32_bf16 v[128:143], a[184:187], v[16:23], v236
    s_add_u32 s53, s46, 135168
    v_exp_f32 v27, v27
    v_exp_f32 v28, v28
    v_exp_f32 v29, v29
    v_exp_f32 v30, v30
    v_exp_f32 v31, v31
    v_exp_f32 v32, v32
    v_exp_f32 v33, v33
    v_smfmac_f32_32x32x32_bf16 v[128:143], a[188:191], v[24:31], v236
    s_waitcnt vmcnt(62)
    buffer_load_dwordx4 a[160:163], v241, s[20:23], s53 offen offset:0 sc1
    s_waitcnt vmcnt(62)
    buffer_load_dwordx4 a[164:167], v241, s[20:23], s53 offen offset:1024 sc1
    s_waitcnt vmcnt(62)
    buffer_load_dwordx4 a[168:171], v241, s[20:23], s53 offen offset:2048 sc1
    s_waitcnt vmcnt(62)
    buffer_load_dwordx4 a[172:175], v241, s[20:23], s53 offen offset:3072 sc1
    s_add_u32 s53, s46, 139264
    s_waitcnt vmcnt(62)
    buffer_load_dwordx4 a[56:59], v241, s[20:23], s53 offen offset:0 sc1
    s_waitcnt vmcnt(62)
    buffer_load_dwordx4 a[60:63], v241, s[20:23], s53 offen offset:1024 sc1
    v_exp_f32 v34, v34
    v_exp_f32 v35, v35
    v_exp_f32 v36, v36
    v_exp_f32 v37, v37
    v_exp_f32 v38, v38
    v_exp_f32 v39, v39
    v_exp_f32 v40, v40
    v_exp_f32 v41, v41
    v_exp_f32 v42, v42
    v_exp_f32 v43, v43
    v_exp_f32 v44, v44
    v_smfmac_f32_32x32x32_bf16 v[144:159], a[176:179], v[32:39], v236
    ds_write_b128 v242, v[128:131] offset:20480
    v_exp_f32 v45, v45
    v_exp_f32 v46, v46
    v_exp_f32 v47, v47
    v_exp_f32 v48, v48
    v_exp_f32 v49, v49
    v_smfmac_f32_32x32x32_bf16 v[144:159], a[180:183], v[40:47], v236
    ds_write_b128 v242, v[132:135] offset:21504
    v_exp_f32 v50, v50
    v_exp_f32 v51, v51
    v_exp_f32 v52, v52
    ds_write_b64 v243, v[136:137] offset:22528
    v_exp_f32 v53, v53
    v_exp_f32 v54, v54
    v_exp_f32 v55, v55
    s_waitcnt vmcnt(62)
    buffer_load_dwordx4 a[176:179], v241, s[20:23], s53 offen offset:2048 sc1
    v_exp_f32 v56, v56
    v_exp_f32 v57, v57
    v_exp_f32 v58, v58
    v_smfmac_f32_32x32x32_bf16 v[144:159], a[184:187], v[48:55], v236
    s_waitcnt vmcnt(62)
    buffer_load_dwordx4 a[180:183], v241, s[20:23], s53 offen offset:3072 sc1
    v_exp_f32 v59, v59
    v_exp_f32 v60, v60
    v_exp_f32 v61, v61
    v_exp_f32 v62, v62
    v_exp_f32 v63, v63
KF_TAIL:
    v_add_u32 v124, s43, v241
    v_add_u32 v125, s47, v241
    v_smfmac_f32_32x32x32_bf16 v[144:159], a[188:191], v[56:63], v236
    s_add_u32 s57, s30, 200704
    s_waitcnt vmcnt(62)
    buffer_load_dwordx4 a[184:187], v241, s[20:23], s57 offen offset:0 sc1
    s_add_u32 s57, s30, 208896
    s_waitcnt vmcnt(62)
    buffer_load_dwordx4 a[188:191], v241, s[20:23], s57 offen offset:0 sc1
    s_nop 5
    ds_write_b128 v242, v[144:147] offset:30720
    ds_write_b128 v242, v[148:151] offset:31744
    ds_write_b64 v243, v[152:153] offset:32768
    s_waitcnt lgkmcnt(0)
    s_barrier
    ds_read_b128 v[0:3], v244 offset:0
    ds_read_b128 v[4:7], v244 offset:1024
    ds_read_b64 v[8:9], v245 offset:2048
    ds_read_b128 v[10:13], v244 offset:2560
    ds_read_b128 v[14:17], v244 offset:3584
    ds_read_b64 v[18:19], v245 offset:4608
    ds_read_b128 v[20:23], v244 offset:5120
    ds_read_b128 v[24:27], v244 offset:6144
    ds_read_b64 v[28:29], v245 offset:7168
    ds_read_b128 v[30:33], v244 offset:7680
    ds_read_b128 v[34:37], v244 offset:8704
    ds_read_b64 v[38:39], v245 offset:9728
    s_add_u32 s58, s30, 65536
    s_waitcnt vmcnt(62)
    buffer_load_dwordx4 v[128:131], v241, s[20:23], s58 offen offset:0 sc1
    s_add_u32 s58, s30, 73728
    s_waitcnt vmcnt(62)
    buffer_load_dwordx4 v[132:135], v241, s[20:23], s58 offen offset:0 sc1
    s_add_u32 s58, s30, 69632
    s_waitcnt vmcnt(62)
    buffer_load_dwordx4 v[136:139], v241, s[20:23], s58 offen offset:0 sc1
    s_add_u32 s58, s30, 77824
    s_waitcnt vmcnt(62)
    buffer_load_dwordx4 v[140:143], v241, s[20:23], s58 offen offset:0 sc1
    s_waitcnt lgkmcnt(8)
    v_pk_add_f32 v[0:1], v[0:1], v[10:11]
    v_pk_add_f32 v[2:3], v[2:3], v[12:13]
    s_waitcnt lgkmcnt(7)
    v_pk_add_f32 v[4:5], v[4:5], v[14:15]
    v_pk_add_f32 v[6:7], v[6:7], v[16:17]
    s_waitcnt lgkmcnt(6)
    v_pk_add_f32 v[8:9], v[8:9], v[18:19]
    s_waitcnt lgkmcnt(2)
    v_pk_add_f32 v[20:21], v[20:21], v[30:31]
    v_pk_add_f32 v[22:23], v[22:23], v[32:33]
    s_waitcnt lgkmcnt(1)
    v_pk_add_f32 v[24:25], v[24:25], v[34:35]
    v_pk_add_f32 v[26:27], v[26:27], v[36:37]
    s_waitcnt lgkmcnt(0)
    v_pk_add_f32 v[28:29], v[28:29], v[38:39]
    v_pk_add_f32 v[8:9], v[8:9], v[28:29]
    v_pk_add_f32 v[0:1], v[0:1], v[20:21]
    v_pk_add_f32 v[2:3], v[2:3], v[22:23]
    v_pk_add_f32 v[4:5], v[4:5], v[24:25]
    v_pk_add_f32 v[6:7], v[6:7], v[26:27]
    v_rcp_f32 v10, v9
    v_maximum3_f32 v13, abs(v0), abs(v1), abs(v2)
    v_maximum3_f32 v13, abs(v3), abs(v4), v13
    v_maximum3_f32 v13, abs(v5), abs(v6), v13
    v_maximum3_f32 v13, abs(v7), abs(v8), v13
    v_fma_f32 v12, 0, v13, v9
    v_subrev_u32 v12, 0x2b800000, v12
    v_cmp_le_u32 vcc, 0x46000000, v12
    v_mov_b32 v11, v10
    v_pk_mul_f32 v[0:1], v[0:1], v[10:11]
    v_pk_mul_f32 v[2:3], v[2:3], v[10:11]
    v_pk_mul_f32 v[4:5], v[4:5], v[10:11]
    v_pk_mul_f32 v[6:7], v[6:7], v[10:11]
    v_mul_f32 v8, v10, v8
    s_or_b64 s[34:35], s[34:35], vcc
    v_cvt_pk_bf16_f32 v0, v0, v1
    v_cvt_pk_bf16_f32 v1, v2, v3
    v_cvt_pk_bf16_f32 v2, v4, v5
    v_cvt_pk_bf16_f32 v3, v6, v7
    v_cvt_pk_bf16_f32 v8, v8, v8
    ds_write_b128 v248, v[0:3] offset:45056
    ds_write_b16 v249, v8 offset:49664
    s_cmp_lg_u64 s[34:35], 0
    s_cselect_b32 s53, 1, 0
    v_mov_b32 v112, s53
    ds_write_b32 v229, v112 offset:50176
    s_add_u32 s57, s30, 212992
    s_waitcnt vmcnt(62)
    buffer_load_dwordx4 v[144:147], v241, s[20:23], s57 offen offset:0 sc1
    s_add_u32 s57, s30, 221184
    s_waitcnt vmcnt(62)
    buffer_load_dwordx4 v[148:151], v241, s[20:23], s57 offen offset:0 sc1
    s_add_u32 s57, s30, 217088
    s_waitcnt vmcnt(62)
    buffer_load_dwordx4 v[152:155], v241, s[20:23], s57 offen offset:0 sc1
    s_add_u32 s57, s30, 225280
    s_waitcnt vmcnt(62)
    buffer_load_dwordx4 v[156:159], v241, s[20:23], s57 offen offset:0 sc1
    s_waitcnt lgkmcnt(0)
    s_barrier
    ds_read_b128 v[100:103], v241 offset:45056
    ds_read_b128 v[108:111], v238 offset:50176
    ds_read_b128 v[104:107], v241 offset:46080
HOP1_4:
    s_cbranch_execz HOPRET1
    s_waitcnt lgkmcnt(2)
    v_smfmac_f32_16x16x64_bf16 v[64:67], v[100:103], v[208:215], v237
    v_smfmac_f32_16x16x64_bf16 v[68:71], v[100:103], a[0:7], v237
    ds_read_b128 v[0:3], v124 offset:0
    v_smfmac_f32_16x16x64_bf16 v[72:75], v[100:103], a[208:215], v237
    s_waitcnt lgkmcnt(2)
    v_or3_b32 v108, v108, v109, v110
    v_or_b32 v108, v108, v111
    v_smfmac_f32_16x16x64_bf16 v[76:79], v[100:103], a[64:71], v237
    v_readfirstlane_b32 s53, v108
    v_smfmac_f32_16x16x64_bf16 v[80:83], v[100:103], a[8:15], v237
    s_andn2_b32 s53, s53, s33
    s_cbranch_scc1 KF_FALLBACK
    v_smfmac_f32_16x16x64_bf16 v[84:87], v[100:103], a[216:223], v237
    ds_read_b128 v[4:7], v124 offset:1024
    s_mov_b32 s54, 0x00ffffff
    v_smfmac_f32_16x16x64_bf16 v[88:91], v[100:103], a[72:79], v237
    s_add_u32 s58, s30, 0
    s_waitcnt vmcnt(62)
    buffer_load_dwordx4 a[64:67], v241, s[20:23], s58 offen offset:0 sc1
    v_smfmac_f32_16x16x64_bf16 v[92:95], v[100:103], v[168:175], v237
    ds_read_b128 v[8:11], v124 offset:2048
    s_mov_b32 s55, 0x00ffffff
    v_smfmac_f32_16x16x64_bf16 v[96:99], v[100:103], a[80:87], v237
    ds_read_b128 v[100:103], v241 offset:47104
    s_waitcnt vmcnt(62) lgkmcnt(4)
    v_smfmac_f32_16x16x64_bf16 v[64:67], v[104:107], v[176:183], v237
    s_add_u32 s58, s30, 8192
    buffer_load_dwordx4 a[68:71], v241, s[20:23], s58 offen offset:0 sc1
    s_waitcnt vmcnt(61)
    v_smfmac_f32_16x16x64_bf16 v[68:71], v[104:107], a[88:95], v237
    ds_read_b128 v[12:15], v124 offset:3072
    s_add_u32 s56, s45, 3407872
    s_waitcnt vmcnt(59)
    v_smfmac_f32_16x16x64_bf16 v[72:75], v[104:107], v[184:191], v237
    ds_read_b128 v[16:19], v124 offset:4096
    s_lshl_b32 s64, s32, 1
    s_waitcnt vmcnt(57)
    v_smfmac_f32_16x16x64_bf16 v[76:79], v[104:107], a[16:23], v237
    s_add_u32 s58, s30, 4096
    buffer_load_dwordx4 a[72:75], v241, s[20:23], s58 offen offset:0 sc1
    s_waitcnt vmcnt(56)
    v_smfmac_f32_16x16x64_bf16 v[80:83], v[104:107], a[224:231], v237
    ds_read_b128 v[20:23], v124 offset:5120
    s_add_u32 s65, s64, 1
    s_waitcnt vmcnt(54)
    v_smfmac_f32_16x16x64_bf16 v[84:87], v[104:107], v[192:199], v237
    ds_read_b128 v[24:27], v124 offset:6144
    s_max_u32 s64, s64, 1
    s_waitcnt vmcnt(52)
    v_smfmac_f32_16x16x64_bf16 v[88:91], v[104:107], a[96:103], v237
    s_add_u32 s58, s30, 12288
    buffer_load_dwordx4 a[76:79], v241, s[20:23], s58 offen offset:0 sc1
    s_waitcnt vmcnt(50)
    v_smfmac_f32_16x16x64_bf16 v[92:95], v[104:107], v[200:207], v237
    ds_read_b128 v[28:31], v124 offset:7168
    s_add_u32 s66, s64, s48
    s_waitcnt vmcnt(48)
    v_smfmac_f32_16x16x64_bf16 v[96:99], v[104:107], a[104:111], v237
    ds_read_b128 v[104:107], v241 offset:48128
    s_waitcnt vmcnt(46) lgkmcnt(6)
    v_smfmac_f32_16x16x64_bf16 v[64:67], v[100:103], v[160:167], v237
    s_add_u32 s57, s30, 147456
    buffer_load_dwordx4 a[80:83], v241, s[20:23], s57 offen offset:0 sc1
    s_waitcnt vmcnt(45)
    v_smfmac_f32_16x16x64_bf16 v[68:71], v[100:103], a[24:31], v237
    ds_read_b128 v[32:35], v124 offset:8192
    s_and_b32 s66, s66, 7
    s_waitcnt vmcnt(43)
    v_smfmac_f32_16x16x64_bf16 v[72:75], v[100:103], v[216:223], v237
    ds_read_b128 v[36:39], v124 offset:9216
    s_add_u32 s67, s65, s48
    s_waitcnt vmcnt(41)
    v_smfmac_f32_16x16x64_bf16 v[76:79], v[100:103], a[112:119], v237
    s_add_u32 s57, s30, 155648
    buffer_load_dwordx4 a[84:87], v241, s[20:23], s57 offen offset:0 sc1
    s_waitcnt vmcnt(40)
    v_smfmac_f32_16x16x64_bf16 v[80:83], v[100:103], a[120:127], v237
    ds_read_b128 v[40:43], v125 offset:0
    s_and_b32 s67, s67, 7
    s_waitcnt vmcnt(37)
    v_smfmac_f32_16x16x64_bf16 v[84:87], v[100:103], a[32:39], v237
    ds_read_b128 v[44:47], v125 offset:1024
    s_lshl3_add_u32 s66, s31, s66
    s_waitcnt vmcnt(35)
    v_smfmac_f32_16x16x64_bf16 v[88:91], v[100:103], a[128:135], v237
    s_add_u32 s57, s30, 151552
    buffer_load_dwordx4 a[88:91], v241, s[20:23], s57 offen offset:0 sc1
    s_waitcnt vmcnt(34)
    v_smfmac_f32_16x16x64_bf16 v[92:95], v[100:103], a[136:143], v237
    ds_read_b128 v[48:51], v125 offset:2048
    s_lshl3_add_u32 s67, s31, s67
    s_waitcnt vmcnt(32)
    v_smfmac_f32_16x16x64_bf16 v[96:99], v[100:103], a[40:47], v237
    ds_read_b128 v[100:103], v241 offset:49152
    s_waitcnt vmcnt(30) lgkmcnt(6)
    v_smfmac_f32_16x16x64_bf16 v[64:67], v[104:107], a[144:151], v237
    s_add_u32 s57, s30, 159744
    buffer_load_dwordx4 a[92:95], v241, s[20:23], s57 offen offset:0 sc1
    s_waitcnt vmcnt(29)
    v_smfmac_f32_16x16x64_bf16 v[68:71], v[104:107], a[152:159], v237
    ds_read_b128 v[52:55], v125 offset:3072
    s_mul_i32 s66, s66, 9216
    s_waitcnt vmcnt(27)
    v_smfmac_f32_16x16x64_bf16 v[72:75], v[104:107], a[48:55], v237
    ds_read_b128 v[56:59], v125 offset:4096
    s_mul_i32 s67, s67, 9216
    s_waitcnt vmcnt(24)
    v_smfmac_f32_16x16x64_bf16 v[76:79], v[104:107], a[160:167], v237
    s_add_u32 s58, s30, 16384
    buffer_load_dwordx4 a[96:99], v241, s[20:23], s58 offen offset:0 sc1
    s_waitcnt vmcnt(23)
    v_smfmac_f32_16x16x64_bf16 v[80:83], v[104:107], a[168:175], v237
    ds_read_b128 v[60:63], v125 offset:5120
    s_add_u32 s66, s66, 3407872
    s_waitcnt vmcnt(21)
    v_smfmac_f32_16x16x64_bf16 v[84:87], v[104:107], a[56:63], v237
    ds_read_b128 a[0:3], v125 offset:6144
    s_add_u32 s67, s67, 3407872
    s_waitcnt vmcnt(19)
    v_smfmac_f32_16x16x64_bf16 v[88:91], v[104:107], a[176:183], v237
    s_add_u32 s58, s30, 24576
    buffer_load_dwordx4 a[100:103], v241, s[20:23], s58 offen offset:0 sc1
    v_smfmac_f32_16x16x64_bf16 v[92:95], v[104:107], v[0:7], v237
    ds_read_b128 a[4:7], v125 offset:7168
    s_lshl_b32 s64, s64, 10
    v_smfmac_f32_16x16x64_bf16 v[96:99], v[104:107], v[8:15], v237
    ds_read_b128 a[8:11], v125 offset:8192
    s_lshl_b32 s65, s65, 10
    s_waitcnt lgkmcnt(6)
    v_smfmac_f32_16x16x64_bf16 v[64:67], v[100:103], v[16:23], v237
    s_add_u32 s58, s30, 20480
    buffer_load_dwordx4 a[104:107], v241, s[20:23], s58 offen offset:0 sc1
    v_smfmac_f32_16x16x64_bf16 v[68:71], v[100:103], v[24:31], v237
    ds_read_b128 a[12:15], v125 offset:9216
    s_lshl2_add_u32 s49, s2, s32
    v_smfmac_f32_16x16x64_bf16 v[72:75], v[100:103], v[32:39], v237
    ds_read_b128 a[16:19], v125 offset:10240
    s_lshl_b32 s49, s49, 7
    v_smfmac_f32_16x16x64_bf16 v[76:79], v[100:103], v[40:47], v237
    s_add_u32 s58, s30, 28672
    buffer_load_dwordx4 a[108:111], v241, s[20:23], s58 offen offset:0 sc1
    s_waitcnt lgkmcnt(7)
    v_smfmac_f32_16x16x64_bf16 v[80:83], v[100:103], v[48:55], v237
    ds_read_b128 a[20:23], v125 offset:11264
    s_add_u32 s50, s49, 46272512
    s_waitcnt lgkmcnt(6)
    v_smfmac_f32_16x16x64_bf16 v[84:87], v[100:103], v[56:63], v237
    s_add_u32 s57, s30, 163840
    buffer_load_dwordx4 a[112:115], v241, s[20:23], s57 offen offset:0 sc1
    s_waitcnt lgkmcnt(4)
    v_smfmac_f32_16x16x64_bf16 v[88:91], v[100:103], a[0:7], v237
    s_add_u32 s57, s30, 172032
    buffer_load_dwordx4 a[116:119], v241, s[20:23], s57 offen offset:0 sc1
    s_waitcnt lgkmcnt(2)
    v_smfmac_f32_16x16x64_bf16 v[92:95], v[100:103], a[8:15], v237
    s_add_u32 s49, s49, 46141440
    v_xor_b32 v248, 64, v235
    s_waitcnt lgkmcnt(0)
    v_smfmac_f32_16x16x64_bf16 v[96:99], v[100:103], a[16:23], v237
    v_add_u32 v249, 65536, v235
    v_add_u32 v251, 65536, v248
    v_mov_b32 v253, s1
    v_pk_add_f32 v[64:65], v[64:65], v[66:67]
    v_pk_mul_f32 v[114:115], v[64:65], v[64:65]
    v_pk_add_f32 v[68:69], v[68:69], v[70:71]
    v_pk_add_f32 v[112:113], v[64:65], v[68:69]
    v_pk_fma_f32 v[114:115], v[68:69], v[68:69], v[114:115]
    v_pk_add_f32 v[72:73], v[72:73], v[74:75]
    v_pk_add_f32 v[112:113], v[112:113], v[72:73]
    v_pk_fma_f32 v[114:115], v[72:73], v[72:73], v[114:115]
    v_pk_add_f32 v[76:77], v[76:77], v[78:79]
    v_pk_add_f32 v[112:113], v[112:113], v[76:77]
    v_pk_fma_f32 v[114:115], v[76:77], v[76:77], v[114:115]
    v_pk_add_f32 v[80:81], v[80:81], v[82:83]
    v_pk_add_f32 v[112:113], v[112:113], v[80:81]
    v_pk_fma_f32 v[114:115], v[80:81], v[80:81], v[114:115]
    v_pk_add_f32 v[84:85], v[84:85], v[86:87]
    v_pk_add_f32 v[112:113], v[112:113], v[84:85]
    v_pk_fma_f32 v[114:115], v[84:85], v[84:85], v[114:115]
    v_pk_add_f32 v[88:89], v[88:89], v[90:91]
    v_pk_add_f32 v[112:113], v[112:113], v[88:89]
    v_pk_fma_f32 v[114:115], v[88:89], v[88:89], v[114:115]
    v_pk_add_f32 v[92:93], v[92:93], v[94:95]
    v_pk_add_f32 v[112:113], v[112:113], v[92:93]
    v_pk_fma_f32 v[114:115], v[92:93], v[92:93], v[114:115]
    v_pk_add_f32 v[96:97], v[96:97], v[98:99]
    v_pk_add_f32 v[112:113], v[112:113], v[96:97]
    v_pk_fma_f32 v[114:115], v[96:97], v[96:97], v[114:115]
    ds_write2_b32 v225, v64, v68 offset0:0 offset1:16
    ds_write2_b32 v226, v65, v69 offset0:0 offset1:16
    v_add_f32_dpp v112, v112, v112 quad_perm:[1,0,3,2] row_mask:0xf bank_mask:0xf
    v_add_f32_dpp v113, v113, v113 quad_perm:[1,0,3,2] row_mask:0xf bank_mask:0xf
    v_add_f32_dpp v114, v114, v114 quad_perm:[1,0,3,2] row_mask:0xf bank_mask:0xf
    v_add_f32_dpp v115, v115, v115 quad_perm:[1,0,3,2] row_mask:0xf bank_mask:0xf
    ds_write2_b32 v225, v72, v76 offset0:32 offset1:48
    ds_write2_b32 v226, v73, v77 offset0:32 offset1:48
    v_add_f32_dpp v112, v112, v112 quad_perm:[2,3,0,1] row_mask:0xf bank_mask:0xf
    v_add_f32_dpp v113, v113, v113 quad_perm:[2,3,0,1] row_mask:0xf bank_mask:0xf
    v_add_f32_dpp v114, v114, v114 quad_perm:[2,3,0,1] row_mask:0xf bank_mask:0xf
    v_add_f32_dpp v115, v115, v115 quad_perm:[2,3,0,1] row_mask:0xf bank_mask:0xf
    ds_write2_b32 v225, v80, v84 offset0:64 offset1:80
    ds_write2_b32 v226, v81, v85 offset0:64 offset1:80
    v_add_f32_dpp v112, v112, v112 row_half_mirror row_mask:0xf bank_mask:0xf
    v_add_f32_dpp v113, v113, v113 row_half_mirror row_mask:0xf bank_mask:0xf
    v_add_f32_dpp v114, v114, v114 row_half_mirror row_mask:0xf bank_mask:0xf
    v_add_f32_dpp v115, v115, v115 row_half_mirror row_mask:0xf bank_mask:0xf
    ds_write2_b32 v225, v88, v92 offset0:96 offset1:112
    ds_write2_b32 v226, v89, v93 offset0:96 offset1:112
    v_add_f32_dpp v108, v112, v112 row_mirror row_mask:0xf bank_mask:0xf
    v_add_f32_dpp v110, v113, v113 row_mirror row_mask:0xf bank_mask:0xf
    v_add_f32_dpp v109, v114, v114 row_mirror row_mask:0xf bank_mask:0xf
    v_add_f32_dpp v111, v115, v115 row_mirror row_mask:0xf bank_mask:0xf
    ds_write_b128 v230, v[108:111] offset:18688
    ds_write_b32 v225, v96 offset:512
    ds_write_b32 v226, v97 offset:512
    s_add_u32 s57, s30, 167936
    buffer_load_dwordx4 a[120:123], v241, s[20:23], s57 offen offset:0 sc1
    s_add_u32 s57, s30, 176128
    buffer_load_dwordx4 a[124:127], v241, s[20:23], s57 offen offset:0 sc1
    s_add_u32 s58, s30, 32768
    buffer_load_dwordx4 a[128:131], v241, s[20:23], s58 offen offset:0 sc1
    s_add_u32 s58, s30, 40960
    buffer_load_dwordx4 a[132:135], v241, s[20:23], s58 offen offset:0 sc1
    s_add_u32 s58, s30, 36864
    buffer_load_dwordx4 a[136:139], v241, s[20:23], s58 offen offset:0 sc1
    s_add_u32 s58, s30, 45056
    buffer_load_dwordx4 a[140:143], v241, s[20:23], s58 offen offset:0 sc1
    s_waitcnt lgkmcnt(0)
    s_barrier
    ds_read2_b64 v[108:111], v231 offset0:0 offset1:2
    ds_read2_b64 v[112:115], v231 offset0:4 offset1:6
    ds_read_b128 v[0:3], v227 offset:0
    ds_read_b128 v[4:7], v227 offset:16
    ds_read_b128 v[8:11], v227 offset:768
    ds_read_b128 v[12:15], v227 offset:784
    ds_read_b128 v[16:19], v227 offset:1536
    ds_read_b128 v[20:23], v227 offset:1552
    s_add_u32 s57, s30, 180224
    buffer_load_dwordx4 a[144:147], v241, s[20:23], s57 offen offset:0 sc1
    s_add_u32 s57, s30, 188416
    buffer_load_dwordx4 a[148:151], v241, s[20:23], s57 offen offset:0 sc1
    s_mov_b64 exec, s[54:55]
    s_waitcnt lgkmcnt(7)
    v_pk_add_f32 v[108:109], v[108:109], v[110:111]
    s_waitcnt lgkmcnt(6)
    v_pk_add_f32 v[112:113], v[112:113], v[114:115]
    v_mov_b32 v110, 0x3727c5ac
    v_pk_add_f32 v[108:109], v[108:109], v[112:113]
    v_mul_f32 v108, 0x3ae38e39, v108
    v_mul_f32 v109, 0x3ae38e39, v109
    v_fma_f32 v109, -v108, v108, v109
    v_max_f32 v109, 0, v109
    v_add_f32 v109, v110, v109
    v_rsq_f32 v110, v109
    v_mul_f32 v108, 0xbeeff558, v108
    v_mul_f32 v111, v110, v108
    v_mul_f32 v110, 0x3eeff558, v110
    s_waitcnt lgkmcnt(5)
    v_pk_fma_f32 v[0:1], v[0:1], v[110:111], v[110:111] op_sel:[0,0,1] op_sel_hi:[1,0,1]
    v_pk_fma_f32 v[2:3], v[2:3], v[110:111], v[110:111] op_sel:[0,0,1] op_sel_hi:[1,0,1]
    s_waitcnt lgkmcnt(4)
    v_pk_fma_f32 v[4:5], v[4:5], v[110:111], v[110:111] op_sel:[0,0,1] op_sel_hi:[1,0,1]
    v_pk_fma_f32 v[6:7], v[6:7], v[110:111], v[110:111] op_sel:[0,0,1] op_sel_hi:[1,0,1]
    v_cvt_pk_bf16_f32 v24, v0, v1
    v_cvt_pk_bf16_f32 v25, v2, v3
    v_cvt_pk_bf16_f32 v26, v4, v5
    v_cvt_pk_bf16_f32 v27, v6, v7
    buffer_store_dwordx4 v[24:27], v250, s[20:23], s56 offen offset:0 sc1
    s_waitcnt lgkmcnt(3)
    v_pk_fma_f32 v[8:9], v[8:9], v[110:111], v[110:111] op_sel:[0,0,1] op_sel_hi:[1,0,1]
    v_pk_fma_f32 v[10:11], v[10:11], v[110:111], v[110:111] op_sel:[0,0,1] op_sel_hi:[1,0,1]
    s_waitcnt lgkmcnt(2)
    v_pk_fma_f32 v[12:13], v[12:13], v[110:111], v[110:111] op_sel:[0,0,1] op_sel_hi:[1,0,1]
    v_pk_fma_f32 v[14:15], v[14:15], v[110:111], v[110:111] op_sel:[0,0,1] op_sel_hi:[1,0,1]
    v_cvt_pk_bf16_f32 v28, v8, v9
    v_cvt_pk_bf16_f32 v29, v10, v11
    v_cvt_pk_bf16_f32 v30, v12, v13
    v_cvt_pk_bf16_f32 v31, v14, v15
    buffer_store_dwordx4 v[28:31], v250, s[20:23], s56 offen offset:384 sc1
    s_waitcnt lgkmcnt(1)
    v_pk_fma_f32 v[16:17], v[16:17], v[110:111], v[110:111] op_sel:[0,0,1] op_sel_hi:[1,0,1]
    v_pk_fma_f32 v[18:19], v[18:19], v[110:111], v[110:111] op_sel:[0,0,1] op_sel_hi:[1,0,1]
    s_waitcnt lgkmcnt(0)
    v_pk_fma_f32 v[20:21], v[20:21], v[110:111], v[110:111] op_sel:[0,0,1] op_sel_hi:[1,0,1]
    v_pk_fma_f32 v[22:23], v[22:23], v[110:111], v[110:111] op_sel:[0,0,1] op_sel_hi:[1,0,1]
    v_cvt_pk_bf16_f32 v32, v16, v17
    v_cvt_pk_bf16_f32 v33, v18, v19
    v_cvt_pk_bf16_f32 v34, v20, v21
    v_cvt_pk_bf16_f32 v35, v22, v23
    buffer_store_dwordx4 v[32:35], v250, s[20:23], s56 offen offset:768 sc1
    s_mov_b64 exec, -1
    s_mov_b64 exec, s[54:55]
    ds_write_b128 v228, v[24:27] offset:0
    ds_write_b128 v228, v[28:31] offset:24576
    ds_write_b128 v228, v[32:35] offset:49152
    s_mov_b64 exec, -1
    s_add_u32 s57, s30, 184320
    buffer_load_dwordx4 a[152:155], v241, s[20:23], s57 offen offset:0 sc1
    s_add_u32 s57, s30, 192512
    buffer_load_dwordx4 a[156:159], v241, s[20:23], s57 offen offset:0 sc1
    s_add_u32 s58, s30, 49152
    buffer_load_dwordx4 a[160:163], v241, s[20:23], s58 offen offset:0 sc1
    s_add_u32 s58, s30, 57344
    buffer_load_dwordx4 a[164:167], v241, s[20:23], s58 offen offset:0 sc1
    s_add_u32 s58, s30, 53248
    buffer_load_dwordx4 a[168:171], v241, s[20:23], s58 offen offset:0 sc1
    s_add_u32 s58, s30, 61440
    buffer_load_dwordx4 a[172:175], v241, s[20:23], s58 offen offset:0 sc1
    s_waitcnt vmcnt(6)
    s_mov_b32 exec_hi, 0
    buffer_store_dword v253, v255, s[20:23], s49 offen sc1
    s_mov_b64 exec, -1
    s_add_u32 s57, s30, 196608
    buffer_load_dwordx4 a[176:179], v241, s[20:23], s57 offen offset:0 sc1
    s_add_u32 s57, s30, 204800
    buffer_load_dwordx4 a[180:183], v241, s[20:23], s57 offen offset:0 sc1
    s_add_u32 s58, s30, 81920
    buffer_load_dwordx4 v[160:163], v241, s[20:23], s58 offen offset:0 sc1
    s_add_u32 s58, s30, 90112
    buffer_load_dwordx4 v[164:167], v241, s[20:23], s58 offen offset:0 sc1
    s_add_u32 s58, s30, 86016
    buffer_load_dwordx4 v[168:171], v241, s[20:23], s58 offen offset:0 sc1
    s_add_u32 s58, s30, 94208
    buffer_load_dwordx4 v[172:175], v241, s[20:23], s58 offen offset:0 sc1
    s_add_u32 s57, s30, 229376
    buffer_load_dwordx4 v[176:179], v241, s[20:23], s57 offen offset:0 sc1
    s_add_u32 s57, s30, 237568
    buffer_load_dwordx4 v[180:183], v241, s[20:23], s57 offen offset:0 sc1
    s_add_u32 s57, s30, 233472
    buffer_load_dwordx4 v[184:187], v241, s[20:23], s57 offen offset:0 sc1
    s_add_u32 s57, s30, 241664
    buffer_load_dwordx4 v[188:191], v241, s[20:23], s57 offen offset:0 sc1
    s_add_u32 s58, s30, 98304
    buffer_load_dwordx4 v[192:195], v241, s[20:23], s58 offen offset:0 sc1
    s_add_u32 s58, s30, 106496
    buffer_load_dwordx4 v[196:199], v241, s[20:23], s58 offen offset:0 sc1
    s_add_u32 m0, s47, 15360
    s_add_u32 s59, s30, 1986560
    buffer_load_dwordx4 v241, s[20:23], s59 offen sc1 lds
    s_add_u32 m0, s47, 14336
    s_add_u32 s59, s30, 1982464
    buffer_load_dwordx4 v241, s[20:23], s59 offen sc1 lds
    s_add_u32 m0, s47, 13312
    s_add_u32 s59, s30, 1978368
    buffer_load_dwordx4 v241, s[20:23], s59 offen sc1 lds
    s_add_u32 m0, s47, 12288
    s_add_u32 s59, s30, 1974272
    buffer_load_dwordx4 v241, s[20:23], s59 offen sc1 lds
    buffer_load_dword v252, v234, s[20:23], 0 offen sc1
    s_add_u32 s58, s30, 102400
    buffer_load_dwordx4 v[200:203], v241, s[20:23], s58 offen offset:0 sc1
    s_add_u32 s58, s30, 110592
    buffer_load_dwordx4 v[204:207], v241, s[20:23], s58 offen offset:0 sc1
    s_add_u32 s57, s30, 245760
    buffer_load_dwordx4 v[208:211], v241, s[20:23], s57 offen offset:0 sc1
    s_add_u32 s57, s30, 253952
    buffer_load_dwordx4 v[212:215], v241, s[20:23], s57 offen offset:0 sc1
    s_add_u32 s57, s30, 249856
    buffer_load_dwordx4 v[216:219], v241, s[20:23], s57 offen offset:0 sc1
    s_mov_b64 exec, 0
    s_cmp_eq_u32 s32, 0
    s_cbranch_scc1 HOP2_0
    s_cmp_eq_u32 s32, 1
    s_cbranch_scc1 HOP2_1
    s_cmp_eq_u32 s32, 2
    s_cbranch_scc1 HOP2_2
    s_branch HOP2_3
HOPRET2:
    s_mov_b64 exec, -1
    s_waitcnt vmcnt(5)
    v_cmp_ne_u32 vcc, s1, v252
    s_nop 0
    s_cbranch_vccnz KF_S1_SPIN
KF_S1_OK:
    s_add_u32 m0, s64, 18944
    s_nop 0
    buffer_load_dwordx4 v232, s[20:23], s66 offen offset:0 sc1 lds
    s_add_u32 m0, s65, 18944
    s_nop 0
    buffer_load_dwordx4 v233, s[20:23], s67 offen offset:0 sc1 lds
    s_add_u32 m0, s64, 27008
    s_nop 0
    buffer_load_dwordx4 v232, s[20:23], s66 offen offset:128 sc1 lds
    s_add_u32 m0, s65, 27008
    s_nop 0
    buffer_load_dwordx4 v233, s[20:23], s67 offen offset:128 sc1 lds
    s_add_u32 m0, s64, 35072
    s_nop 0
    buffer_load_dwordx4 v232, s[20:23], s66 offen offset:256 sc1 lds
    s_add_u32 m0, s65, 35072
    s_nop 0
    buffer_load_dwordx4 v233, s[20:23], s67 offen offset:256 sc1 lds
    s_add_u32 m0, s47, 11264
    s_add_u32 s59, s30, 1970176
    buffer_load_dwordx4 v241, s[20:23], s59 offen sc1 lds
    s_add_u32 m0, s47, 10240
    s_add_u32 s59, s30, 1966080
    buffer_load_dwordx4 v241, s[20:23], s59 offen sc1 lds
    s_add_u32 m0, s47, 9216
    s_add_u32 s59, s30, 1961984
    buffer_load_dwordx4 v241, s[20:23], s59 offen sc1 lds
    s_add_u32 m0, s47, 8192
    s_add_u32 s59, s30, 1957888
    buffer_load_dwordx4 v241, s[20:23], s59 offen sc1 lds
    s_add_u32 m0, s47, 7168
    s_add_u32 s59, s30, 1953792
    buffer_load_dwordx4 v241, s[20:23], s59 offen sc1 lds
    s_add_u32 m0, s47, 6144
    s_add_u32 s59, s30, 1949696
    buffer_load_dwordx4 v241, s[20:23], s59 offen sc1 lds
    s_add_u32 m0, s47, 5120
    s_add_u32 s59, s30, 1945600
    buffer_load_dwordx4 v241, s[20:23], s59 offen sc1 lds
    s_add_u32 m0, s47, 4096
    s_add_u32 s59, s30, 1941504
    buffer_load_dwordx4 v241, s[20:23], s59 offen sc1 lds
    s_add_u32 m0, s47, 3072
    s_add_u32 s59, s30, 1937408
    buffer_load_dwordx4 v241, s[20:23], s59 offen sc1 lds
    s_add_u32 m0, s47, 2048
    s_add_u32 s59, s30, 1933312
    buffer_load_dwordx4 v241, s[20:23], s59 offen sc1 lds
    s_add_u32 m0, s47, 1024
    s_add_u32 s59, s30, 1929216
    buffer_load_dwordx4 v241, s[20:23], s59 offen sc1 lds
    s_add_u32 m0, s47, 0
    s_add_u32 s59, s30, 1925120
    buffer_load_dwordx4 v241, s[20:23], s59 offen sc1 lds
    s_waitcnt vmcnt(16)
    s_waitcnt lgkmcnt(0)
    s_barrier
    ds_read_b128 a[0:3], v235 offset:0
    ds_read_b128 a[4:7], v235 offset:512
    ds_read_b128 a[8:11], v235 offset:4096
    ds_read_b128 a[12:15], v235 offset:4608
    ds_read_b128 a[16:19], v248 offset:0
    ds_read_b128 a[20:23], v248 offset:512
    ds_read_b128 a[24:27], v248 offset:4096
    ds_read_b128 a[28:31], v248 offset:4608
    s_waitcnt lgkmcnt(7)
    v_mfma_f32_16x16x32_bf16 v[0:3], a[64:67], a[0:3], 0
    s_add_u32 m0, s64, 43136
    s_waitcnt lgkmcnt(3)
    v_mfma_f32_16x16x32_bf16 v[0:3], a[68:71], a[16:19], v[0:3]
    buffer_load_dwordx4 v232, s[20:23], s66 offen offset:384 sc1 lds
    s_waitcnt lgkmcnt(2)
    v_mfma_f32_16x16x32_bf16 v[4:7], a[68:71], a[20:23], 0
    s_add_u32 s57, s30, 258048
    s_add_u32 m0, s65, 43136
    v_mfma_f32_16x16x32_bf16 v[4:7], a[64:67], a[4:7], v[4:7]
    buffer_load_dwordx4 v233, s[20:23], s67 offen offset:384 sc1 lds
    v_mfma_f32_16x16x32_bf16 v[8:11], a[64:67], a[8:11], 0
    s_add_u32 m0, s64, 51200
    s_waitcnt lgkmcnt(1)
    v_mfma_f32_16x16x32_bf16 v[8:11], a[68:71], a[24:27], v[8:11]
    buffer_load_dwordx4 v232, s[20:23], s66 offen offset:512 sc1 lds
    s_waitcnt lgkmcnt(0)
    v_mfma_f32_16x16x32_bf16 v[12:15], a[68:71], a[28:31], 0
    s_add_u32 m0, s65, 51200
    v_mfma_f32_16x16x32_bf16 v[12:15], a[64:67], a[12:15], v[12:15]
    buffer_load_dwordx4 v233, s[20:23], s67 offen offset:512 sc1 lds
    v_mfma_f32_16x16x32_bf16 v[16:19], a[72:75], a[0:3], 0
    v_mfma_f32_16x16x32_bf16 v[16:19], a[76:79], a[16:19], v[16:19]
    v_mfma_f32_16x16x32_bf16 v[20:23], a[76:79], a[20:23], 0
    v_mfma_f32_16x16x32_bf16 v[20:23], a[72:75], a[4:7], v[20:23]
    v_mfma_f32_16x16x32_bf16 v[24:27], a[72:75], a[8:11], 0
    s_waitcnt vmcnt(18)
    s_barrier
    v_mfma_f32_16x16x32_bf16 v[24:27], a[76:79], a[24:27], v[24:27]
    ds_read_b128 a[32:35], v235 offset:8192
    v_mfma_f32_16x16x32_bf16 v[28:31], a[76:79], a[28:31], 0
    ds_read_b128 a[36:39], v235 offset:8704
    v_mfma_f32_16x16x32_bf16 v[28:31], a[72:75], a[12:15], v[28:31]
    ds_read_b128 a[40:43], v235 offset:12288
    v_mfma_f32_16x16x32_bf16 v[32:35], a[80:83], a[0:3], 0
    ds_read_b128 a[44:47], v235 offset:12800
    v_mfma_f32_16x16x32_bf16 v[32:35], a[84:87], a[16:19], v[32:35]
    ds_read_b128 a[48:51], v248 offset:8192
    v_mfma_f32_16x16x32_bf16 v[36:39], a[84:87], a[20:23], 0
    ds_read_b128 a[52:55], v248 offset:8704
    v_mfma_f32_16x16x32_bf16 v[36:39], a[80:83], a[4:7], v[36:39]
    ds_read_b128 a[56:59], v248 offset:12288
    v_mfma_f32_16x16x32_bf16 v[40:43], a[80:83], a[8:11], 0
    ds_read_b128 a[60:63], v248 offset:12800
    v_mfma_f32_16x16x32_bf16 v[40:43], a[84:87], a[24:27], v[40:43]
    v_mfma_f32_16x16x32_bf16 v[44:47], a[84:87], a[28:31], 0
    v_mfma_f32_16x16x32_bf16 v[44:47], a[80:83], a[12:15], v[44:47]
    v_mfma_f32_16x16x32_bf16 v[48:51], a[88:91], a[0:3], 0
    v_mfma_f32_16x16x32_bf16 v[48:51], a[92:95], a[16:19], v[48:51]
    v_mfma_f32_16x16x32_bf16 v[52:55], a[92:95], a[20:23], 0
    v_mfma_f32_16x16x32_bf16 v[52:55], a[88:91], a[4:7], v[52:55]
    v_mfma_f32_16x16x32_bf16 v[56:59], a[88:91], a[8:11], 0
    v_mfma_f32_16x16x32_bf16 v[56:59], a[92:95], a[24:27], v[56:59]
    v_mfma_f32_16x16x32_bf16 v[60:63], a[92:95], a[28:31], 0
    v_mfma_f32_16x16x32_bf16 v[60:63], a[88:91], a[12:15], v[60:63]
    s_waitcnt lgkmcnt(0)
    v_mfma_f32_16x16x32_bf16 v[0:3], a[96:99], a[32:35], v[0:3]
    s_add_u32 m0, s64, 59264
    v_mfma_f32_16x16x32_bf16 v[0:3], a[100:103], a[48:51], v[0:3]
    buffer_load_dwordx4 v232, s[20:23], s66 offen offset:640 sc1 lds
    v_mfma_f32_16x16x32_bf16 v[4:7], a[100:103], a[52:55], v[4:7]
    s_add_u32 m0, s65, 59264
    v_mfma_f32_16x16x32_bf16 v[4:7], a[96:99], a[36:39], v[4:7]
    buffer_load_dwordx4 v233, s[20:23], s67 offen offset:640 sc1 lds
    v_mfma_f32_16x16x32_bf16 v[8:11], a[96:99], a[40:43], v[8:11]
    s_add_u32 m0, s64, 67328
    v_mfma_f32_16x16x32_bf16 v[8:11], a[100:103], a[56:59], v[8:11]
    buffer_load_dwordx4 v232, s[20:23], s66 offen offset:768 sc1 lds
    v_mfma_f32_16x16x32_bf16 v[12:15], a[100:103], a[60:63], v[12:15]
    s_add_u32 m0, s65, 67328
    v_mfma_f32_16x16x32_bf16 v[12:15], a[96:99], a[44:47], v[12:15]
    buffer_load_dwordx4 v233, s[20:23], s67 offen offset:768 sc1 lds
    v_mfma_f32_16x16x32_bf16 v[16:19], a[104:107], a[32:35], v[16:19]
    v_mfma_f32_16x16x32_bf16 v[16:19], a[108:111], a[48:51], v[16:19]
    v_mfma_f32_16x16x32_bf16 v[20:23], a[108:111], a[52:55], v[20:23]
    v_mfma_f32_16x16x32_bf16 v[20:23], a[104:107], a[36:39], v[20:23]
    v_mfma_f32_16x16x32_bf16 v[24:27], a[104:107], a[40:43], v[24:27]
    s_waitcnt vmcnt(20)
    s_barrier
    v_mfma_f32_16x16x32_bf16 v[24:27], a[108:111], a[56:59], v[24:27]
    ds_read_b128 a[64:67], v235 offset:16384
    v_mfma_f32_16x16x32_bf16 v[28:31], a[108:111], a[60:63], v[28:31]
    ds_read_b128 a[68:71], v235 offset:16896
    v_mfma_f32_16x16x32_bf16 v[28:31], a[104:107], a[44:47], v[28:31]
    ds_read_b128 a[72:75], v235 offset:20480
    v_mfma_f32_16x16x32_bf16 v[32:35], a[112:115], a[32:35], v[32:35]
    ds_read_b128 a[76:79], v235 offset:20992
    v_mfma_f32_16x16x32_bf16 v[32:35], a[116:119], a[48:51], v[32:35]
    ds_read_b128 a[80:83], v248 offset:16384
    v_mfma_f32_16x16x32_bf16 v[36:39], a[116:119], a[52:55], v[36:39]
    ds_read_b128 a[84:87], v248 offset:16896
    v_mfma_f32_16x16x32_bf16 v[36:39], a[112:115], a[36:39], v[36:39]
    ds_read_b128 a[88:91], v248 offset:20480
    v_mfma_f32_16x16x32_bf16 v[40:43], a[112:115], a[40:43], v[40:43]
    ds_read_b128 a[92:95], v248 offset:20992
    v_mfma_f32_16x16x32_bf16 v[40:43], a[116:119], a[56:59], v[40:43]
    v_mfma_f32_16x16x32_bf16 v[44:47], a[116:119], a[60:63], v[44:47]
    v_mfma_f32_16x16x32_bf16 v[44:47], a[112:115], a[44:47], v[44:47]
    v_mfma_f32_16x16x32_bf16 v[48:51], a[120:123], a[32:35], v[48:51]
    v_mfma_f32_16x16x32_bf16 v[48:51], a[124:127], a[48:51], v[48:51]
    v_mfma_f32_16x16x32_bf16 v[52:55], a[124:127], a[52:55], v[52:55]
    v_mfma_f32_16x16x32_bf16 v[52:55], a[120:123], a[36:39], v[52:55]
    v_mfma_f32_16x16x32_bf16 v[56:59], a[120:123], a[40:43], v[56:59]
    v_mfma_f32_16x16x32_bf16 v[56:59], a[124:127], a[56:59], v[56:59]
    v_mfma_f32_16x16x32_bf16 v[60:63], a[124:127], a[60:63], v[60:63]
    v_mfma_f32_16x16x32_bf16 v[60:63], a[120:123], a[44:47], v[60:63]
    s_waitcnt lgkmcnt(0)
    v_mfma_f32_16x16x32_bf16 v[0:3], a[128:131], a[64:67], v[0:3]
    s_add_u32 m0, s64, 75392
    v_mfma_f32_16x16x32_bf16 v[0:3], a[132:135], a[80:83], v[0:3]
    buffer_load_dwordx4 v232, s[20:23], s66 offen offset:896 sc1 lds
    v_mfma_f32_16x16x32_bf16 v[4:7], a[132:135], a[84:87], v[4:7]
    s_add_u32 m0, s65, 75392
    v_mfma_f32_16x16x32_bf16 v[4:7], a[128:131], a[68:71], v[4:7]
    buffer_load_dwordx4 v233, s[20:23], s67 offen offset:896 sc1 lds
    v_mfma_f32_16x16x32_bf16 v[8:11], a[128:131], a[72:75], v[8:11]
    s_add_u32 m0, s64, 83456
    v_mfma_f32_16x16x32_bf16 v[8:11], a[132:135], a[88:91], v[8:11]
    buffer_load_dwordx4 v232, s[20:23], s66 offen offset:1024 sc1 lds
    v_mfma_f32_16x16x32_bf16 v[12:15], a[132:135], a[92:95], v[12:15]
    s_add_u32 m0, s65, 83456
    v_mfma_f32_16x16x32_bf16 v[12:15], a[128:131], a[76:79], v[12:15]
HOP2_0:
    s_cbranch_execz HOP2_4
    buffer_load_dwordx4 v233, s[20:23], s67 offen offset:1024 sc1 lds
    v_mfma_f32_16x16x32_bf16 v[16:19], a[136:139], a[64:67], v[16:19]
    s_mul_i32 s79, s31, 43
    s_lshr_b32 s79, s79, 7
    v_mfma_f32_16x16x32_bf16 v[16:19], a[140:143], a[80:83], v[16:19]
    s_mul_i32 s79, s79, 3
    s_sub_u32 s79, s31, s79
    v_mfma_f32_16x16x32_bf16 v[20:23], a[140:143], a[84:87], v[20:23]
    s_sub_u32 s69, s79, 3
    s_nop 0
    v_mfma_f32_16x16x32_bf16 v[20:23], a[136:139], a[68:71], v[20:23]
    s_cmp_lt_u32 s79, 3
    s_cselect_b32 s70, s79, s69
    v_mfma_f32_16x16x32_bf16 v[24:27], a[136:139], a[72:75], v[24:27]
    s_mul_i32 s73, s70, 294912
    s_add_u32 s73, s73, s30
    v_mfma_f32_16x16x32_bf16 v[24:27], a[140:143], a[88:91], v[24:27]
    s_mul_i32 s76, s70, 147456
    s_add_u32 s76, s76, s30
    v_mfma_f32_16x16x32_bf16 v[28:31], a[140:143], a[92:95], v[28:31]
    s_waitcnt vmcnt(10)
    s_barrier
    v_mfma_f32_16x16x32_bf16 v[28:31], a[136:139], a[76:79], v[28:31]
    ds_read_b128 a[96:99], v235 offset:24576
    v_mfma_f32_16x16x32_bf16 v[32:35], a[144:147], a[64:67], v[32:35]
    ds_read_b128 a[100:103], v235 offset:25088
    v_mfma_f32_16x16x32_bf16 v[32:35], a[148:151], a[80:83], v[32:35]
    ds_read_b128 a[104:107], v235 offset:28672
    v_mfma_f32_16x16x32_bf16 v[36:39], a[148:151], a[84:87], v[36:39]
    ds_read_b128 a[108:111], v235 offset:29184
    v_mfma_f32_16x16x32_bf16 v[36:39], a[144:147], a[68:71], v[36:39]
    ds_read_b128 a[112:115], v248 offset:24576
    v_mfma_f32_16x16x32_bf16 v[40:43], a[144:147], a[72:75], v[40:43]
    ds_read_b128 a[116:119], v248 offset:25088
    v_mfma_f32_16x16x32_bf16 v[40:43], a[148:151], a[88:91], v[40:43]
    ds_read_b128 a[120:123], v248 offset:28672
    v_mfma_f32_16x16x32_bf16 v[44:47], a[148:151], a[92:95], v[44:47]
    ds_read_b128 a[124:127], v248 offset:29184
    v_mfma_f32_16x16x32_bf16 v[44:47], a[144:147], a[76:79], v[44:47]
    v_mfma_f32_16x16x32_bf16 v[48:51], a[152:155], a[64:67], v[48:51]
    v_mfma_f32_16x16x32_bf16 v[48:51], a[156:159], a[80:83], v[48:51]
    v_mfma_f32_16x16x32_bf16 v[52:55], a[156:159], a[84:87], v[52:55]
    v_mfma_f32_16x16x32_bf16 v[52:55], a[152:155], a[68:71], v[52:55]
    v_mfma_f32_16x16x32_bf16 v[56:59], a[152:155], a[72:75], v[56:59]
    v_mfma_f32_16x16x32_bf16 v[56:59], a[156:159], a[88:91], v[56:59]
    v_mfma_f32_16x16x32_bf16 v[60:63], a[156:159], a[92:95], v[60:63]
    v_mfma_f32_16x16x32_bf16 v[60:63], a[152:155], a[76:79], v[60:63]
    s_waitcnt lgkmcnt(0)
    v_mfma_f32_16x16x32_bf16 v[0:3], a[160:163], a[96:99], v[0:3]
    s_cmp_lt_u32 s79, 2
    s_cselect_b32 s71, s79, s69
    v_mfma_f32_16x16x32_bf16 v[0:3], a[164:167], a[112:115], v[0:3]
    s_mul_i32 s74, s71, 294912
    s_add_u32 s74, s74, s30
    v_mfma_f32_16x16x32_bf16 v[4:7], a[164:167], a[116:119], v[4:7]
    s_mul_i32 s77, s71, 147456
    s_add_u32 s77, s77, s30
    v_mfma_f32_16x16x32_bf16 v[4:7], a[160:163], a[100:103], v[4:7]
    s_cmp_lt_u32 s79, 1
    s_cselect_b32 s72, s79, s69
    v_mfma_f32_16x16x32_bf16 v[8:11], a[160:163], a[104:107], v[8:11]
    s_mul_i32 s75, s72, 294912
    s_add_u32 s75, s75, s30
    v_mfma_f32_16x16x32_bf16 v[8:11], a[164:167], a[120:123], v[8:11]
    s_mul_i32 s78, s72, 147456
    s_add_u32 s78, s78, s30
    v_mfma_f32_16x16x32_bf16 v[12:15], a[164:167], a[124:127], v[12:15]
    v_mfma_f32_16x16x32_bf16 v[12:15], a[160:163], a[108:111], v[12:15]
    v_mfma_f32_16x16x32_bf16 v[16:19], a[168:171], a[96:99], v[16:19]
    v_mfma_f32_16x16x32_bf16 v[16:19], a[172:175], a[112:115], v[16:19]
    v_mfma_f32_16x16x32_bf16 v[20:23], a[172:175], a[116:119], v[20:23]
    v_mfma_f32_16x16x32_bf16 v[20:23], a[168:171], a[100:103], v[20:23]
    v_mfma_f32_16x16x32_bf16 v[24:27], a[168:171], a[104:107], v[24:27]
    s_waitcnt vmcnt(8)
    s_barrier
    v_mfma_f32_16x16x32_bf16 v[24:27], a[172:175], a[120:123], v[24:27]
    ds_read_b128 a[128:131], v235 offset:32768
    v_mfma_f32_16x16x32_bf16 v[28:31], a[172:175], a[124:127], v[28:31]
    ds_read_b128 a[132:135], v235 offset:33280
    v_mfma_f32_16x16x32_bf16 v[28:31], a[168:171], a[108:111], v[28:31]
    ds_read_b128 a[136:139], v235 offset:36864
    v_mfma_f32_16x16x32_bf16 v[32:35], a[176:179], a[96:99], v[32:35]
    ds_read_b128 a[140:143], v235 offset:37376
    v_mfma_f32_16x16x32_bf16 v[32:35], a[180:183], a[112:115], v[32:35]
    ds_read_b128 a[144:147], v248 offset:32768
    v_mfma_f32_16x16x32_bf16 v[36:39], a[180:183], a[116:119], v[36:39]
    ds_read_b128 a[148:151], v248 offset:33280
    v_mfma_f32_16x16x32_bf16 v[36:39], a[176:179], a[100:103], v[36:39]
    ds_read_b128 a[152:155], v248 offset:36864
    v_mfma_f32_16x16x32_bf16 v[40:43], a[176:179], a[104:107], v[40:43]
    ds_read_b128 a[156:159], v248 offset:37376
    v_mfma_f32_16x16x32_bf16 v[40:43], a[180:183], a[120:123], v[40:43]
    v_mfma_f32_16x16x32_bf16 v[44:47], a[180:183], a[124:127], v[44:47]
    v_mfma_f32_16x16x32_bf16 v[44:47], a[176:179], a[108:111], v[44:47]
    v_mfma_f32_16x16x32_bf16 v[48:51], a[184:187], a[96:99], v[48:51]
    v_mfma_f32_16x16x32_bf16 v[48:51], a[188:191], a[112:115], v[48:51]
    v_mfma_f32_16x16x32_bf16 v[52:55], a[188:191], a[116:119], v[52:55]
    v_mfma_f32_16x16x32_bf16 v[52:55], a[184:187], a[100:103], v[52:55]
    v_mfma_f32_16x16x32_bf16 v[56:59], a[184:187], a[104:107], v[56:59]
    v_mfma_f32_16x16x32_bf16 v[56:59], a[188:191], a[120:123], v[56:59]
    v_mfma_f32_16x16x32_bf16 v[60:63], a[188:191], a[124:127], v[60:63]
    v_mfma_f32_16x16x32_bf16 v[60:63], a[184:187], a[108:111], v[60:63]
    s_waitcnt lgkmcnt(0)
    v_mfma_f32_16x16x32_bf16 v[0:3], v[128:131], a[128:131], v[0:3]
    buffer_load_dwordx4 v[220:223], v241, s[20:23], s57 offen offset:0 sc1
    v_mfma_f32_16x16x32_bf16 v[0:3], v[132:135], a[144:147], v[0:3]
    s_lshl_b32 s39, s32, 14
    s_add_u32 s39, s39, 18944
    v_mfma_f32_16x16x32_bf16 v[4:7], v[132:135], a[148:151], v[4:7]
    s_add_u32 s58, s30, 114688
    v_add_u32 v242, s39, v241
    s_mov_b32 s68, s39
    v_mfma_f32_16x16x32_bf16 v[4:7], v[128:131], a[132:135], v[4:7]
    s_nop 0
    s_lshr_b32 s37, s32, 1
    v_mfma_f32_16x16x32_bf16 v[8:11], v[128:131], a[136:139], v[8:11]
    s_and_b32 s38, s32, 1
    s_lshl_b32 s39, s37, 12
    v_mfma_f32_16x16x32_bf16 v[8:11], v[132:135], a[152:155], v[8:11]
    s_lshl3_add_u32 s39, s38, s39
    s_add_u32 s39, s39, 84480
    v_mfma_f32_16x16x32_bf16 v[12:15], v[132:135], a[156:159], v[12:15]
    v_add_u32 v243, s39, v241
    v_add_u32 v245, 18944, v241
    v_mfma_f32_16x16x32_bf16 v[12:15], v[128:131], a[140:143], v[12:15]
    v_mfma_f32_16x16x32_bf16 v[16:19], v[136:139], a[128:131], v[16:19]
    buffer_load_dwordx4 v[128:131], v241, s[20:23], s58 offen offset:0 sc1
    v_mfma_f32_16x16x32_bf16 v[16:19], v[140:143], a[144:147], v[16:19]
    v_mfma_f32_16x16x32_bf16 v[20:23], v[140:143], a[148:151], v[20:23]
    s_add_u32 s58, s30, 122880
    v_mfma_f32_16x16x32_bf16 v[20:23], v[136:139], a[132:135], v[20:23]
    v_mfma_f32_16x16x32_bf16 v[24:27], v[136:139], a[136:139], v[24:27]
    buffer_load_dwordx4 v[132:135], v241, s[20:23], s58 offen offset:0 sc1
    v_mfma_f32_16x16x32_bf16 v[24:27], v[140:143], a[152:155], v[24:27]
    v_mfma_f32_16x16x32_bf16 v[28:31], v[140:143], a[156:159], v[28:31]
    s_add_u32 s58, s30, 118784
    v_mfma_f32_16x16x32_bf16 v[28:31], v[136:139], a[140:143], v[28:31]
    s_waitcnt vmcnt(9)
    s_barrier
    v_mfma_f32_16x16x32_bf16 v[32:35], v[144:147], a[128:131], v[32:35]
    buffer_load_dwordx4 v[136:139], v241, s[20:23], s58 offen offset:0 sc1
    v_mfma_f32_16x16x32_bf16 v[32:35], v[148:151], a[144:147], v[32:35]
    ds_read_b128 a[160:163], v235 offset:40960
    v_mfma_f32_16x16x32_bf16 v[36:39], v[148:151], a[148:151], v[36:39]
    s_add_u32 s58, s30, 126976
    ds_read_b128 a[164:167], v235 offset:41472
    v_mfma_f32_16x16x32_bf16 v[36:39], v[144:147], a[132:135], v[36:39]
    ds_read_b128 a[168:171], v235 offset:45056
    v_mfma_f32_16x16x32_bf16 v[40:43], v[144:147], a[136:139], v[40:43]
    buffer_load_dwordx4 v[140:143], v241, s[20:23], s58 offen offset:0 sc1
    v_mfma_f32_16x16x32_bf16 v[40:43], v[148:151], a[152:155], v[40:43]
    ds_read_b128 a[172:175], v235 offset:45568
    v_mfma_f32_16x16x32_bf16 v[44:47], v[148:151], a[156:159], v[44:47]
    s_add_u32 s57, s30, 262144
    ds_read_b128 a[176:179], v248 offset:40960
    v_mfma_f32_16x16x32_bf16 v[44:47], v[144:147], a[140:143], v[44:47]
    ds_read_b128 a[180:183], v248 offset:41472
    v_mfma_f32_16x16x32_bf16 v[48:51], v[152:155], a[128:131], v[48:51]
    buffer_load_dwordx4 v[144:147], v241, s[20:23], s57 offen offset:0 sc1
    v_mfma_f32_16x16x32_bf16 v[48:51], v[156:159], a[144:147], v[48:51]
    ds_read_b128 a[184:187], v248 offset:45056
    v_mfma_f32_16x16x32_bf16 v[52:55], v[156:159], a[148:151], v[52:55]
    s_add_u32 s57, s30, 270336
    ds_read_b128 a[188:191], v248 offset:45568
    v_mfma_f32_16x16x32_bf16 v[52:55], v[152:155], a[132:135], v[52:55]
    v_mfma_f32_16x16x32_bf16 v[56:59], v[152:155], a[136:139], v[56:59]
    buffer_load_dwordx4 v[148:151], v241, s[20:23], s57 offen offset:0 sc1
    v_mfma_f32_16x16x32_bf16 v[56:59], v[156:159], a[152:155], v[56:59]
    v_mfma_f32_16x16x32_bf16 v[60:63], v[156:159], a[156:159], v[60:63]
    s_add_u32 s57, s30, 266240
    v_mfma_f32_16x16x32_bf16 v[60:63], v[152:155], a[140:143], v[60:63]
    s_waitcnt lgkmcnt(0)
    v_mfma_f32_16x16x32_bf16 v[0:3], v[160:163], a[160:163], v[0:3]
    buffer_load_dwordx4 v[152:155], v241, s[20:23], s57 offen offset:0 sc1
    v_mfma_f32_16x16x32_bf16 v[0:3], v[164:167], a[176:179], v[0:3]
    v_add_u32 v246, 84480, v241
    v_bfe_u32 v236, v240, 2, 2
    v_mfma_f32_16x16x32_bf16 v[4:7], v[164:167], a[180:183], v[4:7]
    s_add_u32 s57, s30, 274432
    v_lshrrev_b32 v237, 4, v240
    v_lshlrev_b32 v237, 6, v237
    v_mfma_f32_16x16x32_bf16 v[4:7], v[160:163], a[164:167], v[4:7]
    v_and_b32 v238, 3, v240
    v_lshl_add_u32 v237, v238, 4, v237
    v_mfma_f32_16x16x32_bf16 v[8:11], v[160:163], a[168:171], v[8:11]
    buffer_load_dwordx4 v[156:159], v241, s[20:23], s57 offen offset:0 sc1
    v_mfma_f32_16x16x32_bf16 v[8:11], v[164:167], a[184:187], v[8:11]
    v_lshl_add_u32 v237, v236, 8, v237
    v_cmp_eq_u32 vcc, 0, v236
    v_mfma_f32_16x16x32_bf16 v[12:15], v[164:167], a[188:191], v[12:15]
    s_add_u32 s58, s30, 131072
    v_add_u32 v236, s48, v236
    v_and_b32 v236, 7, v236
    v_mfma_f32_16x16x32_bf16 v[12:15], v[160:163], a[172:175], v[12:15]
    v_xor_b32 v238, 4, v236
    s_mov_b32 s39, 73728
    v_mfma_f32_16x16x32_bf16 v[16:19], v[168:171], a[160:163], v[16:19]
    buffer_load_dwordx4 v[160:163], v241, s[20:23], s58 offen offset:0 sc1
    v_mfma_f32_16x16x32_bf16 v[16:19], v[172:175], a[176:179], v[16:19]
    v_mfma_f32_16x16x32_bf16 v[20:23], v[172:175], a[180:183], v[20:23]
    s_add_u32 s58, s30, 139264
    v_mfma_f32_16x16x32_bf16 v[20:23], v[168:171], a[164:167], v[20:23]
    v_mfma_f32_16x16x32_bf16 v[24:27], v[168:171], a[168:171], v[24:27]
    buffer_load_dwordx4 v[164:167], v241, s[20:23], s58 offen offset:0 sc1
    v_mfma_f32_16x16x32_bf16 v[24:27], v[172:175], a[184:187], v[24:27]
    v_mfma_f32_16x16x32_bf16 v[28:31], v[172:175], a[188:191], v[28:31]
    s_add_u32 s58, s30, 135168
    v_mfma_f32_16x16x32_bf16 v[28:31], v[168:171], a[172:175], v[28:31]
    v_mfma_f32_16x16x32_bf16 v[32:35], v[176:179], a[160:163], v[32:35]
    buffer_load_dwordx4 v[168:171], v241, s[20:23], s58 offen offset:0 sc1
    v_mfma_f32_16x16x32_bf16 v[32:35], v[180:183], a[176:179], v[32:35]
    s_waitcnt vmcnt(16)
    s_barrier
    v_mfma_f32_16x16x32_bf16 v[36:39], v[180:183], a[180:183], v[36:39]
    s_add_u32 s58, s30, 143360
    ds_read_b128 a[192:195], v235 offset:49152
    v_mfma_f32_16x16x32_bf16 v[36:39], v[176:179], a[164:167], v[36:39]
    ds_read_b128 a[196:199], v235 offset:49664
    v_mfma_f32_16x16x32_bf16 v[40:43], v[176:179], a[168:171], v[40:43]
    buffer_load_dwordx4 v[172:175], v241, s[20:23], s58 offen offset:0 sc1
    v_mfma_f32_16x16x32_bf16 v[40:43], v[180:183], a[184:187], v[40:43]
    ds_read_b128 a[200:203], v235 offset:53248
    v_mfma_f32_16x16x32_bf16 v[44:47], v[180:183], a[188:191], v[44:47]
    s_add_u32 s57, s30, 278528
    ds_read_b128 a[204:207], v235 offset:53760
    v_mfma_f32_16x16x32_bf16 v[44:47], v[176:179], a[172:175], v[44:47]
    ds_read_b128 a[208:211], v248 offset:49152
    v_mfma_f32_16x16x32_bf16 v[48:51], v[184:187], a[160:163], v[48:51]
    buffer_load_dwordx4 v[176:179], v241, s[20:23], s57 offen offset:0 sc1
    v_mfma_f32_16x16x32_bf16 v[48:51], v[188:191], a[176:179], v[48:51]
    ds_read_b128 a[212:215], v248 offset:49664
    v_mfma_f32_16x16x32_bf16 v[52:55], v[188:191], a[180:183], v[52:55]
    s_add_u32 s57, s30, 286720
    ds_read_b128 a[216:219], v248 offset:53248
    v_mfma_f32_16x16x32_bf16 v[52:55], v[184:187], a[164:167], v[52:55]
    ds_read_b128 a[220:223], v248 offset:53760
    v_mfma_f32_16x16x32_bf16 v[56:59], v[184:187], a[168:171], v[56:59]
    buffer_load_dwordx4 v[180:183], v241, s[20:23], s57 offen offset:0 sc1
    v_mfma_f32_16x16x32_bf16 v[56:59], v[188:191], a[184:187], v[56:59]
    v_mfma_f32_16x16x32_bf16 v[60:63], v[188:191], a[188:191], v[60:63]
    s_add_u32 s57, s30, 282624
    v_mfma_f32_16x16x32_bf16 v[60:63], v[184:187], a[172:175], v[60:63]
    s_waitcnt lgkmcnt(0)
    v_mfma_f32_16x16x32_bf16 v[0:3], v[192:195], a[192:195], v[0:3]
    buffer_load_dwordx4 v[184:187], v241, s[20:23], s57 offen offset:0 sc1
    v_mfma_f32_16x16x32_bf16 v[0:3], v[196:199], a[208:211], v[0:3]
    v_mad_u32_u24 v236, v236, s39, v237
    v_mad_u32_u24 v250, v238, s39, v237
    v_mfma_f32_16x16x32_bf16 v[4:7], v[196:199], a[212:215], v[4:7]
    s_add_u32 s57, s30, 290816
    v_mov_b32 v237, 1073741824
    v_cndmask_b32 v244, v236, v237, vcc
    v_mfma_f32_16x16x32_bf16 v[4:7], v[192:195], a[196:199], v[4:7]
    s_mul_i32 s41, s32, 18432
    s_add_u32 s41, s41, 27262976
    v_mfma_f32_16x16x32_bf16 v[8:11], v[192:195], a[200:203], v[8:11]
    buffer_load_dwordx4 v[188:191], v241, s[20:23], s57 offen offset:0 sc1
    v_mfma_f32_16x16x32_bf16 v[8:11], v[196:199], a[216:219], v[8:11]
    s_mul_i32 s40, s31, 589824
    s_add_u32 s40, s40, s41
    v_mfma_f32_16x16x32_bf16 v[12:15], v[196:199], a[220:223], v[12:15]
    s_add_u32 s58, s30, 294912
    s_mul_i32 s44, s2, 73728
    s_add_u32 s44, s44, s41
    v_mfma_f32_16x16x32_bf16 v[12:15], v[192:195], a[204:207], v[12:15]
    s_mov_b32 s42, 0xc09d30fc
    v_and_b32 v236, 7, v240
    v_mfma_f32_16x16x32_bf16 v[16:19], v[200:203], a[192:195], v[16:19]
    buffer_load_dwordx4 v[192:195], v241, s[20:23], s58 offen offset:0 sc1
    v_mfma_f32_16x16x32_bf16 v[16:19], v[204:207], a[208:211], v[16:19]
    v_mfma_f32_16x16x32_bf16 v[20:23], v[204:207], a[212:215], v[20:23]
    s_add_u32 s58, s30, 303104
    v_mfma_f32_16x16x32_bf16 v[20:23], v[200:203], a[196:199], v[20:23]
    v_mfma_f32_16x16x32_bf16 v[24:27], v[200:203], a[200:203], v[24:27]
    buffer_load_dwordx4 v[196:199], v241, s[20:23], s58 offen offset:0 sc1
    v_mfma_f32_16x16x32_bf16 v[24:27], v[204:207], a[216:219], v[24:27]
    v_mfma_f32_16x16x32_bf16 v[28:31], v[204:207], a[220:223], v[28:31]
    s_add_u32 s58, s30, 311296
    v_mfma_f32_16x16x32_bf16 v[28:31], v[200:203], a[204:207], v[28:31]
    v_mfma_f32_16x16x32_bf16 v[32:35], v[208:211], a[192:195], v[32:35]
    buffer_load_dwordx4 v[200:203], v241, s[20:23], s58 offen offset:0 sc1
    v_mfma_f32_16x16x32_bf16 v[32:35], v[212:215], a[208:211], v[32:35]
    s_waitcnt vmcnt(22)
    s_barrier
    v_mfma_f32_16x16x32_bf16 v[36:39], v[212:215], a[212:215], v[36:39]
    s_add_u32 s58, s30, 299008
    ds_read_b128 a[224:227], v235 offset:57344
    v_mfma_f32_16x16x32_bf16 v[36:39], v[208:211], a[196:199], v[36:39]
    ds_read_b128 a[228:231], v235 offset:57856
    v_mfma_f32_16x16x32_bf16 v[40:43], v[208:211], a[200:203], v[40:43]
    buffer_load_dwordx4 v[204:207], v241, s[20:23], s58 offen offset:0 sc1
    v_mfma_f32_16x16x32_bf16 v[40:43], v[212:215], a[216:219], v[40:43]
    ds_read_b128 a[232:235], v235 offset:61440
    v_mfma_f32_16x16x32_bf16 v[44:47], v[212:215], a[220:223], v[44:47]
    s_add_u32 s58, s30, 307200
    ds_read_b128 a[236:239], v235 offset:61952
    v_mfma_f32_16x16x32_bf16 v[44:47], v[208:211], a[204:207], v[44:47]
    s_waitcnt vmcnt(19)
    ds_read_b128 a[240:243], v248 offset:57344
    v_mfma_f32_16x16x32_bf16 v[48:51], v[216:219], a[192:195], v[48:51]
    buffer_load_dwordx4 v[208:211], v241, s[20:23], s58 offen offset:0 sc1
    v_mfma_f32_16x16x32_bf16 v[48:51], v[220:223], a[208:211], v[48:51]
    ds_read_b128 a[244:247], v248 offset:57856
    v_mfma_f32_16x16x32_bf16 v[52:55], v[220:223], a[212:215], v[52:55]
    s_add_u32 s58, s30, 315392
    ds_read_b128 a[248:251], v248 offset:61440
    v_mfma_f32_16x16x32_bf16 v[52:55], v[216:219], a[196:199], v[52:55]
    ds_read_b128 a[252:255], v248 offset:61952
    v_mfma_f32_16x16x32_bf16 v[56:59], v[216:219], a[200:203], v[56:59]
    buffer_load_dwordx4 v[212:215], v241, s[20:23], s58 offen offset:0 sc1
    v_mfma_f32_16x16x32_bf16 v[56:59], v[220:223], a[216:219], v[56:59]
    v_mfma_f32_16x16x32_bf16 v[60:63], v[220:223], a[220:223], v[60:63]
    s_add_u32 s58, s30, 319488
    v_mfma_f32_16x16x32_bf16 v[60:63], v[216:219], a[204:207], v[60:63]
    s_waitcnt vmcnt(19) lgkmcnt(0)
    v_mfma_f32_16x16x32_bf16 v[0:3], v[128:131], a[224:227], v[0:3]
    buffer_load_dwordx4 v[216:219], v241, s[20:23], s58 offen offset:0 sc1
    v_mfma_f32_16x16x32_bf16 v[0:3], v[132:135], a[240:243], v[0:3]
    v_max_u32 v236, 1, v236
    v_add_u32 v236, s48, v236
    v_mfma_f32_16x16x32_bf16 v[4:7], v[132:135], a[244:247], v[4:7]
    s_add_u32 s58, s30, 327680
    v_and_b32 v236, 7, v236
    v_lshlrev_b32 v247, 9, v236
    v_mfma_f32_16x16x32_bf16 v[4:7], v[128:131], a[228:231], v[4:7]
    s_lshl_b32 s52, s31, 5
    s_add_u32 s52, s52, s32
    v_mfma_f32_16x16x32_bf16 v[8:11], v[128:131], a[232:235], v[8:11]
    buffer_load_dwordx4 v[220:223], v241, s[20:23], s58 offen offset:0 sc1
    v_mfma_f32_16x16x32_bf16 v[8:11], v[132:135], a[248:251], v[8:11]
    s_lshl_b32 s52, s52, 7
    s_add_u32 s52, s52, 46272512
    v_mfma_f32_16x16x32_bf16 v[12:15], v[132:135], a[252:255], v[12:15]
    s_add_u32 s58, s30, 335872
    s_mov_b32 s54, 0x000f000f
    s_mov_b32 s55, 0x000f000f
    v_mfma_f32_16x16x32_bf16 v[12:15], v[128:131], a[236:239], v[12:15]
    s_waitcnt vmcnt(19)
    s_mul_i32 s39, s32, 5120
    s_add_u32 s39, s39, 18944
    v_mfma_f32_16x16x32_bf16 v[16:19], v[136:139], a[224:227], v[16:19]
    buffer_load_dwordx4 v[128:131], v241, s[20:23], s58 offen offset:0 sc1
    v_mfma_f32_16x16x32_bf16 v[16:19], v[140:143], a[240:243], v[16:19]
    v_mfma_f32_16x16x32_bf16 v[20:23], v[140:143], a[244:247], v[20:23]
    s_add_u32 s58, s30, 323584
    v_mfma_f32_16x16x32_bf16 v[20:23], v[136:139], a[228:231], v[20:23]
    v_mfma_f32_16x16x32_bf16 v[24:27], v[136:139], a[232:235], v[24:27]
    buffer_load_dwordx4 v[132:135], v241, s[20:23], s58 offen offset:0 sc1
    v_mfma_f32_16x16x32_bf16 v[24:27], v[140:143], a[248:251], v[24:27]
    v_mfma_f32_16x16x32_bf16 v[28:31], v[140:143], a[252:255], v[28:31]
    s_add_u32 s58, s30, 331776
    v_mfma_f32_16x16x32_bf16 v[28:31], v[136:139], a[236:239], v[28:31]
    s_waitcnt vmcnt(19)
    v_mfma_f32_16x16x32_bf16 v[32:35], v[144:147], a[224:227], v[32:35]
    buffer_load_dwordx4 v[136:139], v241, s[20:23], s58 offen offset:0 sc1
    v_mfma_f32_16x16x32_bf16 v[32:35], v[148:151], a[240:243], v[32:35]
    s_barrier
    v_mfma_f32_16x16x32_bf16 v[36:39], v[148:151], a[244:247], v[36:39]
    s_add_u32 s58, s30, 339968
    ds_read_b128 v[96:99], v249 offset:0
    v_mfma_f32_16x16x32_bf16 v[36:39], v[144:147], a[228:231], v[36:39]
    ds_read_b128 v[100:103], v249 offset:512
    v_mfma_f32_16x16x32_bf16 v[40:43], v[144:147], a[232:235], v[40:43]
    buffer_load_dwordx4 v[140:143], v241, s[20:23], s58 offen offset:0 sc1
    v_mfma_f32_16x16x32_bf16 v[40:43], v[148:151], a[248:251], v[40:43]
    ds_read_b128 v[104:107], v249 offset:4096
    v_mfma_f32_16x16x32_bf16 v[44:47], v[148:151], a[252:255], v[44:47]
    s_add_u32 s58, s30, 344064
    ds_read_b128 v[108:111], v249 offset:4608
    v_mfma_f32_16x16x32_bf16 v[44:47], v[144:147], a[236:239], v[44:47]
    s_waitcnt vmcnt(19)
    ds_read_b128 v[112:115], v251 offset:0
    v_mfma_f32_16x16x32_bf16 v[48:51], v[152:155], a[224:227], v[48:51]
    buffer_load_dwordx4 v[144:147], v241, s[20:23], s58 offen offset:0 sc1
    v_mfma_f32_16x16x32_bf16 v[48:51], v[156:159], a[240:243], v[48:51]
    ds_read_b128 v[116:119], v251 offset:512
    v_mfma_f32_16x16x32_bf16 v[52:55], v[156:159], a[244:247], v[52:55]
    s_add_u32 s58, s30, 352256
    ds_read_b128 v[120:123], v251 offset:4096
    v_mfma_f32_16x16x32_bf16 v[52:55], v[152:155], a[228:231], v[52:55]
    ds_read_b128 v[124:127], v251 offset:4608
    v_mfma_f32_16x16x32_bf16 v[56:59], v[152:155], a[232:235], v[56:59]
    buffer_load_dwordx4 v[148:151], v241, s[20:23], s58 offen offset:0 sc1
    v_mfma_f32_16x16x32_bf16 v[56:59], v[156:159], a[248:251], v[56:59]
    v_mfma_f32_16x16x32_bf16 v[60:63], v[156:159], a[252:255], v[60:63]
    s_add_u32 s58, s30, 360448
    v_mfma_f32_16x16x32_bf16 v[60:63], v[152:155], a[236:239], v[60:63]
    s_waitcnt vmcnt(19) lgkmcnt(0)
    v_mfma_f32_16x16x32_bf16 v[0:3], v[160:163], v[96:99], v[0:3]
    buffer_load_dwordx4 v[152:155], v241, s[20:23], s58 offen offset:0 sc1
    v_mfma_f32_16x16x32_bf16 v[0:3], v[164:167], v[112:115], v[0:3]
    v_mfma_f32_16x16x32_bf16 v[4:7], v[164:167], v[116:119], v[4:7]
    s_add_u32 s58, s30, 348160
    v_mfma_f32_16x16x32_bf16 v[4:7], v[160:163], v[100:103], v[4:7]
    v_mfma_f32_16x16x32_bf16 v[8:11], v[160:163], v[104:107], v[8:11]
    buffer_load_dwordx4 v[156:159], v241, s[20:23], s58 offen offset:0 sc1
    v_mfma_f32_16x16x32_bf16 v[8:11], v[164:167], v[120:123], v[8:11]
    v_mfma_f32_16x16x32_bf16 v[12:15], v[164:167], v[124:127], v[12:15]
    s_add_u32 s58, s30, 356352
    v_mfma_f32_16x16x32_bf16 v[12:15], v[160:163], v[108:111], v[12:15]
    s_waitcnt vmcnt(19)
    v_mfma_f32_16x16x32_bf16 v[16:19], v[168:171], v[96:99], v[16:19]
    buffer_load_dwordx4 v[160:163], v241, s[20:23], s58 offen offset:0 sc1
    v_mfma_f32_16x16x32_bf16 v[16:19], v[172:175], v[112:115], v[16:19]
    v_mfma_f32_16x16x32_bf16 v[20:23], v[172:175], v[116:119], v[20:23]
    s_add_u32 s58, s30, 364544
    v_mfma_f32_16x16x32_bf16 v[20:23], v[168:171], v[100:103], v[20:23]
    v_mfma_f32_16x16x32_bf16 v[24:27], v[168:171], v[104:107], v[24:27]
    buffer_load_dwordx4 v[164:167], v241, s[20:23], s58 offen offset:0 sc1
    v_mfma_f32_16x16x32_bf16 v[24:27], v[172:175], v[120:123], v[24:27]
    v_mfma_f32_16x16x32_bf16 v[28:31], v[172:175], v[124:127], v[28:31]
    s_add_u32 s58, s30, 368640
    v_mfma_f32_16x16x32_bf16 v[28:31], v[168:171], v[108:111], v[28:31]
    s_waitcnt vmcnt(19)
    v_mfma_f32_16x16x32_bf16 v[32:35], v[176:179], v[96:99], v[32:35]
    buffer_load_dwordx4 v[168:171], v241, s[20:23], s58 offen offset:0 sc1
    v_mfma_f32_16x16x32_bf16 v[32:35], v[180:183], v[112:115], v[32:35]
    v_mfma_f32_16x16x32_bf16 v[36:39], v[180:183], v[116:119], v[36:39]
    s_add_u32 s58, s30, 376832
    v_mfma_f32_16x16x32_bf16 v[36:39], v[176:179], v[100:103], v[36:39]
    v_mfma_f32_16x16x32_bf16 v[40:43], v[176:179], v[104:107], v[40:43]
    buffer_load_dwordx4 v[172:175], v241, s[20:23], s58 offen offset:0 sc1
    v_mfma_f32_16x16x32_bf16 v[40:43], v[180:183], v[120:123], v[40:43]
    v_mfma_f32_16x16x32_bf16 v[44:47], v[180:183], v[124:127], v[44:47]
    s_add_u32 s58, s30, 385024
    v_mfma_f32_16x16x32_bf16 v[44:47], v[176:179], v[108:111], v[44:47]
    s_waitcnt vmcnt(19)
    v_mfma_f32_16x16x32_bf16 v[48:51], v[184:187], v[96:99], v[48:51]
    buffer_load_dwordx4 v[176:179], v241, s[20:23], s58 offen offset:0 sc1
    v_mfma_f32_16x16x32_bf16 v[48:51], v[188:191], v[112:115], v[48:51]
    v_mfma_f32_16x16x32_bf16 v[52:55], v[188:191], v[116:119], v[52:55]
    s_add_u32 s58, s30, 372736
    v_mfma_f32_16x16x32_bf16 v[52:55], v[184:187], v[100:103], v[52:55]
    v_mfma_f32_16x16x32_bf16 v[56:59], v[184:187], v[104:107], v[56:59]
    buffer_load_dwordx4 v[180:183], v241, s[20:23], s58 offen offset:0 sc1
    v_mfma_f32_16x16x32_bf16 v[56:59], v[188:191], v[120:123], v[56:59]
    v_mfma_f32_16x16x32_bf16 v[60:63], v[188:191], v[124:127], v[60:63]
    s_add_u32 s58, s30, 380928
    v_mfma_f32_16x16x32_bf16 v[60:63], v[184:187], v[108:111], v[60:63]
    s_waitcnt vmcnt(19)
    v_mfma_f32_16x16x32_bf16 v[64:67], v[192:195], a[0:3], 0
    buffer_load_dwordx4 v[184:187], v241, s[20:23], s58 offen offset:0 sc1
    v_mfma_f32_16x16x32_bf16 v[64:67], v[196:199], a[16:19], v[64:67]
    s_barrier
    v_mfma_f32_16x16x32_bf16 v[64:67], v[200:203], a[32:35], v[64:67]
    s_add_u32 s58, s30, 389120
    v_fma_f32 v224, -v0, v0, s42
    v_fma_f32 v225, -v1, v1, s42
    v_mfma_f32_16x16x32_bf16 v[68:71], v[200:203], a[36:39], 0
    v_mul_f32 v224, v224, v0
    v_mul_f32 v225, v225, v1
    v_mfma_f32_16x16x32_bf16 v[68:71], v[196:199], a[20:23], v[68:71]
    buffer_load_dwordx4 v[188:191], v241, s[20:23], s58 offen offset:0 sc1
    v_mfma_f32_16x16x32_bf16 v[68:71], v[192:195], a[4:7], v[68:71]
    v_fma_f32 v226, -v2, v2, s42
    v_fma_f32 v227, -v3, v3, s42
    v_mfma_f32_16x16x32_bf16 v[72:75], v[192:195], a[8:11], 0
    s_add_u32 s58, s30, 393216
    v_mul_f32 v226, v226, v2
    v_mul_f32 v227, v227, v3
    v_mfma_f32_16x16x32_bf16 v[72:75], v[196:199], a[24:27], v[72:75]
    v_exp_f32 v224, v224
    v_mfma_f32_16x16x32_bf16 v[72:75], v[200:203], a[40:43], v[72:75]
    v_exp_f32 v225, v225
    v_mfma_f32_16x16x32_bf16 v[76:79], v[200:203], a[44:47], 0
    v_exp_f32 v226, v226
    v_mfma_f32_16x16x32_bf16 v[76:79], v[196:199], a[28:31], v[76:79]
    v_exp_f32 v227, v227
    v_mfma_f32_16x16x32_bf16 v[76:79], v[192:195], a[12:15], v[76:79]
    s_waitcnt vmcnt(18)
    v_add_f32 v224, 1.0, v224
    v_add_f32 v225, 1.0, v225
    v_mfma_f32_16x16x32_bf16 v[80:83], v[204:207], a[0:3], 0
    buffer_load_dwordx4 v[192:195], v241, s[20:23], s58 offen offset:0 sc1
    v_mfma_f32_16x16x32_bf16 v[80:83], v[208:211], a[16:19], v[80:83]
    v_add_f32 v226, 1.0, v226
    v_add_f32 v227, 1.0, v227
    v_mfma_f32_16x16x32_bf16 v[80:83], v[212:215], a[32:35], v[80:83]
    s_add_u32 s58, s30, 401408
    v_rcp_f32 v224, v224
    v_mfma_f32_16x16x32_bf16 v[84:87], v[212:215], a[36:39], 0
    v_rcp_f32 v225, v225
    v_mfma_f32_16x16x32_bf16 v[84:87], v[208:211], a[20:23], v[84:87]
    buffer_load_dwordx4 v[196:199], v241, s[20:23], s58 offen offset:0 sc1
    v_mfma_f32_16x16x32_bf16 v[84:87], v[204:207], a[4:7], v[84:87]
    v_rcp_f32 v226, v226
    v_mfma_f32_16x16x32_bf16 v[88:91], v[204:207], a[8:11], 0
    s_add_u32 s58, s30, 409600
    v_rcp_f32 v227, v227
    v_mfma_f32_16x16x32_bf16 v[88:91], v[208:211], a[24:27], v[88:91]
    v_mul_f32 v0, v0, v16
    v_mul_f32 v1, v1, v17
    v_mfma_f32_16x16x32_bf16 v[88:91], v[212:215], a[40:43], v[88:91]
    buffer_load_dwordx4 v[200:203], v241, s[20:23], s58 offen offset:0 sc1
    v_mfma_f32_16x16x32_bf16 v[92:95], v[212:215], a[44:47], 0
    v_mul_f32 v2, v2, v18
    v_mul_f32 v3, v3, v19
    v_mfma_f32_16x16x32_bf16 v[92:95], v[208:211], a[28:31], v[92:95]
    s_add_u32 s58, s30, 397312
    v_mul_f32 v224, v224, v0
    v_mul_f32 v225, v225, v1
    v_mfma_f32_16x16x32_bf16 v[92:95], v[204:207], a[12:15], v[92:95]
    s_waitcnt vmcnt(18)
    v_mul_f32 v226, v226, v2
    v_mul_f32 v227, v227, v3
    v_mfma_f32_16x16x32_bf16 v[64:67], v[216:219], a[48:51], v[64:67]
    buffer_load_dwordx4 v[204:207], v241, s[20:23], s58 offen offset:0 sc1
    v_mfma_f32_16x16x32_bf16 v[64:67], v[220:223], a[64:67], v[64:67]
    v_cvt_pk_bf16_f32 v232, v224, v225
    v_cvt_pk_bf16_f32 v233, v226, v227
    v_mfma_f32_16x16x32_bf16 v[64:67], v[128:131], a[80:83], v[64:67]
    s_add_u32 s58, s30, 405504
    ds_write_b64 v242, v[232:233] offset:0
    v_mfma_f32_16x16x32_bf16 v[68:71], v[128:131], a[84:87], v[68:71]
    v_fma_f32 v228, -v4, v4, s42
    v_fma_f32 v229, -v5, v5, s42
    v_mfma_f32_16x16x32_bf16 v[68:71], v[220:223], a[68:71], v[68:71]
    buffer_load_dwordx4 v[208:211], v241, s[20:23], s58 offen offset:0 sc1
    v_mfma_f32_16x16x32_bf16 v[68:71], v[216:219], a[52:55], v[68:71]
    v_mul_f32 v228, v228, v4
    v_mul_f32 v229, v229, v5
    v_mfma_f32_16x16x32_bf16 v[72:75], v[216:219], a[56:59], v[72:75]
    s_add_u32 s58, s30, 413696
    v_fma_f32 v230, -v6, v6, s42
    v_fma_f32 v231, -v7, v7, s42
    v_mfma_f32_16x16x32_bf16 v[72:75], v[220:223], a[72:75], v[72:75]
    v_mul_f32 v230, v230, v6
    v_mul_f32 v231, v231, v7
    v_mfma_f32_16x16x32_bf16 v[72:75], v[128:131], a[88:91], v[72:75]
    buffer_load_dwordx4 v[212:215], v241, s[20:23], s58 offen offset:0 sc1
    v_mfma_f32_16x16x32_bf16 v[76:79], v[128:131], a[92:95], v[76:79]
    v_exp_f32 v228, v228
    v_mfma_f32_16x16x32_bf16 v[76:79], v[220:223], a[76:79], v[76:79]
    s_add_u32 s58, s30, 417792
    v_exp_f32 v229, v229
    v_mfma_f32_16x16x32_bf16 v[76:79], v[216:219], a[60:63], v[76:79]
    s_waitcnt vmcnt(18)
    v_exp_f32 v230, v230
    v_mfma_f32_16x16x32_bf16 v[80:83], v[132:135], a[48:51], v[80:83]
    buffer_load_dwordx4 v[216:219], v241, s[20:23], s58 offen offset:0 sc1
    v_mfma_f32_16x16x32_bf16 v[80:83], v[136:139], a[64:67], v[80:83]
    v_exp_f32 v231, v231
    v_mfma_f32_16x16x32_bf16 v[80:83], v[140:143], a[80:83], v[80:83]
    s_add_u32 s58, s30, 425984
    v_add_f32 v228, 1.0, v228
    v_add_f32 v229, 1.0, v229
    v_mfma_f32_16x16x32_bf16 v[84:87], v[140:143], a[84:87], v[84:87]
    v_add_f32 v230, 1.0, v230
    v_add_f32 v231, 1.0, v231
    v_mfma_f32_16x16x32_bf16 v[84:87], v[136:139], a[68:71], v[84:87]
    buffer_load_dwordx4 v[220:223], v241, s[20:23], s58 offen offset:0 sc1
    v_mfma_f32_16x16x32_bf16 v[84:87], v[132:135], a[52:55], v[84:87]
    v_rcp_f32 v228, v228
    v_mfma_f32_16x16x32_bf16 v[88:91], v[132:135], a[56:59], v[88:91]
    s_add_u32 s58, s30, 434176
    v_rcp_f32 v229, v229
    v_mfma_f32_16x16x32_bf16 v[88:91], v[136:139], a[72:75], v[88:91]
    v_rcp_f32 v230, v230
    v_mfma_f32_16x16x32_bf16 v[88:91], v[140:143], a[88:91], v[88:91]
    buffer_load_dwordx4 v[128:131], v241, s[20:23], s58 offen offset:0 sc1
    v_mfma_f32_16x16x32_bf16 v[92:95], v[140:143], a[92:95], v[92:95]
    v_rcp_f32 v231, v231
    v_mfma_f32_16x16x32_bf16 v[92:95], v[136:139], a[76:79], v[92:95]
    s_add_u32 s58, s30, 421888
    v_mul_f32 v4, v4, v20
    v_mul_f32 v5, v5, v21
    v_mfma_f32_16x16x32_bf16 v[92:95], v[132:135], a[60:63], v[92:95]
    s_waitcnt vmcnt(18)
    v_mul_f32 v6, v6, v22
    v_mul_f32 v7, v7, v23
    v_mfma_f32_16x16x32_bf16 v[64:67], v[144:147], a[96:99], v[64:67]
HOP2_1:
    s_cbranch_execz HOP2_5
    buffer_load_dwordx4 v[132:135], v241, s[20:23], s58 offen offset:0 sc1
    v_mfma_f32_16x16x32_bf16 v[64:67], v[148:151], a[112:115], v[64:67]
    v_mul_f32 v228, v228, v4
    v_mul_f32 v229, v229, v5
    v_mfma_f32_16x16x32_bf16 v[64:67], v[152:155], a[128:131], v[64:67]
    s_add_u32 s58, s30, 430080
    v_mul_f32 v230, v230, v6
    v_mul_f32 v231, v231, v7
    v_mfma_f32_16x16x32_bf16 v[68:71], v[152:155], a[132:135], v[68:71]
    v_cvt_pk_bf16_f32 v234, v228, v229
    v_cvt_pk_bf16_f32 v235, v230, v231
    v_mfma_f32_16x16x32_bf16 v[68:71], v[148:151], a[116:119], v[68:71]
    buffer_load_dwordx4 v[136:139], v241, s[20:23], s58 offen offset:0 sc1
    v_mfma_f32_16x16x32_bf16 v[68:71], v[144:147], a[100:103], v[68:71]
    ds_write_b64 v242, v[234:235] offset:1024
    v_mfma_f32_16x16x32_bf16 v[72:75], v[144:147], a[104:107], v[72:75]
    s_add_u32 s58, s30, 438272
    v_fma_f32 v224, -v8, v8, s42
    v_fma_f32 v225, -v9, v9, s42
    v_mfma_f32_16x16x32_bf16 v[72:75], v[148:151], a[120:123], v[72:75]
    v_mul_f32 v224, v224, v8
    v_mul_f32 v225, v225, v9
    v_mfma_f32_16x16x32_bf16 v[72:75], v[152:155], a[136:139], v[72:75]
    buffer_load_dwordx4 v[140:143], v241, s[20:23], s58 offen offset:0 sc1
    v_mfma_f32_16x16x32_bf16 v[76:79], v[152:155], a[140:143], v[76:79]
    v_fma_f32 v226, -v10, v10, s42
    v_fma_f32 v227, -v11, v11, s42
    v_mfma_f32_16x16x32_bf16 v[76:79], v[148:151], a[124:127], v[76:79]
    s_add_u32 s58, s30, 442368
    v_mul_f32 v226, v226, v10
    v_mul_f32 v227, v227, v11
    v_mfma_f32_16x16x32_bf16 v[76:79], v[144:147], a[108:111], v[76:79]
    s_waitcnt vmcnt(18)
    v_exp_f32 v224, v224
    v_mfma_f32_16x16x32_bf16 v[80:83], v[156:159], a[96:99], v[80:83]
    buffer_load_dwordx4 v[144:147], v241, s[20:23], s58 offen offset:0 sc1
    v_mfma_f32_16x16x32_bf16 v[80:83], v[160:163], a[112:115], v[80:83]
    v_exp_f32 v225, v225
    v_mfma_f32_16x16x32_bf16 v[80:83], v[164:167], a[128:131], v[80:83]
    s_add_u32 s58, s30, 450560
    v_exp_f32 v226, v226
    v_mfma_f32_16x16x32_bf16 v[84:87], v[164:167], a[132:135], v[84:87]
    v_exp_f32 v227, v227
    v_mfma_f32_16x16x32_bf16 v[84:87], v[160:163], a[116:119], v[84:87]
    buffer_load_dwordx4 v[148:151], v241, s[20:23], s58 offen offset:0 sc1
    v_mfma_f32_16x16x32_bf16 v[84:87], v[156:159], a[100:103], v[84:87]
    v_add_f32 v224, 1.0, v224
    v_add_f32 v225, 1.0, v225
    v_mfma_f32_16x16x32_bf16 v[88:91], v[156:159], a[104:107], v[88:91]
    s_add_u32 s58, s30, 458752
    v_add_f32 v226, 1.0, v226
    v_add_f32 v227, 1.0, v227
    v_mfma_f32_16x16x32_bf16 v[88:91], v[160:163], a[120:123], v[88:91]
    v_rcp_f32 v224, v224
    v_mfma_f32_16x16x32_bf16 v[88:91], v[164:167], a[136:139], v[88:91]
    buffer_load_dwordx4 v[152:155], v241, s[20:23], s58 offen offset:0 sc1
    v_mfma_f32_16x16x32_bf16 v[92:95], v[164:167], a[140:143], v[92:95]
    v_rcp_f32 v225, v225
    v_mfma_f32_16x16x32_bf16 v[92:95], v[160:163], a[124:127], v[92:95]
    s_add_u32 s58, s30, 446464
    v_rcp_f32 v226, v226
    v_mfma_f32_16x16x32_bf16 v[92:95], v[156:159], a[108:111], v[92:95]
    s_waitcnt vmcnt(18)
    v_rcp_f32 v227, v227
    v_mfma_f32_16x16x32_bf16 v[64:67], v[168:171], a[144:147], v[64:67]
    buffer_load_dwordx4 v[156:159], v241, s[20:23], s58 offen offset:0 sc1
    v_mfma_f32_16x16x32_bf16 v[64:67], v[172:175], a[160:163], v[64:67]
    v_mul_f32 v8, v8, v24
    v_mul_f32 v9, v9, v25
    v_mfma_f32_16x16x32_bf16 v[64:67], v[176:179], a[176:179], v[64:67]
    s_add_u32 s58, s30, 454656
    v_mul_f32 v10, v10, v26
    v_mul_f32 v11, v11, v27
    v_mfma_f32_16x16x32_bf16 v[68:71], v[176:179], a[180:183], v[68:71]
    v_mul_f32 v224, v224, v8
    v_mul_f32 v225, v225, v9
    v_mfma_f32_16x16x32_bf16 v[68:71], v[172:175], a[164:167], v[68:71]
    buffer_load_dwordx4 v[160:163], v241, s[20:23], s58 offen offset:0 sc1
    v_mfma_f32_16x16x32_bf16 v[68:71], v[168:171], a[148:151], v[68:71]
    v_mul_f32 v226, v226, v10
    v_mul_f32 v227, v227, v11
    v_mfma_f32_16x16x32_bf16 v[72:75], v[168:171], a[152:155], v[72:75]
    s_add_u32 s58, s30, 462848
    v_cvt_pk_bf16_f32 v236, v224, v225
    v_cvt_pk_bf16_f32 v237, v226, v227
    v_mfma_f32_16x16x32_bf16 v[72:75], v[172:175], a[168:171], v[72:75]
    ds_write_b64 v242, v[236:237] offset:2048
    v_mfma_f32_16x16x32_bf16 v[72:75], v[176:179], a[184:187], v[72:75]
    buffer_load_dwordx4 v[164:167], v241, s[20:23], s58 offen offset:0 sc1
    v_mfma_f32_16x16x32_bf16 v[76:79], v[176:179], a[188:191], v[76:79]
    v_fma_f32 v228, -v12, v12, s42
    v_fma_f32 v229, -v13, v13, s42
    v_mfma_f32_16x16x32_bf16 v[76:79], v[172:175], a[172:175], v[76:79]
    s_add_u32 s58, s30, 466944
    v_mul_f32 v228, v228, v12
    v_mul_f32 v229, v229, v13
    v_mfma_f32_16x16x32_bf16 v[76:79], v[168:171], a[156:159], v[76:79]
    s_waitcnt vmcnt(18)
    v_fma_f32 v230, -v14, v14, s42
    v_fma_f32 v231, -v15, v15, s42
    v_mfma_f32_16x16x32_bf16 v[80:83], v[180:183], a[144:147], v[80:83]
    buffer_load_dwordx4 v[168:171], v241, s[20:23], s58 offen offset:0 sc1
    v_mfma_f32_16x16x32_bf16 v[80:83], v[184:187], a[160:163], v[80:83]
    v_mul_f32 v230, v230, v14
    v_mul_f32 v231, v231, v15
    v_mfma_f32_16x16x32_bf16 v[80:83], v[188:191], a[176:179], v[80:83]
    s_add_u32 s58, s30, 475136
    v_exp_f32 v228, v228
    v_mfma_f32_16x16x32_bf16 v[84:87], v[188:191], a[180:183], v[84:87]
    v_exp_f32 v229, v229
    v_mfma_f32_16x16x32_bf16 v[84:87], v[184:187], a[164:167], v[84:87]
    buffer_load_dwordx4 v[172:175], v241, s[20:23], s58 offen offset:0 sc1
    v_mfma_f32_16x16x32_bf16 v[84:87], v[180:183], a[148:151], v[84:87]
    v_exp_f32 v230, v230
    v_mfma_f32_16x16x32_bf16 v[88:91], v[180:183], a[152:155], v[88:91]
    s_add_u32 s58, s30, 483328
    v_exp_f32 v231, v231
    v_mfma_f32_16x16x32_bf16 v[88:91], v[184:187], a[168:171], v[88:91]
    v_add_f32 v228, 1.0, v228
    v_add_f32 v229, 1.0, v229
    v_mfma_f32_16x16x32_bf16 v[88:91], v[188:191], a[184:187], v[88:91]
    buffer_load_dwordx4 v[176:179], v241, s[20:23], s58 offen offset:0 sc1
    v_mfma_f32_16x16x32_bf16 v[92:95], v[188:191], a[188:191], v[92:95]
    v_add_f32 v230, 1.0, v230
    v_add_f32 v231, 1.0, v231
    v_mfma_f32_16x16x32_bf16 v[92:95], v[184:187], a[172:175], v[92:95]
    s_add_u32 s58, s30, 471040
    v_rcp_f32 v228, v228
    v_mfma_f32_16x16x32_bf16 v[92:95], v[180:183], a[156:159], v[92:95]
    s_waitcnt vmcnt(18)
    v_rcp_f32 v229, v229
    v_mfma_f32_16x16x32_bf16 v[64:67], v[192:195], a[192:195], v[64:67]
    buffer_load_dwordx4 v[180:183], v241, s[20:23], s58 offen offset:0 sc1
    v_mfma_f32_16x16x32_bf16 v[64:67], v[196:199], a[208:211], v[64:67]
    v_rcp_f32 v230, v230
    v_mfma_f32_16x16x32_bf16 v[64:67], v[200:203], a[224:227], v[64:67]
    s_add_u32 s58, s30, 479232
    v_rcp_f32 v231, v231
    v_mfma_f32_16x16x32_bf16 v[68:71], v[200:203], a[228:231], v[68:71]
    v_mul_f32 v12, v12, v28
    v_mul_f32 v13, v13, v29
    v_mfma_f32_16x16x32_bf16 v[68:71], v[196:199], a[212:215], v[68:71]
    buffer_load_dwordx4 v[184:187], v241, s[20:23], s58 offen offset:0 sc1
    v_mfma_f32_16x16x32_bf16 v[68:71], v[192:195], a[196:199], v[68:71]
    v_mul_f32 v14, v14, v30
    v_mul_f32 v15, v15, v31
    v_mfma_f32_16x16x32_bf16 v[72:75], v[192:195], a[200:203], v[72:75]
    s_add_u32 s58, s30, 487424
    v_mul_f32 v228, v228, v12
    v_mul_f32 v229, v229, v13
    v_mfma_f32_16x16x32_bf16 v[72:75], v[196:199], a[216:219], v[72:75]
    v_mul_f32 v230, v230, v14
    v_mul_f32 v231, v231, v15
    v_mfma_f32_16x16x32_bf16 v[72:75], v[200:203], a[232:235], v[72:75]
    buffer_load_dwordx4 v[188:191], v241, s[20:23], s58 offen offset:0 sc1
    v_mfma_f32_16x16x32_bf16 v[76:79], v[200:203], a[236:239], v[76:79]
    v_cvt_pk_bf16_f32 v238, v228, v229
    v_cvt_pk_bf16_f32 v239, v230, v231
    v_mfma_f32_16x16x32_bf16 v[76:79], v[196:199], a[220:223], v[76:79]
    s_add_u32 s58, s30, 491520
    ds_write_b64 v242, v[238:239] offset:3072
    v_mfma_f32_16x16x32_bf16 v[76:79], v[192:195], a[204:207], v[76:79]
    s_waitcnt vmcnt(18)
    v_fma_f32 v224, -v32, v32, s42
    v_fma_f32 v225, -v33, v33, s42
    v_mfma_f32_16x16x32_bf16 v[80:83], v[204:207], a[192:195], v[80:83]
    buffer_load_dwordx4 v[192:195], v241, s[20:23], s58 offen offset:0 sc1
    v_mfma_f32_16x16x32_bf16 v[80:83], v[208:211], a[208:211], v[80:83]
    v_mul_f32 v224, v224, v32
    v_mul_f32 v225, v225, v33
    v_mfma_f32_16x16x32_bf16 v[80:83], v[212:215], a[224:227], v[80:83]
    s_add_u32 s58, s30, 499712
    v_fma_f32 v226, -v34, v34, s42
    v_fma_f32 v227, -v35, v35, s42
    v_mfma_f32_16x16x32_bf16 v[84:87], v[212:215], a[228:231], v[84:87]
    v_mul_f32 v226, v226, v34
    v_mul_f32 v227, v227, v35
    v_mfma_f32_16x16x32_bf16 v[84:87], v[208:211], a[212:215], v[84:87]
    buffer_load_dwordx4 v[196:199], v241, s[20:23], s58 offen offset:0 sc1
    v_mfma_f32_16x16x32_bf16 v[84:87], v[204:207], a[196:199], v[84:87]
    v_exp_f32 v224, v224
    v_mfma_f32_16x16x32_bf16 v[88:91], v[204:207], a[200:203], v[88:91]
    s_add_u32 s58, s30, 507904
    v_exp_f32 v225, v225
    v_mfma_f32_16x16x32_bf16 v[88:91], v[208:211], a[216:219], v[88:91]
    v_exp_f32 v226, v226
    v_mfma_f32_16x16x32_bf16 v[88:91], v[212:215], a[232:235], v[88:91]
    buffer_load_dwordx4 v[200:203], v241, s[20:23], s58 offen offset:0 sc1
    v_mfma_f32_16x16x32_bf16 v[92:95], v[212:215], a[236:239], v[92:95]
    v_exp_f32 v227, v227
    v_mfma_f32_16x16x32_bf16 v[92:95], v[208:211], a[220:223], v[92:95]
    s_add_u32 s58, s30, 495616
    v_add_f32 v224, 1.0, v224
    v_add_f32 v225, 1.0, v225
    v_mfma_f32_16x16x32_bf16 v[92:95], v[204:207], a[204:207], v[92:95]
    s_waitcnt vmcnt(18)
    v_add_f32 v226, 1.0, v226
    v_add_f32 v227, 1.0, v227
    v_mfma_f32_16x16x32_bf16 v[64:67], v[216:219], a[240:243], v[64:67]
    buffer_load_dwordx4 v[204:207], v241, s[20:23], s58 offen offset:0 sc1
    v_mfma_f32_16x16x32_bf16 v[64:67], v[220:223], v[96:99], v[64:67]
    v_rcp_f32 v224, v224
    v_mfma_f32_16x16x32_bf16 v[64:67], v[128:131], v[112:115], v[64:67]
    s_add_u32 s58, s30, 503808
    v_rcp_f32 v225, v225
    v_mfma_f32_16x16x32_bf16 v[68:71], v[128:131], v[116:119], v[68:71]
    v_rcp_f32 v226, v226
    v_mfma_f32_16x16x32_bf16 v[68:71], v[220:223], v[100:103], v[68:71]
    buffer_load_dwordx4 v[208:211], v241, s[20:23], s58 offen offset:0 sc1
    v_mfma_f32_16x16x32_bf16 v[68:71], v[216:219], a[244:247], v[68:71]
    v_rcp_f32 v227, v227
    v_mfma_f32_16x16x32_bf16 v[72:75], v[216:219], a[248:251], v[72:75]
    s_add_u32 s58, s30, 512000
    v_mul_f32 v32, v32, v48
    v_mul_f32 v33, v33, v49
    v_mfma_f32_16x16x32_bf16 v[72:75], v[220:223], v[104:107], v[72:75]
    v_mul_f32 v34, v34, v50
    v_mul_f32 v35, v35, v51
    v_mfma_f32_16x16x32_bf16 v[72:75], v[128:131], v[120:123], v[72:75]
    buffer_load_dwordx4 v[212:215], v241, s[20:23], s58 offen offset:0 sc1
    v_mfma_f32_16x16x32_bf16 v[76:79], v[128:131], v[124:127], v[76:79]
    v_mul_f32 v224, v224, v32
    v_mul_f32 v225, v225, v33
    v_mfma_f32_16x16x32_bf16 v[76:79], v[220:223], v[108:111], v[76:79]
    s_add_u32 s58, s30, 516096
    v_mul_f32 v226, v226, v34
    v_mul_f32 v227, v227, v35
    v_mfma_f32_16x16x32_bf16 v[76:79], v[216:219], a[252:255], v[76:79]
    s_waitcnt vmcnt(18)
    v_cvt_pk_bf16_f32 v232, v224, v225
    v_cvt_pk_bf16_f32 v233, v226, v227
    v_mfma_f32_16x16x32_bf16 v[80:83], v[132:135], a[240:243], v[80:83]
    buffer_load_dwordx4 v[216:219], v241, s[20:23], s58 offen offset:0 sc1
    v_mfma_f32_16x16x32_bf16 v[80:83], v[136:139], v[96:99], v[80:83]
    ds_write_b64 v242, v[232:233] offset:8
    v_mfma_f32_16x16x32_bf16 v[80:83], v[140:143], v[112:115], v[80:83]
    s_add_u32 s58, s30, 524288
    v_fma_f32 v228, -v36, v36, s42
    v_fma_f32 v229, -v37, v37, s42
    v_mfma_f32_16x16x32_bf16 v[84:87], v[140:143], v[116:119], v[84:87]
    v_mul_f32 v228, v228, v36
    v_mul_f32 v229, v229, v37
    v_mfma_f32_16x16x32_bf16 v[84:87], v[136:139], v[100:103], v[84:87]
    buffer_load_dwordx4 v[220:223], v241, s[20:23], s58 offen offset:0 sc1
    v_mfma_f32_16x16x32_bf16 v[84:87], v[132:135], a[244:247], v[84:87]
    v_fma_f32 v230, -v38, v38, s42
    v_fma_f32 v231, -v39, v39, s42
    v_mfma_f32_16x16x32_bf16 v[88:91], v[132:135], a[248:251], v[88:91]
    s_add_u32 s58, s30, 532480
    v_mul_f32 v230, v230, v38
    v_mul_f32 v231, v231, v39
    v_mfma_f32_16x16x32_bf16 v[88:91], v[136:139], v[104:107], v[88:91]
    v_exp_f32 v228, v228
    v_mfma_f32_16x16x32_bf16 v[88:91], v[140:143], v[120:123], v[88:91]
    buffer_load_dwordx4 v[128:131], v241, s[20:23], s58 offen offset:0 sc1
    v_mfma_f32_16x16x32_bf16 v[92:95], v[140:143], v[124:127], v[92:95]
    v_exp_f32 v229, v229
    v_mfma_f32_16x16x32_bf16 v[92:95], v[136:139], v[108:111], v[92:95]
    s_add_u32 s58, s30, 520192
    v_exp_f32 v230, v230
    v_mfma_f32_16x16x32_bf16 v[92:95], v[132:135], a[252:255], v[92:95]
    s_waitcnt vmcnt(18)
    v_exp_f32 v231, v231
    v_mfma_f32_16x16x32_bf16 v[0:3], v[144:147], a[0:3], 0
    buffer_load_dwordx4 v[132:135], v241, s[20:23], s58 offen offset:0 sc1
    v_mfma_f32_16x16x32_bf16 v[0:3], v[148:151], a[16:19], v[0:3]
    v_add_f32 v228, 1.0, v228
    v_add_f32 v229, 1.0, v229
    v_mfma_f32_16x16x32_bf16 v[0:3], v[152:155], a[32:35], v[0:3]
    s_add_u32 s58, s30, 528384
    v_add_f32 v230, 1.0, v230
    v_add_f32 v231, 1.0, v231
    v_mfma_f32_16x16x32_bf16 v[4:7], v[152:155], a[36:39], 0
    v_rcp_f32 v228, v228
    v_mfma_f32_16x16x32_bf16 v[4:7], v[148:151], a[20:23], v[4:7]
    buffer_load_dwordx4 v[136:139], v241, s[20:23], s58 offen offset:0 sc1
    v_mfma_f32_16x16x32_bf16 v[4:7], v[144:147], a[4:7], v[4:7]
    v_rcp_f32 v229, v229
    v_mfma_f32_16x16x32_bf16 v[8:11], v[144:147], a[8:11], 0
    s_add_u32 s58, s30, 536576
    v_rcp_f32 v230, v230
    v_mfma_f32_16x16x32_bf16 v[8:11], v[148:151], a[24:27], v[8:11]
    v_rcp_f32 v231, v231
    v_mfma_f32_16x16x32_bf16 v[8:11], v[152:155], a[40:43], v[8:11]
    buffer_load_dwordx4 v[140:143], v241, s[20:23], s58 offen offset:0 sc1
    v_mfma_f32_16x16x32_bf16 v[12:15], v[152:155], a[44:47], 0
    v_mul_f32 v36, v36, v52
    v_mul_f32 v37, v37, v53
    v_mfma_f32_16x16x32_bf16 v[12:15], v[148:151], a[28:31], v[12:15]
    s_add_u32 s58, s30, 540672
    v_mul_f32 v38, v38, v54
    v_mul_f32 v39, v39, v55
    v_mfma_f32_16x16x32_bf16 v[12:15], v[144:147], a[12:15], v[12:15]
    s_waitcnt vmcnt(18)
    v_mul_f32 v228, v228, v36
    v_mul_f32 v229, v229, v37
    v_mfma_f32_16x16x32_bf16 v[16:19], v[156:159], a[0:3], 0
    buffer_load_dwordx4 v[144:147], v241, s[20:23], s58 offen offset:0 sc1
    v_mfma_f32_16x16x32_bf16 v[16:19], v[160:163], a[16:19], v[16:19]
    v_mul_f32 v230, v230, v38
    v_mul_f32 v231, v231, v39
    v_mfma_f32_16x16x32_bf16 v[16:19], v[164:167], a[32:35], v[16:19]
    s_add_u32 s58, s30, 548864
    v_cvt_pk_bf16_f32 v234, v228, v229
    v_cvt_pk_bf16_f32 v235, v230, v231
    v_mfma_f32_16x16x32_bf16 v[20:23], v[164:167], a[36:39], 0
    ds_write_b64 v242, v[234:235] offset:1032
    v_mfma_f32_16x16x32_bf16 v[20:23], v[160:163], a[20:23], v[20:23]
    buffer_load_dwordx4 v[148:151], v241, s[20:23], s58 offen offset:0 sc1
    v_mfma_f32_16x16x32_bf16 v[20:23], v[156:159], a[4:7], v[20:23]
    v_fma_f32 v224, -v40, v40, s42
    v_fma_f32 v225, -v41, v41, s42
    v_mfma_f32_16x16x32_bf16 v[24:27], v[156:159], a[8:11], 0
    s_add_u32 s58, s30, 557056
    v_mul_f32 v224, v224, v40
    v_mul_f32 v225, v225, v41
    v_mfma_f32_16x16x32_bf16 v[24:27], v[160:163], a[24:27], v[24:27]
    v_fma_f32 v226, -v42, v42, s42
    v_fma_f32 v227, -v43, v43, s42
    v_mfma_f32_16x16x32_bf16 v[24:27], v[164:167], a[40:43], v[24:27]
    buffer_load_dwordx4 v[152:155], v241, s[20:23], s58 offen offset:0 sc1
    v_mfma_f32_16x16x32_bf16 v[28:31], v[164:167], a[44:47], 0
    v_mul_f32 v226, v226, v42
    v_mul_f32 v227, v227, v43
    v_mfma_f32_16x16x32_bf16 v[28:31], v[160:163], a[28:31], v[28:31]
    s_add_u32 s58, s30, 544768
    v_exp_f32 v224, v224
    v_mfma_f32_16x16x32_bf16 v[28:31], v[156:159], a[12:15], v[28:31]
    s_waitcnt vmcnt(18)
    v_exp_f32 v225, v225
    v_mfma_f32_16x16x32_bf16 v[0:3], v[168:171], a[48:51], v[0:3]
    buffer_load_dwordx4 v[156:159], v241, s[20:23], s58 offen offset:0 sc1
    v_mfma_f32_16x16x32_bf16 v[0:3], v[172:175], a[64:67], v[0:3]
    v_exp_f32 v226, v226
    v_mfma_f32_16x16x32_bf16 v[0:3], v[176:179], a[80:83], v[0:3]
    s_add_u32 s58, s30, 552960
    v_exp_f32 v227, v227
    v_mfma_f32_16x16x32_bf16 v[4:7], v[176:179], a[84:87], v[4:7]
    v_add_f32 v224, 1.0, v224
    v_add_f32 v225, 1.0, v225
    v_mfma_f32_16x16x32_bf16 v[4:7], v[172:175], a[68:71], v[4:7]
    buffer_load_dwordx4 v[160:163], v241, s[20:23], s58 offen offset:0 sc1
    v_mfma_f32_16x16x32_bf16 v[4:7], v[168:171], a[52:55], v[4:7]
    v_add_f32 v226, 1.0, v226
    v_add_f32 v227, 1.0, v227
    v_mfma_f32_16x16x32_bf16 v[8:11], v[168:171], a[56:59], v[8:11]
    s_add_u32 s58, s30, 561152
    v_rcp_f32 v224, v224
    v_mfma_f32_16x16x32_bf16 v[8:11], v[172:175], a[72:75], v[8:11]
    v_rcp_f32 v225, v225
    v_mfma_f32_16x16x32_bf16 v[8:11], v[176:179], a[88:91], v[8:11]
    buffer_load_dwordx4 v[164:167], v241, s[20:23], s58 offen offset:0 sc1
    v_mfma_f32_16x16x32_bf16 v[12:15], v[176:179], a[92:95], v[12:15]
    v_rcp_f32 v226, v226
    v_mfma_f32_16x16x32_bf16 v[12:15], v[172:175], a[76:79], v[12:15]
    s_add_u32 s58, s30, 565248
    v_rcp_f32 v227, v227
    v_mfma_f32_16x16x32_bf16 v[12:15], v[168:171], a[60:63], v[12:15]
    s_waitcnt vmcnt(18)
    v_mul_f32 v40, v40, v56
    v_mul_f32 v41, v41, v57
    v_mfma_f32_16x16x32_bf16 v[16:19], v[180:183], a[48:51], v[16:19]
    buffer_load_dwordx4 v[168:171], v241, s[20:23], s58 offen offset:0 sc1
    v_mfma_f32_16x16x32_bf16 v[16:19], v[184:187], a[64:67], v[16:19]
    v_mul_f32 v42, v42, v58
    v_mul_f32 v43, v43, v59
    v_mfma_f32_16x16x32_bf16 v[16:19], v[188:191], a[80:83], v[16:19]
    s_add_u32 s58, s30, 573440
    v_mul_f32 v224, v224, v40
    v_mul_f32 v225, v225, v41
    v_mfma_f32_16x16x32_bf16 v[20:23], v[188:191], a[84:87], v[20:23]
    v_mul_f32 v226, v226, v42
    v_mul_f32 v227, v227, v43
    v_mfma_f32_16x16x32_bf16 v[20:23], v[184:187], a[68:71], v[20:23]
    buffer_load_dwordx4 v[172:175], v241, s[20:23], s58 offen offset:0 sc1
    v_mfma_f32_16x16x32_bf16 v[20:23], v[180:183], a[52:55], v[20:23]
    v_cvt_pk_bf16_f32 v236, v224, v225
    v_cvt_pk_bf16_f32 v237, v226, v227
    v_mfma_f32_16x16x32_bf16 v[24:27], v[180:183], a[56:59], v[24:27]
    s_add_u32 s58, s30, 581632
    ds_write_b64 v242, v[236:237] offset:2056
    v_mfma_f32_16x16x32_bf16 v[24:27], v[184:187], a[72:75], v[24:27]
    v_fma_f32 v228, -v44, v44, s42
    v_fma_f32 v229, -v45, v45, s42
    v_mfma_f32_16x16x32_bf16 v[24:27], v[188:191], a[88:91], v[24:27]
    buffer_load_dwordx4 v[176:179], v241, s[20:23], s58 offen offset:0 sc1
    v_mfma_f32_16x16x32_bf16 v[28:31], v[188:191], a[92:95], v[28:31]
    v_mul_f32 v228, v228, v44
    v_mul_f32 v229, v229, v45
    v_mfma_f32_16x16x32_bf16 v[28:31], v[184:187], a[76:79], v[28:31]
    s_add_u32 s58, s30, 569344
    v_fma_f32 v230, -v46, v46, s42
    v_fma_f32 v231, -v47, v47, s42
    v_mfma_f32_16x16x32_bf16 v[28:31], v[180:183], a[60:63], v[28:31]
    s_waitcnt vmcnt(18)
    v_mul_f32 v230, v230, v46
    v_mul_f32 v231, v231, v47
    v_mfma_f32_16x16x32_bf16 v[0:3], v[192:195], a[96:99], v[0:3]
    buffer_load_dwordx4 v[180:183], v241, s[20:23], s58 offen offset:0 sc1
    v_mfma_f32_16x16x32_bf16 v[0:3], v[196:199], a[112:115], v[0:3]
    v_exp_f32 v228, v228
    v_mfma_f32_16x16x32_bf16 v[0:3], v[200:203], a[128:131], v[0:3]
    s_add_u32 s58, s30, 577536
    v_exp_f32 v229, v229
    v_mfma_f32_16x16x32_bf16 v[4:7], v[200:203], a[132:135], v[4:7]
    v_exp_f32 v230, v230
    v_mfma_f32_16x16x32_bf16 v[4:7], v[196:199], a[116:119], v[4:7]
    buffer_load_dwordx4 v[184:187], v241, s[20:23], s58 offen offset:0 sc1
    v_mfma_f32_16x16x32_bf16 v[4:7], v[192:195], a[100:103], v[4:7]
    v_exp_f32 v231, v231
    v_mfma_f32_16x16x32_bf16 v[8:11], v[192:195], a[104:107], v[8:11]
    s_add_u32 s58, s30, 585728
    v_add_f32 v228, 1.0, v228
    v_add_f32 v229, 1.0, v229
    v_mfma_f32_16x16x32_bf16 v[8:11], v[196:199], a[120:123], v[8:11]
    v_add_f32 v230, 1.0, v230
    v_add_f32 v231, 1.0, v231
    v_mfma_f32_16x16x32_bf16 v[8:11], v[200:203], a[136:139], v[8:11]
    buffer_load_dwordx4 v[188:191], v241, s[20:23], s58 offen offset:0 sc1
    v_mfma_f32_16x16x32_bf16 v[12:15], v[200:203], a[140:143], v[12:15]
    v_rcp_f32 v228, v228
    v_mfma_f32_16x16x32_bf16 v[12:15], v[196:199], a[124:127], v[12:15]
    s_add_u32 s58, s30, 589824
    v_rcp_f32 v229, v229
    v_mfma_f32_16x16x32_bf16 v[12:15], v[192:195], a[108:111], v[12:15]
    s_waitcnt vmcnt(18)
    v_rcp_f32 v230, v230
    v_mfma_f32_16x16x32_bf16 v[16:19], v[204:207], a[96:99], v[16:19]
    buffer_load_dwordx4 v[192:195], v241, s[20:23], s58 offen offset:0 sc1
    v_mfma_f32_16x16x32_bf16 v[16:19], v[208:211], a[112:115], v[16:19]
    v_rcp_f32 v231, v231
    v_mfma_f32_16x16x32_bf16 v[16:19], v[212:215], a[128:131], v[16:19]
    s_add_u32 s58, s30, 598016
    v_mul_f32 v44, v44, v60
    v_mul_f32 v45, v45, v61
    v_mfma_f32_16x16x32_bf16 v[20:23], v[212:215], a[132:135], v[20:23]
    v_mul_f32 v46, v46, v62
    v_mul_f32 v47, v47, v63
    v_mfma_f32_16x16x32_bf16 v[20:23], v[208:211], a[116:119], v[20:23]
    buffer_load_dwordx4 v[196:199], v241, s[20:23], s58 offen offset:0 sc1
    v_mfma_f32_16x16x32_bf16 v[20:23], v[204:207], a[100:103], v[20:23]
    v_mul_f32 v228, v228, v44
    v_mul_f32 v229, v229, v45
    v_mfma_f32_16x16x32_bf16 v[24:27], v[204:207], a[104:107], v[24:27]
    s_add_u32 s58, s30, 606208
    v_mul_f32 v230, v230, v46
    v_mul_f32 v231, v231, v47
    v_mfma_f32_16x16x32_bf16 v[24:27], v[208:211], a[120:123], v[24:27]
    v_cvt_pk_bf16_f32 v238, v228, v229
    v_cvt_pk_bf16_f32 v239, v230, v231
    v_mfma_f32_16x16x32_bf16 v[24:27], v[212:215], a[136:139], v[24:27]
    buffer_load_dwordx4 v[200:203], v241, s[20:23], s58 offen offset:0 sc1
    v_mfma_f32_16x16x32_bf16 v[28:31], v[212:215], a[140:143], v[28:31]
    ds_write_b64 v242, v[238:239] offset:3080
    v_mfma_f32_16x16x32_bf16 v[28:31], v[208:211], a[124:127], v[28:31]
    s_add_u32 s58, s30, 593920
    v_fma_f32 v224, -v64, v64, s42
    v_fma_f32 v225, -v65, v65, s42
    v_mfma_f32_16x16x32_bf16 v[28:31], v[204:207], a[108:111], v[28:31]
    s_waitcnt vmcnt(18)
    v_mul_f32 v224, v224, v64
    v_mul_f32 v225, v225, v65
    v_mfma_f32_16x16x32_bf16 v[0:3], v[216:219], a[144:147], v[0:3]
    buffer_load_dwordx4 v[204:207], v241, s[20:23], s58 offen offset:0 sc1
    v_mfma_f32_16x16x32_bf16 v[0:3], v[220:223], a[160:163], v[0:3]
    v_fma_f32 v226, -v66, v66, s42
    v_fma_f32 v227, -v67, v67, s42
    v_mfma_f32_16x16x32_bf16 v[0:3], v[128:131], a[176:179], v[0:3]
    s_add_u32 s58, s30, 602112
    v_mul_f32 v226, v226, v66
    v_mul_f32 v227, v227, v67
    v_mfma_f32_16x16x32_bf16 v[4:7], v[128:131], a[180:183], v[4:7]
    v_exp_f32 v224, v224
    v_mfma_f32_16x16x32_bf16 v[4:7], v[220:223], a[164:167], v[4:7]
    buffer_load_dwordx4 v[208:211], v241, s[20:23], s58 offen offset:0 sc1
    v_mfma_f32_16x16x32_bf16 v[4:7], v[216:219], a[148:151], v[4:7]
    v_exp_f32 v225, v225
    v_mfma_f32_16x16x32_bf16 v[8:11], v[216:219], a[152:155], v[8:11]
    s_add_u32 s58, s30, 610304
    v_exp_f32 v226, v226
    v_mfma_f32_16x16x32_bf16 v[8:11], v[220:223], a[168:171], v[8:11]
    v_exp_f32 v227, v227
    v_mfma_f32_16x16x32_bf16 v[8:11], v[128:131], a[184:187], v[8:11]
    buffer_load_dwordx4 v[212:215], v241, s[20:23], s58 offen offset:0 sc1
    v_mfma_f32_16x16x32_bf16 v[12:15], v[128:131], a[188:191], v[12:15]
    v_add_f32 v224, 1.0, v224
    v_add_f32 v225, 1.0, v225
    v_mfma_f32_16x16x32_bf16 v[12:15], v[220:223], a[172:175], v[12:15]
    s_add_u32 s58, s30, 614400
    v_add_f32 v226, 1.0, v226
    v_add_f32 v227, 1.0, v227
    v_mfma_f32_16x16x32_bf16 v[12:15], v[216:219], a[156:159], v[12:15]
    s_waitcnt vmcnt(18)
    v_rcp_f32 v224, v224
    v_mfma_f32_16x16x32_bf16 v[16:19], v[132:135], a[144:147], v[16:19]
    buffer_load_dwordx4 v[216:219], v241, s[20:23], s58 offen offset:0 sc1
    v_mfma_f32_16x16x32_bf16 v[16:19], v[136:139], a[160:163], v[16:19]
    v_rcp_f32 v225, v225
    v_mfma_f32_16x16x32_bf16 v[16:19], v[140:143], a[176:179], v[16:19]
    s_add_u32 s58, s30, 622592
    v_rcp_f32 v226, v226
    v_mfma_f32_16x16x32_bf16 v[20:23], v[140:143], a[180:183], v[20:23]
    v_rcp_f32 v227, v227
    v_mfma_f32_16x16x32_bf16 v[20:23], v[136:139], a[164:167], v[20:23]
    buffer_load_dwordx4 v[220:223], v241, s[20:23], s58 offen offset:0 sc1
    v_mfma_f32_16x16x32_bf16 v[20:23], v[132:135], a[148:151], v[20:23]
    v_mul_f32 v64, v64, v80
    v_mul_f32 v65, v65, v81
    v_mfma_f32_16x16x32_bf16 v[24:27], v[132:135], a[152:155], v[24:27]
    s_add_u32 s58, s30, 630784
    v_mul_f32 v66, v66, v82
    v_mul_f32 v67, v67, v83
    v_mfma_f32_16x16x32_bf16 v[24:27], v[136:139], a[168:171], v[24:27]
    v_mul_f32 v224, v224, v64
    v_mul_f32 v225, v225, v65
    v_mfma_f32_16x16x32_bf16 v[24:27], v[140:143], a[184:187], v[24:27]
    buffer_load_dwordx4 v[128:131], v241, s[20:23], s58 offen offset:0 sc1
    v_mfma_f32_16x16x32_bf16 v[28:31], v[140:143], a[188:191], v[28:31]
    v_mul_f32 v226, v226, v66
    v_mul_f32 v227, v227, v67
    v_mfma_f32_16x16x32_bf16 v[28:31], v[136:139], a[172:175], v[28:31]
    s_add_u32 s58, s30, 618496
    v_cvt_pk_bf16_f32 v232, v224, v225
    v_cvt_pk_bf16_f32 v233, v226, v227
    v_mfma_f32_16x16x32_bf16 v[28:31], v[132:135], a[156:159], v[28:31]
    s_waitcnt vmcnt(18)
    ds_write_b64 v242, v[232:233] offset:4096
    v_mfma_f32_16x16x32_bf16 v[0:3], v[144:147], a[192:195], v[0:3]
    buffer_load_dwordx4 v[132:135], v241, s[20:23], s58 offen offset:0 sc1
    v_mfma_f32_16x16x32_bf16 v[0:3], v[148:151], a[208:211], v[0:3]
    v_fma_f32 v228, -v68, v68, s42
    v_fma_f32 v229, -v69, v69, s42
    v_mfma_f32_16x16x32_bf16 v[0:3], v[152:155], a[224:227], v[0:3]
    s_add_u32 s58, s30, 626688
    v_mul_f32 v228, v228, v68
    v_mul_f32 v229, v229, v69
    v_mfma_f32_16x16x32_bf16 v[4:7], v[152:155], a[228:231], v[4:7]
    v_fma_f32 v230, -v70, v70, s42
    v_fma_f32 v231, -v71, v71, s42
    v_mfma_f32_16x16x32_bf16 v[4:7], v[148:151], a[212:215], v[4:7]
    buffer_load_dwordx4 v[136:139], v241, s[20:23], s58 offen offset:0 sc1
    v_mfma_f32_16x16x32_bf16 v[4:7], v[144:147], a[196:199], v[4:7]
    v_mul_f32 v230, v230, v70
    v_mul_f32 v231, v231, v71
    v_mfma_f32_16x16x32_bf16 v[8:11], v[144:147], a[200:203], v[8:11]
    s_add_u32 s58, s30, 634880
    v_exp_f32 v228, v228
    v_mfma_f32_16x16x32_bf16 v[8:11], v[148:151], a[216:219], v[8:11]
    v_exp_f32 v229, v229
    v_mfma_f32_16x16x32_bf16 v[8:11], v[152:155], a[232:235], v[8:11]
    buffer_load_dwordx4 v[140:143], v241, s[20:23], s58 offen offset:0 sc1
    v_mfma_f32_16x16x32_bf16 v[12:15], v[152:155], a[236:239], v[12:15]
    v_exp_f32 v230, v230
    v_mfma_f32_16x16x32_bf16 v[12:15], v[148:151], a[220:223], v[12:15]
    s_add_u32 s58, s30, 638976
    v_exp_f32 v231, v231
    v_mfma_f32_16x16x32_bf16 v[12:15], v[144:147], a[204:207], v[12:15]
    s_waitcnt vmcnt(18)
    v_add_f32 v228, 1.0, v228
    v_add_f32 v229, 1.0, v229
    v_mfma_f32_16x16x32_bf16 v[16:19], v[156:159], a[192:195], v[16:19]
    buffer_load_dwordx4 v[144:147], v241, s[20:23], s58 offen offset:0 sc1
    v_mfma_f32_16x16x32_bf16 v[16:19], v[160:163], a[208:211], v[16:19]
    v_add_f32 v230, 1.0, v230
    v_add_f32 v231, 1.0, v231
    v_mfma_f32_16x16x32_bf16 v[16:19], v[164:167], a[224:227], v[16:19]
    s_add_u32 s58, s30, 647168
    v_rcp_f32 v228, v228
    v_mfma_f32_16x16x32_bf16 v[20:23], v[164:167], a[228:231], v[20:23]
    v_rcp_f32 v229, v229
    v_mfma_f32_16x16x32_bf16 v[20:23], v[160:163], a[212:215], v[20:23]
    buffer_load_dwordx4 v[148:151], v241, s[20:23], s58 offen offset:0 sc1
    v_mfma_f32_16x16x32_bf16 v[20:23], v[156:159], a[196:199], v[20:23]
    v_rcp_f32 v230, v230
    v_mfma_f32_16x16x32_bf16 v[24:27], v[156:159], a[200:203], v[24:27]
    s_add_u32 s58, s30, 655360
    v_rcp_f32 v231, v231
    v_mfma_f32_16x16x32_bf16 v[24:27], v[160:163], a[216:219], v[24:27]
    v_mul_f32 v68, v68, v84
    v_mul_f32 v69, v69, v85
    v_mfma_f32_16x16x32_bf16 v[24:27], v[164:167], a[232:235], v[24:27]
    buffer_load_dwordx4 v[152:155], v241, s[20:23], s58 offen offset:0 sc1
    v_mfma_f32_16x16x32_bf16 v[28:31], v[164:167], a[236:239], v[28:31]
    v_mul_f32 v70, v70, v86
    v_mul_f32 v71, v71, v87
    v_mfma_f32_16x16x32_bf16 v[28:31], v[160:163], a[220:223], v[28:31]
    s_add_u32 s58, s30, 643072
    v_mul_f32 v228, v228, v68
    v_mul_f32 v229, v229, v69
    v_mfma_f32_16x16x32_bf16 v[28:31], v[156:159], a[204:207], v[28:31]
    s_waitcnt vmcnt(18)
    v_mul_f32 v230, v230, v70
    v_mul_f32 v231, v231, v71
    v_mfma_f32_16x16x32_bf16 v[0:3], v[168:171], a[240:243], v[0:3]
    buffer_load_dwordx4 v[156:159], v241, s[20:23], s58 offen offset:0 sc1
    v_mfma_f32_16x16x32_bf16 v[0:3], v[172:175], v[96:99], v[0:3]
    v_cvt_pk_bf16_f32 v234, v228, v229
    v_cvt_pk_bf16_f32 v235, v230, v231
    v_mfma_f32_16x16x32_bf16 v[0:3], v[176:179], v[112:115], v[0:3]
    s_add_u32 s58, s30, 651264
    ds_write_b64 v242, v[234:235] offset:5120
    v_mfma_f32_16x16x32_bf16 v[4:7], v[176:179], v[116:119], v[4:7]
    v_fma_f32 v224, -v72, v72, s42
    v_fma_f32 v225, -v73, v73, s42
    v_mfma_f32_16x16x32_bf16 v[4:7], v[172:175], v[100:103], v[4:7]
    buffer_load_dwordx4 v[160:163], v241, s[20:23], s58 offen offset:0 sc1
    v_mfma_f32_16x16x32_bf16 v[4:7], v[168:171], a[244:247], v[4:7]
    v_mul_f32 v224, v224, v72
    v_mul_f32 v225, v225, v73
    v_mfma_f32_16x16x32_bf16 v[8:11], v[168:171], a[248:251], v[8:11]
    s_add_u32 s58, s30, 659456
    v_fma_f32 v226, -v74, v74, s42
    v_fma_f32 v227, -v75, v75, s42
    v_mfma_f32_16x16x32_bf16 v[8:11], v[172:175], v[104:107], v[8:11]
    v_mul_f32 v226, v226, v74
    v_mul_f32 v227, v227, v75
    v_mfma_f32_16x16x32_bf16 v[8:11], v[176:179], v[120:123], v[8:11]
    buffer_load_dwordx4 v[164:167], v241, s[20:23], s58 offen offset:0 sc1
    v_mfma_f32_16x16x32_bf16 v[12:15], v[176:179], v[124:127], v[12:15]
    v_exp_f32 v224, v224
    v_mfma_f32_16x16x32_bf16 v[12:15], v[172:175], v[108:111], v[12:15]
HOP2_2:
    s_cbranch_execz HOP2_6
    s_add_u32 s58, s30, 663552
    v_exp_f32 v225, v225
    v_mfma_f32_16x16x32_bf16 v[12:15], v[168:171], a[252:255], v[12:15]
    s_waitcnt vmcnt(18)
    v_exp_f32 v226, v226
    v_mfma_f32_16x16x32_bf16 v[16:19], v[180:183], a[240:243], v[16:19]
    buffer_load_dwordx4 v[168:171], v241, s[20:23], s58 offen offset:0 sc1
    v_mfma_f32_16x16x32_bf16 v[16:19], v[184:187], v[96:99], v[16:19]
    v_exp_f32 v227, v227
    v_mfma_f32_16x16x32_bf16 v[16:19], v[188:191], v[112:115], v[16:19]
    s_add_u32 s58, s30, 671744
    v_add_f32 v224, 1.0, v224
    v_add_f32 v225, 1.0, v225
    v_mfma_f32_16x16x32_bf16 v[20:23], v[188:191], v[116:119], v[20:23]
    v_add_f32 v226, 1.0, v226
    v_add_f32 v227, 1.0, v227
    v_mfma_f32_16x16x32_bf16 v[20:23], v[184:187], v[100:103], v[20:23]
    buffer_load_dwordx4 v[172:175], v241, s[20:23], s58 offen offset:0 sc1
    v_mfma_f32_16x16x32_bf16 v[20:23], v[180:183], a[244:247], v[20:23]
    v_rcp_f32 v224, v224
    v_mfma_f32_16x16x32_bf16 v[24:27], v[180:183], a[248:251], v[24:27]
    s_add_u32 s58, s30, 679936
    v_rcp_f32 v225, v225
    v_mfma_f32_16x16x32_bf16 v[24:27], v[184:187], v[104:107], v[24:27]
    v_rcp_f32 v226, v226
    v_mfma_f32_16x16x32_bf16 v[24:27], v[188:191], v[120:123], v[24:27]
    buffer_load_dwordx4 v[176:179], v241, s[20:23], s58 offen offset:0 sc1
    v_mfma_f32_16x16x32_bf16 v[28:31], v[188:191], v[124:127], v[28:31]
    v_rcp_f32 v227, v227
    v_mfma_f32_16x16x32_bf16 v[28:31], v[184:187], v[108:111], v[28:31]
    s_add_u32 s58, s30, 667648
    v_mul_f32 v72, v72, v88
    v_mul_f32 v73, v73, v89
    v_mfma_f32_16x16x32_bf16 v[28:31], v[180:183], a[252:255], v[28:31]
    s_waitcnt vmcnt(18)
    v_mul_f32 v74, v74, v90
    v_mul_f32 v75, v75, v91
    v_mfma_f32_16x16x32_bf16 v[32:35], v[192:195], a[0:3], 0
    buffer_load_dwordx4 v[180:183], v241, s[20:23], s58 offen offset:0 sc1
    v_mfma_f32_16x16x32_bf16 v[32:35], v[196:199], a[16:19], v[32:35]
    v_mul_f32 v224, v224, v72
    v_mul_f32 v225, v225, v73
    v_mfma_f32_16x16x32_bf16 v[32:35], v[200:203], a[32:35], v[32:35]
    s_add_u32 s58, s30, 675840
    v_mul_f32 v226, v226, v74
    v_mul_f32 v227, v227, v75
    v_mfma_f32_16x16x32_bf16 v[36:39], v[200:203], a[36:39], 0
    v_cvt_pk_bf16_f32 v236, v224, v225
    v_cvt_pk_bf16_f32 v237, v226, v227
    v_mfma_f32_16x16x32_bf16 v[36:39], v[196:199], a[20:23], v[36:39]
    buffer_load_dwordx4 v[184:187], v241, s[20:23], s58 offen offset:0 sc1
    v_mfma_f32_16x16x32_bf16 v[36:39], v[192:195], a[4:7], v[36:39]
    ds_write_b64 v242, v[236:237] offset:6144
    v_mfma_f32_16x16x32_bf16 v[40:43], v[192:195], a[8:11], 0
    s_add_u32 s58, s30, 684032
    s_load_dwordx2 s[62:63], s[12:13], 0
    v_mfma_f32_16x16x32_bf16 v[40:43], v[196:199], a[24:27], v[40:43]
    s_load_dwordx2 s[62:63], s[12:13], 128
    v_mfma_f32_16x16x32_bf16 v[40:43], v[200:203], a[40:43], v[40:43]
    buffer_load_dwordx4 v[188:191], v241, s[20:23], s58 offen offset:0 sc1
    v_mfma_f32_16x16x32_bf16 v[44:47], v[200:203], a[44:47], 0
    s_load_dwordx2 s[62:63], s[12:13], 256
    v_mfma_f32_16x16x32_bf16 v[44:47], v[196:199], a[28:31], v[44:47]
    s_add_u32 s58, s30, 688128
    v_fma_f32 v228, -v76, v76, s42
    v_fma_f32 v229, -v77, v77, s42
    v_mfma_f32_16x16x32_bf16 v[44:47], v[192:195], a[12:15], v[44:47]
    s_waitcnt vmcnt(18)
    v_mul_f32 v228, v228, v76
    v_mul_f32 v229, v229, v77
    v_mfma_f32_16x16x32_bf16 v[48:51], v[204:207], a[0:3], 0
    buffer_load_dwordx4 v[192:195], v241, s[20:23], s58 offen offset:0 sc1
    v_mfma_f32_16x16x32_bf16 v[48:51], v[208:211], a[16:19], v[48:51]
    v_fma_f32 v230, -v78, v78, s42
    v_fma_f32 v231, -v79, v79, s42
    v_mfma_f32_16x16x32_bf16 v[48:51], v[212:215], a[32:35], v[48:51]
    s_add_u32 s58, s30, 696320
    v_mul_f32 v230, v230, v78
    v_mul_f32 v231, v231, v79
    v_mfma_f32_16x16x32_bf16 v[52:55], v[212:215], a[36:39], 0
    v_exp_f32 v228, v228
    v_mfma_f32_16x16x32_bf16 v[52:55], v[208:211], a[20:23], v[52:55]
    buffer_load_dwordx4 v[196:199], v241, s[20:23], s58 offen offset:0 sc1
    v_mfma_f32_16x16x32_bf16 v[52:55], v[204:207], a[4:7], v[52:55]
    v_exp_f32 v229, v229
    v_mfma_f32_16x16x32_bf16 v[56:59], v[204:207], a[8:11], 0
    s_add_u32 s58, s30, 704512
    v_exp_f32 v230, v230
    v_mfma_f32_16x16x32_bf16 v[56:59], v[208:211], a[24:27], v[56:59]
    v_exp_f32 v231, v231
    v_mfma_f32_16x16x32_bf16 v[56:59], v[212:215], a[40:43], v[56:59]
    buffer_load_dwordx4 v[200:203], v241, s[20:23], s58 offen offset:0 sc1
    v_mfma_f32_16x16x32_bf16 v[60:63], v[212:215], a[44:47], 0
    v_add_f32 v228, 1.0, v228
    v_add_f32 v229, 1.0, v229
    v_mfma_f32_16x16x32_bf16 v[60:63], v[208:211], a[28:31], v[60:63]
    s_add_u32 s58, s30, 692224
    v_add_f32 v230, 1.0, v230
    v_add_f32 v231, 1.0, v231
    v_mfma_f32_16x16x32_bf16 v[60:63], v[204:207], a[12:15], v[60:63]
    s_waitcnt vmcnt(18)
    v_rcp_f32 v228, v228
    v_mfma_f32_16x16x32_bf16 v[32:35], v[216:219], a[48:51], v[32:35]
    buffer_load_dwordx4 v[204:207], v241, s[20:23], s58 offen offset:0 sc1
    v_mfma_f32_16x16x32_bf16 v[32:35], v[220:223], a[64:67], v[32:35]
    v_rcp_f32 v229, v229
    v_mfma_f32_16x16x32_bf16 v[32:35], v[128:131], a[80:83], v[32:35]
    s_add_u32 s58, s30, 700416
    v_rcp_f32 v230, v230
    v_mfma_f32_16x16x32_bf16 v[36:39], v[128:131], a[84:87], v[36:39]
    v_rcp_f32 v231, v231
    v_mfma_f32_16x16x32_bf16 v[36:39], v[220:223], a[68:71], v[36:39]
    buffer_load_dwordx4 v[208:211], v241, s[20:23], s58 offen offset:0 sc1
    v_mfma_f32_16x16x32_bf16 v[36:39], v[216:219], a[52:55], v[36:39]
    v_mul_f32 v76, v76, v92
    v_mul_f32 v77, v77, v93
    v_mfma_f32_16x16x32_bf16 v[40:43], v[216:219], a[56:59], v[40:43]
    s_add_u32 s58, s30, 708608
    v_mul_f32 v78, v78, v94
    v_mul_f32 v79, v79, v95
    v_mfma_f32_16x16x32_bf16 v[40:43], v[220:223], a[72:75], v[40:43]
    v_mul_f32 v228, v228, v76
    v_mul_f32 v229, v229, v77
    v_mfma_f32_16x16x32_bf16 v[40:43], v[128:131], a[88:91], v[40:43]
    buffer_load_dwordx4 v[212:215], v241, s[20:23], s58 offen offset:0 sc1
    v_mfma_f32_16x16x32_bf16 v[44:47], v[128:131], a[92:95], v[44:47]
    v_mul_f32 v230, v230, v78
    v_mul_f32 v231, v231, v79
    v_mfma_f32_16x16x32_bf16 v[44:47], v[220:223], a[76:79], v[44:47]
    s_add_u32 s58, s30, 712704
    v_cvt_pk_bf16_f32 v238, v228, v229
    v_cvt_pk_bf16_f32 v239, v230, v231
    v_mfma_f32_16x16x32_bf16 v[44:47], v[216:219], a[60:63], v[44:47]
    s_waitcnt vmcnt(18)
    ds_write_b64 v242, v[238:239] offset:7168
    v_mfma_f32_16x16x32_bf16 v[48:51], v[132:135], a[48:51], v[48:51]
    buffer_load_dwordx4 v[216:219], v241, s[20:23], s58 offen offset:0 sc1
    v_mfma_f32_16x16x32_bf16 v[48:51], v[136:139], a[64:67], v[48:51]
    v_fma_f32 v224, -v0, v0, s42
    v_fma_f32 v225, -v1, v1, s42
    v_mfma_f32_16x16x32_bf16 v[48:51], v[140:143], a[80:83], v[48:51]
    s_add_u32 s58, s30, 720896
    v_mul_f32 v224, v224, v0
    v_mul_f32 v225, v225, v1
    v_mfma_f32_16x16x32_bf16 v[52:55], v[140:143], a[84:87], v[52:55]
    v_fma_f32 v226, -v2, v2, s42
    v_fma_f32 v227, -v3, v3, s42
    v_mfma_f32_16x16x32_bf16 v[52:55], v[136:139], a[68:71], v[52:55]
    buffer_load_dwordx4 v[220:223], v241, s[20:23], s58 offen offset:0 sc1
    v_mfma_f32_16x16x32_bf16 v[52:55], v[132:135], a[52:55], v[52:55]
    v_mul_f32 v226, v226, v2
    v_mul_f32 v227, v227, v3
    v_mfma_f32_16x16x32_bf16 v[56:59], v[132:135], a[56:59], v[56:59]
    s_add_u32 s58, s30, 729088
    v_exp_f32 v224, v224
    v_mfma_f32_16x16x32_bf16 v[56:59], v[136:139], a[72:75], v[56:59]
    v_exp_f32 v225, v225
    v_mfma_f32_16x16x32_bf16 v[56:59], v[140:143], a[88:91], v[56:59]
    buffer_load_dwordx4 v[128:131], v241, s[20:23], s58 offen offset:0 sc1
    v_mfma_f32_16x16x32_bf16 v[60:63], v[140:143], a[92:95], v[60:63]
    v_exp_f32 v226, v226
    v_mfma_f32_16x16x32_bf16 v[60:63], v[136:139], a[76:79], v[60:63]
    s_add_u32 s58, s30, 716800
    v_exp_f32 v227, v227
    v_mfma_f32_16x16x32_bf16 v[60:63], v[132:135], a[60:63], v[60:63]
    s_waitcnt vmcnt(18)
    v_add_f32 v224, 1.0, v224
    v_add_f32 v225, 1.0, v225
    v_mfma_f32_16x16x32_bf16 v[32:35], v[144:147], a[96:99], v[32:35]
    buffer_load_dwordx4 v[132:135], v241, s[20:23], s58 offen offset:0 sc1
    v_mfma_f32_16x16x32_bf16 v[32:35], v[148:151], a[112:115], v[32:35]
    v_add_f32 v226, 1.0, v226
    v_add_f32 v227, 1.0, v227
    v_mfma_f32_16x16x32_bf16 v[32:35], v[152:155], a[128:131], v[32:35]
    s_add_u32 s58, s30, 724992
    v_rcp_f32 v224, v224
    v_mfma_f32_16x16x32_bf16 v[36:39], v[152:155], a[132:135], v[36:39]
    v_rcp_f32 v225, v225
    v_mfma_f32_16x16x32_bf16 v[36:39], v[148:151], a[116:119], v[36:39]
    buffer_load_dwordx4 v[136:139], v241, s[20:23], s58 offen offset:0 sc1
    v_mfma_f32_16x16x32_bf16 v[36:39], v[144:147], a[100:103], v[36:39]
    v_rcp_f32 v226, v226
    v_mfma_f32_16x16x32_bf16 v[40:43], v[144:147], a[104:107], v[40:43]
    s_add_u32 s58, s30, 733184
    v_rcp_f32 v227, v227
    v_mfma_f32_16x16x32_bf16 v[40:43], v[148:151], a[120:123], v[40:43]
    v_mul_f32 v0, v0, v16
    v_mul_f32 v1, v1, v17
    v_mfma_f32_16x16x32_bf16 v[40:43], v[152:155], a[136:139], v[40:43]
    buffer_load_dwordx4 v[140:143], v241, s[20:23], s58 offen offset:0 sc1
    v_mfma_f32_16x16x32_bf16 v[44:47], v[152:155], a[140:143], v[44:47]
    v_mul_f32 v2, v2, v18
    v_mul_f32 v3, v3, v19
    v_mfma_f32_16x16x32_bf16 v[44:47], v[148:151], a[124:127], v[44:47]
    s_add_u32 s58, s30, 737280
    v_mul_f32 v224, v224, v0
    v_mul_f32 v225, v225, v1
    v_mfma_f32_16x16x32_bf16 v[44:47], v[144:147], a[108:111], v[44:47]
    s_waitcnt vmcnt(18)
    v_mul_f32 v226, v226, v2
    v_mul_f32 v227, v227, v3
    v_mfma_f32_16x16x32_bf16 v[48:51], v[156:159], a[96:99], v[48:51]
    buffer_load_dwordx4 v[144:147], v241, s[20:23], s58 offen offset:0 sc1
    v_mfma_f32_16x16x32_bf16 v[48:51], v[160:163], a[112:115], v[48:51]
    v_cvt_pk_bf16_f32 v232, v224, v225
    v_cvt_pk_bf16_f32 v233, v226, v227
    v_mfma_f32_16x16x32_bf16 v[48:51], v[164:167], a[128:131], v[48:51]
    s_add_u32 s58, s30, 745472
    ds_write_b64 v242, v[232:233] offset:4104
    v_mfma_f32_16x16x32_bf16 v[52:55], v[164:167], a[132:135], v[52:55]
    v_fma_f32 v228, -v4, v4, s42
    v_fma_f32 v229, -v5, v5, s42
    v_mfma_f32_16x16x32_bf16 v[52:55], v[160:163], a[116:119], v[52:55]
    buffer_load_dwordx4 v[148:151], v241, s[20:23], s58 offen offset:0 sc1
    v_mfma_f32_16x16x32_bf16 v[52:55], v[156:159], a[100:103], v[52:55]
    v_mul_f32 v228, v228, v4
    v_mul_f32 v229, v229, v5
    v_mfma_f32_16x16x32_bf16 v[56:59], v[156:159], a[104:107], v[56:59]
    s_add_u32 s58, s30, 753664
    v_fma_f32 v230, -v6, v6, s42
    v_fma_f32 v231, -v7, v7, s42
    v_mfma_f32_16x16x32_bf16 v[56:59], v[160:163], a[120:123], v[56:59]
    v_mul_f32 v230, v230, v6
    v_mul_f32 v231, v231, v7
    v_mfma_f32_16x16x32_bf16 v[56:59], v[164:167], a[136:139], v[56:59]
    buffer_load_dwordx4 v[152:155], v241, s[20:23], s58 offen offset:0 sc1
    v_mfma_f32_16x16x32_bf16 v[60:63], v[164:167], a[140:143], v[60:63]
    v_exp_f32 v228, v228
    v_mfma_f32_16x16x32_bf16 v[60:63], v[160:163], a[124:127], v[60:63]
    s_add_u32 s58, s30, 741376
    v_exp_f32 v229, v229
    v_mfma_f32_16x16x32_bf16 v[60:63], v[156:159], a[108:111], v[60:63]
    s_waitcnt vmcnt(18)
    v_exp_f32 v230, v230
    v_mfma_f32_16x16x32_bf16 v[32:35], v[168:171], a[144:147], v[32:35]
    buffer_load_dwordx4 v[156:159], v241, s[20:23], s58 offen offset:0 sc1
    v_mfma_f32_16x16x32_bf16 v[32:35], v[172:175], a[160:163], v[32:35]
    v_exp_f32 v231, v231
    v_mfma_f32_16x16x32_bf16 v[32:35], v[176:179], a[176:179], v[32:35]
    s_add_u32 s58, s30, 749568
    v_add_f32 v228, 1.0, v228
    v_add_f32 v229, 1.0, v229
    v_mfma_f32_16x16x32_bf16 v[36:39], v[176:179], a[180:183], v[36:39]
    v_add_f32 v230, 1.0, v230
    v_add_f32 v231, 1.0, v231
    v_mfma_f32_16x16x32_bf16 v[36:39], v[172:175], a[164:167], v[36:39]
    buffer_load_dwordx4 v[160:163], v241, s[20:23], s58 offen offset:0 sc1
    v_mfma_f32_16x16x32_bf16 v[36:39], v[168:171], a[148:151], v[36:39]
    v_rcp_f32 v228, v228
    v_mfma_f32_16x16x32_bf16 v[40:43], v[168:171], a[152:155], v[40:43]
    s_add_u32 s58, s30, 757760
    v_rcp_f32 v229, v229
    v_mfma_f32_16x16x32_bf16 v[40:43], v[172:175], a[168:171], v[40:43]
    v_rcp_f32 v230, v230
    v_mfma_f32_16x16x32_bf16 v[40:43], v[176:179], a[184:187], v[40:43]
    buffer_load_dwordx4 v[164:167], v241, s[20:23], s58 offen offset:0 sc1
    v_mfma_f32_16x16x32_bf16 v[44:47], v[176:179], a[188:191], v[44:47]
    v_rcp_f32 v231, v231
    v_mfma_f32_16x16x32_bf16 v[44:47], v[172:175], a[172:175], v[44:47]
    s_add_u32 s58, s30, 761856
    v_mul_f32 v4, v4, v20
    v_mul_f32 v5, v5, v21
    v_mfma_f32_16x16x32_bf16 v[44:47], v[168:171], a[156:159], v[44:47]
    s_waitcnt vmcnt(18)
    v_mul_f32 v6, v6, v22
    v_mul_f32 v7, v7, v23
    v_mfma_f32_16x16x32_bf16 v[48:51], v[180:183], a[144:147], v[48:51]
    buffer_load_dwordx4 v[168:171], v241, s[20:23], s58 offen offset:0 sc1
    v_mfma_f32_16x16x32_bf16 v[48:51], v[184:187], a[160:163], v[48:51]
    v_mul_f32 v228, v228, v4
    v_mul_f32 v229, v229, v5
    v_mfma_f32_16x16x32_bf16 v[48:51], v[188:191], a[176:179], v[48:51]
    s_add_u32 s58, s30, 770048
    v_mul_f32 v230, v230, v6
    v_mul_f32 v231, v231, v7
    v_mfma_f32_16x16x32_bf16 v[52:55], v[188:191], a[180:183], v[52:55]
    v_cvt_pk_bf16_f32 v234, v228, v229
    v_cvt_pk_bf16_f32 v235, v230, v231
    v_mfma_f32_16x16x32_bf16 v[52:55], v[184:187], a[164:167], v[52:55]
    buffer_load_dwordx4 v[172:175], v241, s[20:23], s58 offen offset:0 sc1
    v_mfma_f32_16x16x32_bf16 v[52:55], v[180:183], a[148:151], v[52:55]
    ds_write_b64 v242, v[234:235] offset:5128
    v_mfma_f32_16x16x32_bf16 v[56:59], v[180:183], a[152:155], v[56:59]
    s_add_u32 s58, s30, 778240
    v_fma_f32 v224, -v8, v8, s42
    v_fma_f32 v225, -v9, v9, s42
    v_mfma_f32_16x16x32_bf16 v[56:59], v[184:187], a[168:171], v[56:59]
    v_mul_f32 v224, v224, v8
    v_mul_f32 v225, v225, v9
    v_mfma_f32_16x16x32_bf16 v[56:59], v[188:191], a[184:187], v[56:59]
    buffer_load_dwordx4 v[176:179], v241, s[20:23], s58 offen offset:0 sc1
    v_mfma_f32_16x16x32_bf16 v[60:63], v[188:191], a[188:191], v[60:63]
    v_fma_f32 v226, -v10, v10, s42
    v_fma_f32 v227, -v11, v11, s42
    v_mfma_f32_16x16x32_bf16 v[60:63], v[184:187], a[172:175], v[60:63]
    s_add_u32 s58, s30, 765952
    v_mul_f32 v226, v226, v10
    v_mul_f32 v227, v227, v11
    v_mfma_f32_16x16x32_bf16 v[60:63], v[180:183], a[156:159], v[60:63]
    s_waitcnt vmcnt(18)
    v_exp_f32 v224, v224
    v_mfma_f32_16x16x32_bf16 v[32:35], v[192:195], a[192:195], v[32:35]
    buffer_load_dwordx4 v[180:183], v241, s[20:23], s58 offen offset:0 sc1
    v_mfma_f32_16x16x32_bf16 v[32:35], v[196:199], a[208:211], v[32:35]
    v_exp_f32 v225, v225
    v_mfma_f32_16x16x32_bf16 v[32:35], v[200:203], a[224:227], v[32:35]
    s_add_u32 s58, s30, 774144
    v_exp_f32 v226, v226
    v_mfma_f32_16x16x32_bf16 v[36:39], v[200:203], a[228:231], v[36:39]
    v_exp_f32 v227, v227
    v_mfma_f32_16x16x32_bf16 v[36:39], v[196:199], a[212:215], v[36:39]
    buffer_load_dwordx4 v[184:187], v241, s[20:23], s58 offen offset:0 sc1
    v_mfma_f32_16x16x32_bf16 v[36:39], v[192:195], a[196:199], v[36:39]
    v_add_f32 v224, 1.0, v224
    v_add_f32 v225, 1.0, v225
    v_mfma_f32_16x16x32_bf16 v[40:43], v[192:195], a[200:203], v[40:43]
    s_add_u32 s58, s30, 782336
    v_add_f32 v226, 1.0, v226
    v_add_f32 v227, 1.0, v227
    v_mfma_f32_16x16x32_bf16 v[40:43], v[196:199], a[216:219], v[40:43]
    v_rcp_f32 v224, v224
    v_mfma_f32_16x16x32_bf16 v[40:43], v[200:203], a[232:235], v[40:43]
    buffer_load_dwordx4 v[188:191], v241, s[20:23], s58 offen offset:0 sc1
    v_mfma_f32_16x16x32_bf16 v[44:47], v[200:203], a[236:239], v[44:47]
    v_rcp_f32 v225, v225
    v_mfma_f32_16x16x32_bf16 v[44:47], v[196:199], a[220:223], v[44:47]
    s_add_u32 s58, s30, 786432
    v_rcp_f32 v226, v226
    v_mfma_f32_16x16x32_bf16 v[44:47], v[192:195], a[204:207], v[44:47]
    s_waitcnt vmcnt(18)
    v_rcp_f32 v227, v227
    v_mfma_f32_16x16x32_bf16 v[48:51], v[204:207], a[192:195], v[48:51]
    buffer_load_dwordx4 v[192:195], v241, s[20:23], s58 offen offset:0 sc1
    v_mfma_f32_16x16x32_bf16 v[48:51], v[208:211], a[208:211], v[48:51]
    v_mul_f32 v8, v8, v24
    v_mul_f32 v9, v9, v25
    v_mfma_f32_16x16x32_bf16 v[48:51], v[212:215], a[224:227], v[48:51]
    s_add_u32 s58, s30, 794624
    v_mul_f32 v10, v10, v26
    v_mul_f32 v11, v11, v27
    v_mfma_f32_16x16x32_bf16 v[52:55], v[212:215], a[228:231], v[52:55]
    v_mul_f32 v224, v224, v8
    v_mul_f32 v225, v225, v9
    v_mfma_f32_16x16x32_bf16 v[52:55], v[208:211], a[212:215], v[52:55]
    buffer_load_dwordx4 v[196:199], v241, s[20:23], s58 offen offset:0 sc1
    v_mfma_f32_16x16x32_bf16 v[52:55], v[204:207], a[196:199], v[52:55]
    v_mul_f32 v226, v226, v10
    v_mul_f32 v227, v227, v11
    v_mfma_f32_16x16x32_bf16 v[56:59], v[204:207], a[200:203], v[56:59]
    s_add_u32 s58, s30, 802816
    v_cvt_pk_bf16_f32 v236, v224, v225
    v_cvt_pk_bf16_f32 v237, v226, v227
    v_mfma_f32_16x16x32_bf16 v[56:59], v[208:211], a[216:219], v[56:59]
    ds_write_b64 v242, v[236:237] offset:6152
    v_mfma_f32_16x16x32_bf16 v[56:59], v[212:215], a[232:235], v[56:59]
    buffer_load_dwordx4 v[200:203], v241, s[20:23], s58 offen offset:0 sc1
    v_mfma_f32_16x16x32_bf16 v[60:63], v[212:215], a[236:239], v[60:63]
    v_fma_f32 v228, -v12, v12, s42
    v_fma_f32 v229, -v13, v13, s42
    v_mfma_f32_16x16x32_bf16 v[60:63], v[208:211], a[220:223], v[60:63]
    s_add_u32 s58, s30, 790528
    v_mul_f32 v228, v228, v12
    v_mul_f32 v229, v229, v13
    v_mfma_f32_16x16x32_bf16 v[60:63], v[204:207], a[204:207], v[60:63]
    s_waitcnt vmcnt(18)
    v_fma_f32 v230, -v14, v14, s42
    v_fma_f32 v231, -v15, v15, s42
    v_mfma_f32_16x16x32_bf16 v[32:35], v[216:219], a[240:243], v[32:35]
    buffer_load_dwordx4 v[204:207], v241, s[20:23], s58 offen offset:0 sc1
    v_mfma_f32_16x16x32_bf16 v[32:35], v[220:223], v[96:99], v[32:35]
    v_mul_f32 v230, v230, v14
    v_mul_f32 v231, v231, v15
    v_mfma_f32_16x16x32_bf16 v[32:35], v[128:131], v[112:115], v[32:35]
    s_add_u32 s58, s30, 798720
    v_exp_f32 v228, v228
    v_mfma_f32_16x16x32_bf16 v[36:39], v[128:131], v[116:119], v[36:39]
    v_exp_f32 v229, v229
    v_mfma_f32_16x16x32_bf16 v[36:39], v[220:223], v[100:103], v[36:39]
    buffer_load_dwordx4 v[208:211], v241, s[20:23], s58 offen offset:0 sc1
    v_mfma_f32_16x16x32_bf16 v[36:39], v[216:219], a[244:247], v[36:39]
    v_exp_f32 v230, v230
    v_mfma_f32_16x16x32_bf16 v[40:43], v[216:219], a[248:251], v[40:43]
    s_add_u32 s58, s30, 806912
    v_exp_f32 v231, v231
    v_mfma_f32_16x16x32_bf16 v[40:43], v[220:223], v[104:107], v[40:43]
    v_add_f32 v228, 1.0, v228
    v_add_f32 v229, 1.0, v229
    v_mfma_f32_16x16x32_bf16 v[40:43], v[128:131], v[120:123], v[40:43]
    buffer_load_dwordx4 v[212:215], v241, s[20:23], s58 offen offset:0 sc1
    v_mfma_f32_16x16x32_bf16 v[44:47], v[128:131], v[124:127], v[44:47]
    v_add_f32 v230, 1.0, v230
    v_add_f32 v231, 1.0, v231
    v_mfma_f32_16x16x32_bf16 v[44:47], v[220:223], v[108:111], v[44:47]
    s_add_u32 s58, s30, 811008
    v_rcp_f32 v228, v228
    v_mfma_f32_16x16x32_bf16 v[44:47], v[216:219], a[252:255], v[44:47]
    s_waitcnt vmcnt(18)
    v_rcp_f32 v229, v229
    v_mfma_f32_16x16x32_bf16 v[48:51], v[132:135], a[240:243], v[48:51]
    buffer_load_dwordx4 v[216:219], v241, s[20:23], s58 offen offset:0 sc1
    v_mfma_f32_16x16x32_bf16 v[48:51], v[136:139], v[96:99], v[48:51]
    v_rcp_f32 v230, v230
    v_mfma_f32_16x16x32_bf16 v[48:51], v[140:143], v[112:115], v[48:51]
    s_add_u32 s58, s30, 819200
    v_rcp_f32 v231, v231
    v_mfma_f32_16x16x32_bf16 v[52:55], v[140:143], v[116:119], v[52:55]
    v_mul_f32 v12, v12, v28
    v_mul_f32 v13, v13, v29
    v_mfma_f32_16x16x32_bf16 v[52:55], v[136:139], v[100:103], v[52:55]
    buffer_load_dwordx4 v[220:223], v241, s[20:23], s58 offen offset:0 sc1
    v_mfma_f32_16x16x32_bf16 v[52:55], v[132:135], a[244:247], v[52:55]
    v_mul_f32 v14, v14, v30
    v_mul_f32 v15, v15, v31
    v_mfma_f32_16x16x32_bf16 v[56:59], v[132:135], a[248:251], v[56:59]
    s_add_u32 s58, s30, 827392
    v_mul_f32 v228, v228, v12
    v_mul_f32 v229, v229, v13
    v_mfma_f32_16x16x32_bf16 v[56:59], v[136:139], v[104:107], v[56:59]
    v_mul_f32 v230, v230, v14
    v_mul_f32 v231, v231, v15
    v_mfma_f32_16x16x32_bf16 v[56:59], v[140:143], v[120:123], v[56:59]
    buffer_load_dwordx4 v[128:131], v241, s[20:23], s58 offen offset:0 sc1
    v_mfma_f32_16x16x32_bf16 v[60:63], v[140:143], v[124:127], v[60:63]
    v_cvt_pk_bf16_f32 v238, v228, v229
    v_cvt_pk_bf16_f32 v239, v230, v231
    v_mfma_f32_16x16x32_bf16 v[60:63], v[136:139], v[108:111], v[60:63]
    s_add_u32 s58, s30, 815104
    ds_write_b64 v242, v[238:239] offset:7176
    v_mfma_f32_16x16x32_bf16 v[60:63], v[132:135], a[252:255], v[60:63]
    s_waitcnt vmcnt(18)
    v_mfma_f32_16x16x32_bf16 v[64:67], v[144:147], a[0:3], 0
    buffer_load_dwordx4 v[132:135], v241, s[20:23], s58 offen offset:0 sc1
    v_mfma_f32_16x16x32_bf16 v[64:67], v[148:151], a[16:19], v[64:67]
    v_mfma_f32_16x16x32_bf16 v[64:67], v[152:155], a[32:35], v[64:67]
    s_add_u32 s58, s30, 823296
    v_mfma_f32_16x16x32_bf16 v[68:71], v[152:155], a[36:39], 0
    v_mfma_f32_16x16x32_bf16 v[68:71], v[148:151], a[20:23], v[68:71]
    buffer_load_dwordx4 v[136:139], v241, s[20:23], s58 offen offset:0 sc1
    v_mfma_f32_16x16x32_bf16 v[68:71], v[144:147], a[4:7], v[68:71]
    v_fma_f32 v224, -v32, v32, s42
    v_fma_f32 v225, -v33, v33, s42
    v_mfma_f32_16x16x32_bf16 v[72:75], v[144:147], a[8:11], 0
    s_add_u32 s58, s30, 831488
    v_mul_f32 v224, v224, v32
    v_mul_f32 v225, v225, v33
    v_mfma_f32_16x16x32_bf16 v[72:75], v[148:151], a[24:27], v[72:75]
    v_fma_f32 v226, -v34, v34, s42
    v_fma_f32 v227, -v35, v35, s42
    v_mfma_f32_16x16x32_bf16 v[72:75], v[152:155], a[40:43], v[72:75]
    buffer_load_dwordx4 v[140:143], v241, s[20:23], s58 offen offset:0 sc1
    v_mfma_f32_16x16x32_bf16 v[76:79], v[152:155], a[44:47], 0
    v_mul_f32 v226, v226, v34
    v_mul_f32 v227, v227, v35
    v_mfma_f32_16x16x32_bf16 v[76:79], v[148:151], a[28:31], v[76:79]
    s_add_u32 s58, s30, 835584
    v_exp_f32 v224, v224
    v_mfma_f32_16x16x32_bf16 v[76:79], v[144:147], a[12:15], v[76:79]
    s_waitcnt vmcnt(18)
    v_exp_f32 v225, v225
    v_mfma_f32_16x16x32_bf16 v[80:83], v[156:159], a[0:3], 0
    buffer_load_dwordx4 v[144:147], v241, s[20:23], s58 offen offset:0 sc1
    v_mfma_f32_16x16x32_bf16 v[80:83], v[160:163], a[16:19], v[80:83]
    v_exp_f32 v226, v226
    v_mfma_f32_16x16x32_bf16 v[80:83], v[164:167], a[32:35], v[80:83]
    s_add_u32 s58, s30, 843776
    v_exp_f32 v227, v227
    v_mfma_f32_16x16x32_bf16 v[84:87], v[164:167], a[36:39], 0
    v_add_f32 v224, 1.0, v224
    v_add_f32 v225, 1.0, v225
    v_mfma_f32_16x16x32_bf16 v[84:87], v[160:163], a[20:23], v[84:87]
    buffer_load_dwordx4 v[148:151], v241, s[20:23], s58 offen offset:0 sc1
    v_mfma_f32_16x16x32_bf16 v[84:87], v[156:159], a[4:7], v[84:87]
    v_add_f32 v226, 1.0, v226
    v_add_f32 v227, 1.0, v227
    v_mfma_f32_16x16x32_bf16 v[88:91], v[156:159], a[8:11], 0
    s_add_u32 s58, s30, 851968
    v_rcp_f32 v224, v224
    v_mfma_f32_16x16x32_bf16 v[88:91], v[160:163], a[24:27], v[88:91]
    v_rcp_f32 v225, v225
    v_mfma_f32_16x16x32_bf16 v[88:91], v[164:167], a[40:43], v[88:91]
    buffer_load_dwordx4 v[152:155], v241, s[20:23], s58 offen offset:0 sc1
    v_mfma_f32_16x16x32_bf16 v[92:95], v[164:167], a[44:47], 0
    v_rcp_f32 v226, v226
    v_mfma_f32_16x16x32_bf16 v[92:95], v[160:163], a[28:31], v[92:95]
    s_add_u32 s58, s30, 839680
    v_rcp_f32 v227, v227
    v_mfma_f32_16x16x32_bf16 v[92:95], v[156:159], a[12:15], v[92:95]
    s_waitcnt vmcnt(18)
    v_mul_f32 v32, v32, v48
    v_mul_f32 v33, v33, v49
    v_mfma_f32_16x16x32_bf16 v[64:67], v[168:171], a[48:51], v[64:67]
    buffer_load_dwordx4 v[156:159], v241, s[20:23], s58 offen offset:0 sc1
    v_mfma_f32_16x16x32_bf16 v[64:67], v[172:175], a[64:67], v[64:67]
    v_mul_f32 v34, v34, v50
    v_mul_f32 v35, v35, v51
    v_mfma_f32_16x16x32_bf16 v[64:67], v[176:179], a[80:83], v[64:67]
    s_add_u32 s58, s30, 847872
    v_mul_f32 v224, v224, v32
    v_mul_f32 v225, v225, v33
    v_mfma_f32_16x16x32_bf16 v[68:71], v[176:179], a[84:87], v[68:71]
    v_mul_f32 v226, v226, v34
    v_mul_f32 v227, v227, v35
    v_mfma_f32_16x16x32_bf16 v[68:71], v[172:175], a[68:71], v[68:71]
    buffer_load_dwordx4 v[160:163], v241, s[20:23], s58 offen offset:0 sc1
    v_mfma_f32_16x16x32_bf16 v[68:71], v[168:171], a[52:55], v[68:71]
    v_cvt_pk_bf16_f32 v232, v224, v225
    v_cvt_pk_bf16_f32 v233, v226, v227
    v_mfma_f32_16x16x32_bf16 v[72:75], v[168:171], a[56:59], v[72:75]
    s_add_u32 s58, s30, 856064
    ds_write_b64 v242, v[232:233] offset:8192
    v_mfma_f32_16x16x32_bf16 v[72:75], v[172:175], a[72:75], v[72:75]
    v_fma_f32 v228, -v36, v36, s42
    v_fma_f32 v229, -v37, v37, s42
    v_mfma_f32_16x16x32_bf16 v[72:75], v[176:179], a[88:91], v[72:75]
    buffer_load_dwordx4 v[164:167], v241, s[20:23], s58 offen offset:0 sc1
    v_mfma_f32_16x16x32_bf16 v[76:79], v[176:179], a[92:95], v[76:79]
    v_mul_f32 v228, v228, v36
    v_mul_f32 v229, v229, v37
    v_mfma_f32_16x16x32_bf16 v[76:79], v[172:175], a[76:79], v[76:79]
    s_add_u32 s58, s30, 860160
    v_fma_f32 v230, -v38, v38, s42
    v_fma_f32 v231, -v39, v39, s42
    v_mfma_f32_16x16x32_bf16 v[76:79], v[168:171], a[60:63], v[76:79]
    s_waitcnt vmcnt(18)
    v_mul_f32 v230, v230, v38
    v_mul_f32 v231, v231, v39
    v_mfma_f32_16x16x32_bf16 v[80:83], v[180:183], a[48:51], v[80:83]
    buffer_load_dwordx4 v[168:171], v241, s[20:23], s58 offen offset:0 sc1
    v_mfma_f32_16x16x32_bf16 v[80:83], v[184:187], a[64:67], v[80:83]
    v_exp_f32 v228, v228
    v_mfma_f32_16x16x32_bf16 v[80:83], v[188:191], a[80:83], v[80:83]
    s_add_u32 s58, s30, 868352
    v_exp_f32 v229, v229
    v_mfma_f32_16x16x32_bf16 v[84:87], v[188:191], a[84:87], v[84:87]
    v_exp_f32 v230, v230
    v_mfma_f32_16x16x32_bf16 v[84:87], v[184:187], a[68:71], v[84:87]
    buffer_load_dwordx4 v[172:175], v241, s[20:23], s58 offen offset:0 sc1
    v_mfma_f32_16x16x32_bf16 v[84:87], v[180:183], a[52:55], v[84:87]
    v_exp_f32 v231, v231
    v_mfma_f32_16x16x32_bf16 v[88:91], v[180:183], a[56:59], v[88:91]
    s_add_u32 s58, s30, 876544
    v_add_f32 v228, 1.0, v228
    v_add_f32 v229, 1.0, v229
    v_mfma_f32_16x16x32_bf16 v[88:91], v[184:187], a[72:75], v[88:91]
    v_add_f32 v230, 1.0, v230
    v_add_f32 v231, 1.0, v231
    v_mfma_f32_16x16x32_bf16 v[88:91], v[188:191], a[88:91], v[88:91]
    buffer_load_dwordx4 v[176:179], v241, s[20:23], s58 offen offset:0 sc1
    v_mfma_f32_16x16x32_bf16 v[92:95], v[188:191], a[92:95], v[92:95]
    v_rcp_f32 v228, v228
    v_mfma_f32_16x16x32_bf16 v[92:95], v[184:187], a[76:79], v[92:95]
    s_add_u32 s58, s30, 864256
    v_rcp_f32 v229, v229
    v_mfma_f32_16x16x32_bf16 v[92:95], v[180:183], a[60:63], v[92:95]
    s_waitcnt vmcnt(18)
    v_rcp_f32 v230, v230
    v_mfma_f32_16x16x32_bf16 v[64:67], v[192:195], a[96:99], v[64:67]
    buffer_load_dwordx4 v[180:183], v241, s[20:23], s58 offen offset:0 sc1
    v_mfma_f32_16x16x32_bf16 v[64:67], v[196:199], a[112:115], v[64:67]
    v_rcp_f32 v231, v231
    v_mfma_f32_16x16x32_bf16 v[64:67], v[200:203], a[128:131], v[64:67]
    s_add_u32 s58, s30, 872448
    v_mul_f32 v36, v36, v52
    v_mul_f32 v37, v37, v53
    v_mfma_f32_16x16x32_bf16 v[68:71], v[200:203], a[132:135], v[68:71]
    v_mul_f32 v38, v38, v54
    v_mul_f32 v39, v39, v55
    v_mfma_f32_16x16x32_bf16 v[68:71], v[196:199], a[116:119], v[68:71]
    buffer_load_dwordx4 v[184:187], v241, s[20:23], s58 offen offset:0 sc1
    v_mfma_f32_16x16x32_bf16 v[68:71], v[192:195], a[100:103], v[68:71]
    v_mul_f32 v228, v228, v36
    v_mul_f32 v229, v229, v37
    v_mfma_f32_16x16x32_bf16 v[72:75], v[192:195], a[104:107], v[72:75]
    s_add_u32 s58, s30, 880640
    v_mul_f32 v230, v230, v38
    v_mul_f32 v231, v231, v39
    v_mfma_f32_16x16x32_bf16 v[72:75], v[196:199], a[120:123], v[72:75]
    v_cvt_pk_bf16_f32 v234, v228, v229
    v_cvt_pk_bf16_f32 v235, v230, v231
    v_mfma_f32_16x16x32_bf16 v[72:75], v[200:203], a[136:139], v[72:75]
    buffer_load_dwordx4 v[188:191], v241, s[20:23], s58 offen offset:0 sc1
    v_mfma_f32_16x16x32_bf16 v[76:79], v[200:203], a[140:143], v[76:79]
    ds_write_b64 v242, v[234:235] offset:9216
    v_mfma_f32_16x16x32_bf16 v[76:79], v[196:199], a[124:127], v[76:79]
    s_add_u32 s58, s30, 884736
    v_fma_f32 v224, -v40, v40, s42
    v_fma_f32 v225, -v41, v41, s42
    v_mfma_f32_16x16x32_bf16 v[76:79], v[192:195], a[108:111], v[76:79]
    s_waitcnt vmcnt(18)
    v_mul_f32 v224, v224, v40
    v_mul_f32 v225, v225, v41
    v_mfma_f32_16x16x32_bf16 v[80:83], v[204:207], a[96:99], v[80:83]
    buffer_load_dwordx4 v[192:195], v241, s[20:23], s58 offen offset:0 sc1
    v_mfma_f32_16x16x32_bf16 v[80:83], v[208:211], a[112:115], v[80:83]
    v_fma_f32 v226, -v42, v42, s42
    v_fma_f32 v227, -v43, v43, s42
    v_mfma_f32_16x16x32_bf16 v[80:83], v[212:215], a[128:131], v[80:83]
    s_add_u32 s58, s30, 892928
    v_mul_f32 v226, v226, v42
    v_mul_f32 v227, v227, v43
    v_mfma_f32_16x16x32_bf16 v[84:87], v[212:215], a[132:135], v[84:87]
    v_exp_f32 v224, v224
    v_mfma_f32_16x16x32_bf16 v[84:87], v[208:211], a[116:119], v[84:87]
    buffer_load_dwordx4 v[196:199], v241, s[20:23], s58 offen offset:0 sc1
    v_mfma_f32_16x16x32_bf16 v[84:87], v[204:207], a[100:103], v[84:87]
    v_exp_f32 v225, v225
    v_mfma_f32_16x16x32_bf16 v[88:91], v[204:207], a[104:107], v[88:91]
    s_add_u32 s58, s30, 901120
    v_exp_f32 v226, v226
    v_mfma_f32_16x16x32_bf16 v[88:91], v[208:211], a[120:123], v[88:91]
    v_exp_f32 v227, v227
    v_mfma_f32_16x16x32_bf16 v[88:91], v[212:215], a[136:139], v[88:91]
    buffer_load_dwordx4 v[200:203], v241, s[20:23], s58 offen offset:0 sc1
    v_mfma_f32_16x16x32_bf16 v[92:95], v[212:215], a[140:143], v[92:95]
    v_add_f32 v224, 1.0, v224
    v_add_f32 v225, 1.0, v225
    v_mfma_f32_16x16x32_bf16 v[92:95], v[208:211], a[124:127], v[92:95]
    s_add_u32 s58, s30, 888832
    v_add_f32 v226, 1.0, v226
    v_add_f32 v227, 1.0, v227
    v_mfma_f32_16x16x32_bf16 v[92:95], v[204:207], a[108:111], v[92:95]
HOP2_3:
    s_cbranch_execz HOP2_7
    s_waitcnt vmcnt(18)
    v_rcp_f32 v224, v224
    v_mfma_f32_16x16x32_bf16 v[64:67], v[216:219], a[144:147], v[64:67]
    buffer_load_dwordx4 v[204:207], v241, s[20:23], s58 offen offset:0 sc1
    v_mfma_f32_16x16x32_bf16 v[64:67], v[220:223], a[160:163], v[64:67]
    v_rcp_f32 v225, v225
    v_mfma_f32_16x16x32_bf16 v[64:67], v[128:131], a[176:179], v[64:67]
    s_add_u32 s58, s30, 897024
    v_rcp_f32 v226, v226
    v_mfma_f32_16x16x32_bf16 v[68:71], v[128:131], a[180:183], v[68:71]
    v_rcp_f32 v227, v227
    v_mfma_f32_16x16x32_bf16 v[68:71], v[220:223], a[164:167], v[68:71]
    buffer_load_dwordx4 v[208:211], v241, s[20:23], s58 offen offset:0 sc1
    v_mfma_f32_16x16x32_bf16 v[68:71], v[216:219], a[148:151], v[68:71]
    v_mul_f32 v40, v40, v56
    v_mul_f32 v41, v41, v57
    v_mfma_f32_16x16x32_bf16 v[72:75], v[216:219], a[152:155], v[72:75]
    s_add_u32 s58, s30, 905216
    v_mul_f32 v42, v42, v58
    v_mul_f32 v43, v43, v59
    v_mfma_f32_16x16x32_bf16 v[72:75], v[220:223], a[168:171], v[72:75]
    v_mul_f32 v224, v224, v40
    v_mul_f32 v225, v225, v41
    v_mfma_f32_16x16x32_bf16 v[72:75], v[128:131], a[184:187], v[72:75]
    buffer_load_dwordx4 v[212:215], v241, s[20:23], s58 offen offset:0 sc1
    v_mfma_f32_16x16x32_bf16 v[76:79], v[128:131], a[188:191], v[76:79]
    v_mul_f32 v226, v226, v42
    v_mul_f32 v227, v227, v43
    v_mfma_f32_16x16x32_bf16 v[76:79], v[220:223], a[172:175], v[76:79]
    s_add_u32 s58, s30, 909312
    v_cvt_pk_bf16_f32 v236, v224, v225
    v_cvt_pk_bf16_f32 v237, v226, v227
    v_mfma_f32_16x16x32_bf16 v[76:79], v[216:219], a[156:159], v[76:79]
    s_waitcnt vmcnt(18)
    ds_write_b64 v242, v[236:237] offset:10240
    v_mfma_f32_16x16x32_bf16 v[80:83], v[132:135], a[144:147], v[80:83]
    buffer_load_dwordx4 v[216:219], v241, s[20:23], s58 offen offset:0 sc1
    v_mfma_f32_16x16x32_bf16 v[80:83], v[136:139], a[160:163], v[80:83]
    v_fma_f32 v228, -v44, v44, s42
    v_fma_f32 v229, -v45, v45, s42
    v_mfma_f32_16x16x32_bf16 v[80:83], v[140:143], a[176:179], v[80:83]
    s_add_u32 s58, s30, 917504
    v_mul_f32 v228, v228, v44
    v_mul_f32 v229, v229, v45
    v_mfma_f32_16x16x32_bf16 v[84:87], v[140:143], a[180:183], v[84:87]
    v_fma_f32 v230, -v46, v46, s42
    v_fma_f32 v231, -v47, v47, s42
    v_mfma_f32_16x16x32_bf16 v[84:87], v[136:139], a[164:167], v[84:87]
    buffer_load_dwordx4 v[220:223], v241, s[20:23], s58 offen offset:0 sc1
    v_mfma_f32_16x16x32_bf16 v[84:87], v[132:135], a[148:151], v[84:87]
    v_mul_f32 v230, v230, v46
    v_mul_f32 v231, v231, v47
    v_mfma_f32_16x16x32_bf16 v[88:91], v[132:135], a[152:155], v[88:91]
    s_add_u32 s58, s30, 925696
    v_exp_f32 v228, v228
    v_mfma_f32_16x16x32_bf16 v[88:91], v[136:139], a[168:171], v[88:91]
    v_exp_f32 v229, v229
    v_mfma_f32_16x16x32_bf16 v[88:91], v[140:143], a[184:187], v[88:91]
    buffer_load_dwordx4 v[128:131], v241, s[20:23], s58 offen offset:0 sc1
    v_mfma_f32_16x16x32_bf16 v[92:95], v[140:143], a[188:191], v[92:95]
    v_exp_f32 v230, v230
    v_mfma_f32_16x16x32_bf16 v[92:95], v[136:139], a[172:175], v[92:95]
    s_add_u32 s58, s30, 913408
    v_exp_f32 v231, v231
    v_mfma_f32_16x16x32_bf16 v[92:95], v[132:135], a[156:159], v[92:95]
    s_waitcnt vmcnt(18)
    v_add_f32 v228, 1.0, v228
    v_add_f32 v229, 1.0, v229
    v_mfma_f32_16x16x32_bf16 v[64:67], v[144:147], a[192:195], v[64:67]
    buffer_load_dwordx4 v[132:135], v241, s[20:23], s58 offen offset:0 sc1
    v_mfma_f32_16x16x32_bf16 v[64:67], v[148:151], a[208:211], v[64:67]
    v_add_f32 v230, 1.0, v230
    v_add_f32 v231, 1.0, v231
    v_mfma_f32_16x16x32_bf16 v[64:67], v[152:155], a[224:227], v[64:67]
    s_add_u32 s58, s30, 921600
    v_rcp_f32 v228, v228
    v_mfma_f32_16x16x32_bf16 v[68:71], v[152:155], a[228:231], v[68:71]
    v_rcp_f32 v229, v229
    v_mfma_f32_16x16x32_bf16 v[68:71], v[148:151], a[212:215], v[68:71]
    buffer_load_dwordx4 v[136:139], v241, s[20:23], s58 offen offset:0 sc1
    v_mfma_f32_16x16x32_bf16 v[68:71], v[144:147], a[196:199], v[68:71]
    v_rcp_f32 v230, v230
    v_mfma_f32_16x16x32_bf16 v[72:75], v[144:147], a[200:203], v[72:75]
    s_add_u32 s58, s30, 929792
    v_rcp_f32 v231, v231
    v_mfma_f32_16x16x32_bf16 v[72:75], v[148:151], a[216:219], v[72:75]
    v_mul_f32 v44, v44, v60
    v_mul_f32 v45, v45, v61
    v_mfma_f32_16x16x32_bf16 v[72:75], v[152:155], a[232:235], v[72:75]
    buffer_load_dwordx4 v[140:143], v241, s[20:23], s58 offen offset:0 sc1
    v_mfma_f32_16x16x32_bf16 v[76:79], v[152:155], a[236:239], v[76:79]
    v_mul_f32 v46, v46, v62
    v_mul_f32 v47, v47, v63
    v_mfma_f32_16x16x32_bf16 v[76:79], v[148:151], a[220:223], v[76:79]
    s_add_u32 s58, s30, 933888
    v_mul_f32 v228, v228, v44
    v_mul_f32 v229, v229, v45
    v_mfma_f32_16x16x32_bf16 v[76:79], v[144:147], a[204:207], v[76:79]
    s_waitcnt vmcnt(18)
    v_mul_f32 v230, v230, v46
    v_mul_f32 v231, v231, v47
    v_mfma_f32_16x16x32_bf16 v[80:83], v[156:159], a[192:195], v[80:83]
    buffer_load_dwordx4 v[144:147], v241, s[20:23], s58 offen offset:0 sc1
    v_mfma_f32_16x16x32_bf16 v[80:83], v[160:163], a[208:211], v[80:83]
    v_cvt_pk_bf16_f32 v238, v228, v229
    v_cvt_pk_bf16_f32 v239, v230, v231
    v_mfma_f32_16x16x32_bf16 v[80:83], v[164:167], a[224:227], v[80:83]
    s_add_u32 s58, s30, 942080
    ds_write_b64 v242, v[238:239] offset:11264
    v_mfma_f32_16x16x32_bf16 v[84:87], v[164:167], a[228:231], v[84:87]
    v_mfma_f32_16x16x32_bf16 v[84:87], v[160:163], a[212:215], v[84:87]
    buffer_load_dwordx4 v[148:151], v241, s[20:23], s58 offen offset:0 sc1
    v_mfma_f32_16x16x32_bf16 v[84:87], v[156:159], a[196:199], v[84:87]
    v_mfma_f32_16x16x32_bf16 v[88:91], v[156:159], a[200:203], v[88:91]
    s_add_u32 s58, s30, 950272
    v_mfma_f32_16x16x32_bf16 v[88:91], v[160:163], a[216:219], v[88:91]
    v_mfma_f32_16x16x32_bf16 v[88:91], v[164:167], a[232:235], v[88:91]
    buffer_load_dwordx4 v[152:155], v241, s[20:23], s58 offen offset:0 sc1
    v_mfma_f32_16x16x32_bf16 v[92:95], v[164:167], a[236:239], v[92:95]
    v_mfma_f32_16x16x32_bf16 v[92:95], v[160:163], a[220:223], v[92:95]
    s_add_u32 s58, s30, 937984
    v_mfma_f32_16x16x32_bf16 v[92:95], v[156:159], a[204:207], v[92:95]
    s_waitcnt vmcnt(18)
    v_mfma_f32_16x16x32_bf16 v[64:67], v[168:171], a[240:243], v[64:67]
    buffer_load_dwordx4 v[156:159], v241, s[20:23], s58 offen offset:0 sc1
    v_mfma_f32_16x16x32_bf16 v[64:67], v[172:175], v[96:99], v[64:67]
    v_mfma_f32_16x16x32_bf16 v[64:67], v[176:179], v[112:115], v[64:67]
    s_add_u32 s58, s30, 946176
    v_mfma_f32_16x16x32_bf16 v[68:71], v[176:179], v[116:119], v[68:71]
    v_mfma_f32_16x16x32_bf16 v[68:71], v[172:175], v[100:103], v[68:71]
    buffer_load_dwordx4 v[160:163], v241, s[20:23], s58 offen offset:0 sc1
    v_mfma_f32_16x16x32_bf16 v[68:71], v[168:171], a[244:247], v[68:71]
    v_mfma_f32_16x16x32_bf16 v[72:75], v[168:171], a[248:251], v[72:75]
    s_add_u32 s58, s30, 954368
    v_mfma_f32_16x16x32_bf16 v[72:75], v[172:175], v[104:107], v[72:75]
    v_mfma_f32_16x16x32_bf16 v[72:75], v[176:179], v[120:123], v[72:75]
    buffer_load_dwordx4 v[164:167], v241, s[20:23], s58 offen offset:0 sc1
    v_mfma_f32_16x16x32_bf16 v[76:79], v[176:179], v[124:127], v[76:79]
    v_mfma_f32_16x16x32_bf16 v[76:79], v[172:175], v[108:111], v[76:79]
    s_add_u32 s58, s30, 958464
    v_mfma_f32_16x16x32_bf16 v[76:79], v[168:171], a[252:255], v[76:79]
    s_waitcnt vmcnt(18)
    v_mfma_f32_16x16x32_bf16 v[80:83], v[180:183], a[240:243], v[80:83]
    buffer_load_dwordx4 v[168:171], v241, s[20:23], s58 offen offset:0 sc1
    v_mfma_f32_16x16x32_bf16 v[80:83], v[184:187], v[96:99], v[80:83]
    v_mfma_f32_16x16x32_bf16 v[80:83], v[188:191], v[112:115], v[80:83]
    s_add_u32 s58, s30, 966656
    v_mfma_f32_16x16x32_bf16 v[84:87], v[188:191], v[116:119], v[84:87]
    v_mfma_f32_16x16x32_bf16 v[84:87], v[184:187], v[100:103], v[84:87]
    buffer_load_dwordx4 v[172:175], v241, s[20:23], s58 offen offset:0 sc1
    v_mfma_f32_16x16x32_bf16 v[84:87], v[180:183], a[244:247], v[84:87]
    v_mfma_f32_16x16x32_bf16 v[88:91], v[180:183], a[248:251], v[88:91]
    s_add_u32 s58, s30, 974848
    v_mfma_f32_16x16x32_bf16 v[88:91], v[184:187], v[104:107], v[88:91]
    v_mfma_f32_16x16x32_bf16 v[88:91], v[188:191], v[120:123], v[88:91]
    buffer_load_dwordx4 v[176:179], v241, s[20:23], s58 offen offset:0 sc1
    v_mfma_f32_16x16x32_bf16 v[92:95], v[188:191], v[124:127], v[92:95]
    v_mfma_f32_16x16x32_bf16 v[92:95], v[184:187], v[108:111], v[92:95]
    s_add_u32 s58, s30, 962560
    v_mfma_f32_16x16x32_bf16 v[92:95], v[180:183], a[252:255], v[92:95]
    s_waitcnt vmcnt(18)
    v_mfma_f32_16x16x32_bf16 v[0:3], v[192:195], a[0:3], 0
    buffer_load_dwordx4 v[180:183], v241, s[20:23], s58 offen offset:0 sc1
    v_mfma_f32_16x16x32_bf16 v[0:3], v[196:199], a[16:19], v[0:3]
    v_mfma_f32_16x16x32_bf16 v[0:3], v[200:203], a[32:35], v[0:3]
    s_add_u32 s58, s30, 970752
    v_mfma_f32_16x16x32_bf16 v[4:7], v[200:203], a[36:39], 0
    v_mfma_f32_16x16x32_bf16 v[4:7], v[196:199], a[20:23], v[4:7]
    buffer_load_dwordx4 v[184:187], v241, s[20:23], s58 offen offset:0 sc1
    v_mfma_f32_16x16x32_bf16 v[4:7], v[192:195], a[4:7], v[4:7]
    v_fma_f32 v224, -v64, v64, s42
    v_fma_f32 v225, -v65, v65, s42
    v_mfma_f32_16x16x32_bf16 v[8:11], v[192:195], a[8:11], 0
    s_add_u32 s58, s30, 978944
    v_mul_f32 v224, v224, v64
    v_mul_f32 v225, v225, v65
    v_mfma_f32_16x16x32_bf16 v[8:11], v[196:199], a[24:27], v[8:11]
    v_fma_f32 v226, -v66, v66, s42
    v_fma_f32 v227, -v67, v67, s42
    v_mfma_f32_16x16x32_bf16 v[8:11], v[200:203], a[40:43], v[8:11]
    buffer_load_dwordx4 v[188:191], v241, s[20:23], s58 offen offset:0 sc1
    v_mfma_f32_16x16x32_bf16 v[12:15], v[200:203], a[44:47], 0
    v_mul_f32 v226, v226, v66
    v_mul_f32 v227, v227, v67
    v_mfma_f32_16x16x32_bf16 v[12:15], v[196:199], a[28:31], v[12:15]
    s_add_u32 s58, s30, 983040
    v_exp_f32 v224, v224
    v_mfma_f32_16x16x32_bf16 v[12:15], v[192:195], a[12:15], v[12:15]
    s_waitcnt vmcnt(18)
    v_exp_f32 v225, v225
    v_mfma_f32_16x16x32_bf16 v[16:19], v[204:207], a[0:3], 0
    buffer_load_dwordx4 v[192:195], v241, s[20:23], s58 offen offset:0 sc1
    v_mfma_f32_16x16x32_bf16 v[16:19], v[208:211], a[16:19], v[16:19]
    v_exp_f32 v226, v226
    v_mfma_f32_16x16x32_bf16 v[16:19], v[212:215], a[32:35], v[16:19]
    s_add_u32 s58, s30, 991232
    v_exp_f32 v227, v227
    v_mfma_f32_16x16x32_bf16 v[20:23], v[212:215], a[36:39], 0
    v_add_f32 v224, 1.0, v224
    v_add_f32 v225, 1.0, v225
    v_mfma_f32_16x16x32_bf16 v[20:23], v[208:211], a[20:23], v[20:23]
    buffer_load_dwordx4 v[196:199], v241, s[20:23], s58 offen offset:0 sc1
    v_mfma_f32_16x16x32_bf16 v[20:23], v[204:207], a[4:7], v[20:23]
    v_add_f32 v226, 1.0, v226
    v_add_f32 v227, 1.0, v227
    v_mfma_f32_16x16x32_bf16 v[24:27], v[204:207], a[8:11], 0
    s_add_u32 s58, s30, 999424
    v_rcp_f32 v224, v224
    v_mfma_f32_16x16x32_bf16 v[24:27], v[208:211], a[24:27], v[24:27]
    v_rcp_f32 v225, v225
    v_mfma_f32_16x16x32_bf16 v[24:27], v[212:215], a[40:43], v[24:27]
    buffer_load_dwordx4 v[200:203], v241, s[20:23], s58 offen offset:0 sc1
    v_mfma_f32_16x16x32_bf16 v[28:31], v[212:215], a[44:47], 0
    v_rcp_f32 v226, v226
    v_mfma_f32_16x16x32_bf16 v[28:31], v[208:211], a[28:31], v[28:31]
    s_add_u32 s58, s30, 987136
    v_rcp_f32 v227, v227
    v_mfma_f32_16x16x32_bf16 v[28:31], v[204:207], a[12:15], v[28:31]
    s_waitcnt vmcnt(18)
    v_mul_f32 v64, v64, v80
    v_mul_f32 v65, v65, v81
    v_mfma_f32_16x16x32_bf16 v[0:3], v[216:219], a[48:51], v[0:3]
    buffer_load_dwordx4 v[204:207], v241, s[20:23], s58 offen offset:0 sc1
    v_mfma_f32_16x16x32_bf16 v[0:3], v[220:223], a[64:67], v[0:3]
    v_mul_f32 v66, v66, v82
    v_mul_f32 v67, v67, v83
    v_mfma_f32_16x16x32_bf16 v[0:3], v[128:131], a[80:83], v[0:3]
    s_add_u32 s58, s30, 995328
    v_mul_f32 v224, v224, v64
    v_mul_f32 v225, v225, v65
    v_mfma_f32_16x16x32_bf16 v[4:7], v[128:131], a[84:87], v[4:7]
    v_mul_f32 v226, v226, v66
    v_mul_f32 v227, v227, v67
    v_mfma_f32_16x16x32_bf16 v[4:7], v[220:223], a[68:71], v[4:7]
    buffer_load_dwordx4 v[208:211], v241, s[20:23], s58 offen offset:0 sc1
    v_mfma_f32_16x16x32_bf16 v[4:7], v[216:219], a[52:55], v[4:7]
    v_cvt_pk_bf16_f32 v232, v224, v225
    v_cvt_pk_bf16_f32 v233, v226, v227
    v_mfma_f32_16x16x32_bf16 v[8:11], v[216:219], a[56:59], v[8:11]
    s_add_u32 s58, s30, 1003520
    ds_write_b64 v242, v[232:233] offset:8200
    v_mfma_f32_16x16x32_bf16 v[8:11], v[220:223], a[72:75], v[8:11]
    v_fma_f32 v228, -v68, v68, s42
    v_fma_f32 v229, -v69, v69, s42
    v_mfma_f32_16x16x32_bf16 v[8:11], v[128:131], a[88:91], v[8:11]
    buffer_load_dwordx4 v[212:215], v241, s[20:23], s58 offen offset:0 sc1
    v_mfma_f32_16x16x32_bf16 v[12:15], v[128:131], a[92:95], v[12:15]
    v_mul_f32 v228, v228, v68
    v_mul_f32 v229, v229, v69
    v_mfma_f32_16x16x32_bf16 v[12:15], v[220:223], a[76:79], v[12:15]
    s_add_u32 s58, s30, 1007616
    v_fma_f32 v230, -v70, v70, s42
    v_fma_f32 v231, -v71, v71, s42
    v_mfma_f32_16x16x32_bf16 v[12:15], v[216:219], a[60:63], v[12:15]
    s_waitcnt vmcnt(18)
    v_mul_f32 v230, v230, v70
    v_mul_f32 v231, v231, v71
    v_mfma_f32_16x16x32_bf16 v[16:19], v[132:135], a[48:51], v[16:19]
    buffer_load_dwordx4 v[216:219], v241, s[20:23], s58 offen offset:0 sc1
    v_mfma_f32_16x16x32_bf16 v[16:19], v[136:139], a[64:67], v[16:19]
    v_exp_f32 v228, v228
    v_mfma_f32_16x16x32_bf16 v[16:19], v[140:143], a[80:83], v[16:19]
    s_add_u32 s58, s30, 1015808
    v_exp_f32 v229, v229
    v_mfma_f32_16x16x32_bf16 v[20:23], v[140:143], a[84:87], v[20:23]
    v_exp_f32 v230, v230
    v_mfma_f32_16x16x32_bf16 v[20:23], v[136:139], a[68:71], v[20:23]
    buffer_load_dwordx4 v[220:223], v241, s[20:23], s58 offen offset:0 sc1
    v_mfma_f32_16x16x32_bf16 v[20:23], v[132:135], a[52:55], v[20:23]
    v_exp_f32 v231, v231
    v_mfma_f32_16x16x32_bf16 v[24:27], v[132:135], a[56:59], v[24:27]
    s_add_u32 s58, s30, 1024000
    v_add_f32 v228, 1.0, v228
    v_add_f32 v229, 1.0, v229
    v_mfma_f32_16x16x32_bf16 v[24:27], v[136:139], a[72:75], v[24:27]
    v_add_f32 v230, 1.0, v230
    v_add_f32 v231, 1.0, v231
    v_mfma_f32_16x16x32_bf16 v[24:27], v[140:143], a[88:91], v[24:27]
    buffer_load_dwordx4 v[128:131], v241, s[20:23], s58 offen offset:0 sc1
    v_mfma_f32_16x16x32_bf16 v[28:31], v[140:143], a[92:95], v[28:31]
    v_rcp_f32 v228, v228
    v_mfma_f32_16x16x32_bf16 v[28:31], v[136:139], a[76:79], v[28:31]
    s_add_u32 s58, s30, 1011712
    v_rcp_f32 v229, v229
    v_mfma_f32_16x16x32_bf16 v[28:31], v[132:135], a[60:63], v[28:31]
    s_waitcnt vmcnt(18)
    v_rcp_f32 v230, v230
    v_mfma_f32_16x16x32_bf16 v[0:3], v[144:147], a[96:99], v[0:3]
    buffer_load_dwordx4 v[132:135], v241, s[20:23], s58 offen offset:0 sc1
    v_mfma_f32_16x16x32_bf16 v[0:3], v[148:151], a[112:115], v[0:3]
    v_rcp_f32 v231, v231
    v_mfma_f32_16x16x32_bf16 v[0:3], v[152:155], a[128:131], v[0:3]
    s_add_u32 s58, s30, 1019904
    v_mul_f32 v68, v68, v84
    v_mul_f32 v69, v69, v85
    v_mfma_f32_16x16x32_bf16 v[4:7], v[152:155], a[132:135], v[4:7]
    v_mul_f32 v70, v70, v86
    v_mul_f32 v71, v71, v87
    v_mfma_f32_16x16x32_bf16 v[4:7], v[148:151], a[116:119], v[4:7]
    buffer_load_dwordx4 v[136:139], v241, s[20:23], s58 offen offset:0 sc1
    v_mfma_f32_16x16x32_bf16 v[4:7], v[144:147], a[100:103], v[4:7]
    v_mul_f32 v228, v228, v68
    v_mul_f32 v229, v229, v69
    v_mfma_f32_16x16x32_bf16 v[8:11], v[144:147], a[104:107], v[8:11]
    s_add_u32 s58, s30, 1028096
    v_mul_f32 v230, v230, v70
    v_mul_f32 v231, v231, v71
    v_mfma_f32_16x16x32_bf16 v[8:11], v[148:151], a[120:123], v[8:11]
    v_cvt_pk_bf16_f32 v234, v228, v229
    v_cvt_pk_bf16_f32 v235, v230, v231
    v_mfma_f32_16x16x32_bf16 v[8:11], v[152:155], a[136:139], v[8:11]
    buffer_load_dwordx4 v[140:143], v241, s[20:23], s58 offen offset:0 sc1
    v_mfma_f32_16x16x32_bf16 v[12:15], v[152:155], a[140:143], v[12:15]
    ds_write_b64 v242, v[234:235] offset:9224
    v_mfma_f32_16x16x32_bf16 v[12:15], v[148:151], a[124:127], v[12:15]
    s_add_u32 s58, s30, 1032192
    v_fma_f32 v224, -v72, v72, s42
    v_fma_f32 v225, -v73, v73, s42
    v_mfma_f32_16x16x32_bf16 v[12:15], v[144:147], a[108:111], v[12:15]
    s_waitcnt vmcnt(18)
    v_mul_f32 v224, v224, v72
    v_mul_f32 v225, v225, v73
    v_mfma_f32_16x16x32_bf16 v[16:19], v[156:159], a[96:99], v[16:19]
    buffer_load_dwordx4 v[144:147], v241, s[20:23], s58 offen offset:0 sc1
    v_mfma_f32_16x16x32_bf16 v[16:19], v[160:163], a[112:115], v[16:19]
    v_fma_f32 v226, -v74, v74, s42
    v_fma_f32 v227, -v75, v75, s42
    v_mfma_f32_16x16x32_bf16 v[16:19], v[164:167], a[128:131], v[16:19]
    s_add_u32 s58, s30, 1040384
    v_mul_f32 v226, v226, v74
    v_mul_f32 v227, v227, v75
    v_mfma_f32_16x16x32_bf16 v[20:23], v[164:167], a[132:135], v[20:23]
    v_exp_f32 v224, v224
    v_mfma_f32_16x16x32_bf16 v[20:23], v[160:163], a[116:119], v[20:23]
    buffer_load_dwordx4 v[148:151], v241, s[20:23], s58 offen offset:0 sc1
    v_mfma_f32_16x16x32_bf16 v[20:23], v[156:159], a[100:103], v[20:23]
    v_exp_f32 v225, v225
    v_mfma_f32_16x16x32_bf16 v[24:27], v[156:159], a[104:107], v[24:27]
    s_add_u32 s58, s30, 1048576
    v_exp_f32 v226, v226
    v_mfma_f32_16x16x32_bf16 v[24:27], v[160:163], a[120:123], v[24:27]
    v_exp_f32 v227, v227
    v_mfma_f32_16x16x32_bf16 v[24:27], v[164:167], a[136:139], v[24:27]
    buffer_load_dwordx4 v[152:155], v241, s[20:23], s58 offen offset:0 sc1
    v_mfma_f32_16x16x32_bf16 v[28:31], v[164:167], a[140:143], v[28:31]
    v_add_f32 v224, 1.0, v224
    v_add_f32 v225, 1.0, v225
    v_mfma_f32_16x16x32_bf16 v[28:31], v[160:163], a[124:127], v[28:31]
    s_add_u32 s58, s30, 1036288
    v_add_f32 v226, 1.0, v226
    v_add_f32 v227, 1.0, v227
    v_mfma_f32_16x16x32_bf16 v[28:31], v[156:159], a[108:111], v[28:31]
    s_waitcnt vmcnt(18)
    v_rcp_f32 v224, v224
    v_mfma_f32_16x16x32_bf16 v[0:3], v[168:171], a[144:147], v[0:3]
    buffer_load_dwordx4 v[156:159], v241, s[20:23], s58 offen offset:0 sc1
    v_mfma_f32_16x16x32_bf16 v[0:3], v[172:175], a[160:163], v[0:3]
    v_rcp_f32 v225, v225
    v_mfma_f32_16x16x32_bf16 v[0:3], v[176:179], a[176:179], v[0:3]
    s_add_u32 s58, s30, 1044480
    v_rcp_f32 v226, v226
    v_mfma_f32_16x16x32_bf16 v[4:7], v[176:179], a[180:183], v[4:7]
    v_rcp_f32 v227, v227
    v_mfma_f32_16x16x32_bf16 v[4:7], v[172:175], a[164:167], v[4:7]
    buffer_load_dwordx4 v[160:163], v241, s[20:23], s58 offen offset:0 sc1
    v_mfma_f32_16x16x32_bf16 v[4:7], v[168:171], a[148:151], v[4:7]
    v_mul_f32 v72, v72, v88
    v_mul_f32 v73, v73, v89
    v_mfma_f32_16x16x32_bf16 v[8:11], v[168:171], a[152:155], v[8:11]
    s_add_u32 s58, s30, 1052672
    v_mul_f32 v74, v74, v90
    v_mul_f32 v75, v75, v91
    v_mfma_f32_16x16x32_bf16 v[8:11], v[172:175], a[168:171], v[8:11]
    v_mul_f32 v224, v224, v72
    v_mul_f32 v225, v225, v73
    v_mfma_f32_16x16x32_bf16 v[8:11], v[176:179], a[184:187], v[8:11]
    buffer_load_dwordx4 v[164:167], v241, s[20:23], s58 offen offset:0 sc1
    v_mfma_f32_16x16x32_bf16 v[12:15], v[176:179], a[188:191], v[12:15]
    v_mul_f32 v226, v226, v74
    v_mul_f32 v227, v227, v75
    v_mfma_f32_16x16x32_bf16 v[12:15], v[172:175], a[172:175], v[12:15]
    s_add_u32 s58, s30, 1056768
    v_cvt_pk_bf16_f32 v236, v224, v225
    v_cvt_pk_bf16_f32 v237, v226, v227
    v_mfma_f32_16x16x32_bf16 v[12:15], v[168:171], a[156:159], v[12:15]
    s_waitcnt vmcnt(18)
    ds_write_b64 v242, v[236:237] offset:10248
    v_mfma_f32_16x16x32_bf16 v[16:19], v[180:183], a[144:147], v[16:19]
    buffer_load_dwordx4 v[168:171], v241, s[20:23], s58 offen offset:0 sc1
    v_mfma_f32_16x16x32_bf16 v[16:19], v[184:187], a[160:163], v[16:19]
    v_fma_f32 v228, -v76, v76, s42
    v_fma_f32 v229, -v77, v77, s42
    v_mfma_f32_16x16x32_bf16 v[16:19], v[188:191], a[176:179], v[16:19]
    s_add_u32 s58, s30, 1064960
    v_mul_f32 v228, v228, v76
    v_mul_f32 v229, v229, v77
    v_mfma_f32_16x16x32_bf16 v[20:23], v[188:191], a[180:183], v[20:23]
    v_fma_f32 v230, -v78, v78, s42
    v_fma_f32 v231, -v79, v79, s42
    v_mfma_f32_16x16x32_bf16 v[20:23], v[184:187], a[164:167], v[20:23]
    buffer_load_dwordx4 v[172:175], v241, s[20:23], s58 offen offset:0 sc1
    v_mfma_f32_16x16x32_bf16 v[20:23], v[180:183], a[148:151], v[20:23]
    v_mul_f32 v230, v230, v78
    v_mul_f32 v231, v231, v79
    v_mfma_f32_16x16x32_bf16 v[24:27], v[180:183], a[152:155], v[24:27]
    s_add_u32 s58, s30, 1073152
    v_exp_f32 v228, v228
    v_mfma_f32_16x16x32_bf16 v[24:27], v[184:187], a[168:171], v[24:27]
    v_exp_f32 v229, v229
    v_mfma_f32_16x16x32_bf16 v[24:27], v[188:191], a[184:187], v[24:27]
    buffer_load_dwordx4 v[176:179], v241, s[20:23], s58 offen offset:0 sc1
    v_mfma_f32_16x16x32_bf16 v[28:31], v[188:191], a[188:191], v[28:31]
    v_exp_f32 v230, v230
    v_mfma_f32_16x16x32_bf16 v[28:31], v[184:187], a[172:175], v[28:31]
    s_add_u32 s58, s30, 1060864
    v_exp_f32 v231, v231
    v_mfma_f32_16x16x32_bf16 v[28:31], v[180:183], a[156:159], v[28:31]
    s_waitcnt vmcnt(18)
    v_add_f32 v228, 1.0, v228
    v_add_f32 v229, 1.0, v229
    v_mfma_f32_16x16x32_bf16 v[0:3], v[192:195], a[192:195], v[0:3]
    buffer_load_dwordx4 v[180:183], v241, s[20:23], s58 offen offset:0 sc1
    v_mfma_f32_16x16x32_bf16 v[0:3], v[196:199], a[208:211], v[0:3]
    v_add_f32 v230, 1.0, v230
    v_add_f32 v231, 1.0, v231
    v_mfma_f32_16x16x32_bf16 v[0:3], v[200:203], a[224:227], v[0:3]
    s_add_u32 s58, s30, 1069056
    v_rcp_f32 v228, v228
    v_mfma_f32_16x16x32_bf16 v[4:7], v[200:203], a[228:231], v[4:7]
    v_rcp_f32 v229, v229
    v_mfma_f32_16x16x32_bf16 v[4:7], v[196:199], a[212:215], v[4:7]
    buffer_load_dwordx4 v[184:187], v241, s[20:23], s58 offen offset:0 sc1
    v_mfma_f32_16x16x32_bf16 v[4:7], v[192:195], a[196:199], v[4:7]
    v_rcp_f32 v230, v230
    v_mfma_f32_16x16x32_bf16 v[8:11], v[192:195], a[200:203], v[8:11]
    s_add_u32 s58, s30, 1077248
    v_rcp_f32 v231, v231
    v_mfma_f32_16x16x32_bf16 v[8:11], v[196:199], a[216:219], v[8:11]
    v_mul_f32 v76, v76, v92
    v_mul_f32 v77, v77, v93
    v_mfma_f32_16x16x32_bf16 v[8:11], v[200:203], a[232:235], v[8:11]
    buffer_load_dwordx4 v[188:191], v241, s[20:23], s58 offen offset:0 sc1
    v_mfma_f32_16x16x32_bf16 v[12:15], v[200:203], a[236:239], v[12:15]
    v_mul_f32 v78, v78, v94
    v_mul_f32 v79, v79, v95
    v_mfma_f32_16x16x32_bf16 v[12:15], v[196:199], a[220:223], v[12:15]
    s_add_u32 s58, s30, 1081344
    v_mul_f32 v228, v228, v76
    v_mul_f32 v229, v229, v77
    v_mfma_f32_16x16x32_bf16 v[12:15], v[192:195], a[204:207], v[12:15]
    s_waitcnt vmcnt(18)
    v_mul_f32 v230, v230, v78
    v_mul_f32 v231, v231, v79
    v_mfma_f32_16x16x32_bf16 v[16:19], v[204:207], a[192:195], v[16:19]
    buffer_load_dwordx4 v[192:195], v241, s[20:23], s58 offen offset:0 sc1
    v_mfma_f32_16x16x32_bf16 v[16:19], v[208:211], a[208:211], v[16:19]
    v_cvt_pk_bf16_f32 v238, v228, v229
    v_cvt_pk_bf16_f32 v239, v230, v231
    v_mfma_f32_16x16x32_bf16 v[16:19], v[212:215], a[224:227], v[16:19]
    s_add_u32 s58, s30, 1089536
    ds_write_b64 v242, v[238:239] offset:11272
    v_mfma_f32_16x16x32_bf16 v[20:23], v[212:215], a[228:231], v[20:23]
    v_mfma_f32_16x16x32_bf16 v[20:23], v[208:211], a[212:215], v[20:23]
    buffer_load_dwordx4 v[196:199], v241, s[20:23], s58 offen offset:0 sc1
    v_mfma_f32_16x16x32_bf16 v[20:23], v[204:207], a[196:199], v[20:23]
    v_mfma_f32_16x16x32_bf16 v[24:27], v[204:207], a[200:203], v[24:27]
    s_add_u32 s58, s30, 1097728
    v_mfma_f32_16x16x32_bf16 v[24:27], v[208:211], a[216:219], v[24:27]
    v_mfma_f32_16x16x32_bf16 v[24:27], v[212:215], a[232:235], v[24:27]
    buffer_load_dwordx4 v[200:203], v241, s[20:23], s58 offen offset:0 sc1
    v_mfma_f32_16x16x32_bf16 v[28:31], v[212:215], a[236:239], v[28:31]
    v_mfma_f32_16x16x32_bf16 v[28:31], v[208:211], a[220:223], v[28:31]
    s_add_u32 s58, s30, 1085440
    v_mfma_f32_16x16x32_bf16 v[28:31], v[204:207], a[204:207], v[28:31]
    s_waitcnt vmcnt(18)
    v_mfma_f32_16x16x32_bf16 v[0:3], v[216:219], a[240:243], v[0:3]
    buffer_load_dwordx4 v[204:207], v241, s[20:23], s58 offen offset:0 sc1
    v_mfma_f32_16x16x32_bf16 v[0:3], v[220:223], v[96:99], v[0:3]
    v_mfma_f32_16x16x32_bf16 v[0:3], v[128:131], v[112:115], v[0:3]
    s_add_u32 s58, s30, 1093632
    v_mfma_f32_16x16x32_bf16 v[4:7], v[128:131], v[116:119], v[4:7]
    v_mfma_f32_16x16x32_bf16 v[4:7], v[220:223], v[100:103], v[4:7]
    buffer_load_dwordx4 v[208:211], v241, s[20:23], s58 offen offset:0 sc1
    v_mfma_f32_16x16x32_bf16 v[4:7], v[216:219], a[244:247], v[4:7]
    v_mfma_f32_16x16x32_bf16 v[8:11], v[216:219], a[248:251], v[8:11]
    s_add_u32 s58, s30, 1101824
    v_mfma_f32_16x16x32_bf16 v[8:11], v[220:223], v[104:107], v[8:11]
    v_mfma_f32_16x16x32_bf16 v[8:11], v[128:131], v[120:123], v[8:11]
    buffer_load_dwordx4 v[212:215], v241, s[20:23], s58 offen offset:0 sc1
    v_mfma_f32_16x16x32_bf16 v[12:15], v[128:131], v[124:127], v[12:15]
    v_mfma_f32_16x16x32_bf16 v[12:15], v[220:223], v[108:111], v[12:15]
    s_add_u32 s58, s30, 1105920
    v_mfma_f32_16x16x32_bf16 v[12:15], v[216:219], a[252:255], v[12:15]
    s_waitcnt vmcnt(18)
    v_mfma_f32_16x16x32_bf16 v[16:19], v[132:135], a[240:243], v[16:19]
    buffer_load_dwordx4 v[216:219], v241, s[20:23], s58 offen offset:0 sc1
    v_mfma_f32_16x16x32_bf16 v[16:19], v[136:139], v[96:99], v[16:19]
    v_mfma_f32_16x16x32_bf16 v[16:19], v[140:143], v[112:115], v[16:19]
    s_add_u32 s58, s30, 1114112
    v_mfma_f32_16x16x32_bf16 v[20:23], v[140:143], v[116:119], v[20:23]
    v_mfma_f32_16x16x32_bf16 v[20:23], v[136:139], v[100:103], v[20:23]
    buffer_load_dwordx4 v[220:223], v241, s[20:23], s58 offen offset:0 sc1
    v_mfma_f32_16x16x32_bf16 v[20:23], v[132:135], a[244:247], v[20:23]
    v_mfma_f32_16x16x32_bf16 v[24:27], v[132:135], a[248:251], v[24:27]
    s_add_u32 s58, s30, 1122304
    v_mfma_f32_16x16x32_bf16 v[24:27], v[136:139], v[104:107], v[24:27]
    v_mfma_f32_16x16x32_bf16 v[24:27], v[140:143], v[120:123], v[24:27]
    buffer_load_dwordx4 v[128:131], v241, s[20:23], s58 offen offset:0 sc1
    v_mfma_f32_16x16x32_bf16 v[28:31], v[140:143], v[124:127], v[28:31]
    v_mfma_f32_16x16x32_bf16 v[28:31], v[136:139], v[108:111], v[28:31]
    s_add_u32 s58, s30, 1110016
    v_mfma_f32_16x16x32_bf16 v[28:31], v[132:135], a[252:255], v[28:31]
    s_waitcnt vmcnt(18)
    v_mfma_f32_16x16x32_bf16 v[32:35], v[144:147], a[0:3], 0
    buffer_load_dwordx4 v[132:135], v241, s[20:23], s58 offen offset:0 sc1
    v_mfma_f32_16x16x32_bf16 v[32:35], v[148:151], a[16:19], v[32:35]
    v_mfma_f32_16x16x32_bf16 v[32:35], v[152:155], a[32:35], v[32:35]
    s_add_u32 s58, s30, 1118208
    v_mfma_f32_16x16x32_bf16 v[36:39], v[152:155], a[36:39], 0
    v_mfma_f32_16x16x32_bf16 v[36:39], v[148:151], a[20:23], v[36:39]
    buffer_load_dwordx4 v[136:139], v241, s[20:23], s58 offen offset:0 sc1
    v_mfma_f32_16x16x32_bf16 v[36:39], v[144:147], a[4:7], v[36:39]
    v_fma_f32 v224, -v0, v0, s42
    v_fma_f32 v225, -v1, v1, s42
    v_mfma_f32_16x16x32_bf16 v[40:43], v[144:147], a[8:11], 0
    s_add_u32 s58, s30, 1126400
    v_mul_f32 v224, v224, v0
    v_mul_f32 v225, v225, v1
    v_mfma_f32_16x16x32_bf16 v[40:43], v[148:151], a[24:27], v[40:43]
    v_fma_f32 v226, -v2, v2, s42
    v_fma_f32 v227, -v3, v3, s42
    v_mfma_f32_16x16x32_bf16 v[40:43], v[152:155], a[40:43], v[40:43]
    buffer_load_dwordx4 v[140:143], v241, s[20:23], s58 offen offset:0 sc1
    v_mfma_f32_16x16x32_bf16 v[44:47], v[152:155], a[44:47], 0
    v_mul_f32 v226, v226, v2
    v_mul_f32 v227, v227, v3
    v_mfma_f32_16x16x32_bf16 v[44:47], v[148:151], a[28:31], v[44:47]
    s_add_u32 s58, s30, 1130496
    v_exp_f32 v224, v224
    v_mfma_f32_16x16x32_bf16 v[44:47], v[144:147], a[12:15], v[44:47]
    s_waitcnt vmcnt(18)
    v_exp_f32 v225, v225
    v_mfma_f32_16x16x32_bf16 v[48:51], v[156:159], a[0:3], 0
    buffer_load_dwordx4 v[144:147], v241, s[20:23], s58 offen offset:0 sc1
    v_mfma_f32_16x16x32_bf16 v[48:51], v[160:163], a[16:19], v[48:51]
    v_exp_f32 v226, v226
    v_mfma_f32_16x16x32_bf16 v[48:51], v[164:167], a[32:35], v[48:51]
    s_add_u32 s58, s30, 1138688
    v_exp_f32 v227, v227
    v_mfma_f32_16x16x32_bf16 v[52:55], v[164:167], a[36:39], 0
    v_add_f32 v224, 1.0, v224
    v_add_f32 v225, 1.0, v225
    v_mfma_f32_16x16x32_bf16 v[52:55], v[160:163], a[20:23], v[52:55]
    buffer_load_dwordx4 v[148:151], v241, s[20:23], s58 offen offset:0 sc1
    v_mfma_f32_16x16x32_bf16 v[52:55], v[156:159], a[4:7], v[52:55]
    v_add_f32 v226, 1.0, v226
    v_add_f32 v227, 1.0, v227
    v_mfma_f32_16x16x32_bf16 v[56:59], v[156:159], a[8:11], 0
    s_add_u32 s58, s30, 1146880
    v_rcp_f32 v224, v224
    v_mfma_f32_16x16x32_bf16 v[56:59], v[160:163], a[24:27], v[56:59]
    v_rcp_f32 v225, v225
    v_mfma_f32_16x16x32_bf16 v[56:59], v[164:167], a[40:43], v[56:59]
    buffer_load_dwordx4 v[152:155], v241, s[20:23], s58 offen offset:0 sc1
    v_mfma_f32_16x16x32_bf16 v[60:63], v[164:167], a[44:47], 0
    v_rcp_f32 v226, v226
    v_mfma_f32_16x16x32_bf16 v[60:63], v[160:163], a[28:31], v[60:63]
    s_add_u32 s58, s30, 1134592
    v_rcp_f32 v227, v227
    v_mfma_f32_16x16x32_bf16 v[60:63], v[156:159], a[12:15], v[60:63]
    s_waitcnt vmcnt(18)
    v_mul_f32 v0, v0, v16
    v_mul_f32 v1, v1, v17
    v_mfma_f32_16x16x32_bf16 v[32:35], v[168:171], a[48:51], v[32:35]
    buffer_load_dwordx4 v[156:159], v241, s[20:23], s58 offen offset:0 sc1
    v_mfma_f32_16x16x32_bf16 v[32:35], v[172:175], a[64:67], v[32:35]
    v_mul_f32 v2, v2, v18
    v_mul_f32 v3, v3, v19
    v_mfma_f32_16x16x32_bf16 v[32:35], v[176:179], a[80:83], v[32:35]
    s_add_u32 s58, s30, 1142784
    v_mul_f32 v224, v224, v0
    v_mul_f32 v225, v225, v1
    v_mfma_f32_16x16x32_bf16 v[36:39], v[176:179], a[84:87], v[36:39]
    v_mul_f32 v226, v226, v2
    v_mul_f32 v227, v227, v3
    v_mfma_f32_16x16x32_bf16 v[36:39], v[172:175], a[68:71], v[36:39]
    buffer_load_dwordx4 v[160:163], v241, s[20:23], s58 offen offset:0 sc1
    v_mfma_f32_16x16x32_bf16 v[36:39], v[168:171], a[52:55], v[36:39]
    v_cvt_pk_bf16_f32 v232, v224, v225
    v_cvt_pk_bf16_f32 v233, v226, v227
    v_mfma_f32_16x16x32_bf16 v[40:43], v[168:171], a[56:59], v[40:43]
    s_add_u32 s58, s30, 1150976
    ds_write_b64 v242, v[232:233] offset:12288
    v_mfma_f32_16x16x32_bf16 v[40:43], v[172:175], a[72:75], v[40:43]
    v_fma_f32 v228, -v4, v4, s42
    v_fma_f32 v229, -v5, v5, s42
    v_mfma_f32_16x16x32_bf16 v[40:43], v[176:179], a[88:91], v[40:43]
    buffer_load_dwordx4 v[164:167], v241, s[20:23], s58 offen offset:0 sc1
    v_mfma_f32_16x16x32_bf16 v[44:47], v[176:179], a[92:95], v[44:47]
    v_mul_f32 v228, v228, v4
    v_mul_f32 v229, v229, v5
    v_mfma_f32_16x16x32_bf16 v[44:47], v[172:175], a[76:79], v[44:47]
HOP2_4:
    s_cbranch_execz HOPRET2
    s_add_u32 s58, s30, 1155072
    v_fma_f32 v230, -v6, v6, s42
    v_fma_f32 v231, -v7, v7, s42
    v_mfma_f32_16x16x32_bf16 v[44:47], v[168:171], a[60:63], v[44:47]
    s_waitcnt vmcnt(18)
    v_mul_f32 v230, v230, v6
    v_mul_f32 v231, v231, v7
    v_mfma_f32_16x16x32_bf16 v[48:51], v[180:183], a[48:51], v[48:51]
    buffer_load_dwordx4 v[168:171], v241, s[20:23], s58 offen offset:0 sc1
    v_mfma_f32_16x16x32_bf16 v[48:51], v[184:187], a[64:67], v[48:51]
    v_exp_f32 v228, v228
    v_mfma_f32_16x16x32_bf16 v[48:51], v[188:191], a[80:83], v[48:51]
    s_add_u32 s58, s30, 1163264
    v_exp_f32 v229, v229
    v_mfma_f32_16x16x32_bf16 v[52:55], v[188:191], a[84:87], v[52:55]
    v_exp_f32 v230, v230
    v_mfma_f32_16x16x32_bf16 v[52:55], v[184:187], a[68:71], v[52:55]
    buffer_load_dwordx4 v[172:175], v241, s[20:23], s58 offen offset:0 sc1
    v_mfma_f32_16x16x32_bf16 v[52:55], v[180:183], a[52:55], v[52:55]
    v_exp_f32 v231, v231
    v_mfma_f32_16x16x32_bf16 v[56:59], v[180:183], a[56:59], v[56:59]
    s_add_u32 s58, s30, 1171456
    v_add_f32 v228, 1.0, v228
    v_add_f32 v229, 1.0, v229
    v_mfma_f32_16x16x32_bf16 v[56:59], v[184:187], a[72:75], v[56:59]
    v_add_f32 v230, 1.0, v230
    v_add_f32 v231, 1.0, v231
    v_mfma_f32_16x16x32_bf16 v[56:59], v[188:191], a[88:91], v[56:59]
    buffer_load_dwordx4 v[176:179], v241, s[20:23], s58 offen offset:0 sc1
    v_mfma_f32_16x16x32_bf16 v[60:63], v[188:191], a[92:95], v[60:63]
    v_rcp_f32 v228, v228
    v_mfma_f32_16x16x32_bf16 v[60:63], v[184:187], a[76:79], v[60:63]
    s_add_u32 s58, s30, 1159168
    v_rcp_f32 v229, v229
    v_mfma_f32_16x16x32_bf16 v[60:63], v[180:183], a[60:63], v[60:63]
    s_waitcnt vmcnt(18)
    v_rcp_f32 v230, v230
    v_mfma_f32_16x16x32_bf16 v[32:35], v[192:195], a[96:99], v[32:35]
    buffer_load_dwordx4 v[180:183], v241, s[20:23], s58 offen offset:0 sc1
    v_mfma_f32_16x16x32_bf16 v[32:35], v[196:199], a[112:115], v[32:35]
    v_rcp_f32 v231, v231
    v_mfma_f32_16x16x32_bf16 v[32:35], v[200:203], a[128:131], v[32:35]
    s_add_u32 s58, s30, 1167360
    v_mul_f32 v4, v4, v20
    v_mul_f32 v5, v5, v21
    v_mfma_f32_16x16x32_bf16 v[36:39], v[200:203], a[132:135], v[36:39]
    v_mul_f32 v6, v6, v22
    v_mul_f32 v7, v7, v23
    v_mfma_f32_16x16x32_bf16 v[36:39], v[196:199], a[116:119], v[36:39]
    buffer_load_dwordx4 v[184:187], v241, s[20:23], s58 offen offset:0 sc1
    v_mfma_f32_16x16x32_bf16 v[36:39], v[192:195], a[100:103], v[36:39]
    v_mul_f32 v228, v228, v4
    v_mul_f32 v229, v229, v5
    v_mfma_f32_16x16x32_bf16 v[40:43], v[192:195], a[104:107], v[40:43]
    s_add_u32 s58, s30, 1175552
    v_mul_f32 v230, v230, v6
    v_mul_f32 v231, v231, v7
    v_mfma_f32_16x16x32_bf16 v[40:43], v[196:199], a[120:123], v[40:43]
    v_cvt_pk_bf16_f32 v234, v228, v229
    v_cvt_pk_bf16_f32 v235, v230, v231
    v_mfma_f32_16x16x32_bf16 v[40:43], v[200:203], a[136:139], v[40:43]
    buffer_load_dwordx4 v[188:191], v241, s[20:23], s58 offen offset:0 sc1
    v_mfma_f32_16x16x32_bf16 v[44:47], v[200:203], a[140:143], v[44:47]
    ds_write_b64 v242, v[234:235] offset:13312
    v_mfma_f32_16x16x32_bf16 v[44:47], v[196:199], a[124:127], v[44:47]
    s_add_u32 s58, s30, 1179648
    v_fma_f32 v224, -v8, v8, s42
    v_fma_f32 v225, -v9, v9, s42
    v_mfma_f32_16x16x32_bf16 v[44:47], v[192:195], a[108:111], v[44:47]
    s_waitcnt vmcnt(18)
    v_mul_f32 v224, v224, v8
    v_mul_f32 v225, v225, v9
    v_mfma_f32_16x16x32_bf16 v[48:51], v[204:207], a[96:99], v[48:51]
    buffer_load_dwordx4 v[192:195], v241, s[20:23], s58 offen offset:0 sc1
    v_mfma_f32_16x16x32_bf16 v[48:51], v[208:211], a[112:115], v[48:51]
    v_fma_f32 v226, -v10, v10, s42
    v_fma_f32 v227, -v11, v11, s42
    v_mfma_f32_16x16x32_bf16 v[48:51], v[212:215], a[128:131], v[48:51]
    s_add_u32 s58, s30, 1187840
    v_mul_f32 v226, v226, v10
    v_mul_f32 v227, v227, v11
    v_mfma_f32_16x16x32_bf16 v[52:55], v[212:215], a[132:135], v[52:55]
    v_exp_f32 v224, v224
    v_mfma_f32_16x16x32_bf16 v[52:55], v[208:211], a[116:119], v[52:55]
    buffer_load_dwordx4 v[196:199], v241, s[20:23], s58 offen offset:0 sc1
    v_mfma_f32_16x16x32_bf16 v[52:55], v[204:207], a[100:103], v[52:55]
    v_exp_f32 v225, v225
    v_mfma_f32_16x16x32_bf16 v[56:59], v[204:207], a[104:107], v[56:59]
    s_add_u32 s58, s30, 1183744
    v_exp_f32 v226, v226
    v_mfma_f32_16x16x32_bf16 v[56:59], v[208:211], a[120:123], v[56:59]
    v_exp_f32 v227, v227
    v_mfma_f32_16x16x32_bf16 v[56:59], v[212:215], a[136:139], v[56:59]
    buffer_load_dwordx4 v[200:203], v241, s[20:23], s58 offen offset:0 sc1
    v_mfma_f32_16x16x32_bf16 v[60:63], v[212:215], a[140:143], v[60:63]
    v_add_f32 v224, 1.0, v224
    v_add_f32 v225, 1.0, v225
    v_mfma_f32_16x16x32_bf16 v[60:63], v[208:211], a[124:127], v[60:63]
    s_add_u32 s58, s30, 1191936
    v_add_f32 v226, 1.0, v226
    v_add_f32 v227, 1.0, v227
    v_mfma_f32_16x16x32_bf16 v[60:63], v[204:207], a[108:111], v[60:63]
    s_waitcnt vmcnt(18)
    v_rcp_f32 v224, v224
    v_mfma_f32_16x16x32_bf16 v[32:35], v[216:219], a[144:147], v[32:35]
    buffer_load_dwordx4 v[204:207], v241, s[20:23], s58 offen offset:0 sc1
    v_mfma_f32_16x16x32_bf16 v[32:35], v[220:223], a[160:163], v[32:35]
    v_rcp_f32 v225, v225
    v_mfma_f32_16x16x32_bf16 v[32:35], v[128:131], a[176:179], v[32:35]
    s_add_u32 s58, s30, 1196032
    v_rcp_f32 v226, v226
    v_mfma_f32_16x16x32_bf16 v[36:39], v[128:131], a[180:183], v[36:39]
    v_rcp_f32 v227, v227
    v_mfma_f32_16x16x32_bf16 v[36:39], v[220:223], a[164:167], v[36:39]
    buffer_load_dwordx4 v[208:211], v241, s[20:23], s58 offen offset:0 sc1
    v_mfma_f32_16x16x32_bf16 v[36:39], v[216:219], a[148:151], v[36:39]
    v_mul_f32 v8, v8, v24
    v_mul_f32 v9, v9, v25
    v_mfma_f32_16x16x32_bf16 v[40:43], v[216:219], a[152:155], v[40:43]
    s_add_u32 s58, s30, 1204224
    v_mul_f32 v10, v10, v26
    v_mul_f32 v11, v11, v27
    v_mfma_f32_16x16x32_bf16 v[40:43], v[220:223], a[168:171], v[40:43]
    v_mul_f32 v224, v224, v8
    v_mul_f32 v225, v225, v9
    v_mfma_f32_16x16x32_bf16 v[40:43], v[128:131], a[184:187], v[40:43]
    buffer_load_dwordx4 v[212:215], v241, s[20:23], s58 offen offset:0 sc1
    v_mfma_f32_16x16x32_bf16 v[44:47], v[128:131], a[188:191], v[44:47]
    v_mul_f32 v226, v226, v10
    v_mul_f32 v227, v227, v11
    v_mfma_f32_16x16x32_bf16 v[44:47], v[220:223], a[172:175], v[44:47]
    s_add_u32 s58, s30, 1200128
    v_cvt_pk_bf16_f32 v236, v224, v225
    v_cvt_pk_bf16_f32 v237, v226, v227
    v_mfma_f32_16x16x32_bf16 v[44:47], v[216:219], a[156:159], v[44:47]
    s_waitcnt vmcnt(18)
    ds_write_b64 v242, v[236:237] offset:14336
    v_mfma_f32_16x16x32_bf16 v[48:51], v[132:135], a[144:147], v[48:51]
    buffer_load_dwordx4 v[216:219], v241, s[20:23], s58 offen offset:0 sc1
    v_mfma_f32_16x16x32_bf16 v[48:51], v[136:139], a[160:163], v[48:51]
    v_fma_f32 v228, -v12, v12, s42
    v_fma_f32 v229, -v13, v13, s42
    v_mfma_f32_16x16x32_bf16 v[48:51], v[140:143], a[176:179], v[48:51]
    s_add_u32 s58, s30, 1208320
    v_mul_f32 v228, v228, v12
    v_mul_f32 v229, v229, v13
    v_mfma_f32_16x16x32_bf16 v[52:55], v[140:143], a[180:183], v[52:55]
    v_fma_f32 v230, -v14, v14, s42
    v_fma_f32 v231, -v15, v15, s42
    v_mfma_f32_16x16x32_bf16 v[52:55], v[136:139], a[164:167], v[52:55]
    buffer_load_dwordx4 v[220:223], v241, s[20:23], s58 offen offset:0 sc1
    v_mfma_f32_16x16x32_bf16 v[52:55], v[132:135], a[148:151], v[52:55]
    v_mul_f32 v230, v230, v14
    v_mul_f32 v231, v231, v15
    v_mfma_f32_16x16x32_bf16 v[56:59], v[132:135], a[152:155], v[56:59]
    s_add_u32 s58, s30, 1212416
    v_exp_f32 v228, v228
    v_mfma_f32_16x16x32_bf16 v[56:59], v[136:139], a[168:171], v[56:59]
    v_exp_f32 v229, v229
    v_mfma_f32_16x16x32_bf16 v[56:59], v[140:143], a[184:187], v[56:59]
    buffer_load_dwordx4 v[128:131], v241, s[20:23], s58 offen offset:0 sc1
    v_mfma_f32_16x16x32_bf16 v[60:63], v[140:143], a[188:191], v[60:63]
    v_exp_f32 v230, v230
    v_mfma_f32_16x16x32_bf16 v[60:63], v[136:139], a[172:175], v[60:63]
    s_add_u32 s58, s30, 1220608
    v_exp_f32 v231, v231
    v_mfma_f32_16x16x32_bf16 v[60:63], v[132:135], a[156:159], v[60:63]
    s_waitcnt vmcnt(18)
    v_add_f32 v228, 1.0, v228
    v_add_f32 v229, 1.0, v229
    v_mfma_f32_16x16x32_bf16 v[32:35], v[144:147], a[192:195], v[32:35]
    buffer_load_dwordx4 v[132:135], v241, s[20:23], s58 offen offset:0 sc1
    v_mfma_f32_16x16x32_bf16 v[32:35], v[148:151], a[208:211], v[32:35]
    v_add_f32 v230, 1.0, v230
    v_add_f32 v231, 1.0, v231
    v_mfma_f32_16x16x32_bf16 v[32:35], v[152:155], a[224:227], v[32:35]
    s_add_u32 s58, s30, 1216512
    v_rcp_f32 v228, v228
    v_mfma_f32_16x16x32_bf16 v[36:39], v[152:155], a[228:231], v[36:39]
    v_rcp_f32 v229, v229
    v_mfma_f32_16x16x32_bf16 v[36:39], v[148:151], a[212:215], v[36:39]
    buffer_load_dwordx4 v[136:139], v241, s[20:23], s58 offen offset:0 sc1
    v_mfma_f32_16x16x32_bf16 v[36:39], v[144:147], a[196:199], v[36:39]
    v_rcp_f32 v230, v230
    v_mfma_f32_16x16x32_bf16 v[40:43], v[144:147], a[200:203], v[40:43]
    s_add_u32 s58, s30, 1224704
    v_rcp_f32 v231, v231
    v_mfma_f32_16x16x32_bf16 v[40:43], v[148:151], a[216:219], v[40:43]
    v_mul_f32 v12, v12, v28
    v_mul_f32 v13, v13, v29
    v_mfma_f32_16x16x32_bf16 v[40:43], v[152:155], a[232:235], v[40:43]
    buffer_load_dwordx4 v[140:143], v241, s[20:23], s58 offen offset:0 sc1
    v_mfma_f32_16x16x32_bf16 v[44:47], v[152:155], a[236:239], v[44:47]
    v_mul_f32 v14, v14, v30
    v_mul_f32 v15, v15, v31
    v_mfma_f32_16x16x32_bf16 v[44:47], v[148:151], a[220:223], v[44:47]
    s_add_u32 s58, s30, 1228800
    v_mul_f32 v228, v228, v12
    v_mul_f32 v229, v229, v13
    v_mfma_f32_16x16x32_bf16 v[44:47], v[144:147], a[204:207], v[44:47]
    s_waitcnt vmcnt(18)
    v_mul_f32 v230, v230, v14
    v_mul_f32 v231, v231, v15
    v_mfma_f32_16x16x32_bf16 v[48:51], v[156:159], a[192:195], v[48:51]
    buffer_load_dwordx4 v[144:147], v241, s[20:23], s58 offen offset:0 sc1
    v_mfma_f32_16x16x32_bf16 v[48:51], v[160:163], a[208:211], v[48:51]
    v_cvt_pk_bf16_f32 v238, v228, v229
    v_cvt_pk_bf16_f32 v239, v230, v231
    v_mfma_f32_16x16x32_bf16 v[48:51], v[164:167], a[224:227], v[48:51]
    s_add_u32 s58, s30, 1236992
    ds_write_b64 v242, v[238:239] offset:15360
    v_mfma_f32_16x16x32_bf16 v[52:55], v[164:167], a[228:231], v[52:55]
    v_mfma_f32_16x16x32_bf16 v[52:55], v[160:163], a[212:215], v[52:55]
    buffer_load_dwordx4 v[148:151], v241, s[20:23], s58 offen offset:0 sc1
    v_mfma_f32_16x16x32_bf16 v[52:55], v[156:159], a[196:199], v[52:55]
    v_mfma_f32_16x16x32_bf16 v[56:59], v[156:159], a[200:203], v[56:59]
    s_add_u32 s58, s30, 1232896
    v_mfma_f32_16x16x32_bf16 v[56:59], v[160:163], a[216:219], v[56:59]
    v_mfma_f32_16x16x32_bf16 v[56:59], v[164:167], a[232:235], v[56:59]
    buffer_load_dwordx4 v[152:155], v241, s[20:23], s58 offen offset:0 sc1
    v_mfma_f32_16x16x32_bf16 v[60:63], v[164:167], a[236:239], v[60:63]
    v_mfma_f32_16x16x32_bf16 v[60:63], v[160:163], a[220:223], v[60:63]
    s_add_u32 s58, s30, 1241088
    v_mfma_f32_16x16x32_bf16 v[60:63], v[156:159], a[204:207], v[60:63]
    s_waitcnt vmcnt(18)
    v_mfma_f32_16x16x32_bf16 v[32:35], v[168:171], a[240:243], v[32:35]
    buffer_load_dwordx4 v[156:159], v241, s[20:23], s58 offen offset:0 sc1
    v_mfma_f32_16x16x32_bf16 v[32:35], v[172:175], v[96:99], v[32:35]
    v_mfma_f32_16x16x32_bf16 v[32:35], v[176:179], v[112:115], v[32:35]
    s_add_u32 s58, s30, 1245184
    v_mfma_f32_16x16x32_bf16 v[36:39], v[176:179], v[116:119], v[36:39]
    v_mfma_f32_16x16x32_bf16 v[36:39], v[172:175], v[100:103], v[36:39]
    buffer_load_dwordx4 v[160:163], v241, s[20:23], s58 offen offset:0 sc1
    v_mfma_f32_16x16x32_bf16 v[36:39], v[168:171], a[244:247], v[36:39]
    v_mfma_f32_16x16x32_bf16 v[40:43], v[168:171], a[248:251], v[40:43]
    s_add_u32 s58, s30, 1253376
    v_mfma_f32_16x16x32_bf16 v[40:43], v[172:175], v[104:107], v[40:43]
    v_mfma_f32_16x16x32_bf16 v[40:43], v[176:179], v[120:123], v[40:43]
    buffer_load_dwordx4 v[164:167], v241, s[20:23], s58 offen offset:0 sc1
    v_mfma_f32_16x16x32_bf16 v[44:47], v[176:179], v[124:127], v[44:47]
    v_mfma_f32_16x16x32_bf16 v[44:47], v[172:175], v[108:111], v[44:47]
    s_add_u32 s58, s30, 1249280
    v_mfma_f32_16x16x32_bf16 v[44:47], v[168:171], a[252:255], v[44:47]
    s_waitcnt vmcnt(18)
    v_mfma_f32_16x16x32_bf16 v[48:51], v[180:183], a[240:243], v[48:51]
    buffer_load_dwordx4 v[168:171], v241, s[20:23], s58 offen offset:0 sc1
    v_mfma_f32_16x16x32_bf16 v[48:51], v[184:187], v[96:99], v[48:51]
    v_mfma_f32_16x16x32_bf16 v[48:51], v[188:191], v[112:115], v[48:51]
    s_add_u32 s58, s30, 1257472
    v_mfma_f32_16x16x32_bf16 v[52:55], v[188:191], v[116:119], v[52:55]
    v_mfma_f32_16x16x32_bf16 v[52:55], v[184:187], v[100:103], v[52:55]
    buffer_load_dwordx4 v[172:175], v241, s[20:23], s58 offen offset:0 sc1
    v_mfma_f32_16x16x32_bf16 v[52:55], v[180:183], a[244:247], v[52:55]
    v_mfma_f32_16x16x32_bf16 v[56:59], v[180:183], a[248:251], v[56:59]
    s_add_u32 s58, s30, 1261568
    v_mfma_f32_16x16x32_bf16 v[56:59], v[184:187], v[104:107], v[56:59]
    v_mfma_f32_16x16x32_bf16 v[56:59], v[188:191], v[120:123], v[56:59]
    buffer_load_dwordx4 v[176:179], v241, s[20:23], s58 offen offset:0 sc1
    v_mfma_f32_16x16x32_bf16 v[60:63], v[188:191], v[124:127], v[60:63]
    v_mfma_f32_16x16x32_bf16 v[60:63], v[184:187], v[108:111], v[60:63]
    s_add_u32 s58, s30, 1269760
    v_mfma_f32_16x16x32_bf16 v[60:63], v[180:183], a[252:255], v[60:63]
    s_waitcnt vmcnt(18)
    v_mfma_f32_16x16x32_bf16 v[64:67], v[192:195], a[0:3], 0
    buffer_load_dwordx4 v[180:183], v241, s[20:23], s58 offen offset:0 sc1
    v_mfma_f32_16x16x32_bf16 v[64:67], v[196:199], a[16:19], v[64:67]
    v_mfma_f32_16x16x32_bf16 v[68:71], v[196:199], a[20:23], 0
    s_add_u32 s58, s30, 1265664
    v_mfma_f32_16x16x32_bf16 v[68:71], v[192:195], a[4:7], v[68:71]
    v_mfma_f32_16x16x32_bf16 v[72:75], v[192:195], a[8:11], 0
    buffer_load_dwordx4 v[184:187], v241, s[20:23], s58 offen offset:0 sc1
    v_mfma_f32_16x16x32_bf16 v[72:75], v[196:199], a[24:27], v[72:75]
    v_fma_f32 v224, -v32, v32, s42
    v_fma_f32 v225, -v33, v33, s42
    v_mfma_f32_16x16x32_bf16 v[76:79], v[196:199], a[28:31], 0
    s_add_u32 s58, s30, 1273856
    v_mul_f32 v224, v224, v32
    v_mul_f32 v225, v225, v33
    v_mfma_f32_16x16x32_bf16 v[76:79], v[192:195], a[12:15], v[76:79]
    s_waitcnt vmcnt(18)
    v_fma_f32 v226, -v34, v34, s42
    v_fma_f32 v227, -v35, v35, s42
    v_mfma_f32_16x16x32_bf16 v[80:83], v[200:203], a[0:3], 0
    buffer_load_dwordx4 v[188:191], v241, s[20:23], s58 offen offset:0 sc1
    v_mfma_f32_16x16x32_bf16 v[80:83], v[204:207], a[16:19], v[80:83]
    v_mul_f32 v226, v226, v34
    v_mul_f32 v227, v227, v35
    v_mfma_f32_16x16x32_bf16 v[84:87], v[204:207], a[20:23], 0
    s_add_u32 s58, s30, 1277952
    v_exp_f32 v224, v224
    v_mfma_f32_16x16x32_bf16 v[84:87], v[200:203], a[4:7], v[84:87]
    v_exp_f32 v225, v225
    v_mfma_f32_16x16x32_bf16 v[88:91], v[200:203], a[8:11], 0
    buffer_load_dwordx4 v[192:195], v241, s[20:23], s58 offen offset:0 sc1
    v_mfma_f32_16x16x32_bf16 v[88:91], v[204:207], a[24:27], v[88:91]
    v_exp_f32 v226, v226
    v_mfma_f32_16x16x32_bf16 v[92:95], v[204:207], a[28:31], 0
    s_add_u32 s58, s30, 1286144
    v_exp_f32 v227, v227
    v_mfma_f32_16x16x32_bf16 v[92:95], v[200:203], a[12:15], v[92:95]
    s_waitcnt vmcnt(18)
    v_add_f32 v224, 1.0, v224
    v_add_f32 v225, 1.0, v225
    v_mfma_f32_16x16x32_bf16 v[64:67], v[208:211], a[32:35], v[64:67]
    buffer_load_dwordx4 v[196:199], v241, s[20:23], s58 offen offset:0 sc1
    v_mfma_f32_16x16x32_bf16 v[64:67], v[212:215], a[48:51], v[64:67]
    v_add_f32 v226, 1.0, v226
    v_add_f32 v227, 1.0, v227
    v_mfma_f32_16x16x32_bf16 v[68:71], v[212:215], a[52:55], v[68:71]
    s_add_u32 s58, s30, 1282048
    v_rcp_f32 v224, v224
    v_mfma_f32_16x16x32_bf16 v[68:71], v[208:211], a[36:39], v[68:71]
    v_rcp_f32 v225, v225
    v_mfma_f32_16x16x32_bf16 v[72:75], v[208:211], a[40:43], v[72:75]
    buffer_load_dwordx4 v[200:203], v241, s[20:23], s58 offen offset:0 sc1
    v_mfma_f32_16x16x32_bf16 v[72:75], v[212:215], a[56:59], v[72:75]
    v_rcp_f32 v226, v226
    v_mfma_f32_16x16x32_bf16 v[76:79], v[212:215], a[60:63], v[76:79]
    s_add_u32 s58, s30, 1290240
    v_rcp_f32 v227, v227
    v_mfma_f32_16x16x32_bf16 v[76:79], v[208:211], a[44:47], v[76:79]
    s_waitcnt vmcnt(18)
    v_mul_f32 v32, v32, v48
    v_mul_f32 v33, v33, v49
    v_mfma_f32_16x16x32_bf16 v[80:83], v[216:219], a[32:35], v[80:83]
    buffer_load_dwordx4 v[204:207], v241, s[20:23], s58 offen offset:0 sc1
    v_mfma_f32_16x16x32_bf16 v[80:83], v[220:223], a[48:51], v[80:83]
    v_mul_f32 v34, v34, v50
    v_mul_f32 v35, v35, v51
    v_mfma_f32_16x16x32_bf16 v[84:87], v[220:223], a[52:55], v[84:87]
    s_add_u32 s58, s30, 1294336
    v_mul_f32 v224, v224, v32
    v_mul_f32 v225, v225, v33
    v_mfma_f32_16x16x32_bf16 v[84:87], v[216:219], a[36:39], v[84:87]
    v_mul_f32 v226, v226, v34
    v_mul_f32 v227, v227, v35
    v_mfma_f32_16x16x32_bf16 v[88:91], v[216:219], a[40:43], v[88:91]
    buffer_load_dwordx4 v[208:211], v241, s[20:23], s58 offen offset:0 sc1
    v_mfma_f32_16x16x32_bf16 v[88:91], v[220:223], a[56:59], v[88:91]
    v_cvt_pk_bf16_f32 v232, v224, v225
    v_cvt_pk_bf16_f32 v233, v226, v227
    v_mfma_f32_16x16x32_bf16 v[92:95], v[220:223], a[60:63], v[92:95]
    s_add_u32 s58, s30, 1302528
    ds_write_b64 v242, v[232:233] offset:12296
    v_mfma_f32_16x16x32_bf16 v[92:95], v[216:219], a[44:47], v[92:95]
    s_waitcnt vmcnt(18)
    v_fma_f32 v228, -v36, v36, s42
    v_fma_f32 v229, -v37, v37, s42
    v_mfma_f32_16x16x32_bf16 v[64:67], v[128:131], a[64:67], v[64:67]
    buffer_load_dwordx4 v[212:215], v241, s[20:23], s58 offen offset:0 sc1
    v_mfma_f32_16x16x32_bf16 v[64:67], v[132:135], a[80:83], v[64:67]
    v_mul_f32 v228, v228, v36
    v_mul_f32 v229, v229, v37
    v_mfma_f32_16x16x32_bf16 v[68:71], v[132:135], a[84:87], v[68:71]
    s_add_u32 s58, s30, 1298432
    v_fma_f32 v230, -v38, v38, s42
    v_fma_f32 v231, -v39, v39, s42
    v_mfma_f32_16x16x32_bf16 v[68:71], v[128:131], a[68:71], v[68:71]
    v_mul_f32 v230, v230, v38
    v_mul_f32 v231, v231, v39
    v_mfma_f32_16x16x32_bf16 v[72:75], v[128:131], a[72:75], v[72:75]
    buffer_load_dwordx4 v[216:219], v241, s[20:23], s58 offen offset:0 sc1
    v_mfma_f32_16x16x32_bf16 v[72:75], v[132:135], a[88:91], v[72:75]
    v_exp_f32 v228, v228
    v_mfma_f32_16x16x32_bf16 v[76:79], v[132:135], a[92:95], v[76:79]
    s_add_u32 s58, s30, 1306624
    v_exp_f32 v229, v229
    v_mfma_f32_16x16x32_bf16 v[76:79], v[128:131], a[76:79], v[76:79]
    s_waitcnt vmcnt(18)
    v_exp_f32 v230, v230
    v_mfma_f32_16x16x32_bf16 v[80:83], v[136:139], a[64:67], v[80:83]
    buffer_load_dwordx4 v[220:223], v241, s[20:23], s58 offen offset:0 sc1
    v_mfma_f32_16x16x32_bf16 v[80:83], v[140:143], a[80:83], v[80:83]
    v_exp_f32 v231, v231
    v_mfma_f32_16x16x32_bf16 v[84:87], v[140:143], a[84:87], v[84:87]
    s_add_u32 s58, s30, 1310720
    v_add_f32 v228, 1.0, v228
    v_add_f32 v229, 1.0, v229
    v_mfma_f32_16x16x32_bf16 v[84:87], v[136:139], a[68:71], v[84:87]
    v_add_f32 v230, 1.0, v230
    v_add_f32 v231, 1.0, v231
    v_mfma_f32_16x16x32_bf16 v[88:91], v[136:139], a[72:75], v[88:91]
    buffer_load_dwordx4 v[128:131], v241, s[20:23], s58 offen offset:0 sc1
    v_mfma_f32_16x16x32_bf16 v[88:91], v[140:143], a[88:91], v[88:91]
    v_rcp_f32 v228, v228
    v_mfma_f32_16x16x32_bf16 v[92:95], v[140:143], a[92:95], v[92:95]
    s_add_u32 s58, s30, 1318912
    v_rcp_f32 v229, v229
    v_mfma_f32_16x16x32_bf16 v[92:95], v[136:139], a[76:79], v[92:95]
    s_waitcnt vmcnt(18)
    v_rcp_f32 v230, v230
    v_mfma_f32_16x16x32_bf16 v[64:67], v[144:147], a[96:99], v[64:67]
    buffer_load_dwordx4 v[132:135], v241, s[20:23], s58 offen offset:0 sc1
    v_mfma_f32_16x16x32_bf16 v[64:67], v[148:151], a[112:115], v[64:67]
    v_rcp_f32 v231, v231
    v_mfma_f32_16x16x32_bf16 v[68:71], v[148:151], a[116:119], v[68:71]
    s_add_u32 s58, s30, 1314816
    v_mul_f32 v36, v36, v52
    v_mul_f32 v37, v37, v53
    v_mfma_f32_16x16x32_bf16 v[68:71], v[144:147], a[100:103], v[68:71]
    v_mul_f32 v38, v38, v54
    v_mul_f32 v39, v39, v55
    v_mfma_f32_16x16x32_bf16 v[72:75], v[144:147], a[104:107], v[72:75]
    buffer_load_dwordx4 v[136:139], v241, s[20:23], s58 offen offset:0 sc1
    v_mfma_f32_16x16x32_bf16 v[72:75], v[148:151], a[120:123], v[72:75]
    v_mul_f32 v228, v228, v36
    v_mul_f32 v229, v229, v37
    v_mfma_f32_16x16x32_bf16 v[76:79], v[148:151], a[124:127], v[76:79]
    s_add_u32 s58, s30, 1323008
    v_mul_f32 v230, v230, v38
    v_mul_f32 v231, v231, v39
    v_mfma_f32_16x16x32_bf16 v[76:79], v[144:147], a[108:111], v[76:79]
    s_waitcnt vmcnt(18)
    v_cvt_pk_bf16_f32 v234, v228, v229
    v_cvt_pk_bf16_f32 v235, v230, v231
    v_mfma_f32_16x16x32_bf16 v[80:83], v[152:155], a[96:99], v[80:83]
    buffer_load_dwordx4 v[140:143], v241, s[20:23], s58 offen offset:0 sc1
    v_mfma_f32_16x16x32_bf16 v[80:83], v[156:159], a[112:115], v[80:83]
    ds_write_b64 v242, v[234:235] offset:13320
    v_mfma_f32_16x16x32_bf16 v[84:87], v[156:159], a[116:119], v[84:87]
    s_add_u32 s58, s30, 1327104
    v_fma_f32 v224, -v40, v40, s42
    v_fma_f32 v225, -v41, v41, s42
    v_mfma_f32_16x16x32_bf16 v[84:87], v[152:155], a[100:103], v[84:87]
    v_mul_f32 v224, v224, v40
    v_mul_f32 v225, v225, v41
    v_mfma_f32_16x16x32_bf16 v[88:91], v[152:155], a[104:107], v[88:91]
    buffer_load_dwordx4 v[144:147], v241, s[20:23], s58 offen offset:0 sc1
    v_mfma_f32_16x16x32_bf16 v[88:91], v[156:159], a[120:123], v[88:91]
    v_fma_f32 v226, -v42, v42, s42
    v_fma_f32 v227, -v43, v43, s42
    v_mfma_f32_16x16x32_bf16 v[92:95], v[156:159], a[124:127], v[92:95]
    s_add_u32 s58, s30, 1331200
    v_mul_f32 v226, v226, v42
    v_mul_f32 v227, v227, v43
    v_mfma_f32_16x16x32_bf16 v[92:95], v[152:155], a[108:111], v[92:95]
    s_waitcnt vmcnt(18)
    v_exp_f32 v224, v224
    v_mfma_f32_16x16x32_bf16 v[64:67], v[160:163], a[128:131], v[64:67]
    buffer_load_dwordx4 v[148:151], v241, s[20:23], s58 offen offset:0 sc1
    v_mfma_f32_16x16x32_bf16 v[64:67], v[164:167], a[144:147], v[64:67]
    v_exp_f32 v225, v225
    v_mfma_f32_16x16x32_bf16 v[68:71], v[164:167], a[148:151], v[68:71]
    s_add_u32 s57, s30, 1400832
    v_exp_f32 v226, v226
    v_mfma_f32_16x16x32_bf16 v[68:71], v[160:163], a[132:135], v[68:71]
    v_exp_f32 v227, v227
    v_mfma_f32_16x16x32_bf16 v[72:75], v[160:163], a[136:139], v[72:75]
    buffer_load_dwordx4 v[152:155], v241, s[20:23], s57 offen offset:0 sc1
    v_mfma_f32_16x16x32_bf16 v[72:75], v[164:167], a[152:155], v[72:75]
    v_add_f32 v224, 1.0, v224
    v_add_f32 v225, 1.0, v225
    v_mfma_f32_16x16x32_bf16 v[76:79], v[164:167], a[156:159], v[76:79]
    s_add_u32 s57, s30, 1404928
    v_add_f32 v226, 1.0, v226
    v_add_f32 v227, 1.0, v227
    v_mfma_f32_16x16x32_bf16 v[76:79], v[160:163], a[140:143], v[76:79]
    s_waitcnt vmcnt(18)
    v_rcp_f32 v224, v224
    v_mfma_f32_16x16x32_bf16 v[80:83], v[168:171], a[128:131], v[80:83]
    buffer_load_dwordx4 v[156:159], v241, s[20:23], s57 offen offset:0 sc1
    v_mfma_f32_16x16x32_bf16 v[80:83], v[172:175], a[144:147], v[80:83]
    v_rcp_f32 v225, v225
    v_mfma_f32_16x16x32_bf16 v[84:87], v[172:175], a[148:151], v[84:87]
    s_add_u32 s58, s30, 1335296
    v_rcp_f32 v226, v226
    v_mfma_f32_16x16x32_bf16 v[84:87], v[168:171], a[132:135], v[84:87]
    v_rcp_f32 v227, v227
    v_mfma_f32_16x16x32_bf16 v[88:91], v[168:171], a[136:139], v[88:91]
    buffer_load_dwordx4 v[160:163], v241, s[20:23], s58 offen offset:0 sc1
    v_mfma_f32_16x16x32_bf16 v[88:91], v[172:175], a[152:155], v[88:91]
    v_mul_f32 v40, v40, v56
    v_mul_f32 v41, v41, v57
    v_mfma_f32_16x16x32_bf16 v[92:95], v[172:175], a[156:159], v[92:95]
    s_add_u32 s58, s30, 1339392
    v_mul_f32 v42, v42, v58
    v_mul_f32 v43, v43, v59
    v_mfma_f32_16x16x32_bf16 v[92:95], v[168:171], a[140:143], v[92:95]
    s_waitcnt vmcnt(18)
    v_mul_f32 v224, v224, v40
    v_mul_f32 v225, v225, v41
    v_mfma_f32_16x16x32_bf16 v[64:67], v[176:179], a[160:163], v[64:67]
    buffer_load_dwordx4 v[164:167], v241, s[20:23], s58 offen offset:0 sc1
    v_mfma_f32_16x16x32_bf16 v[64:67], v[180:183], a[176:179], v[64:67]
    v_mul_f32 v226, v226, v42
    v_mul_f32 v227, v227, v43
    v_mfma_f32_16x16x32_bf16 v[68:71], v[180:183], a[180:183], v[68:71]
    s_add_u32 s57, s30, 1409024
    v_cvt_pk_bf16_f32 v236, v224, v225
    v_cvt_pk_bf16_f32 v237, v226, v227
    v_mfma_f32_16x16x32_bf16 v[68:71], v[176:179], a[164:167], v[68:71]
    ds_write_b64 v242, v[236:237] offset:14344
    v_mfma_f32_16x16x32_bf16 v[72:75], v[176:179], a[168:171], v[72:75]
    buffer_load_dwordx4 v[168:171], v241, s[20:23], s57 offen offset:0 sc1
    v_mfma_f32_16x16x32_bf16 v[72:75], v[180:183], a[184:187], v[72:75]
    v_fma_f32 v228, -v44, v44, s42
    v_fma_f32 v229, -v45, v45, s42
    v_mfma_f32_16x16x32_bf16 v[76:79], v[180:183], a[188:191], v[76:79]
    s_add_u32 s57, s30, 1413120
    v_mul_f32 v228, v228, v44
    v_mul_f32 v229, v229, v45
    v_mfma_f32_16x16x32_bf16 v[76:79], v[176:179], a[172:175], v[76:79]
    s_waitcnt vmcnt(18)
    v_fma_f32 v230, -v46, v46, s42
    v_fma_f32 v231, -v47, v47, s42
    v_mfma_f32_16x16x32_bf16 v[80:83], v[184:187], a[160:163], v[80:83]
    buffer_load_dwordx4 v[172:175], v241, s[20:23], s57 offen offset:0 sc1
    v_mfma_f32_16x16x32_bf16 v[80:83], v[188:191], a[176:179], v[80:83]
    v_mul_f32 v230, v230, v46
    v_mul_f32 v231, v231, v47
    v_mfma_f32_16x16x32_bf16 v[84:87], v[188:191], a[180:183], v[84:87]
    s_add_u32 s58, s30, 1343488
    v_exp_f32 v228, v228
    v_mfma_f32_16x16x32_bf16 v[84:87], v[184:187], a[164:167], v[84:87]
    v_exp_f32 v229, v229
    v_mfma_f32_16x16x32_bf16 v[88:91], v[184:187], a[168:171], v[88:91]
    buffer_load_dwordx4 v[176:179], v241, s[20:23], s58 offen offset:0 sc1
    v_mfma_f32_16x16x32_bf16 v[88:91], v[188:191], a[184:187], v[88:91]
    v_exp_f32 v230, v230
    v_mfma_f32_16x16x32_bf16 v[92:95], v[188:191], a[188:191], v[92:95]
    s_add_u32 s58, s30, 1347584
    v_exp_f32 v231, v231
    v_mfma_f32_16x16x32_bf16 v[92:95], v[184:187], a[172:175], v[92:95]
    s_waitcnt vmcnt(18)
    v_add_f32 v228, 1.0, v228
    v_add_f32 v229, 1.0, v229
    v_mfma_f32_16x16x32_bf16 v[64:67], v[192:195], a[192:195], v[64:67]
    buffer_load_dwordx4 v[180:183], v241, s[20:23], s58 offen offset:0 sc1
    v_mfma_f32_16x16x32_bf16 v[64:67], v[196:199], a[208:211], v[64:67]
    v_add_f32 v230, 1.0, v230
    v_add_f32 v231, 1.0, v231
    v_mfma_f32_16x16x32_bf16 v[68:71], v[196:199], a[212:215], v[68:71]
    s_add_u32 s57, s30, 1417216
    v_rcp_f32 v228, v228
    v_mfma_f32_16x16x32_bf16 v[68:71], v[192:195], a[196:199], v[68:71]
    v_rcp_f32 v229, v229
    v_mfma_f32_16x16x32_bf16 v[72:75], v[192:195], a[200:203], v[72:75]
    buffer_load_dwordx4 v[184:187], v241, s[20:23], s57 offen offset:0 sc1
    v_mfma_f32_16x16x32_bf16 v[72:75], v[196:199], a[216:219], v[72:75]
    v_rcp_f32 v230, v230
    v_mfma_f32_16x16x32_bf16 v[76:79], v[196:199], a[220:223], v[76:79]
    s_add_u32 s57, s30, 1421312
    v_rcp_f32 v231, v231
    v_mfma_f32_16x16x32_bf16 v[76:79], v[192:195], a[204:207], v[76:79]
    s_waitcnt vmcnt(18)
    v_mul_f32 v44, v44, v60
    v_mul_f32 v45, v45, v61
    v_mfma_f32_16x16x32_bf16 v[80:83], v[200:203], a[192:195], v[80:83]
    buffer_load_dwordx4 v[188:191], v241, s[20:23], s57 offen offset:0 sc1
    v_mfma_f32_16x16x32_bf16 v[80:83], v[204:207], a[208:211], v[80:83]
    v_mul_f32 v46, v46, v62
    v_mul_f32 v47, v47, v63
    v_mfma_f32_16x16x32_bf16 v[84:87], v[204:207], a[212:215], v[84:87]
    s_add_u32 s58, s30, 1351680
    v_mul_f32 v228, v228, v44
    v_mul_f32 v229, v229, v45
    v_mfma_f32_16x16x32_bf16 v[84:87], v[200:203], a[196:199], v[84:87]
    v_mul_f32 v230, v230, v46
    v_mul_f32 v231, v231, v47
    v_mfma_f32_16x16x32_bf16 v[88:91], v[200:203], a[200:203], v[88:91]
    buffer_load_dwordx4 v[192:195], v241, s[20:23], s58 offen offset:0 sc1
    v_mfma_f32_16x16x32_bf16 v[88:91], v[204:207], a[216:219], v[88:91]
    v_cvt_pk_bf16_f32 v238, v228, v229
    v_cvt_pk_bf16_f32 v239, v230, v231
    v_mfma_f32_16x16x32_bf16 v[92:95], v[204:207], a[220:223], v[92:95]
    s_add_u32 s58, s30, 1355776
    ds_write_b64 v242, v[238:239] offset:15368
    v_mfma_f32_16x16x32_bf16 v[92:95], v[200:203], a[204:207], v[92:95]
    s_waitcnt vmcnt(18)
    v_mfma_f32_16x16x32_bf16 v[64:67], v[208:211], a[224:227], v[64:67]
    buffer_load_dwordx4 v[196:199], v241, s[20:23], s58 offen offset:0 sc1
    v_mfma_f32_16x16x32_bf16 v[64:67], v[212:215], a[240:243], v[64:67]
    s_waitcnt lgkmcnt(0)
    s_barrier
    v_mfma_f32_16x16x32_bf16 v[68:71], v[212:215], a[244:247], v[68:71]
    s_add_u32 s57, s30, 1425408
    ds_read_b128 a[0:3], v245 offset:0
    ds_read_b128 a[4:7], v245 offset:1024
    v_mfma_f32_16x16x32_bf16 v[68:71], v[208:211], a[228:231], v[68:71]
    ds_read_b128 a[8:11], v245 offset:2048
    v_mfma_f32_16x16x32_bf16 v[72:75], v[208:211], a[232:235], v[72:75]
    buffer_load_dwordx4 v[200:203], v241, s[20:23], s57 offen offset:0 sc1
    v_mfma_f32_16x16x32_bf16 v[72:75], v[212:215], a[248:251], v[72:75]
    ds_read_b128 a[12:15], v245 offset:3072
    v_mfma_f32_16x16x32_bf16 v[76:79], v[212:215], a[252:255], v[76:79]
    s_add_u32 s57, s30, 1429504
    ds_read_b128 a[16:19], v245 offset:4096
    v_mfma_f32_16x16x32_bf16 v[76:79], v[208:211], a[236:239], v[76:79]
    s_waitcnt vmcnt(18)
    ds_read_b128 a[20:23], v245 offset:5120
    v_mfma_f32_16x16x32_bf16 v[80:83], v[216:219], a[224:227], v[80:83]
    buffer_load_dwordx4 v[204:207], v241, s[20:23], s57 offen offset:0 sc1
    v_mfma_f32_16x16x32_bf16 v[80:83], v[220:223], a[240:243], v[80:83]
    ds_read_b128 a[24:27], v245 offset:6144
    v_mfma_f32_16x16x32_bf16 v[84:87], v[220:223], a[244:247], v[84:87]
    s_add_u32 s58, s30, 1359872
    ds_read_b128 a[28:31], v245 offset:7168
    v_mfma_f32_16x16x32_bf16 v[84:87], v[216:219], a[228:231], v[84:87]
    ds_read_b128 a[32:35], v245 offset:8192
    v_mfma_f32_16x16x32_bf16 v[88:91], v[216:219], a[232:235], v[88:91]
    buffer_load_dwordx4 v[208:211], v241, s[20:23], s58 offen offset:0 sc1
    v_mfma_f32_16x16x32_bf16 v[88:91], v[220:223], a[248:251], v[88:91]
    ds_read_b128 a[36:39], v245 offset:9216
    v_mfma_f32_16x16x32_bf16 v[92:95], v[220:223], a[252:255], v[92:95]
    s_add_u32 s58, s30, 1363968
    ds_read_b128 a[40:43], v245 offset:10240
    v_mfma_f32_16x16x32_bf16 v[92:95], v[216:219], a[236:239], v[92:95]
HOP2_5:
    s_cbranch_execz HOPRET2
    s_waitcnt vmcnt(18)
    ds_read_b128 a[44:47], v245 offset:11264
    v_mfma_f32_16x16x32_bf16 v[64:67], v[128:131], v[96:99], v[64:67]
    buffer_load_dwordx4 v[212:215], v241, s[20:23], s58 offen offset:0 sc1
    v_mfma_f32_16x16x32_bf16 v[64:67], v[132:135], v[112:115], v[64:67]
    ds_read_b128 a[48:51], v245 offset:12288
    v_mfma_f32_16x16x32_bf16 v[68:71], v[132:135], v[116:119], v[68:71]
    s_add_u32 s57, s30, 1433600
    ds_read_b128 a[52:55], v245 offset:13312
    v_mfma_f32_16x16x32_bf16 v[68:71], v[128:131], v[100:103], v[68:71]
    ds_read_b128 a[56:59], v245 offset:14336
    v_mfma_f32_16x16x32_bf16 v[72:75], v[128:131], v[104:107], v[72:75]
    buffer_load_dwordx4 v[216:219], v241, s[20:23], s57 offen offset:0 sc1
    v_mfma_f32_16x16x32_bf16 v[72:75], v[132:135], v[120:123], v[72:75]
    ds_read_b128 a[60:63], v245 offset:15360
    v_mfma_f32_16x16x32_bf16 v[76:79], v[132:135], v[124:127], v[76:79]
    s_add_u32 s57, s30, 1437696
    ds_read_b128 a[64:67], v245 offset:16384
    v_mfma_f32_16x16x32_bf16 v[76:79], v[128:131], v[108:111], v[76:79]
    s_waitcnt vmcnt(18)
    ds_read_b128 a[68:71], v245 offset:17408
    v_mfma_f32_16x16x32_bf16 v[80:83], v[136:139], v[96:99], v[80:83]
    buffer_load_dwordx4 v[220:223], v241, s[20:23], s57 offen offset:0 sc1
    v_mfma_f32_16x16x32_bf16 v[80:83], v[140:143], v[112:115], v[80:83]
    ds_read_b128 a[72:75], v245 offset:18432
    v_mfma_f32_16x16x32_bf16 v[84:87], v[140:143], v[116:119], v[84:87]
    s_add_u32 s58, s30, 1368064
    ds_read_b128 a[76:79], v245 offset:19456
    v_mfma_f32_16x16x32_bf16 v[84:87], v[136:139], v[100:103], v[84:87]
    ds_read_b128 a[80:83], v245 offset:20480
    v_mfma_f32_16x16x32_bf16 v[88:91], v[136:139], v[104:107], v[88:91]
    buffer_load_dwordx4 v[128:131], v241, s[20:23], s58 offen offset:0 sc1
    v_mfma_f32_16x16x32_bf16 v[88:91], v[140:143], v[120:123], v[88:91]
    ds_read_b128 a[84:87], v245 offset:21504
    v_mfma_f32_16x16x32_bf16 v[92:95], v[140:143], v[124:127], v[92:95]
    s_add_u32 s58, s30, 1372160
    ds_read_b128 a[88:91], v245 offset:22528
    v_mfma_f32_16x16x32_bf16 v[92:95], v[136:139], v[108:111], v[92:95]
    s_waitcnt vmcnt(18) lgkmcnt(15)
    ds_read_b128 a[92:95], v245 offset:23552
    v_mfma_f32_16x16x32_bf16 v[0:3], v[144:147], a[0:3], 0
    buffer_load_dwordx4 v[132:135], v241, s[20:23], s58 offen offset:0 sc1
    v_mfma_f32_16x16x32_bf16 v[0:3], v[148:151], a[16:19], v[0:3]
    v_mfma_f32_16x16x32_bf16 v[4:7], v[148:151], a[20:23], 0
    s_add_u32 s57, s30, 1441792
    v_mfma_f32_16x16x32_bf16 v[4:7], v[144:147], a[4:7], v[4:7]
    v_fma_f32 v224, -v64, v64, s42
    v_fma_f32 v225, -v65, v65, s42
    v_mfma_f32_16x16x32_bf16 v[8:11], v[144:147], a[8:11], 0
    buffer_load_dwordx4 v[136:139], v241, s[20:23], s57 offen offset:0 sc1
    v_mfma_f32_16x16x32_bf16 v[8:11], v[148:151], a[24:27], v[8:11]
    ds_read_b128 a[96:99], v245 offset:24576
    v_mul_f32 v224, v224, v64
    v_mul_f32 v225, v225, v65
    v_mfma_f32_16x16x32_bf16 v[12:15], v[148:151], a[28:31], 0
    s_add_u32 s57, s30, 1445888
    v_fma_f32 v226, -v66, v66, s42
    v_fma_f32 v227, -v67, v67, s42
    v_mfma_f32_16x16x32_bf16 v[12:15], v[144:147], a[12:15], v[12:15]
    s_waitcnt vmcnt(18)
    ds_read_b128 a[100:103], v245 offset:25600
    v_mul_f32 v226, v226, v66
    v_mul_f32 v227, v227, v67
    v_mfma_f32_16x16x32_bf16 v[16:19], v[152:155], a[0:3], 0
    buffer_load_dwordx4 v[140:143], v241, s[20:23], s57 offen offset:0 sc1
    v_mfma_f32_16x16x32_bf16 v[16:19], v[156:159], a[16:19], v[16:19]
    v_exp_f32 v224, v224
    v_mfma_f32_16x16x32_bf16 v[20:23], v[156:159], a[20:23], 0
    s_add_u32 s58, s30, 1376256
    ds_read_b128 a[104:107], v245 offset:26624
    v_exp_f32 v225, v225
    v_mfma_f32_16x16x32_bf16 v[20:23], v[152:155], a[4:7], v[20:23]
    v_exp_f32 v226, v226
    v_mfma_f32_16x16x32_bf16 v[24:27], v[152:155], a[8:11], 0
    buffer_load_dwordx4 v[144:147], v241, s[20:23], s58 offen offset:0 sc1
    v_mfma_f32_16x16x32_bf16 v[24:27], v[156:159], a[24:27], v[24:27]
    ds_read_b128 a[108:111], v245 offset:27648
    v_exp_f32 v227, v227
    v_mfma_f32_16x16x32_bf16 v[28:31], v[156:159], a[28:31], 0
    s_add_u32 s58, s30, 1380352
    v_add_f32 v224, 1.0, v224
    v_add_f32 v225, 1.0, v225
    v_mfma_f32_16x16x32_bf16 v[28:31], v[152:155], a[12:15], v[28:31]
    s_waitcnt vmcnt(18) lgkmcnt(12)
    ds_read_b128 a[112:115], v245 offset:28672
    v_add_f32 v226, 1.0, v226
    v_add_f32 v227, 1.0, v227
    v_mfma_f32_16x16x32_bf16 v[0:3], v[160:163], a[32:35], v[0:3]
    buffer_load_dwordx4 v[148:151], v241, s[20:23], s58 offen offset:0 sc1
    v_mfma_f32_16x16x32_bf16 v[0:3], v[164:167], a[48:51], v[0:3]
    v_rcp_f32 v224, v224
    v_mfma_f32_16x16x32_bf16 v[4:7], v[164:167], a[52:55], v[4:7]
    s_add_u32 s57, s30, 1449984
    ds_read_b128 a[116:119], v245 offset:29696
    v_rcp_f32 v225, v225
    v_mfma_f32_16x16x32_bf16 v[4:7], v[160:163], a[36:39], v[4:7]
    v_rcp_f32 v226, v226
    v_mfma_f32_16x16x32_bf16 v[8:11], v[160:163], a[40:43], v[8:11]
    buffer_load_dwordx4 v[152:155], v241, s[20:23], s57 offen offset:0 sc1
    v_mfma_f32_16x16x32_bf16 v[8:11], v[164:167], a[56:59], v[8:11]
    ds_read_b128 a[120:123], v245 offset:30720
    v_rcp_f32 v227, v227
    v_mfma_f32_16x16x32_bf16 v[12:15], v[164:167], a[60:63], v[12:15]
    s_add_u32 s57, s30, 1454080
    v_mul_f32 v64, v64, v80
    v_mul_f32 v65, v65, v81
    v_mfma_f32_16x16x32_bf16 v[12:15], v[160:163], a[44:47], v[12:15]
    s_waitcnt vmcnt(18)
    ds_read_b128 a[124:127], v245 offset:31744
    v_mul_f32 v66, v66, v82
    v_mul_f32 v67, v67, v83
    v_mfma_f32_16x16x32_bf16 v[16:19], v[168:171], a[32:35], v[16:19]
    buffer_load_dwordx4 v[156:159], v241, s[20:23], s57 offen offset:0 sc1
    v_mfma_f32_16x16x32_bf16 v[16:19], v[172:175], a[48:51], v[16:19]
    v_mul_f32 v224, v224, v64
    v_mul_f32 v225, v225, v65
    v_mfma_f32_16x16x32_bf16 v[20:23], v[172:175], a[52:55], v[20:23]
    s_add_u32 s58, s30, 1384448
    ds_read_b128 a[128:131], v245 offset:32768
    v_mul_f32 v226, v226, v66
    v_mul_f32 v227, v227, v67
    v_mfma_f32_16x16x32_bf16 v[20:23], v[168:171], a[36:39], v[20:23]
    v_cvt_pk_bf16_f32 v232, v224, v225
    v_cvt_pk_bf16_f32 v233, v226, v227
    v_mfma_f32_16x16x32_bf16 v[24:27], v[168:171], a[40:43], v[24:27]
    buffer_load_dwordx4 v[160:163], v241, s[20:23], s58 offen offset:0 sc1
    v_mfma_f32_16x16x32_bf16 v[24:27], v[172:175], a[56:59], v[24:27]
    ds_read_b128 a[132:135], v245 offset:33792
    ds_write_b64 v243, v[232:233] offset:0
    v_mfma_f32_16x16x32_bf16 v[28:31], v[172:175], a[60:63], v[28:31]
    s_add_u32 s58, s30, 1388544
    v_fma_f32 v228, -v68, v68, s42
    v_fma_f32 v229, -v69, v69, s42
    v_mfma_f32_16x16x32_bf16 v[28:31], v[168:171], a[44:47], v[28:31]
    s_waitcnt vmcnt(18) lgkmcnt(11)
    ds_read_b128 a[136:139], v245 offset:34816
    v_mul_f32 v228, v228, v68
    v_mul_f32 v229, v229, v69
    v_mfma_f32_16x16x32_bf16 v[0:3], v[176:179], a[64:67], v[0:3]
    buffer_load_dwordx4 v[164:167], v241, s[20:23], s58 offen offset:0 sc1
    v_mfma_f32_16x16x32_bf16 v[0:3], v[180:183], a[80:83], v[0:3]
    v_fma_f32 v230, -v70, v70, s42
    v_fma_f32 v231, -v71, v71, s42
    v_mfma_f32_16x16x32_bf16 v[4:7], v[180:183], a[84:87], v[4:7]
    s_add_u32 s57, s30, 1458176
    ds_read_b128 a[140:143], v245 offset:35840
    v_mul_f32 v230, v230, v70
    v_mul_f32 v231, v231, v71
    v_mfma_f32_16x16x32_bf16 v[4:7], v[176:179], a[68:71], v[4:7]
    v_exp_f32 v228, v228
    v_mfma_f32_16x16x32_bf16 v[8:11], v[176:179], a[72:75], v[8:11]
    buffer_load_dwordx4 v[168:171], v241, s[20:23], s57 offen offset:0 sc1
    v_mfma_f32_16x16x32_bf16 v[8:11], v[180:183], a[88:91], v[8:11]
    ds_read_b128 a[144:147], v245 offset:36864
    v_exp_f32 v229, v229
    v_mfma_f32_16x16x32_bf16 v[12:15], v[180:183], a[92:95], v[12:15]
    s_add_u32 s57, s30, 1462272
    v_exp_f32 v230, v230
    v_mfma_f32_16x16x32_bf16 v[12:15], v[176:179], a[76:79], v[12:15]
    s_waitcnt vmcnt(18)
    ds_read_b128 a[148:151], v245 offset:37888
    v_exp_f32 v231, v231
    v_mfma_f32_16x16x32_bf16 v[16:19], v[184:187], a[64:67], v[16:19]
    buffer_load_dwordx4 v[172:175], v241, s[20:23], s57 offen offset:0 sc1
    v_mfma_f32_16x16x32_bf16 v[16:19], v[188:191], a[80:83], v[16:19]
    v_add_f32 v228, 1.0, v228
    v_add_f32 v229, 1.0, v229
    v_mfma_f32_16x16x32_bf16 v[20:23], v[188:191], a[84:87], v[20:23]
    s_add_u32 s58, s30, 1392640
    ds_read_b128 a[152:155], v245 offset:38912
    v_add_f32 v230, 1.0, v230
    v_add_f32 v231, 1.0, v231
    v_mfma_f32_16x16x32_bf16 v[20:23], v[184:187], a[68:71], v[20:23]
    v_rcp_f32 v228, v228
    v_mfma_f32_16x16x32_bf16 v[24:27], v[184:187], a[72:75], v[24:27]
    buffer_load_dwordx4 v[176:179], v241, s[20:23], s58 offen offset:0 sc1
    v_mfma_f32_16x16x32_bf16 v[24:27], v[188:191], a[88:91], v[24:27]
    ds_read_b128 a[156:159], v245 offset:39936
    v_rcp_f32 v229, v229
    v_mfma_f32_16x16x32_bf16 v[28:31], v[188:191], a[92:95], v[28:31]
    s_add_u32 s58, s30, 1396736
    v_rcp_f32 v230, v230
    v_mfma_f32_16x16x32_bf16 v[28:31], v[184:187], a[76:79], v[28:31]
    s_waitcnt vmcnt(18) lgkmcnt(9)
    ds_read_b128 a[160:163], v245 offset:40960
    v_rcp_f32 v231, v231
    v_mfma_f32_16x16x32_bf16 v[0:3], v[192:195], a[96:99], v[0:3]
    buffer_load_dwordx4 v[180:183], v241, s[20:23], s58 offen offset:0 sc1
    v_mfma_f32_16x16x32_bf16 v[0:3], v[196:199], a[112:115], v[0:3]
    v_mul_f32 v68, v68, v84
    v_mul_f32 v69, v69, v85
    v_mfma_f32_16x16x32_bf16 v[4:7], v[196:199], a[116:119], v[4:7]
    s_add_u32 s57, s30, 1466368
    ds_read_b128 a[164:167], v245 offset:41984
    v_mul_f32 v70, v70, v86
    v_mul_f32 v71, v71, v87
    v_mfma_f32_16x16x32_bf16 v[4:7], v[192:195], a[100:103], v[4:7]
    v_mul_f32 v228, v228, v68
    v_mul_f32 v229, v229, v69
    v_mfma_f32_16x16x32_bf16 v[8:11], v[192:195], a[104:107], v[8:11]
    buffer_load_dwordx4 v[184:187], v241, s[20:23], s57 offen offset:0 sc1
    v_mfma_f32_16x16x32_bf16 v[8:11], v[196:199], a[120:123], v[8:11]
    ds_read_b128 a[168:171], v245 offset:43008
    v_mul_f32 v230, v230, v70
    v_mul_f32 v231, v231, v71
    v_mfma_f32_16x16x32_bf16 v[12:15], v[196:199], a[124:127], v[12:15]
    s_add_u32 s57, s30, 1470464
    v_cvt_pk_bf16_f32 v234, v228, v229
    v_cvt_pk_bf16_f32 v235, v230, v231
    v_mfma_f32_16x16x32_bf16 v[12:15], v[192:195], a[108:111], v[12:15]
    s_waitcnt vmcnt(18)
    ds_read_b128 a[172:175], v245 offset:44032
    ds_write_b64 v243, v[234:235] offset:1024
    v_mfma_f32_16x16x32_bf16 v[16:19], v[200:203], a[96:99], v[16:19]
    buffer_load_dwordx4 v[188:191], v241, s[20:23], s57 offen offset:0 sc1
    v_mfma_f32_16x16x32_bf16 v[16:19], v[204:207], a[112:115], v[16:19]
    v_fma_f32 v224, -v72, v72, s42
    v_fma_f32 v225, -v73, v73, s42
    v_mfma_f32_16x16x32_bf16 v[20:23], v[204:207], a[116:119], v[20:23]
    s_add_u32 s58, s76, 1474560
    ds_read_b128 a[176:179], v245 offset:45056
    v_mul_f32 v224, v224, v72
    v_mul_f32 v225, v225, v73
    v_mfma_f32_16x16x32_bf16 v[20:23], v[200:203], a[100:103], v[20:23]
    v_fma_f32 v226, -v74, v74, s42
    v_fma_f32 v227, -v75, v75, s42
    v_mfma_f32_16x16x32_bf16 v[24:27], v[200:203], a[104:107], v[24:27]
    buffer_load_dwordx4 v[192:195], v241, s[20:23], s58 offen offset:0 sc1
    v_mfma_f32_16x16x32_bf16 v[24:27], v[204:207], a[120:123], v[24:27]
    ds_read_b128 a[180:183], v245 offset:46080
    v_mul_f32 v226, v226, v74
    v_mul_f32 v227, v227, v75
    v_mfma_f32_16x16x32_bf16 v[28:31], v[204:207], a[124:127], v[28:31]
    s_add_u32 s58, s76, 1478656
    v_exp_f32 v224, v224
    v_mfma_f32_16x16x32_bf16 v[28:31], v[200:203], a[108:111], v[28:31]
    s_waitcnt vmcnt(18) lgkmcnt(7)
    ds_read_b128 a[184:187], v245 offset:47104
    v_exp_f32 v225, v225
    v_mfma_f32_16x16x32_bf16 v[0:3], v[208:211], a[128:131], v[0:3]
    buffer_load_dwordx4 v[196:199], v241, s[20:23], s58 offen offset:0 sc1
    v_mfma_f32_16x16x32_bf16 v[0:3], v[212:215], a[144:147], v[0:3]
    v_exp_f32 v226, v226
    v_mfma_f32_16x16x32_bf16 v[4:7], v[212:215], a[148:151], v[4:7]
    s_add_u32 s58, s76, 1482752
    ds_read_b128 a[188:191], v245 offset:48128
    v_exp_f32 v227, v227
    v_mfma_f32_16x16x32_bf16 v[4:7], v[208:211], a[132:135], v[4:7]
    v_add_f32 v224, 1.0, v224
    v_add_f32 v225, 1.0, v225
    v_mfma_f32_16x16x32_bf16 v[8:11], v[208:211], a[136:139], v[8:11]
    buffer_load_dwordx4 v[200:203], v241, s[20:23], s58 offen offset:0 sc1
    v_mfma_f32_16x16x32_bf16 v[8:11], v[212:215], a[152:155], v[8:11]
    ds_read_b128 a[192:195], v245 offset:49152
    v_add_f32 v226, 1.0, v226
    v_add_f32 v227, 1.0, v227
    v_mfma_f32_16x16x32_bf16 v[12:15], v[212:215], a[156:159], v[12:15]
    s_add_u32 s58, s76, 1486848
    v_rcp_f32 v224, v224
    v_mfma_f32_16x16x32_bf16 v[12:15], v[208:211], a[140:143], v[12:15]
    s_waitcnt vmcnt(18)
    ds_read_b128 a[196:199], v245 offset:50176
    v_rcp_f32 v225, v225
    v_mfma_f32_16x16x32_bf16 v[16:19], v[216:219], a[128:131], v[16:19]
    buffer_load_dwordx4 v[204:207], v241, s[20:23], s58 offen offset:0 sc1
    v_mfma_f32_16x16x32_bf16 v[16:19], v[220:223], a[144:147], v[16:19]
    v_rcp_f32 v226, v226
    v_mfma_f32_16x16x32_bf16 v[20:23], v[220:223], a[148:151], v[20:23]
    s_add_u32 s58, s76, 1490944
    ds_read_b128 a[200:203], v245 offset:51200
    v_rcp_f32 v227, v227
    v_mfma_f32_16x16x32_bf16 v[20:23], v[216:219], a[132:135], v[20:23]
    v_mul_f32 v72, v72, v88
    v_mul_f32 v73, v73, v89
    v_mfma_f32_16x16x32_bf16 v[24:27], v[216:219], a[136:139], v[24:27]
    buffer_load_dwordx4 v[208:211], v241, s[20:23], s58 offen offset:0 sc1
    v_mfma_f32_16x16x32_bf16 v[24:27], v[220:223], a[152:155], v[24:27]
    ds_read_b128 a[204:207], v245 offset:52224
    v_mul_f32 v74, v74, v90
    v_mul_f32 v75, v75, v91
    v_mfma_f32_16x16x32_bf16 v[28:31], v[220:223], a[156:159], v[28:31]
    s_add_u32 s58, s76, 1495040
    v_mul_f32 v224, v224, v72
    v_mul_f32 v225, v225, v73
    v_mfma_f32_16x16x32_bf16 v[28:31], v[216:219], a[140:143], v[28:31]
    s_waitcnt vmcnt(18) lgkmcnt(4)
    ds_read_b128 a[208:211], v245 offset:53248
    v_mul_f32 v226, v226, v74
    v_mul_f32 v227, v227, v75
    v_mfma_f32_16x16x32_bf16 v[0:3], v[128:131], a[160:163], v[0:3]
    buffer_load_dwordx4 v[212:215], v241, s[20:23], s58 offen offset:0 sc1
    v_mfma_f32_16x16x32_bf16 v[0:3], v[132:135], a[176:179], v[0:3]
    v_cvt_pk_bf16_f32 v236, v224, v225
    v_cvt_pk_bf16_f32 v237, v226, v227
    v_mfma_f32_16x16x32_bf16 v[4:7], v[132:135], a[180:183], v[4:7]
    s_add_u32 s58, s76, 1499136
    ds_read_b128 a[212:215], v245 offset:54272
    ds_write_b64 v243, v[236:237] offset:2048
    v_mfma_f32_16x16x32_bf16 v[4:7], v[128:131], a[164:167], v[4:7]
    v_fma_f32 v228, -v76, v76, s42
    v_fma_f32 v229, -v77, v77, s42
    v_mfma_f32_16x16x32_bf16 v[8:11], v[128:131], a[168:171], v[8:11]
    buffer_load_dwordx4 v[216:219], v241, s[20:23], s58 offen offset:0 sc1
    v_mfma_f32_16x16x32_bf16 v[8:11], v[132:135], a[184:187], v[8:11]
    ds_read_b128 a[216:219], v245 offset:55296
    v_mul_f32 v228, v228, v76
    v_mul_f32 v229, v229, v77
    v_mfma_f32_16x16x32_bf16 v[12:15], v[132:135], a[188:191], v[12:15]
    s_add_u32 s58, s76, 1503232
    v_fma_f32 v230, -v78, v78, s42
    v_fma_f32 v231, -v79, v79, s42
    v_mfma_f32_16x16x32_bf16 v[12:15], v[128:131], a[172:175], v[12:15]
    s_waitcnt vmcnt(18)
    ds_read_b128 a[220:223], v245 offset:56320
    v_mul_f32 v230, v230, v78
    v_mul_f32 v231, v231, v79
    v_mfma_f32_16x16x32_bf16 v[16:19], v[136:139], a[160:163], v[16:19]
    buffer_load_dwordx4 v[220:223], v241, s[20:23], s58 offen offset:0 sc1
    v_mfma_f32_16x16x32_bf16 v[16:19], v[140:143], a[176:179], v[16:19]
    v_exp_f32 v228, v228
    v_mfma_f32_16x16x32_bf16 v[20:23], v[140:143], a[180:183], v[20:23]
    s_add_u32 s58, s76, 1507328
    ds_read_b128 a[224:227], v245 offset:57344
    v_exp_f32 v229, v229
    v_mfma_f32_16x16x32_bf16 v[20:23], v[136:139], a[164:167], v[20:23]
    v_exp_f32 v230, v230
    v_mfma_f32_16x16x32_bf16 v[24:27], v[136:139], a[168:171], v[24:27]
    buffer_load_dwordx4 v[128:131], v241, s[20:23], s58 offen offset:0 sc1
    v_mfma_f32_16x16x32_bf16 v[24:27], v[140:143], a[184:187], v[24:27]
    ds_read_b128 a[228:231], v245 offset:58368
    v_exp_f32 v231, v231
    v_mfma_f32_16x16x32_bf16 v[28:31], v[140:143], a[188:191], v[28:31]
    s_add_u32 s58, s76, 1511424
    v_add_f32 v228, 1.0, v228
    v_add_f32 v229, 1.0, v229
    v_mfma_f32_16x16x32_bf16 v[28:31], v[136:139], a[172:175], v[28:31]
    s_waitcnt vmcnt(18) lgkmcnt(2)
    ds_read_b128 a[232:235], v245 offset:59392
    v_add_f32 v230, 1.0, v230
    v_add_f32 v231, 1.0, v231
    v_mfma_f32_16x16x32_bf16 v[0:3], v[144:147], a[192:195], v[0:3]
    buffer_load_dwordx4 v[132:135], v241, s[20:23], s58 offen offset:0 sc1
    v_mfma_f32_16x16x32_bf16 v[0:3], v[148:151], a[208:211], v[0:3]
    v_rcp_f32 v228, v228
    v_mfma_f32_16x16x32_bf16 v[4:7], v[148:151], a[212:215], v[4:7]
    s_add_u32 s58, s76, 1515520
    ds_read_b128 a[236:239], v245 offset:60416
    v_rcp_f32 v229, v229
    v_mfma_f32_16x16x32_bf16 v[4:7], v[144:147], a[196:199], v[4:7]
    v_rcp_f32 v230, v230
    v_mfma_f32_16x16x32_bf16 v[8:11], v[144:147], a[200:203], v[8:11]
    buffer_load_dwordx4 v[136:139], v241, s[20:23], s58 offen offset:0 sc1
    v_mfma_f32_16x16x32_bf16 v[8:11], v[148:151], a[216:219], v[8:11]
    ds_read_b128 a[240:243], v245 offset:61440
    v_rcp_f32 v231, v231
    v_mfma_f32_16x16x32_bf16 v[12:15], v[148:151], a[220:223], v[12:15]
    s_add_u32 s58, s76, 1519616
    v_mul_f32 v76, v76, v92
    v_mul_f32 v77, v77, v93
    v_mfma_f32_16x16x32_bf16 v[12:15], v[144:147], a[204:207], v[12:15]
    s_waitcnt vmcnt(18)
    ds_read_b128 a[244:247], v245 offset:62464
    v_mul_f32 v78, v78, v94
    v_mul_f32 v79, v79, v95
    v_mfma_f32_16x16x32_bf16 v[16:19], v[152:155], a[192:195], v[16:19]
    buffer_load_dwordx4 v[140:143], v241, s[20:23], s58 offen offset:0 sc1
    v_mfma_f32_16x16x32_bf16 v[16:19], v[156:159], a[208:211], v[16:19]
    v_mul_f32 v228, v228, v76
    v_mul_f32 v229, v229, v77
    v_mfma_f32_16x16x32_bf16 v[20:23], v[156:159], a[212:215], v[20:23]
    s_add_u32 s58, s76, 1523712
    ds_read_b128 a[248:251], v245 offset:63488
    v_mul_f32 v230, v230, v78
    v_mul_f32 v231, v231, v79
    v_mfma_f32_16x16x32_bf16 v[20:23], v[152:155], a[196:199], v[20:23]
    v_cvt_pk_bf16_f32 v238, v228, v229
    v_cvt_pk_bf16_f32 v239, v230, v231
    v_mfma_f32_16x16x32_bf16 v[24:27], v[152:155], a[200:203], v[24:27]
    buffer_load_dwordx4 v[144:147], v241, s[20:23], s58 offen offset:0 sc1
    v_mfma_f32_16x16x32_bf16 v[24:27], v[156:159], a[216:219], v[24:27]
    ds_read_b128 a[252:255], v245 offset:64512
    ds_write_b64 v243, v[238:239] offset:3072
    v_mfma_f32_16x16x32_bf16 v[28:31], v[156:159], a[220:223], v[28:31]
    s_add_u32 s58, s76, 1527808
    s_waitcnt lgkmcnt(0)
    s_barrier
    v_mfma_f32_16x16x32_bf16 v[28:31], v[152:155], a[204:207], v[28:31]
    s_waitcnt vmcnt(18)
    ds_read_b128 v[96:99], v246 offset:0
    ds_read_b128 v[112:115], v246 offset:4096
    v_mfma_f32_16x16x32_bf16 v[0:3], v[160:163], a[224:227], v[0:3]
    buffer_load_dwordx4 v[148:151], v241, s[20:23], s58 offen offset:0 sc1
    v_mfma_f32_16x16x32_bf16 v[0:3], v[164:167], a[240:243], v[0:3]
    ds_read_b128 v[100:103], v246 offset:1024
    ds_read_b128 v[116:119], v246 offset:5120
    v_mfma_f32_16x16x32_bf16 v[4:7], v[164:167], a[244:247], v[4:7]
    s_add_u32 s58, s76, 1531904
    ds_read_b128 v[104:107], v246 offset:2048
    ds_read_b128 v[120:123], v246 offset:6144
    v_mfma_f32_16x16x32_bf16 v[4:7], v[160:163], a[228:231], v[4:7]
    ds_read_b128 v[108:111], v246 offset:3072
    ds_read_b128 v[124:127], v246 offset:7168
    v_mfma_f32_16x16x32_bf16 v[8:11], v[160:163], a[232:235], v[8:11]
    buffer_load_dwordx4 v[152:155], v241, s[20:23], s58 offen offset:0 sc1
    v_mfma_f32_16x16x32_bf16 v[8:11], v[164:167], a[248:251], v[8:11]
    v_mfma_f32_16x16x32_bf16 v[12:15], v[164:167], a[252:255], v[12:15]
    s_add_u32 s58, s76, 1536000
    v_mfma_f32_16x16x32_bf16 v[12:15], v[160:163], a[236:239], v[12:15]
    s_waitcnt vmcnt(18)
    v_mfma_f32_16x16x32_bf16 v[16:19], v[168:171], a[224:227], v[16:19]
    buffer_load_dwordx4 v[156:159], v241, s[20:23], s58 offen offset:0 sc1
    v_mfma_f32_16x16x32_bf16 v[16:19], v[172:175], a[240:243], v[16:19]
    v_mfma_f32_16x16x32_bf16 v[20:23], v[172:175], a[244:247], v[20:23]
    s_add_u32 s58, s76, 1540096
    v_mfma_f32_16x16x32_bf16 v[20:23], v[168:171], a[228:231], v[20:23]
    v_mfma_f32_16x16x32_bf16 v[24:27], v[168:171], a[232:235], v[24:27]
    buffer_load_dwordx4 v[160:163], v241, s[20:23], s58 offen offset:0 sc1
    v_mfma_f32_16x16x32_bf16 v[24:27], v[172:175], a[248:251], v[24:27]
    v_mfma_f32_16x16x32_bf16 v[28:31], v[172:175], a[252:255], v[28:31]
    s_add_u32 s58, s76, 1544192
    v_mfma_f32_16x16x32_bf16 v[28:31], v[168:171], a[236:239], v[28:31]
    s_waitcnt vmcnt(18) lgkmcnt(0)
    v_mfma_f32_16x16x32_bf16 v[0:3], v[176:179], v[96:99], v[0:3]
    buffer_load_dwordx4 v[164:167], v241, s[20:23], s58 offen offset:0 sc1
    v_mfma_f32_16x16x32_bf16 v[0:3], v[180:183], v[112:115], v[0:3]
    v_mfma_f32_16x16x32_bf16 v[4:7], v[180:183], v[116:119], v[4:7]
    s_add_u32 s58, s76, 1548288
    v_mfma_f32_16x16x32_bf16 v[4:7], v[176:179], v[100:103], v[4:7]
    v_mfma_f32_16x16x32_bf16 v[8:11], v[176:179], v[104:107], v[8:11]
    buffer_load_dwordx4 v[168:171], v241, s[20:23], s58 offen offset:0 sc1
    v_mfma_f32_16x16x32_bf16 v[8:11], v[180:183], v[120:123], v[8:11]
    v_mfma_f32_16x16x32_bf16 v[12:15], v[180:183], v[124:127], v[12:15]
    s_add_u32 s58, s76, 1552384
    v_mfma_f32_16x16x32_bf16 v[12:15], v[176:179], v[108:111], v[12:15]
    s_waitcnt vmcnt(18)
    v_mfma_f32_16x16x32_bf16 v[16:19], v[184:187], v[96:99], v[16:19]
    buffer_load_dwordx4 v[172:175], v241, s[20:23], s58 offen offset:0 sc1
    v_mfma_f32_16x16x32_bf16 v[16:19], v[188:191], v[112:115], v[16:19]
    v_mfma_f32_16x16x32_bf16 v[20:23], v[188:191], v[116:119], v[20:23]
    s_add_u32 s58, s76, 1556480
    v_mfma_f32_16x16x32_bf16 v[20:23], v[184:187], v[100:103], v[20:23]
    v_mfma_f32_16x16x32_bf16 v[24:27], v[184:187], v[104:107], v[24:27]
    buffer_load_dwordx4 v[176:179], v241, s[20:23], s58 offen offset:0 sc1
    v_mfma_f32_16x16x32_bf16 v[24:27], v[188:191], v[120:123], v[24:27]
    v_mfma_f32_16x16x32_bf16 v[28:31], v[188:191], v[124:127], v[28:31]
    s_add_u32 s58, s76, 1560576
    v_mfma_f32_16x16x32_bf16 v[28:31], v[184:187], v[108:111], v[28:31]
    s_waitcnt vmcnt(18)
    v_mfma_f32_16x16x32_bf16 v[32:35], v[192:195], a[0:3], 0
    buffer_load_dwordx4 v[180:183], v241, s[20:23], s58 offen offset:0 sc1
    v_mfma_f32_16x16x32_bf16 v[32:35], v[196:199], a[16:19], v[32:35]
    v_and_b32 v224, 3, v240
    v_and_b32 v225, 16, v240
    v_mfma_f32_16x16x32_bf16 v[32:35], v[200:203], a[32:35], v[32:35]
    s_add_u32 s58, s76, 1564672
    v_lshl_add_u32 v224, v224, 5, v225
    v_and_b32 v225, 32, v240
    v_mfma_f32_16x16x32_bf16 v[36:39], v[200:203], a[36:39], 0
    v_lshl_add_u32 v224, v225, 2, v224
    v_add_u32 v243, s39, v224
    v_mfma_f32_16x16x32_bf16 v[36:39], v[196:199], a[20:23], v[36:39]
    buffer_load_dwordx4 v[184:187], v241, s[20:23], s58 offen offset:0 sc1
    v_mfma_f32_16x16x32_bf16 v[36:39], v[192:195], a[4:7], v[36:39]
    v_and_b32 v224, 56, v240
    v_and_b32 v225, 1, v240
    v_mfma_f32_16x16x32_bf16 v[40:43], v[192:195], a[8:11], 0
    s_add_u32 s58, s76, 1568768
    v_lshl_add_u32 v224, v225, 2, v224
    v_bfe_u32 v225, v240, 1, 2
    v_mfma_f32_16x16x32_bf16 v[40:43], v[196:199], a[24:27], v[40:43]
    v_cmp_gt_u32 vcc, 16, v240
    v_add_lshl_u32 v249, v224, v225, 4
    v_mfma_f32_16x16x32_bf16 v[40:43], v[200:203], a[40:43], v[40:43]
    buffer_load_dwordx4 v[188:191], v241, s[20:23], s58 offen offset:0 sc1
    v_mfma_f32_16x16x32_bf16 v[44:47], v[200:203], a[44:47], 0
    v_mov_b32 v224, 1073741824
    v_add_u32 v251, s47, v241
    v_mfma_f32_16x16x32_bf16 v[44:47], v[196:199], a[28:31], v[44:47]
    s_add_u32 s58, s76, 1572864
    v_cndmask_b32 v248, v249, v224, vcc
    v_mfma_f32_16x16x32_bf16 v[44:47], v[192:195], a[12:15], v[44:47]
    s_waitcnt vmcnt(18)
    v_cvt_pk_bf16_f32 v232, v0, v1
    v_cvt_pk_bf16_f32 v233, v2, v3
    v_mfma_f32_16x16x32_bf16 v[32:35], v[204:207], a[48:51], v[32:35]
    buffer_load_dwordx4 v[192:195], v241, s[20:23], s58 offen offset:0 sc1
    v_mfma_f32_16x16x32_bf16 v[32:35], v[208:211], a[64:67], v[32:35]
    v_cvt_pk_bf16_f32 v234, v4, v5
    v_cvt_pk_bf16_f32 v235, v6, v7
    v_mfma_f32_16x16x32_bf16 v[32:35], v[212:215], a[80:83], v[32:35]
    s_add_u32 s58, s76, 1576960
    s_add_u32 s41, s40, 0
    buffer_store_dwordx4 v[232:235], v244, s[20:23], s41 offen offset:0 sc1
    v_mfma_f32_16x16x32_bf16 v[36:39], v[212:215], a[84:87], v[36:39]
    v_cvt_pk_bf16_f32 v236, v8, v9
    v_cvt_pk_bf16_f32 v237, v10, v11
    v_mfma_f32_16x16x32_bf16 v[36:39], v[208:211], a[68:71], v[36:39]
    buffer_load_dwordx4 v[196:199], v241, s[20:23], s58 offen offset:0 sc1
    v_mfma_f32_16x16x32_bf16 v[36:39], v[204:207], a[52:55], v[36:39]
    v_cvt_pk_bf16_f32 v238, v12, v13
    v_cvt_pk_bf16_f32 v239, v14, v15
    v_mfma_f32_16x16x32_bf16 v[40:43], v[204:207], a[56:59], v[40:43]
    s_add_u32 s58, s76, 1581056
    buffer_store_dwordx4 v[236:239], v250, s[20:23], s41 offen offset:1024 sc1
    v_mfma_f32_16x16x32_bf16 v[40:43], v[208:211], a[72:75], v[40:43]
    s_mov_b64 exec, s[54:55]
    ds_write_b128 v243, v[0:3] offset:0
    s_mov_b64 exec, -1
    v_mfma_f32_16x16x32_bf16 v[40:43], v[212:215], a[88:91], v[40:43]
    buffer_load_dwordx4 v[200:203], v241, s[20:23], s58 offen offset:0 sc1
    v_mfma_f32_16x16x32_bf16 v[44:47], v[212:215], a[92:95], v[44:47]
    s_mov_b64 exec, s[54:55]
    ds_write_b128 v243, v[4:7] offset:256
    s_mov_b64 exec, -1
    v_mfma_f32_16x16x32_bf16 v[44:47], v[208:211], a[76:79], v[44:47]
    s_add_u32 s58, s76, 1585152
    v_mfma_f32_16x16x32_bf16 v[44:47], v[204:207], a[60:63], v[44:47]
    s_waitcnt vmcnt(20)
    v_mfma_f32_16x16x32_bf16 v[32:35], v[216:219], a[96:99], v[32:35]
    buffer_load_dwordx4 v[204:207], v241, s[20:23], s58 offen offset:0 sc1
    v_mfma_f32_16x16x32_bf16 v[32:35], v[220:223], a[112:115], v[32:35]
    v_mfma_f32_16x16x32_bf16 v[32:35], v[128:131], a[128:131], v[32:35]
    s_add_u32 s58, s76, 1589248
    v_mfma_f32_16x16x32_bf16 v[36:39], v[128:131], a[132:135], v[36:39]
    v_mfma_f32_16x16x32_bf16 v[36:39], v[220:223], a[116:119], v[36:39]
    buffer_load_dwordx4 v[208:211], v241, s[20:23], s58 offen offset:0 sc1
    v_mfma_f32_16x16x32_bf16 v[36:39], v[216:219], a[100:103], v[36:39]
    v_mfma_f32_16x16x32_bf16 v[40:43], v[216:219], a[104:107], v[40:43]
    s_add_u32 s58, s76, 1593344
    v_mfma_f32_16x16x32_bf16 v[40:43], v[220:223], a[120:123], v[40:43]
    v_mfma_f32_16x16x32_bf16 v[40:43], v[128:131], a[136:139], v[40:43]
    buffer_load_dwordx4 v[212:215], v241, s[20:23], s58 offen offset:0 sc1
    v_mfma_f32_16x16x32_bf16 v[44:47], v[128:131], a[140:143], v[44:47]
    v_mfma_f32_16x16x32_bf16 v[44:47], v[220:223], a[124:127], v[44:47]
    s_add_u32 s58, s76, 1597440
    v_mfma_f32_16x16x32_bf16 v[44:47], v[216:219], a[108:111], v[44:47]
    s_waitcnt vmcnt(20)
    v_mfma_f32_16x16x32_bf16 v[32:35], v[132:135], a[144:147], v[32:35]
    buffer_load_dwordx4 v[216:219], v241, s[20:23], s58 offen offset:0 sc1
    v_mfma_f32_16x16x32_bf16 v[32:35], v[136:139], a[160:163], v[32:35]
    v_mfma_f32_16x16x32_bf16 v[32:35], v[140:143], a[176:179], v[32:35]
    s_add_u32 s58, s76, 1601536
    v_cvt_pk_bf16_f32 v232, v16, v17
    v_cvt_pk_bf16_f32 v233, v18, v19
    v_mfma_f32_16x16x32_bf16 v[36:39], v[140:143], a[180:183], v[36:39]
    v_cvt_pk_bf16_f32 v234, v20, v21
    v_cvt_pk_bf16_f32 v235, v22, v23
    v_mfma_f32_16x16x32_bf16 v[36:39], v[136:139], a[164:167], v[36:39]
    buffer_load_dwordx4 v[220:223], v241, s[20:23], s58 offen offset:0 sc1
    v_mfma_f32_16x16x32_bf16 v[36:39], v[132:135], a[148:151], v[36:39]
    s_add_u32 s41, s40, 2048
    buffer_store_dwordx4 v[232:235], v244, s[20:23], s41 offen offset:0 sc1
    v_mfma_f32_16x16x32_bf16 v[40:43], v[132:135], a[152:155], v[40:43]
    s_add_u32 s58, s76, 1605632
    v_cvt_pk_bf16_f32 v236, v24, v25
    v_cvt_pk_bf16_f32 v237, v26, v27
    v_mfma_f32_16x16x32_bf16 v[40:43], v[136:139], a[168:171], v[40:43]
    v_cvt_pk_bf16_f32 v238, v28, v29
    v_cvt_pk_bf16_f32 v239, v30, v31
    v_mfma_f32_16x16x32_bf16 v[40:43], v[140:143], a[184:187], v[40:43]
    buffer_load_dwordx4 v[128:131], v241, s[20:23], s58 offen offset:0 sc1
    v_mfma_f32_16x16x32_bf16 v[44:47], v[140:143], a[188:191], v[44:47]
    buffer_store_dwordx4 v[236:239], v250, s[20:23], s41 offen offset:1024 sc1
    v_mfma_f32_16x16x32_bf16 v[44:47], v[136:139], a[172:175], v[44:47]
    s_add_u32 s58, s76, 1609728
    s_mov_b64 exec, s[54:55]
    ds_write_b128 v243, v[16:19] offset:512
    s_mov_b64 exec, -1
    v_mfma_f32_16x16x32_bf16 v[44:47], v[132:135], a[156:159], v[44:47]
    s_waitcnt vmcnt(22)
    s_mov_b64 exec, s[54:55]
    ds_write_b128 v243, v[20:23] offset:768
    s_mov_b64 exec, -1
    v_mfma_f32_16x16x32_bf16 v[32:35], v[144:147], a[192:195], v[32:35]
    buffer_load_dwordx4 v[132:135], v241, s[20:23], s58 offen offset:0 sc1
    v_mfma_f32_16x16x32_bf16 v[32:35], v[148:151], a[208:211], v[32:35]
    v_mfma_f32_16x16x32_bf16 v[32:35], v[152:155], a[224:227], v[32:35]
    s_add_u32 s58, s76, 1613824
    v_mfma_f32_16x16x32_bf16 v[36:39], v[152:155], a[228:231], v[36:39]
    v_mfma_f32_16x16x32_bf16 v[36:39], v[148:151], a[212:215], v[36:39]
    buffer_load_dwordx4 v[136:139], v241, s[20:23], s58 offen offset:0 sc1
    v_mfma_f32_16x16x32_bf16 v[36:39], v[144:147], a[196:199], v[36:39]
HOP2_6:
    s_cbranch_execz HOPRET2
    v_mfma_f32_16x16x32_bf16 v[40:43], v[144:147], a[200:203], v[40:43]
    s_add_u32 s58, s76, 1617920
    v_mfma_f32_16x16x32_bf16 v[40:43], v[148:151], a[216:219], v[40:43]
    v_mfma_f32_16x16x32_bf16 v[40:43], v[152:155], a[232:235], v[40:43]
    buffer_load_dwordx4 v[140:143], v241, s[20:23], s58 offen offset:0 sc1
    v_mfma_f32_16x16x32_bf16 v[44:47], v[152:155], a[236:239], v[44:47]
    v_mfma_f32_16x16x32_bf16 v[44:47], v[148:151], a[220:223], v[44:47]
    s_add_u32 s58, s77, 1622016
    v_mfma_f32_16x16x32_bf16 v[44:47], v[144:147], a[204:207], v[44:47]
    s_waitcnt vmcnt(22)
    v_mfma_f32_16x16x32_bf16 v[32:35], v[156:159], a[240:243], v[32:35]
    buffer_load_dwordx4 v[144:147], v241, s[20:23], s58 offen offset:0 sc1
    v_mfma_f32_16x16x32_bf16 v[32:35], v[160:163], v[96:99], v[32:35]
    v_mfma_f32_16x16x32_bf16 v[32:35], v[164:167], v[112:115], v[32:35]
    s_add_u32 s58, s77, 1626112
    v_mfma_f32_16x16x32_bf16 v[36:39], v[164:167], v[116:119], v[36:39]
    v_mfma_f32_16x16x32_bf16 v[36:39], v[160:163], v[100:103], v[36:39]
    buffer_load_dwordx4 v[148:151], v241, s[20:23], s58 offen offset:0 sc1
    v_mfma_f32_16x16x32_bf16 v[36:39], v[156:159], a[244:247], v[36:39]
    v_mfma_f32_16x16x32_bf16 v[40:43], v[156:159], a[248:251], v[40:43]
    s_add_u32 s58, s77, 1630208
    v_mfma_f32_16x16x32_bf16 v[40:43], v[160:163], v[104:107], v[40:43]
    v_mfma_f32_16x16x32_bf16 v[40:43], v[164:167], v[120:123], v[40:43]
    buffer_load_dwordx4 v[152:155], v241, s[20:23], s58 offen offset:0 sc1
    v_mfma_f32_16x16x32_bf16 v[44:47], v[164:167], v[124:127], v[44:47]
    v_mfma_f32_16x16x32_bf16 v[44:47], v[160:163], v[108:111], v[44:47]
    s_add_u32 s58, s77, 1634304
    v_mfma_f32_16x16x32_bf16 v[44:47], v[156:159], a[252:255], v[44:47]
    s_waitcnt vmcnt(22)
    v_mfma_f32_16x16x32_bf16 v[0:3], v[168:171], a[0:3], 0
    buffer_load_dwordx4 v[156:159], v241, s[20:23], s58 offen offset:0 sc1
    v_mfma_f32_16x16x32_bf16 v[0:3], v[172:175], a[16:19], v[0:3]
    v_mfma_f32_16x16x32_bf16 v[0:3], v[176:179], a[32:35], v[0:3]
    s_add_u32 s58, s77, 1638400
    v_mfma_f32_16x16x32_bf16 v[4:7], v[176:179], a[36:39], 0
    v_mfma_f32_16x16x32_bf16 v[4:7], v[172:175], a[20:23], v[4:7]
    buffer_load_dwordx4 v[160:163], v241, s[20:23], s58 offen offset:0 sc1
    v_mfma_f32_16x16x32_bf16 v[4:7], v[168:171], a[4:7], v[4:7]
    v_cvt_pk_bf16_f32 v232, v32, v33
    v_cvt_pk_bf16_f32 v233, v34, v35
    v_mfma_f32_16x16x32_bf16 v[8:11], v[168:171], a[8:11], 0
    s_add_u32 s58, s77, 1642496
    v_cvt_pk_bf16_f32 v234, v36, v37
    v_cvt_pk_bf16_f32 v235, v38, v39
    v_mfma_f32_16x16x32_bf16 v[8:11], v[172:175], a[24:27], v[8:11]
    s_add_u32 s41, s40, 4096
    buffer_store_dwordx4 v[232:235], v244, s[20:23], s41 offen offset:0 sc1
    v_mfma_f32_16x16x32_bf16 v[8:11], v[176:179], a[40:43], v[8:11]
    buffer_load_dwordx4 v[164:167], v241, s[20:23], s58 offen offset:0 sc1
    v_mfma_f32_16x16x32_bf16 v[12:15], v[176:179], a[44:47], 0
    v_cvt_pk_bf16_f32 v236, v40, v41
    v_cvt_pk_bf16_f32 v237, v42, v43
    v_mfma_f32_16x16x32_bf16 v[12:15], v[172:175], a[28:31], v[12:15]
    s_add_u32 s58, s77, 1646592
    v_cvt_pk_bf16_f32 v238, v44, v45
    v_cvt_pk_bf16_f32 v239, v46, v47
    v_mfma_f32_16x16x32_bf16 v[12:15], v[168:171], a[12:15], v[12:15]
    s_waitcnt vmcnt(23)
    buffer_store_dwordx4 v[236:239], v250, s[20:23], s41 offen offset:1024 sc1
    v_mfma_f32_16x16x32_bf16 v[0:3], v[180:183], a[48:51], v[0:3]
    buffer_load_dwordx4 v[168:171], v241, s[20:23], s58 offen offset:0 sc1
    v_mfma_f32_16x16x32_bf16 v[0:3], v[184:187], a[64:67], v[0:3]
    s_mov_b64 exec, s[54:55]
    ds_write_b128 v243, v[32:35] offset:1024
    s_mov_b64 exec, -1
    v_mfma_f32_16x16x32_bf16 v[0:3], v[188:191], a[80:83], v[0:3]
    s_add_u32 s58, s77, 1650688
    s_mov_b64 exec, s[54:55]
    ds_write_b128 v243, v[36:39] offset:1280
    s_mov_b64 exec, -1
    v_mfma_f32_16x16x32_bf16 v[4:7], v[188:191], a[84:87], v[4:7]
    v_mfma_f32_16x16x32_bf16 v[4:7], v[184:187], a[68:71], v[4:7]
    buffer_load_dwordx4 v[172:175], v241, s[20:23], s58 offen offset:0 sc1
    v_mfma_f32_16x16x32_bf16 v[4:7], v[180:183], a[52:55], v[4:7]
    v_mfma_f32_16x16x32_bf16 v[8:11], v[180:183], a[56:59], v[8:11]
    s_add_u32 s58, s77, 1654784
    v_mfma_f32_16x16x32_bf16 v[8:11], v[184:187], a[72:75], v[8:11]
    v_mfma_f32_16x16x32_bf16 v[8:11], v[188:191], a[88:91], v[8:11]
    buffer_load_dwordx4 v[176:179], v241, s[20:23], s58 offen offset:0 sc1
    v_mfma_f32_16x16x32_bf16 v[12:15], v[188:191], a[92:95], v[12:15]
    v_mfma_f32_16x16x32_bf16 v[12:15], v[184:187], a[76:79], v[12:15]
    s_add_u32 s58, s77, 1658880
    v_mfma_f32_16x16x32_bf16 v[12:15], v[180:183], a[60:63], v[12:15]
    s_waitcnt vmcnt(22)
    v_mfma_f32_16x16x32_bf16 v[0:3], v[192:195], a[96:99], v[0:3]
    buffer_load_dwordx4 v[180:183], v241, s[20:23], s58 offen offset:0 sc1
    v_mfma_f32_16x16x32_bf16 v[0:3], v[196:199], a[112:115], v[0:3]
    v_mfma_f32_16x16x32_bf16 v[0:3], v[200:203], a[128:131], v[0:3]
    s_add_u32 s58, s77, 1662976
    v_mfma_f32_16x16x32_bf16 v[4:7], v[200:203], a[132:135], v[4:7]
    v_mfma_f32_16x16x32_bf16 v[4:7], v[196:199], a[116:119], v[4:7]
    buffer_load_dwordx4 v[184:187], v241, s[20:23], s58 offen offset:0 sc1
    v_mfma_f32_16x16x32_bf16 v[4:7], v[192:195], a[100:103], v[4:7]
    v_mfma_f32_16x16x32_bf16 v[8:11], v[192:195], a[104:107], v[8:11]
    s_add_u32 s58, s77, 1667072
    v_mfma_f32_16x16x32_bf16 v[8:11], v[196:199], a[120:123], v[8:11]
    v_mfma_f32_16x16x32_bf16 v[8:11], v[200:203], a[136:139], v[8:11]
    buffer_load_dwordx4 v[188:191], v241, s[20:23], s58 offen offset:0 sc1
    v_mfma_f32_16x16x32_bf16 v[12:15], v[200:203], a[140:143], v[12:15]
    v_mfma_f32_16x16x32_bf16 v[12:15], v[196:199], a[124:127], v[12:15]
    s_add_u32 s58, s77, 1671168
    v_mfma_f32_16x16x32_bf16 v[12:15], v[192:195], a[108:111], v[12:15]
    s_waitcnt vmcnt(22)
    v_mfma_f32_16x16x32_bf16 v[0:3], v[204:207], a[144:147], v[0:3]
    buffer_load_dwordx4 v[192:195], v241, s[20:23], s58 offen offset:0 sc1
    v_mfma_f32_16x16x32_bf16 v[0:3], v[208:211], a[160:163], v[0:3]
    v_mfma_f32_16x16x32_bf16 v[0:3], v[212:215], a[176:179], v[0:3]
    s_add_u32 s58, s77, 1675264
    v_mfma_f32_16x16x32_bf16 v[4:7], v[212:215], a[180:183], v[4:7]
    v_mfma_f32_16x16x32_bf16 v[4:7], v[208:211], a[164:167], v[4:7]
    buffer_load_dwordx4 v[196:199], v241, s[20:23], s58 offen offset:0 sc1
    v_mfma_f32_16x16x32_bf16 v[4:7], v[204:207], a[148:151], v[4:7]
    v_mfma_f32_16x16x32_bf16 v[8:11], v[204:207], a[152:155], v[8:11]
    s_add_u32 s58, s77, 1679360
    v_mfma_f32_16x16x32_bf16 v[8:11], v[208:211], a[168:171], v[8:11]
    v_mfma_f32_16x16x32_bf16 v[8:11], v[212:215], a[184:187], v[8:11]
    buffer_load_dwordx4 v[200:203], v241, s[20:23], s58 offen offset:0 sc1
    v_mfma_f32_16x16x32_bf16 v[12:15], v[212:215], a[188:191], v[12:15]
    v_mfma_f32_16x16x32_bf16 v[12:15], v[208:211], a[172:175], v[12:15]
    s_add_u32 s58, s77, 1683456
    v_mfma_f32_16x16x32_bf16 v[12:15], v[204:207], a[156:159], v[12:15]
    s_waitcnt vmcnt(21)
    v_mfma_f32_16x16x32_bf16 v[0:3], v[216:219], a[192:195], v[0:3]
    buffer_load_dwordx4 v[204:207], v241, s[20:23], s58 offen offset:0 sc1
    v_mfma_f32_16x16x32_bf16 v[0:3], v[220:223], a[208:211], v[0:3]
    v_mfma_f32_16x16x32_bf16 v[0:3], v[128:131], a[224:227], v[0:3]
    s_add_u32 s58, s77, 1687552
    v_mfma_f32_16x16x32_bf16 v[4:7], v[128:131], a[228:231], v[4:7]
    v_mfma_f32_16x16x32_bf16 v[4:7], v[220:223], a[212:215], v[4:7]
    buffer_load_dwordx4 v[208:211], v241, s[20:23], s58 offen offset:0 sc1
    v_mfma_f32_16x16x32_bf16 v[4:7], v[216:219], a[196:199], v[4:7]
    v_mfma_f32_16x16x32_bf16 v[8:11], v[216:219], a[200:203], v[8:11]
    s_add_u32 s58, s77, 1691648
    v_mfma_f32_16x16x32_bf16 v[8:11], v[220:223], a[216:219], v[8:11]
    v_mfma_f32_16x16x32_bf16 v[8:11], v[128:131], a[232:235], v[8:11]
    buffer_load_dwordx4 v[212:215], v241, s[20:23], s58 offen offset:0 sc1
    v_mfma_f32_16x16x32_bf16 v[12:15], v[128:131], a[236:239], v[12:15]
    v_mfma_f32_16x16x32_bf16 v[12:15], v[220:223], a[220:223], v[12:15]
    s_add_u32 s58, s77, 1695744
    v_mfma_f32_16x16x32_bf16 v[12:15], v[216:219], a[204:207], v[12:15]
    s_waitcnt vmcnt(20)
    v_mfma_f32_16x16x32_bf16 v[0:3], v[132:135], a[240:243], v[0:3]
    buffer_load_dwordx4 v[216:219], v241, s[20:23], s58 offen offset:0 sc1
    v_mfma_f32_16x16x32_bf16 v[0:3], v[136:139], v[96:99], v[0:3]
    v_mfma_f32_16x16x32_bf16 v[0:3], v[140:143], v[112:115], v[0:3]
    s_add_u32 s58, s77, 1699840
    v_mfma_f32_16x16x32_bf16 v[4:7], v[140:143], v[116:119], v[4:7]
    v_mfma_f32_16x16x32_bf16 v[4:7], v[136:139], v[100:103], v[4:7]
    buffer_load_dwordx4 v[220:223], v241, s[20:23], s58 offen offset:0 sc1
    v_mfma_f32_16x16x32_bf16 v[4:7], v[132:135], a[244:247], v[4:7]
    v_mfma_f32_16x16x32_bf16 v[8:11], v[132:135], a[248:251], v[8:11]
    s_add_u32 s58, s77, 1703936
    v_mfma_f32_16x16x32_bf16 v[8:11], v[136:139], v[104:107], v[8:11]
    v_mfma_f32_16x16x32_bf16 v[8:11], v[140:143], v[120:123], v[8:11]
    buffer_load_dwordx4 v[128:131], v241, s[20:23], s58 offen offset:0 sc1
    v_mfma_f32_16x16x32_bf16 v[12:15], v[140:143], v[124:127], v[12:15]
    v_mfma_f32_16x16x32_bf16 v[12:15], v[136:139], v[108:111], v[12:15]
    s_add_u32 s58, s77, 1708032
    v_mfma_f32_16x16x32_bf16 v[12:15], v[132:135], a[252:255], v[12:15]
    s_waitcnt vmcnt(20)
    v_mfma_f32_16x16x32_bf16 v[16:19], v[144:147], a[0:3], 0
    buffer_load_dwordx4 v[132:135], v241, s[20:23], s58 offen offset:0 sc1
    v_mfma_f32_16x16x32_bf16 v[16:19], v[148:151], a[16:19], v[16:19]
    v_mfma_f32_16x16x32_bf16 v[16:19], v[152:155], a[32:35], v[16:19]
    s_add_u32 s58, s77, 1712128
    v_mfma_f32_16x16x32_bf16 v[20:23], v[152:155], a[36:39], 0
    v_mfma_f32_16x16x32_bf16 v[20:23], v[148:151], a[20:23], v[20:23]
    buffer_load_dwordx4 v[136:139], v241, s[20:23], s58 offen offset:0 sc1
    v_mfma_f32_16x16x32_bf16 v[20:23], v[144:147], a[4:7], v[20:23]
    v_cvt_pk_bf16_f32 v232, v0, v1
    v_cvt_pk_bf16_f32 v233, v2, v3
    v_mfma_f32_16x16x32_bf16 v[24:27], v[144:147], a[8:11], 0
    s_add_u32 s58, s77, 1716224
    v_cvt_pk_bf16_f32 v234, v4, v5
    v_cvt_pk_bf16_f32 v235, v6, v7
    v_mfma_f32_16x16x32_bf16 v[24:27], v[148:151], a[24:27], v[24:27]
    s_add_u32 s41, s40, 6144
    buffer_store_dwordx4 v[232:235], v244, s[20:23], s41 offen offset:0 sc1
    v_mfma_f32_16x16x32_bf16 v[24:27], v[152:155], a[40:43], v[24:27]
    buffer_load_dwordx4 v[140:143], v241, s[20:23], s58 offen offset:0 sc1
    v_mfma_f32_16x16x32_bf16 v[28:31], v[152:155], a[44:47], 0
    v_cvt_pk_bf16_f32 v236, v8, v9
    v_cvt_pk_bf16_f32 v237, v10, v11
    v_mfma_f32_16x16x32_bf16 v[28:31], v[148:151], a[28:31], v[28:31]
    s_add_u32 s58, s77, 1720320
    v_cvt_pk_bf16_f32 v238, v12, v13
    v_cvt_pk_bf16_f32 v239, v14, v15
    v_mfma_f32_16x16x32_bf16 v[28:31], v[144:147], a[12:15], v[28:31]
    s_waitcnt vmcnt(20)
    buffer_store_dwordx4 v[236:239], v250, s[20:23], s41 offen offset:1024 sc1
    v_mfma_f32_16x16x32_bf16 v[16:19], v[156:159], a[48:51], v[16:19]
    buffer_load_dwordx4 v[144:147], v241, s[20:23], s58 offen offset:0 sc1
    v_mfma_f32_16x16x32_bf16 v[16:19], v[160:163], a[64:67], v[16:19]
    s_mov_b64 exec, s[54:55]
    ds_write_b128 v243, v[0:3] offset:1536
    s_mov_b64 exec, -1
    v_mfma_f32_16x16x32_bf16 v[16:19], v[164:167], a[80:83], v[16:19]
    s_add_u32 s58, s77, 1724416
    s_mov_b64 exec, s[54:55]
    ds_write_b128 v243, v[4:7] offset:1792
    s_mov_b64 exec, -1
    v_mfma_f32_16x16x32_bf16 v[20:23], v[164:167], a[84:87], v[20:23]
    v_mfma_f32_16x16x32_bf16 v[20:23], v[160:163], a[68:71], v[20:23]
    buffer_load_dwordx4 v[148:151], v241, s[20:23], s58 offen offset:0 sc1
    v_mfma_f32_16x16x32_bf16 v[20:23], v[156:159], a[52:55], v[20:23]
    v_mfma_f32_16x16x32_bf16 v[24:27], v[156:159], a[56:59], v[24:27]
    s_add_u32 s58, s77, 1728512
    v_mfma_f32_16x16x32_bf16 v[24:27], v[160:163], a[72:75], v[24:27]
    v_mfma_f32_16x16x32_bf16 v[24:27], v[164:167], a[88:91], v[24:27]
    buffer_load_dwordx4 v[152:155], v241, s[20:23], s58 offen offset:0 sc1
    v_mfma_f32_16x16x32_bf16 v[28:31], v[164:167], a[92:95], v[28:31]
    v_mfma_f32_16x16x32_bf16 v[28:31], v[160:163], a[76:79], v[28:31]
    s_add_u32 s58, s77, 1732608
    v_mfma_f32_16x16x32_bf16 v[28:31], v[156:159], a[60:63], v[28:31]
    s_waitcnt vmcnt(20)
    v_mfma_f32_16x16x32_bf16 v[16:19], v[168:171], a[96:99], v[16:19]
    buffer_load_dwordx4 v[156:159], v241, s[20:23], s58 offen offset:0 sc1
    v_mfma_f32_16x16x32_bf16 v[16:19], v[172:175], a[112:115], v[16:19]
    v_mfma_f32_16x16x32_bf16 v[16:19], v[176:179], a[128:131], v[16:19]
    s_add_u32 s58, s77, 1736704
    v_mfma_f32_16x16x32_bf16 v[20:23], v[176:179], a[132:135], v[20:23]
    v_mfma_f32_16x16x32_bf16 v[20:23], v[172:175], a[116:119], v[20:23]
    buffer_load_dwordx4 v[160:163], v241, s[20:23], s58 offen offset:0 sc1
    v_mfma_f32_16x16x32_bf16 v[20:23], v[168:171], a[100:103], v[20:23]
    v_mfma_f32_16x16x32_bf16 v[24:27], v[168:171], a[104:107], v[24:27]
    s_add_u32 s58, s77, 1740800
    v_mfma_f32_16x16x32_bf16 v[24:27], v[172:175], a[120:123], v[24:27]
    v_mfma_f32_16x16x32_bf16 v[24:27], v[176:179], a[136:139], v[24:27]
    buffer_load_dwordx4 v[164:167], v241, s[20:23], s58 offen offset:0 sc1
    v_mfma_f32_16x16x32_bf16 v[28:31], v[176:179], a[140:143], v[28:31]
    v_mfma_f32_16x16x32_bf16 v[28:31], v[172:175], a[124:127], v[28:31]
    s_add_u32 s58, s77, 1744896
    v_mfma_f32_16x16x32_bf16 v[28:31], v[168:171], a[108:111], v[28:31]
    s_waitcnt vmcnt(20)
    v_mfma_f32_16x16x32_bf16 v[16:19], v[180:183], a[144:147], v[16:19]
    buffer_load_dwordx4 v[168:171], v241, s[20:23], s58 offen offset:0 sc1
    v_mfma_f32_16x16x32_bf16 v[16:19], v[184:187], a[160:163], v[16:19]
    v_mfma_f32_16x16x32_bf16 v[16:19], v[188:191], a[176:179], v[16:19]
    s_add_u32 s58, s77, 1748992
    v_mfma_f32_16x16x32_bf16 v[20:23], v[188:191], a[180:183], v[20:23]
    v_mfma_f32_16x16x32_bf16 v[20:23], v[184:187], a[164:167], v[20:23]
    buffer_load_dwordx4 v[172:175], v241, s[20:23], s58 offen offset:0 sc1
    v_mfma_f32_16x16x32_bf16 v[20:23], v[180:183], a[148:151], v[20:23]
    v_mfma_f32_16x16x32_bf16 v[24:27], v[180:183], a[152:155], v[24:27]
    s_add_u32 s58, s77, 1753088
    v_mfma_f32_16x16x32_bf16 v[24:27], v[184:187], a[168:171], v[24:27]
    v_mfma_f32_16x16x32_bf16 v[24:27], v[188:191], a[184:187], v[24:27]
    buffer_load_dwordx4 v[176:179], v241, s[20:23], s58 offen offset:0 sc1
    v_mfma_f32_16x16x32_bf16 v[28:31], v[188:191], a[188:191], v[28:31]
    v_mfma_f32_16x16x32_bf16 v[28:31], v[184:187], a[172:175], v[28:31]
    s_add_u32 s58, s77, 1757184
    v_mfma_f32_16x16x32_bf16 v[28:31], v[180:183], a[156:159], v[28:31]
    s_waitcnt vmcnt(20)
    v_mfma_f32_16x16x32_bf16 v[16:19], v[192:195], a[192:195], v[16:19]
    buffer_load_dwordx4 v[180:183], v241, s[20:23], s58 offen offset:0 sc1
    v_mfma_f32_16x16x32_bf16 v[16:19], v[196:199], a[208:211], v[16:19]
    v_mfma_f32_16x16x32_bf16 v[16:19], v[200:203], a[224:227], v[16:19]
    s_add_u32 s58, s77, 1761280
    v_mfma_f32_16x16x32_bf16 v[20:23], v[200:203], a[228:231], v[20:23]
    v_mfma_f32_16x16x32_bf16 v[20:23], v[196:199], a[212:215], v[20:23]
    buffer_load_dwordx4 v[184:187], v241, s[20:23], s58 offen offset:0 sc1
    v_mfma_f32_16x16x32_bf16 v[20:23], v[192:195], a[196:199], v[20:23]
    v_mfma_f32_16x16x32_bf16 v[24:27], v[192:195], a[200:203], v[24:27]
    s_add_u32 s58, s77, 1765376
    v_mfma_f32_16x16x32_bf16 v[24:27], v[196:199], a[216:219], v[24:27]
    v_mfma_f32_16x16x32_bf16 v[24:27], v[200:203], a[232:235], v[24:27]
    buffer_load_dwordx4 v[188:191], v241, s[20:23], s58 offen offset:0 sc1
    v_mfma_f32_16x16x32_bf16 v[28:31], v[200:203], a[236:239], v[28:31]
    v_mfma_f32_16x16x32_bf16 v[28:31], v[196:199], a[220:223], v[28:31]
    s_add_u32 s58, s78, 1769472
    v_mfma_f32_16x16x32_bf16 v[28:31], v[192:195], a[204:207], v[28:31]
    s_waitcnt vmcnt(20)
    v_mfma_f32_16x16x32_bf16 v[16:19], v[204:207], a[240:243], v[16:19]
    buffer_load_dwordx4 v[192:195], v241, s[20:23], s58 offen offset:0 sc1
    v_mfma_f32_16x16x32_bf16 v[16:19], v[208:211], v[96:99], v[16:19]
    v_mfma_f32_16x16x32_bf16 v[16:19], v[212:215], v[112:115], v[16:19]
    s_add_u32 s58, s78, 1773568
    v_mfma_f32_16x16x32_bf16 v[20:23], v[212:215], v[116:119], v[20:23]
    v_mfma_f32_16x16x32_bf16 v[20:23], v[208:211], v[100:103], v[20:23]
    buffer_load_dwordx4 v[196:199], v241, s[20:23], s58 offen offset:0 sc1
    v_mfma_f32_16x16x32_bf16 v[20:23], v[204:207], a[244:247], v[20:23]
    v_mfma_f32_16x16x32_bf16 v[24:27], v[204:207], a[248:251], v[24:27]
    s_add_u32 s58, s78, 1777664
    v_mfma_f32_16x16x32_bf16 v[24:27], v[208:211], v[104:107], v[24:27]
    v_mfma_f32_16x16x32_bf16 v[24:27], v[212:215], v[120:123], v[24:27]
    buffer_load_dwordx4 v[200:203], v241, s[20:23], s58 offen offset:0 sc1
    v_mfma_f32_16x16x32_bf16 v[28:31], v[212:215], v[124:127], v[28:31]
    v_mfma_f32_16x16x32_bf16 v[28:31], v[208:211], v[108:111], v[28:31]
    s_add_u32 s58, s78, 1781760
    v_mfma_f32_16x16x32_bf16 v[28:31], v[204:207], a[252:255], v[28:31]
    s_waitcnt vmcnt(20)
    v_mfma_f32_16x16x32_bf16 v[0:3], v[216:219], a[0:3], 0
    buffer_load_dwordx4 v[204:207], v241, s[20:23], s58 offen offset:0 sc1
    v_mfma_f32_16x16x32_bf16 v[0:3], v[220:223], a[16:19], v[0:3]
    v_mfma_f32_16x16x32_bf16 v[0:3], v[128:131], a[32:35], v[0:3]
    s_add_u32 s58, s78, 1785856
    v_mfma_f32_16x16x32_bf16 v[4:7], v[128:131], a[36:39], 0
    v_mfma_f32_16x16x32_bf16 v[4:7], v[220:223], a[20:23], v[4:7]
    buffer_load_dwordx4 v[208:211], v241, s[20:23], s58 offen offset:0 sc1
    v_mfma_f32_16x16x32_bf16 v[4:7], v[216:219], a[4:7], v[4:7]
    v_cvt_pk_bf16_f32 v232, v16, v17
    v_cvt_pk_bf16_f32 v233, v18, v19
    v_mfma_f32_16x16x32_bf16 v[8:11], v[216:219], a[8:11], 0
    s_add_u32 s58, s78, 1789952
    v_cvt_pk_bf16_f32 v234, v20, v21
    v_cvt_pk_bf16_f32 v235, v22, v23
    v_mfma_f32_16x16x32_bf16 v[8:11], v[220:223], a[24:27], v[8:11]
    s_add_u32 s41, s40, 8192
    buffer_store_dwordx4 v[232:235], v244, s[20:23], s41 offen offset:0 sc1
    v_mfma_f32_16x16x32_bf16 v[8:11], v[128:131], a[40:43], v[8:11]
    buffer_load_dwordx4 v[212:215], v241, s[20:23], s58 offen offset:0 sc1
    v_mfma_f32_16x16x32_bf16 v[12:15], v[128:131], a[44:47], 0
    v_cvt_pk_bf16_f32 v236, v24, v25
    v_cvt_pk_bf16_f32 v237, v26, v27
    v_mfma_f32_16x16x32_bf16 v[12:15], v[220:223], a[28:31], v[12:15]
    s_add_u32 s58, s78, 1794048
    v_cvt_pk_bf16_f32 v238, v28, v29
    v_cvt_pk_bf16_f32 v239, v30, v31
    v_mfma_f32_16x16x32_bf16 v[12:15], v[216:219], a[12:15], v[12:15]
    s_waitcnt vmcnt(20)
    buffer_store_dwordx4 v[236:239], v250, s[20:23], s41 offen offset:1024 sc1
    v_mfma_f32_16x16x32_bf16 v[0:3], v[132:135], a[48:51], v[0:3]
    buffer_load_dwordx4 v[216:219], v241, s[20:23], s58 offen offset:0 sc1
    v_mfma_f32_16x16x32_bf16 v[0:3], v[136:139], a[64:67], v[0:3]
    s_mov_b64 exec, s[54:55]
    ds_write_b128 v243, v[16:19] offset:2048
    s_mov_b64 exec, -1
    v_mfma_f32_16x16x32_bf16 v[0:3], v[140:143], a[80:83], v[0:3]
    s_add_u32 s58, s78, 1798144
    s_mov_b64 exec, s[54:55]
    ds_write_b128 v243, v[20:23] offset:2304
    s_mov_b64 exec, -1
    v_mfma_f32_16x16x32_bf16 v[4:7], v[140:143], a[84:87], v[4:7]
    s_add_u32 s0, s1, 0
    s_waitcnt vmcnt(21)
    v_mov_b32 v253, s0
    s_mov_b32 exec_hi, 0
    buffer_store_dword v253, v255, s[20:23], s50 offen sc1
    s_mov_b64 exec, -1
    v_mfma_f32_16x16x32_bf16 v[4:7], v[136:139], a[68:71], v[4:7]
    buffer_load_dwordx4 v[220:223], v241, s[20:23], s58 offen offset:0 sc1
    v_mfma_f32_16x16x32_bf16 v[4:7], v[132:135], a[52:55], v[4:7]
    v_mfma_f32_16x16x32_bf16 v[8:11], v[132:135], a[56:59], v[8:11]
    s_add_u32 s58, s78, 1802240
    v_mfma_f32_16x16x32_bf16 v[8:11], v[136:139], a[72:75], v[8:11]
    v_mfma_f32_16x16x32_bf16 v[8:11], v[140:143], a[88:91], v[8:11]
    buffer_load_dwordx4 v[128:131], v241, s[20:23], s58 offen offset:0 sc1
    v_mfma_f32_16x16x32_bf16 v[12:15], v[140:143], a[92:95], v[12:15]
    v_mfma_f32_16x16x32_bf16 v[12:15], v[136:139], a[76:79], v[12:15]
    s_add_u32 s58, s78, 1806336
    v_mfma_f32_16x16x32_bf16 v[12:15], v[132:135], a[60:63], v[12:15]
    s_waitcnt vmcnt(21)
    v_mfma_f32_16x16x32_bf16 v[0:3], v[144:147], a[96:99], v[0:3]
    buffer_load_dwordx4 v[132:135], v241, s[20:23], s58 offen offset:0 sc1
    v_mfma_f32_16x16x32_bf16 v[0:3], v[148:151], a[112:115], v[0:3]
    v_mfma_f32_16x16x32_bf16 v[0:3], v[152:155], a[128:131], v[0:3]
    s_add_u32 s58, s78, 1810432
    v_mfma_f32_16x16x32_bf16 v[4:7], v[152:155], a[132:135], v[4:7]
    v_mfma_f32_16x16x32_bf16 v[4:7], v[148:151], a[116:119], v[4:7]
    buffer_load_dwordx4 v[136:139], v241, s[20:23], s58 offen offset:0 sc1
    v_mfma_f32_16x16x32_bf16 v[4:7], v[144:147], a[100:103], v[4:7]
    v_mfma_f32_16x16x32_bf16 v[8:11], v[144:147], a[104:107], v[8:11]
    s_add_u32 s58, s78, 1814528
    v_mfma_f32_16x16x32_bf16 v[8:11], v[148:151], a[120:123], v[8:11]
    v_mfma_f32_16x16x32_bf16 v[8:11], v[152:155], a[136:139], v[8:11]
    buffer_load_dwordx4 v[140:143], v241, s[20:23], s58 offen offset:0 sc1
    v_mfma_f32_16x16x32_bf16 v[12:15], v[152:155], a[140:143], v[12:15]
    v_mfma_f32_16x16x32_bf16 v[12:15], v[148:151], a[124:127], v[12:15]
    s_add_u32 s58, s78, 1818624
    v_mfma_f32_16x16x32_bf16 v[12:15], v[144:147], a[108:111], v[12:15]
    s_waitcnt vmcnt(21)
    v_mfma_f32_16x16x32_bf16 v[0:3], v[156:159], a[144:147], v[0:3]
    buffer_load_dwordx4 v[144:147], v241, s[20:23], s58 offen offset:0 sc1
    v_mfma_f32_16x16x32_bf16 v[0:3], v[160:163], a[160:163], v[0:3]
    v_mfma_f32_16x16x32_bf16 v[0:3], v[164:167], a[176:179], v[0:3]
    s_add_u32 s58, s78, 1822720
    v_mfma_f32_16x16x32_bf16 v[4:7], v[164:167], a[180:183], v[4:7]
    v_mfma_f32_16x16x32_bf16 v[4:7], v[160:163], a[164:167], v[4:7]
    buffer_load_dwordx4 v[148:151], v241, s[20:23], s58 offen offset:0 sc1
    v_mfma_f32_16x16x32_bf16 v[4:7], v[156:159], a[148:151], v[4:7]
    v_mfma_f32_16x16x32_bf16 v[8:11], v[156:159], a[152:155], v[8:11]
    s_add_u32 s58, s78, 1826816
    v_mfma_f32_16x16x32_bf16 v[8:11], v[160:163], a[168:171], v[8:11]
    v_mfma_f32_16x16x32_bf16 v[8:11], v[164:167], a[184:187], v[8:11]
    buffer_load_dwordx4 v[152:155], v241, s[20:23], s58 offen offset:0 sc1
    v_mfma_f32_16x16x32_bf16 v[12:15], v[164:167], a[188:191], v[12:15]
    v_mfma_f32_16x16x32_bf16 v[12:15], v[160:163], a[172:175], v[12:15]
    s_add_u32 s58, s78, 1830912
    v_mfma_f32_16x16x32_bf16 v[12:15], v[156:159], a[156:159], v[12:15]
    s_waitcnt vmcnt(21)
    v_mfma_f32_16x16x32_bf16 v[0:3], v[168:171], a[192:195], v[0:3]
    buffer_load_dwordx4 v[156:159], v241, s[20:23], s58 offen offset:0 sc1
    v_mfma_f32_16x16x32_bf16 v[0:3], v[172:175], a[208:211], v[0:3]
    v_mfma_f32_16x16x32_bf16 v[0:3], v[176:179], a[224:227], v[0:3]
    s_add_u32 s58, s78, 1835008
    v_mfma_f32_16x16x32_bf16 v[4:7], v[176:179], a[228:231], v[4:7]
    v_mfma_f32_16x16x32_bf16 v[4:7], v[172:175], a[212:215], v[4:7]
    buffer_load_dwordx4 v[160:163], v241, s[20:23], s58 offen offset:0 sc1
    v_mfma_f32_16x16x32_bf16 v[4:7], v[168:171], a[196:199], v[4:7]
    v_mfma_f32_16x16x32_bf16 v[8:11], v[168:171], a[200:203], v[8:11]
    s_add_u32 s58, s78, 1839104
    v_mfma_f32_16x16x32_bf16 v[8:11], v[172:175], a[216:219], v[8:11]
    v_mfma_f32_16x16x32_bf16 v[8:11], v[176:179], a[232:235], v[8:11]
    buffer_load_dwordx4 v[164:167], v241, s[20:23], s58 offen offset:0 sc1
    v_mfma_f32_16x16x32_bf16 v[12:15], v[176:179], a[236:239], v[12:15]
    v_mfma_f32_16x16x32_bf16 v[12:15], v[172:175], a[220:223], v[12:15]
    s_add_u32 s58, s78, 1843200
    v_mfma_f32_16x16x32_bf16 v[12:15], v[168:171], a[204:207], v[12:15]
    s_waitcnt vmcnt(21)
    v_mfma_f32_16x16x32_bf16 v[0:3], v[180:183], a[240:243], v[0:3]
    buffer_load_dwordx4 v[168:171], v241, s[20:23], s58 offen offset:0 sc1
    v_mfma_f32_16x16x32_bf16 v[0:3], v[184:187], v[96:99], v[0:3]
    v_mfma_f32_16x16x32_bf16 v[0:3], v[188:191], v[112:115], v[0:3]
    s_add_u32 s58, s78, 1847296
    v_mfma_f32_16x16x32_bf16 v[4:7], v[188:191], v[116:119], v[4:7]
    v_mfma_f32_16x16x32_bf16 v[4:7], v[184:187], v[100:103], v[4:7]
    buffer_load_dwordx4 v[172:175], v241, s[20:23], s58 offen offset:0 sc1
    v_mfma_f32_16x16x32_bf16 v[4:7], v[180:183], a[244:247], v[4:7]
    v_mfma_f32_16x16x32_bf16 v[8:11], v[180:183], a[248:251], v[8:11]
    s_add_u32 s58, s78, 1851392
    v_mfma_f32_16x16x32_bf16 v[8:11], v[184:187], v[104:107], v[8:11]
    v_mfma_f32_16x16x32_bf16 v[8:11], v[188:191], v[120:123], v[8:11]
    buffer_load_dwordx4 v[176:179], v241, s[20:23], s58 offen offset:0 sc1
    v_mfma_f32_16x16x32_bf16 v[12:15], v[188:191], v[124:127], v[12:15]
    v_mfma_f32_16x16x32_bf16 v[12:15], v[184:187], v[108:111], v[12:15]
    s_add_u32 s58, s78, 1855488
    v_mfma_f32_16x16x32_bf16 v[12:15], v[180:183], a[252:255], v[12:15]
    s_waitcnt vmcnt(21)
    v_mfma_f32_16x16x32_bf16 v[16:19], v[192:195], a[0:3], 0
    buffer_load_dwordx4 v[180:183], v241, s[20:23], s58 offen offset:0 sc1
    v_mfma_f32_16x16x32_bf16 v[16:19], v[196:199], a[16:19], v[16:19]
    v_mfma_f32_16x16x32_bf16 v[16:19], v[200:203], a[32:35], v[16:19]
    s_add_u32 s58, s78, 1859584
    v_mfma_f32_16x16x32_bf16 v[20:23], v[200:203], a[36:39], 0
    v_mfma_f32_16x16x32_bf16 v[20:23], v[196:199], a[20:23], v[20:23]
    buffer_load_dwordx4 v[184:187], v241, s[20:23], s58 offen offset:0 sc1
    v_mfma_f32_16x16x32_bf16 v[20:23], v[192:195], a[4:7], v[20:23]
    v_cvt_pk_bf16_f32 v232, v0, v1
    v_cvt_pk_bf16_f32 v233, v2, v3
    v_mfma_f32_16x16x32_bf16 v[24:27], v[192:195], a[8:11], 0
    s_add_u32 s58, s78, 1863680
    v_cvt_pk_bf16_f32 v234, v4, v5
    v_cvt_pk_bf16_f32 v235, v6, v7
    v_mfma_f32_16x16x32_bf16 v[24:27], v[196:199], a[24:27], v[24:27]
    s_add_u32 s41, s40, 10240
    buffer_store_dwordx4 v[232:235], v244, s[20:23], s41 offen offset:0 sc1
    v_mfma_f32_16x16x32_bf16 v[24:27], v[200:203], a[40:43], v[24:27]
    buffer_load_dwordx4 v[188:191], v241, s[20:23], s58 offen offset:0 sc1
    v_mfma_f32_16x16x32_bf16 v[28:31], v[200:203], a[44:47], 0
    v_cvt_pk_bf16_f32 v236, v8, v9
    v_cvt_pk_bf16_f32 v237, v10, v11
    v_mfma_f32_16x16x32_bf16 v[28:31], v[196:199], a[28:31], v[28:31]
    s_add_u32 s58, s78, 1867776
    v_cvt_pk_bf16_f32 v238, v12, v13
    v_cvt_pk_bf16_f32 v239, v14, v15
    v_mfma_f32_16x16x32_bf16 v[28:31], v[192:195], a[12:15], v[28:31]
    s_waitcnt vmcnt(21)
    buffer_store_dwordx4 v[236:239], v250, s[20:23], s41 offen offset:1024 sc1
    v_mfma_f32_16x16x32_bf16 v[16:19], v[204:207], a[48:51], v[16:19]
    buffer_load_dwordx4 v[192:195], v241, s[20:23], s58 offen offset:0 sc1
    v_mfma_f32_16x16x32_bf16 v[16:19], v[208:211], a[64:67], v[16:19]
    s_mov_b64 exec, s[54:55]
    ds_write_b128 v243, v[0:3] offset:2560
    s_mov_b64 exec, -1
    v_mfma_f32_16x16x32_bf16 v[16:19], v[212:215], a[80:83], v[16:19]
    s_add_u32 s58, s78, 1871872
    s_mov_b64 exec, s[54:55]
    ds_write_b128 v243, v[4:7] offset:2816
    s_mov_b64 exec, -1
    v_mfma_f32_16x16x32_bf16 v[20:23], v[212:215], a[84:87], v[20:23]
    buffer_load_dword v252, v247, s[20:23], s52 offen sc1
    v_mfma_f32_16x16x32_bf16 v[20:23], v[208:211], a[68:71], v[20:23]
    buffer_load_dwordx4 v[196:199], v241, s[20:23], s58 offen offset:0 sc1
    v_mfma_f32_16x16x32_bf16 v[20:23], v[204:207], a[52:55], v[20:23]
    v_mfma_f32_16x16x32_bf16 v[24:27], v[204:207], a[56:59], v[24:27]
    s_add_u32 s58, s78, 1875968
    v_mfma_f32_16x16x32_bf16 v[24:27], v[208:211], a[72:75], v[24:27]
    v_mfma_f32_16x16x32_bf16 v[24:27], v[212:215], a[88:91], v[24:27]
    buffer_load_dwordx4 v[200:203], v241, s[20:23], s58 offen offset:0 sc1
    v_mfma_f32_16x16x32_bf16 v[28:31], v[212:215], a[92:95], v[28:31]
    v_mfma_f32_16x16x32_bf16 v[28:31], v[208:211], a[76:79], v[28:31]
    s_add_u32 s58, s78, 1880064
    v_mfma_f32_16x16x32_bf16 v[28:31], v[204:207], a[60:63], v[28:31]
    s_waitcnt vmcnt(21)
    v_mfma_f32_16x16x32_bf16 v[16:19], v[216:219], a[96:99], v[16:19]
    buffer_load_dwordx4 v[204:207], v241, s[20:23], s58 offen offset:0 sc1
    v_mfma_f32_16x16x32_bf16 v[16:19], v[220:223], a[112:115], v[16:19]
    v_mfma_f32_16x16x32_bf16 v[16:19], v[128:131], a[128:131], v[16:19]
    s_add_u32 s58, s78, 1884160
    v_mfma_f32_16x16x32_bf16 v[20:23], v[128:131], a[132:135], v[20:23]
    v_mfma_f32_16x16x32_bf16 v[20:23], v[220:223], a[116:119], v[20:23]
    buffer_load_dwordx4 v[208:211], v241, s[20:23], s58 offen offset:0 sc1
    v_mfma_f32_16x16x32_bf16 v[20:23], v[216:219], a[100:103], v[20:23]
    v_mfma_f32_16x16x32_bf16 v[24:27], v[216:219], a[104:107], v[24:27]
    s_add_u32 s58, s78, 1888256
    v_mfma_f32_16x16x32_bf16 v[24:27], v[220:223], a[120:123], v[24:27]
    v_mfma_f32_16x16x32_bf16 v[24:27], v[128:131], a[136:139], v[24:27]
    buffer_load_dwordx4 v[212:215], v241, s[20:23], s58 offen offset:0 sc1
    v_mfma_f32_16x16x32_bf16 v[28:31], v[128:131], a[140:143], v[28:31]
    v_mfma_f32_16x16x32_bf16 v[28:31], v[220:223], a[124:127], v[28:31]
    s_add_u32 s58, s78, 1892352
    v_mfma_f32_16x16x32_bf16 v[28:31], v[216:219], a[108:111], v[28:31]
    s_waitcnt vmcnt(21)
    v_mfma_f32_16x16x32_bf16 v[16:19], v[132:135], a[144:147], v[16:19]
    buffer_load_dwordx4 v[216:219], v241, s[20:23], s58 offen offset:0 sc1
    v_mfma_f32_16x16x32_bf16 v[16:19], v[136:139], a[160:163], v[16:19]
    v_mfma_f32_16x16x32_bf16 v[16:19], v[140:143], a[176:179], v[16:19]
    s_add_u32 s58, s78, 1896448
    v_mfma_f32_16x16x32_bf16 v[20:23], v[140:143], a[180:183], v[20:23]
    v_mfma_f32_16x16x32_bf16 v[20:23], v[136:139], a[164:167], v[20:23]
    buffer_load_dwordx4 v[220:223], v241, s[20:23], s58 offen offset:0 sc1
    v_mfma_f32_16x16x32_bf16 v[20:23], v[132:135], a[148:151], v[20:23]
    v_mfma_f32_16x16x32_bf16 v[24:27], v[132:135], a[152:155], v[24:27]
    s_add_u32 s58, s78, 1900544
    v_mfma_f32_16x16x32_bf16 v[24:27], v[136:139], a[168:171], v[24:27]
    v_mfma_f32_16x16x32_bf16 v[24:27], v[140:143], a[184:187], v[24:27]
    buffer_load_dwordx4 v[128:131], v241, s[20:23], s58 offen offset:0 sc1
    v_mfma_f32_16x16x32_bf16 v[28:31], v[140:143], a[188:191], v[28:31]
    v_mfma_f32_16x16x32_bf16 v[28:31], v[136:139], a[172:175], v[28:31]
    s_add_u32 s58, s78, 1904640
    v_mfma_f32_16x16x32_bf16 v[28:31], v[132:135], a[156:159], v[28:31]
    s_waitcnt vmcnt(21)
    v_mfma_f32_16x16x32_bf16 v[16:19], v[144:147], a[192:195], v[16:19]
    buffer_load_dwordx4 v[132:135], v241, s[20:23], s58 offen offset:0 sc1
    v_mfma_f32_16x16x32_bf16 v[16:19], v[148:151], a[208:211], v[16:19]
    s_add_u32 s0, s1, 1
    s_waitcnt vmcnt(11)
    v_mov_b32 v253, s0
    s_mov_b32 exec_hi, 0
    buffer_store_dword v253, v255, s[20:23], s50 offen sc1
    s_mov_b64 exec, -1
    v_mfma_f32_16x16x32_bf16 v[16:19], v[152:155], a[224:227], v[16:19]
    s_add_u32 s58, s78, 1908736
    s_waitcnt vmcnt(10)
    v_subrev_u32 v252, s1, v252
    v_subrev_u32 v252, 0, v252
    v_cmp_lt_u32 vcc, 2, v252
    s_nop 0
    s_cbranch_vccnz KF_S21_SPIN
KF_S21_OK:
    v_mfma_f32_16x16x32_bf16 v[20:23], v[152:155], a[228:231], v[20:23]
HOP2_7:
    s_cbranch_execz HOPRET2
    s_add_u32 s45, s44, 0
    buffer_load_dwordx4 v[32:35], v248, s[20:23], s45 offen offset:0 sc1
    v_mfma_f32_16x16x32_bf16 v[20:23], v[148:151], a[212:215], v[20:23]
    buffer_load_dwordx4 v[136:139], v241, s[20:23], s58 offen offset:0 sc1
    v_mfma_f32_16x16x32_bf16 v[20:23], v[144:147], a[196:199], v[20:23]
    buffer_load_dwordx4 v[36:39], v249, s[20:23], s45 offen offset:1024 sc1
    v_mfma_f32_16x16x32_bf16 v[24:27], v[144:147], a[200:203], v[24:27]
    s_add_u32 s58, s78, 1912832
    buffer_load_dwordx4 v[40:43], v248, s[20:23], s45 offen offset:2048 sc1
    v_mfma_f32_16x16x32_bf16 v[24:27], v[148:151], a[216:219], v[24:27]
    buffer_load_dwordx4 v[44:47], v249, s[20:23], s45 offen offset:3072 sc1
    v_mfma_f32_16x16x32_bf16 v[24:27], v[152:155], a[232:235], v[24:27]
    buffer_load_dwordx4 v[140:143], v241, s[20:23], s58 offen offset:0 sc1
    v_mfma_f32_16x16x32_bf16 v[28:31], v[152:155], a[236:239], v[28:31]
    s_add_u32 s45, s44, 4096
    buffer_load_dwordx4 v[48:51], v248, s[20:23], s45 offen offset:0 sc1
    v_mfma_f32_16x16x32_bf16 v[28:31], v[148:151], a[220:223], v[28:31]
    s_add_u32 s58, s30, 1916928
    buffer_load_dwordx4 v[52:55], v249, s[20:23], s45 offen offset:1024 sc1
    v_mfma_f32_16x16x32_bf16 v[28:31], v[144:147], a[204:207], v[28:31]
    buffer_load_dwordx4 v[56:59], v248, s[20:23], s45 offen offset:2048 sc1
    v_mfma_f32_16x16x32_bf16 v[16:19], v[156:159], a[240:243], v[16:19]
    buffer_load_dwordx4 v[144:147], v241, s[20:23], s58 offen offset:0 sc1
    v_mfma_f32_16x16x32_bf16 v[16:19], v[160:163], v[96:99], v[16:19]
    buffer_load_dwordx4 v[60:63], v249, s[20:23], s45 offen offset:3072 sc1
    v_mfma_f32_16x16x32_bf16 v[16:19], v[164:167], v[112:115], v[16:19]
    s_add_u32 s58, s30, 1921024
    v_mfma_f32_16x16x32_bf16 v[20:23], v[164:167], v[116:119], v[20:23]
    v_mfma_f32_16x16x32_bf16 v[20:23], v[160:163], v[100:103], v[20:23]
    buffer_load_dwordx4 v[148:151], v241, s[20:23], s58 offen offset:0 sc1
    v_mfma_f32_16x16x32_bf16 v[20:23], v[156:159], a[244:247], v[20:23]
    v_mfma_f32_16x16x32_bf16 v[24:27], v[156:159], a[248:251], v[24:27]
    v_mfma_f32_16x16x32_bf16 v[24:27], v[160:163], v[104:107], v[24:27]
    v_mfma_f32_16x16x32_bf16 v[24:27], v[164:167], v[120:123], v[24:27]
    ds_read_b128 v[152:155], v251 offset:0
    v_mfma_f32_16x16x32_bf16 v[28:31], v[164:167], v[124:127], v[28:31]
    v_mfma_f32_16x16x32_bf16 v[28:31], v[160:163], v[108:111], v[28:31]
    v_mfma_f32_16x16x32_bf16 v[28:31], v[156:159], a[252:255], v[28:31]
    v_mfma_f32_16x16x32_bf16 v[0:3], v[168:171], a[0:3], 0
    ds_read_b128 v[156:159], v251 offset:1024
    v_mfma_f32_16x16x32_bf16 v[0:3], v[172:175], a[16:19], v[0:3]
    v_mfma_f32_16x16x32_bf16 v[0:3], v[176:179], a[32:35], v[0:3]
    v_mfma_f32_16x16x32_bf16 v[4:7], v[176:179], a[36:39], 0
    v_mfma_f32_16x16x32_bf16 v[4:7], v[172:175], a[20:23], v[4:7]
    ds_read_b128 v[160:163], v251 offset:2048
    v_mfma_f32_16x16x32_bf16 v[4:7], v[168:171], a[4:7], v[4:7]
    v_cvt_pk_bf16_f32 v232, v16, v17
    v_cvt_pk_bf16_f32 v233, v18, v19
    v_mfma_f32_16x16x32_bf16 v[8:11], v[168:171], a[8:11], 0
    v_cvt_pk_bf16_f32 v234, v20, v21
    v_cvt_pk_bf16_f32 v235, v22, v23
    v_mfma_f32_16x16x32_bf16 v[8:11], v[172:175], a[24:27], v[8:11]
    v_min_u32 v232, -2, v232
    v_min_u32 v233, -2, v233
    v_mfma_f32_16x16x32_bf16 v[8:11], v[176:179], a[40:43], v[8:11]
    ds_read_b128 v[164:167], v251 offset:3072
    v_mfma_f32_16x16x32_bf16 v[12:15], v[176:179], a[44:47], 0
    v_min_u32 v234, -2, v234
    v_min_u32 v235, -2, v235
    v_mfma_f32_16x16x32_bf16 v[12:15], v[172:175], a[28:31], v[12:15]
    s_add_u32 s41, s40, 12288
    buffer_store_dwordx4 v[232:235], v244, s[20:23], s41 offen offset:0 sc1
    v_mfma_f32_16x16x32_bf16 v[12:15], v[168:171], a[12:15], v[12:15]
    v_cvt_pk_bf16_f32 v236, v24, v25
    v_cvt_pk_bf16_f32 v237, v26, v27
    v_mfma_f32_16x16x32_bf16 v[0:3], v[180:183], a[48:51], v[0:3]
    ds_read_b128 v[168:171], v251 offset:4096
    v_mfma_f32_16x16x32_bf16 v[0:3], v[184:187], a[64:67], v[0:3]
    v_cvt_pk_bf16_f32 v238, v28, v29
    v_cvt_pk_bf16_f32 v239, v30, v31
    v_mfma_f32_16x16x32_bf16 v[0:3], v[188:191], a[80:83], v[0:3]
    v_min_u32 v236, -2, v236
    v_min_u32 v237, -2, v237
    v_mfma_f32_16x16x32_bf16 v[4:7], v[188:191], a[84:87], v[4:7]
    v_min_u32 v238, -2, v238
    v_min_u32 v239, -2, v239
    v_mfma_f32_16x16x32_bf16 v[4:7], v[184:187], a[68:71], v[4:7]
    ds_read_b128 v[172:175], v251 offset:5120
    v_mfma_f32_16x16x32_bf16 v[4:7], v[180:183], a[52:55], v[4:7]
    buffer_store_dwordx4 v[236:239], v250, s[20:23], s41 offen offset:1024 sc1
    v_mfma_f32_16x16x32_bf16 v[8:11], v[180:183], a[56:59], v[8:11]
    s_mov_b64 exec, s[54:55]
    ds_write_b128 v243, v[16:19] offset:3072
    s_mov_b64 exec, -1
    v_mfma_f32_16x16x32_bf16 v[8:11], v[184:187], a[72:75], v[8:11]
    s_mov_b64 exec, s[54:55]
    ds_write_b128 v243, v[20:23] offset:3328
    s_mov_b64 exec, -1
    v_mfma_f32_16x16x32_bf16 v[8:11], v[188:191], a[88:91], v[8:11]
    ds_read_b128 v[176:179], v251 offset:6144
    v_mfma_f32_16x16x32_bf16 v[12:15], v[188:191], a[92:95], v[12:15]
    v_mfma_f32_16x16x32_bf16 v[12:15], v[184:187], a[76:79], v[12:15]
    v_mfma_f32_16x16x32_bf16 v[12:15], v[180:183], a[60:63], v[12:15]
    s_waitcnt vmcnt(22)
    v_mfma_f32_16x16x32_bf16 v[0:3], v[192:195], a[96:99], v[0:3]
    ds_read_b128 v[180:183], v251 offset:7168
    v_mfma_f32_16x16x32_bf16 v[0:3], v[196:199], a[112:115], v[0:3]
    v_mfma_f32_16x16x32_bf16 v[0:3], v[200:203], a[128:131], v[0:3]
    v_mfma_f32_16x16x32_bf16 v[4:7], v[200:203], a[132:135], v[4:7]
    v_mfma_f32_16x16x32_bf16 v[4:7], v[196:199], a[116:119], v[4:7]
    ds_read_b128 v[184:187], v251 offset:8192
    v_mfma_f32_16x16x32_bf16 v[4:7], v[192:195], a[100:103], v[4:7]
    v_mfma_f32_16x16x32_bf16 v[8:11], v[192:195], a[104:107], v[8:11]
    v_mfma_f32_16x16x32_bf16 v[8:11], v[196:199], a[120:123], v[8:11]
    v_mfma_f32_16x16x32_bf16 v[8:11], v[200:203], a[136:139], v[8:11]
    ds_read_b128 v[188:191], v251 offset:9216
    v_mfma_f32_16x16x32_bf16 v[12:15], v[200:203], a[140:143], v[12:15]
    v_mfma_f32_16x16x32_bf16 v[12:15], v[196:199], a[124:127], v[12:15]
    v_mfma_f32_16x16x32_bf16 v[12:15], v[192:195], a[108:111], v[12:15]
    s_waitcnt vmcnt(19)
    v_mfma_f32_16x16x32_bf16 v[0:3], v[204:207], a[144:147], v[0:3]
    ds_read_b128 v[192:195], v251 offset:10240
    v_mfma_f32_16x16x32_bf16 v[0:3], v[208:211], a[160:163], v[0:3]
    buffer_load_dword v252, v247, s[20:23], s52 offen sc1
    v_mfma_f32_16x16x32_bf16 v[0:3], v[212:215], a[176:179], v[0:3]
    v_mfma_f32_16x16x32_bf16 v[4:7], v[212:215], a[180:183], v[4:7]
    v_mfma_f32_16x16x32_bf16 v[4:7], v[208:211], a[164:167], v[4:7]
    ds_read_b128 v[196:199], v251 offset:11264
    v_mfma_f32_16x16x32_bf16 v[4:7], v[204:207], a[148:151], v[4:7]
    v_mfma_f32_16x16x32_bf16 v[8:11], v[204:207], a[152:155], v[8:11]
    v_mfma_f32_16x16x32_bf16 v[8:11], v[208:211], a[168:171], v[8:11]
    v_mfma_f32_16x16x32_bf16 v[8:11], v[212:215], a[184:187], v[8:11]
    ds_read_b128 v[200:203], v251 offset:12288
    v_mfma_f32_16x16x32_bf16 v[12:15], v[212:215], a[188:191], v[12:15]
    v_mfma_f32_16x16x32_bf16 v[12:15], v[208:211], a[172:175], v[12:15]
    v_mfma_f32_16x16x32_bf16 v[12:15], v[204:207], a[156:159], v[12:15]
    s_waitcnt vmcnt(17)
    v_mfma_f32_16x16x32_bf16 v[0:3], v[216:219], a[192:195], v[0:3]
    ds_read_b128 v[204:207], v251 offset:13312
    v_mfma_f32_16x16x32_bf16 v[0:3], v[220:223], a[208:211], v[0:3]
    v_mfma_f32_16x16x32_bf16 v[0:3], v[128:131], a[224:227], v[0:3]
    v_mfma_f32_16x16x32_bf16 v[4:7], v[128:131], a[228:231], v[4:7]
    v_mfma_f32_16x16x32_bf16 v[4:7], v[220:223], a[212:215], v[4:7]
    ds_read_b128 v[208:211], v251 offset:14336
    v_mfma_f32_16x16x32_bf16 v[4:7], v[216:219], a[196:199], v[4:7]
    v_mfma_f32_16x16x32_bf16 v[8:11], v[216:219], a[200:203], v[8:11]
    v_mfma_f32_16x16x32_bf16 v[8:11], v[220:223], a[216:219], v[8:11]
    v_mfma_f32_16x16x32_bf16 v[8:11], v[128:131], a[232:235], v[8:11]
    ds_read_b128 v[212:215], v251 offset:15360
    v_mfma_f32_16x16x32_bf16 v[12:15], v[128:131], a[236:239], v[12:15]
    v_mfma_f32_16x16x32_bf16 v[12:15], v[220:223], a[220:223], v[12:15]
    v_mfma_f32_16x16x32_bf16 v[12:15], v[216:219], a[204:207], v[12:15]
    s_waitcnt vmcnt(9)
    v_mfma_f32_16x16x32_bf16 v[0:3], v[132:135], a[240:243], v[0:3]
    v_mfma_f32_16x16x32_bf16 v[0:3], v[136:139], v[96:99], v[0:3]
    v_mfma_f32_16x16x32_bf16 v[0:3], v[140:143], v[112:115], v[0:3]
    v_mfma_f32_16x16x32_bf16 v[4:7], v[140:143], v[116:119], v[4:7]
    v_mfma_f32_16x16x32_bf16 v[4:7], v[136:139], v[100:103], v[4:7]
    v_mfma_f32_16x16x32_bf16 v[4:7], v[132:135], a[244:247], v[4:7]
    v_mfma_f32_16x16x32_bf16 v[8:11], v[132:135], a[248:251], v[8:11]
    v_mfma_f32_16x16x32_bf16 v[8:11], v[136:139], v[104:107], v[8:11]
    v_mfma_f32_16x16x32_bf16 v[8:11], v[140:143], v[120:123], v[8:11]
    v_mfma_f32_16x16x32_bf16 v[12:15], v[140:143], v[124:127], v[12:15]
    v_mfma_f32_16x16x32_bf16 v[12:15], v[136:139], v[108:111], v[12:15]
    v_mfma_f32_16x16x32_bf16 v[12:15], v[132:135], a[252:255], v[12:15]
    s_waitcnt vmcnt(3) lgkmcnt(15)
    v_mfma_f32_16x16x32_bf16 v[16:19], v[144:147], a[0:3], 0
    v_mfma_f32_16x16x32_bf16 v[16:19], v[148:151], a[16:19], v[16:19]
    v_mfma_f32_16x16x32_bf16 v[16:19], v[152:155], a[32:35], v[16:19]
    v_mfma_f32_16x16x32_bf16 v[20:23], v[152:155], a[36:39], 0
    v_cvt_pk_bf16_f32 v232, v0, v1
    v_cvt_pk_bf16_f32 v233, v2, v3
    v_mfma_f32_16x16x32_bf16 v[20:23], v[148:151], a[20:23], v[20:23]
    v_cvt_pk_bf16_f32 v234, v4, v5
    v_cvt_pk_bf16_f32 v235, v6, v7
    v_mfma_f32_16x16x32_bf16 v[20:23], v[144:147], a[4:7], v[20:23]
    v_min_u32 v232, -2, v232
    v_min_u32 v233, -2, v233
    v_mfma_f32_16x16x32_bf16 v[24:27], v[144:147], a[8:11], 0
    v_min_u32 v234, -2, v234
    v_min_u32 v235, -2, v235
    v_mfma_f32_16x16x32_bf16 v[24:27], v[148:151], a[24:27], v[24:27]
    s_add_u32 s41, s40, 14336
    buffer_store_dwordx4 v[232:235], v244, s[20:23], s41 offen offset:0 sc1
    v_mfma_f32_16x16x32_bf16 v[24:27], v[152:155], a[40:43], v[24:27]
    v_cvt_pk_bf16_f32 v236, v8, v9
    v_cvt_pk_bf16_f32 v237, v10, v11
    v_mfma_f32_16x16x32_bf16 v[28:31], v[152:155], a[44:47], 0
    v_cvt_pk_bf16_f32 v238, v12, v13
    v_cvt_pk_bf16_f32 v239, v14, v15
    v_mfma_f32_16x16x32_bf16 v[28:31], v[148:151], a[28:31], v[28:31]
    v_min_u32 v236, -2, v236
    v_min_u32 v237, -2, v237
    v_mfma_f32_16x16x32_bf16 v[28:31], v[144:147], a[12:15], v[28:31]
    s_waitcnt lgkmcnt(14)
    v_min_u32 v238, -2, v238
    v_min_u32 v239, -2, v239
    v_mfma_f32_16x16x32_bf16 v[16:19], v[156:159], a[48:51], v[16:19]
    buffer_store_dwordx4 v[236:239], v250, s[20:23], s41 offen offset:1024 sc1
    v_mfma_f32_16x16x32_bf16 v[16:19], v[160:163], a[64:67], v[16:19]
    s_mov_b64 exec, s[54:55]
    ds_write_b128 v243, v[0:3] offset:3584
    s_mov_b64 exec, -1
    v_mfma_f32_16x16x32_bf16 v[16:19], v[164:167], a[80:83], v[16:19]
    s_mov_b64 exec, s[54:55]
    ds_write_b128 v243, v[4:7] offset:3840
    s_mov_b64 exec, -1
    v_mfma_f32_16x16x32_bf16 v[20:23], v[164:167], a[84:87], v[20:23]
    s_waitcnt vmcnt(2)
    v_subrev_u32 v252, s1, v252
    v_subrev_u32 v252, 1, v252
    v_cmp_lt_u32 vcc, 1, v252
    s_nop 0
    s_cbranch_vccnz KF_S22_SPIN
KF_S22_OK:
    v_mfma_f32_16x16x32_bf16 v[20:23], v[160:163], a[68:71], v[20:23]
    s_add_u32 s45, s44, 8192
    buffer_load_dwordx4 v[64:67], v248, s[20:23], s45 offen offset:0 sc1
    v_mfma_f32_16x16x32_bf16 v[20:23], v[156:159], a[52:55], v[20:23]
    buffer_load_dwordx4 v[68:71], v249, s[20:23], s45 offen offset:1024 sc1
    v_mfma_f32_16x16x32_bf16 v[24:27], v[156:159], a[56:59], v[24:27]
    buffer_load_dwordx4 v[72:75], v248, s[20:23], s45 offen offset:2048 sc1
    v_mfma_f32_16x16x32_bf16 v[24:27], v[160:163], a[72:75], v[24:27]
    buffer_load_dwordx4 v[76:79], v249, s[20:23], s45 offen offset:3072 sc1
    v_mfma_f32_16x16x32_bf16 v[24:27], v[164:167], a[88:91], v[24:27]
    v_mfma_f32_16x16x32_bf16 v[28:31], v[164:167], a[92:95], v[28:31]
    v_mfma_f32_16x16x32_bf16 v[28:31], v[160:163], a[76:79], v[28:31]
    v_mfma_f32_16x16x32_bf16 v[28:31], v[156:159], a[60:63], v[28:31]
    s_waitcnt lgkmcnt(11)
    v_mfma_f32_16x16x32_bf16 v[16:19], v[168:171], a[96:99], v[16:19]
    v_mfma_f32_16x16x32_bf16 v[16:19], v[172:175], a[112:115], v[16:19]
    v_mfma_f32_16x16x32_bf16 v[16:19], v[176:179], a[128:131], v[16:19]
    v_mfma_f32_16x16x32_bf16 v[20:23], v[176:179], a[132:135], v[20:23]
    v_mfma_f32_16x16x32_bf16 v[20:23], v[172:175], a[116:119], v[20:23]
    v_mfma_f32_16x16x32_bf16 v[20:23], v[168:171], a[100:103], v[20:23]
    v_mfma_f32_16x16x32_bf16 v[24:27], v[168:171], a[104:107], v[24:27]
    v_mfma_f32_16x16x32_bf16 v[24:27], v[172:175], a[120:123], v[24:27]
    v_mfma_f32_16x16x32_bf16 v[24:27], v[176:179], a[136:139], v[24:27]
    v_mfma_f32_16x16x32_bf16 v[28:31], v[176:179], a[140:143], v[28:31]
    v_mfma_f32_16x16x32_bf16 v[28:31], v[172:175], a[124:127], v[28:31]
    v_mfma_f32_16x16x32_bf16 v[28:31], v[168:171], a[108:111], v[28:31]
    s_waitcnt lgkmcnt(8)
    v_mfma_f32_16x16x32_bf16 v[16:19], v[180:183], a[144:147], v[16:19]
    v_mfma_f32_16x16x32_bf16 v[16:19], v[184:187], a[160:163], v[16:19]
    v_mfma_f32_16x16x32_bf16 v[16:19], v[188:191], a[176:179], v[16:19]
    v_mfma_f32_16x16x32_bf16 v[20:23], v[188:191], a[180:183], v[20:23]
    v_mfma_f32_16x16x32_bf16 v[20:23], v[184:187], a[164:167], v[20:23]
    v_mfma_f32_16x16x32_bf16 v[20:23], v[180:183], a[148:151], v[20:23]
    v_mfma_f32_16x16x32_bf16 v[24:27], v[180:183], a[152:155], v[24:27]
    v_mfma_f32_16x16x32_bf16 v[24:27], v[184:187], a[168:171], v[24:27]
    v_mfma_f32_16x16x32_bf16 v[24:27], v[188:191], a[184:187], v[24:27]
    v_mfma_f32_16x16x32_bf16 v[28:31], v[188:191], a[188:191], v[28:31]
    v_mfma_f32_16x16x32_bf16 v[28:31], v[184:187], a[172:175], v[28:31]
    v_mfma_f32_16x16x32_bf16 v[28:31], v[180:183], a[156:159], v[28:31]
    s_waitcnt lgkmcnt(5)
    v_mfma_f32_16x16x32_bf16 v[16:19], v[192:195], a[192:195], v[16:19]
    v_mfma_f32_16x16x32_bf16 v[16:19], v[196:199], a[208:211], v[16:19]
    v_mfma_f32_16x16x32_bf16 v[16:19], v[200:203], a[224:227], v[16:19]
    v_mfma_f32_16x16x32_bf16 v[20:23], v[200:203], a[228:231], v[20:23]
    v_mfma_f32_16x16x32_bf16 v[20:23], v[196:199], a[212:215], v[20:23]
    v_mfma_f32_16x16x32_bf16 v[20:23], v[192:195], a[196:199], v[20:23]
    v_mfma_f32_16x16x32_bf16 v[24:27], v[192:195], a[200:203], v[24:27]
    v_mfma_f32_16x16x32_bf16 v[24:27], v[196:199], a[216:219], v[24:27]
    v_mfma_f32_16x16x32_bf16 v[24:27], v[200:203], a[232:235], v[24:27]
    v_mfma_f32_16x16x32_bf16 v[28:31], v[200:203], a[236:239], v[28:31]
    v_mfma_f32_16x16x32_bf16 v[28:31], v[196:199], a[220:223], v[28:31]
    v_mfma_f32_16x16x32_bf16 v[28:31], v[192:195], a[204:207], v[28:31]
    s_waitcnt lgkmcnt(2)
    v_mfma_f32_16x16x32_bf16 v[16:19], v[204:207], a[240:243], v[16:19]
    v_mfma_f32_16x16x32_bf16 v[16:19], v[208:211], v[96:99], v[16:19]
    v_mfma_f32_16x16x32_bf16 v[16:19], v[212:215], v[112:115], v[16:19]
    v_mfma_f32_16x16x32_bf16 v[20:23], v[212:215], v[116:119], v[20:23]
    v_mfma_f32_16x16x32_bf16 v[20:23], v[208:211], v[100:103], v[20:23]
    v_mfma_f32_16x16x32_bf16 v[20:23], v[204:207], a[244:247], v[20:23]
    v_mfma_f32_16x16x32_bf16 v[24:27], v[204:207], a[248:251], v[24:27]
    v_mfma_f32_16x16x32_bf16 v[24:27], v[208:211], v[104:107], v[24:27]
    v_mfma_f32_16x16x32_bf16 v[24:27], v[212:215], v[120:123], v[24:27]
    v_mfma_f32_16x16x32_bf16 v[28:31], v[212:215], v[124:127], v[28:31]
    v_mfma_f32_16x16x32_bf16 v[28:31], v[208:211], v[108:111], v[28:31]
    v_mfma_f32_16x16x32_bf16 v[28:31], v[204:207], a[252:255], v[28:31]
    v_bfe_u32 v188, v240, 1, 2
    v_bfe_u32 v189, v240, 4, 1
    v_lshl_add_u32 v188, v189, 2, v188
    v_and_b32 v189, 1, v240
    v_and_b32 v190, 32, v240
    v_lshl_add_u32 v191, v189, 3, v190
    v_and_b32 v189, 8, v240
    v_lshl_add_u32 v191, v189, 1, v191
    v_add_u32 v194, s39, v241
    v_mul_u32_u24 v192, 2336, v188
    v_mul_u32_u24 v188, 1152, v188
    v_cvt_pk_bf16_f32 v232, v16, v17
    v_cvt_pk_bf16_f32 v233, v18, v19
    v_cvt_pk_bf16_f32 v234, v20, v21
    v_cvt_pk_bf16_f32 v235, v22, v23
    v_min_u32 v232, -2, v232
    v_min_u32 v233, -2, v233
    v_min_u32 v234, -2, v234
    v_min_u32 v235, -2, v235
    s_add_u32 s41, s40, 16384
    buffer_store_dwordx4 v[232:235], v244, s[20:23], s41 offen offset:0 sc1
    v_cvt_pk_bf16_f32 v236, v24, v25
    v_cvt_pk_bf16_f32 v237, v26, v27
    v_cvt_pk_bf16_f32 v238, v28, v29
    v_cvt_pk_bf16_f32 v239, v30, v31
    v_min_u32 v236, -2, v236
    v_min_u32 v237, -2, v237
    v_min_u32 v238, -2, v238
    v_min_u32 v239, -2, v239
    buffer_store_dwordx4 v[236:239], v250, s[20:23], s41 offen offset:1024 sc1
    s_mov_b64 exec, s[54:55]
    ds_write_b128 v243, v[16:19] offset:4096
    s_mov_b64 exec, -1
    s_mov_b64 exec, s[54:55]
    ds_write_b128 v243, v[20:23] offset:4352
    s_mov_b64 exec, -1
    v_add_u32 v184, v188, v191
    v_lshl_add_u32 v185, v190, 25, v184
    v_lshl_add_u32 v192, v191, 1, v192
    s_lshl_b32 s37, s32, 9
    v_add_u32 v193, s37, v192
    s_lshl_b32 s37, s32, 6
    v_add_u32 v192, s37, v192
    ds_read_b128 v[136:139], v193 offset:0
    s_add_u32 s81, s70, 1
    v_lshl_add_u32 v195, s81, 7, v193
    ds_read_b128 v[140:143], v195
    s_add_u32 s82, s71, 2
    v_lshl_add_u32 v195, s82, 7, v193
    ds_read_b128 v[144:147], v195
    s_add_u32 s83, s72, 3
    v_lshl_add_u32 v195, s83, 7, v193
    ds_read_b128 v[148:151], v195
    ds_read_b128 v[152:155], v192 offset:2048
    ds_read_b128 v[156:159], v194 offset:0
    ds_read_b128 v[160:163], v194 offset:1024
    ds_read_b128 v[164:167], v194 offset:2048
    ds_read_b128 v[168:171], v194 offset:3072
    ds_read_b128 v[172:175], v194 offset:4096
    s_mov_b32 s16, s26
    s_mov_b32 s17, s27
    s_mov_b32 s18, 2359296
    s_mov_b32 s19, 0x20000
    s_lshl_b32 s37, s32, 8
    s_add_u32 s37, s37, s36
    s_add_u32 s80, s37, 0
    s_lshl_b32 s81, s81, 6
    s_add_u32 s81, s81, s37
    s_lshl_b32 s82, s82, 6
    s_add_u32 s82, s82, s37
    s_lshl_b32 s83, s83, 6
    s_add_u32 s83, s83, s37
    s_lshl_b32 s38, s32, 5
    s_add_u32 s38, s38, s36
    v_and_b32 v188, 1, v240
    v_lshlrev_b32 v188, 4, v188
    v_mov_b32 v189, 0x3f80
    v_lshlrev_b32 v188, v188, v189
    v_bfe_u32 v189, v240, 1, 3
    v_cmp_eq_u32 s[64:65], 0, v189
    v_cmp_eq_u32 s[66:67], 1, v189
    v_cmp_eq_u32 s[68:69], 2, v189
    v_cmp_eq_u32 s[70:71], 3, v189
    v_cmp_eq_u32 s[72:73], 4, v189
    v_cmp_eq_u32 s[74:75], 5, v189
    v_cmp_eq_u32 s[76:77], 6, v189
    v_cmp_eq_u32 s[78:79], 7, v189
    v_cndmask_b32 v176, 0, v188, s[64:65]
    v_cndmask_b32 v177, 0, v188, s[66:67]
    v_cndmask_b32 v178, 0, v188, s[68:69]
    v_cndmask_b32 v179, 0, v188, s[70:71]
    v_cndmask_b32 v180, 0, v188, s[72:73]
    v_cndmask_b32 v181, 0, v188, s[74:75]
    v_cndmask_b32 v182, 0, v188, s[76:77]
    v_cndmask_b32 v183, 0, v188, s[78:79]
    s_mov_b32 s39, 0x4091afa4
    s_waitcnt lgkmcnt(4)
    v_mfma_f32_16x16x32_bf16 v[156:159], v[176:179], v[32:35], v[156:159]
    v_mfma_f32_16x16x32_bf16 v[156:159], v[176:179], v[36:39], v[156:159]
    v_mfma_f32_16x16x32_bf16 v[156:159], v[180:183], v[40:43], v[156:159]
    v_mfma_f32_16x16x32_bf16 v[156:159], v[180:183], v[44:47], v[156:159]
    s_waitcnt lgkmcnt(3)
    v_mfma_f32_16x16x32_bf16 v[160:163], v[176:179], v[48:51], v[160:163]
    v_mfma_f32_16x16x32_bf16 v[160:163], v[176:179], v[52:55], v[160:163]
    v_mfma_f32_16x16x32_bf16 v[160:163], v[180:183], v[56:59], v[160:163]
    v_mfma_f32_16x16x32_bf16 v[160:163], v[180:183], v[60:63], v[160:163]
    s_waitcnt vmcnt(5) lgkmcnt(2)
    v_mfma_f32_16x16x32_bf16 v[164:167], v[176:179], v[64:67], v[164:167]
    s_waitcnt vmcnt(4)
    v_mfma_f32_16x16x32_bf16 v[164:167], v[176:179], v[68:71], v[164:167]
    s_waitcnt vmcnt(3)
    v_mfma_f32_16x16x32_bf16 v[164:167], v[180:183], v[72:75], v[164:167]
    s_waitcnt vmcnt(2)
    v_mfma_f32_16x16x32_bf16 v[164:167], v[180:183], v[76:79], v[164:167]
    v_fmac_f32 v136, s39, v156
    v_fmac_f32 v137, s39, v157
    v_fmac_f32 v138, s39, v158
    v_fmac_f32 v139, s39, v159
    v_cvt_pk_bf16_f32 v136, v136, v137
    v_cvt_pk_bf16_f32 v137, v138, v139
    buffer_store_dwordx2 v[136:137], v184, s[16:19], s80 offen
    v_fmac_f32 v140, s39, v160
    v_fmac_f32 v141, s39, v161
    v_fmac_f32 v142, s39, v162
    v_fmac_f32 v143, s39, v163
    v_cvt_pk_bf16_f32 v140, v140, v141
    v_cvt_pk_bf16_f32 v141, v142, v143
    buffer_store_dwordx2 v[140:141], v184, s[16:19], s81 offen
    v_fmac_f32 v144, s39, v164
    v_fmac_f32 v145, s39, v165
    v_fmac_f32 v146, s39, v166
    v_fmac_f32 v147, s39, v167
    v_cvt_pk_bf16_f32 v144, v144, v145
    v_cvt_pk_bf16_f32 v145, v146, v147
    buffer_store_dwordx2 v[144:145], v184, s[16:19], s82 offen
    s_add_u32 s45, s44, 12288
    buffer_load_dwordx4 v[80:83], v248, s[20:23], s45 offen offset:0 sc1
    buffer_load_dwordx4 v[84:87], v249, s[20:23], s45 offen offset:1024 sc1
    buffer_load_dwordx4 v[88:91], v248, s[20:23], s45 offen offset:2048 sc1
    buffer_load_dwordx4 v[92:95], v249, s[20:23], s45 offen offset:3072 sc1
    s_add_u32 s45, s44, 16384
    buffer_load_dwordx4 v[128:131], v248, s[20:23], s45 offen offset:0 sc1
    buffer_load_dwordx4 v[132:135], v249, s[20:23], s45 offen offset:1024 sc1
    s_waitcnt vmcnt(5)
    v_max3_u32 v196, v80, v81, v81
    v_max3_u32 v196, v82, v83, v196
    s_waitcnt vmcnt(4)
    v_max3_u32 v196, v84, v85, v196
    v_max3_u32 v196, v86, v87, v196
    s_waitcnt vmcnt(3)
    v_max3_u32 v196, v88, v89, v196
    v_max3_u32 v196, v90, v91, v196
    s_waitcnt vmcnt(2)
    v_max3_u32 v196, v92, v93, v196
    v_max3_u32 v196, v94, v95, v196
    s_waitcnt vmcnt(1)
    v_max3_u32 v196, v128, v129, v196
    v_max3_u32 v196, v130, v131, v196
    s_waitcnt vmcnt(0)
    v_max3_u32 v196, v132, v133, v196
    v_max3_u32 v196, v134, v135, v196
    v_cmp_eq_u32 vcc, -1, v196
    s_nop 0
    s_cbranch_vccnz KF_S3_SPIN
KF_S3_OK:
    s_mov_b64 exec, -1
    s_waitcnt lgkmcnt(1)
    v_mfma_f32_16x16x32_bf16 v[168:171], v[176:179], v[80:83], v[168:171]
    v_mfma_f32_16x16x32_bf16 v[168:171], v[176:179], v[84:87], v[168:171]
    v_mfma_f32_16x16x32_bf16 v[168:171], v[180:183], v[88:91], v[168:171]
    v_mfma_f32_16x16x32_bf16 v[168:171], v[180:183], v[92:95], v[168:171]
    s_waitcnt lgkmcnt(0)
    v_mfma_f32_16x16x32_bf16 v[172:175], v[176:179], v[128:131], v[172:175]
    v_mfma_f32_16x16x32_bf16 v[172:175], v[176:179], v[132:135], v[172:175]
    s_nop 4
    v_fmac_f32 v148, s39, v168
    v_fmac_f32 v149, s39, v169
    v_fmac_f32 v150, s39, v170
    v_fmac_f32 v151, s39, v171
    v_cvt_pk_bf16_f32 v148, v148, v149
    v_cvt_pk_bf16_f32 v149, v150, v151
    buffer_store_dwordx2 v[148:149], v184, s[16:19], s83 offen
    v_fmac_f32 v152, s39, v172
    v_fmac_f32 v153, s39, v173
    v_fmac_f32 v154, s39, v174
    v_fmac_f32 v155, s39, v175
    v_cvt_pk_bf16_f32 v152, v152, v153
    v_cvt_pk_bf16_f32 v153, v154, v155
    buffer_store_dwordx2 v[152:153], v185, s[16:19], s38 offen offset:1024
KF_END:
    s_endpgm
K1_EV:
    v_lshl_add_u32 v184, v182, 1, v204
    v_add_u32 v186, v204, v241
    s_cmp_eq_u32 s4, 7
    s_cbranch_scc1 K1_ER
    v_and_b32 v185, 2, v183
    v_add_u32 v185, v185, v183
    v_lshl_add_u32 v184, v185, 6, v184
    ds_write_b16 v184, v120
    ds_write_b16_d16_hi v184, v120 offset:32
    ds_write_b16 v184, v121 offset:128
    ds_write_b16_d16_hi v184, v121 offset:160
    s_mov_b32 exec_hi, 0
    ds_read_b128 v[124:127], v186
    s_waitcnt lgkmcnt(0)
    buffer_store_dwordx4 v[124:127], v241, s[20:23], s61 offen offset:640 sc1
    s_mov_b64 exec, -1
    s_branch K1_EDONE
K1_ER:
    v_mov_b32 v122, v121
    v_mov_b32 v123, 0x3f803f80
    v_lshl_add_u32 v185, v182, 3, v204
    ds_write_b16 v184, v123 offset:192
    s_mov_b32 exec_lo, 0xffff0000
    s_mov_b32 exec_hi, 0
    ds_write_b64 v185, v[122:123]
    s_mov_b32 exec_hi, 0xffff0000
    s_mov_b32 exec_lo, 0
    ds_write_b16 v184, v122 offset:128
    ds_write_b16_d16_hi v184, v122 offset:160
    s_mov_b64 exec, 0xffff
    ds_read_b128 v[124:127], v186
    v_and_b32 v184, 8, v240
    v_lshl_add_u32 v184, v184, 6, v241
    s_waitcnt lgkmcnt(0)
    buffer_store_dwordx4 v[124:127], v184, s[20:23], s61 offen offset:512 sc1
    s_mov_b64 exec, -1
    s_branch K1_EDONE
KF_TAG_SPIN:
    s_mov_b32 s3, 0x200000
KF_TAG_L:
    global_load_dword v173, v238, s[40:41] sc1
    s_sub_u32 s3, s3, 1
    s_waitcnt vmcnt(0) lgkmcnt(0)
    s_cbranch_scc1 KF_TAG_OK
    v_cmp_eq_u32 vcc, 0, v173
    s_nop 0
    s_cbranch_vccnz KF_TAG_L
    s_branch KF_TAG_OK
KF_SQ_SPIN:
    s_mov_b32 s3, 0x200000
KF_SQ_L:
    buffer_load_dword v252, v211, s[20:23], 0 offen sc1
    s_sub_u32 s3, s3, 1
    s_waitcnt vmcnt(0) lgkmcnt(0)
    s_cbranch_scc1 KF_SQ_OK
    v_cmp_ne_u32 vcc, s1, v252
    s_nop 0
    s_cbranch_vccnz KF_SQ_L
    s_branch KF_SQ_OK
KF_SL_SPIN:
    s_mov_b32 s3, 0x200000
KF_SL_L:
    buffer_load_dword v252, v212, s[20:23], 0 offen sc1
    s_sub_u32 s3, s3, 1
    s_waitcnt vmcnt(0) lgkmcnt(0)
    s_cbranch_scc1 KF_SL_OK
    v_cmp_ne_u32 vcc, s1, v252
    s_nop 0
    s_cbranch_vccnz KF_SL_L
    s_branch KF_SL_OK
KF_SW_SPIN:
    s_mov_b32 s3, 0x200000
KF_SW_L:
    buffer_load_dword v205, v253, s[20:23], 0 offen sc1
    s_sub_u32 s3, s3, 1
    s_waitcnt vmcnt(0) lgkmcnt(0)
    s_cbranch_scc1 KF_SW_OK
    v_cmp_ne_u32 vcc, s1, v205
    s_nop 0
    s_cbranch_vccnz KF_SW_L
    s_branch KF_SW_OK
KF_S0_SPIN:
    s_mov_b32 s3, 0x200000
KF_S0_L:
    buffer_load_dwordx2 v[252:253], v251, s[20:23], s28 offen sc1
    s_sub_u32 s3, s3, 1
    s_waitcnt vmcnt(0) lgkmcnt(0)
    s_cbranch_scc1 KF_S0_OK
    v_cmp_ne_u64 vcc, s[0:1], v[252:253]
    s_nop 0
    s_cbranch_vccnz KF_S0_L
    s_branch KF_S0_OK
KF_S1_SPIN:
    s_mov_b32 s3, 0x200000
KF_S1_L:
    buffer_load_dword v252, v234, s[20:23], 0 offen sc1
    s_sub_u32 s3, s3, 1
    s_waitcnt vmcnt(0) lgkmcnt(0)
    s_cbranch_scc1 KF_S1_OK
    v_cmp_ne_u32 vcc, s1, v252
    s_nop 0
    s_cbranch_vccnz KF_S1_L
    s_branch KF_S1_OK
KF_S21_SPIN:
    s_mov_b32 s3, 0x200000
KF_S21_L:
    buffer_load_dword v252, v247, s[20:23], s52 offen sc1
    s_sub_u32 s3, s3, 1
    s_waitcnt vmcnt(0) lgkmcnt(0)
    s_cbranch_scc1 KF_S21_OK
    v_subrev_u32 v252, s1, v252
    v_subrev_u32 v252, 0, v252
    v_cmp_lt_u32 vcc, 2, v252
    s_nop 0
    s_cbranch_vccnz KF_S21_L
    s_branch KF_S21_OK
KF_S22_SPIN:
    s_mov_b32 s3, 0x200000
KF_S22_L:
    buffer_load_dword v252, v247, s[20:23], s52 offen sc1
    s_sub_u32 s3, s3, 1
    s_waitcnt vmcnt(0) lgkmcnt(0)
    s_cbranch_scc1 KF_S22_OK
    v_subrev_u32 v252, s1, v252
    v_subrev_u32 v252, 1, v252
    v_cmp_lt_u32 vcc, 1, v252
    s_nop 0
    s_cbranch_vccnz KF_S22_L
    s_branch KF_S22_OK
KF_S3_SPIN:
    s_mov_b32 s3, 0x200000
KF_S3_L:
    s_mov_b64 exec, vcc
    s_add_u32 s45, s44, 12288
    buffer_load_dwordx4 v[80:83], v248, s[20:23], s45 offen offset:0 sc1
    buffer_load_dwordx4 v[84:87], v249, s[20:23], s45 offen offset:1024 sc1
    buffer_load_dwordx4 v[88:91], v248, s[20:23], s45 offen offset:2048 sc1
    buffer_load_dwordx4 v[92:95], v249, s[20:23], s45 offen offset:3072 sc1
    s_add_u32 s45, s44, 16384
    buffer_load_dwordx4 v[128:131], v248, s[20:23], s45 offen offset:0 sc1
    buffer_load_dwordx4 v[132:135], v249, s[20:23], s45 offen offset:1024 sc1
    s_sub_u32 s3, s3, 1
    s_waitcnt vmcnt(0) lgkmcnt(0)
    s_cbranch_scc1 KF_S3_OK
    v_max3_u32 v196, v80, v81, v81
    v_max3_u32 v196, v82, v83, v196
    v_max3_u32 v196, v84, v85, v196
    v_max3_u32 v196, v86, v87, v196
    v_max3_u32 v196, v88, v89, v196
    v_max3_u32 v196, v90, v91, v196
    v_max3_u32 v196, v92, v93, v196
    v_max3_u32 v196, v94, v95, v196
    v_max3_u32 v196, v128, v129, v196
    v_max3_u32 v196, v130, v131, v196
    v_max3_u32 v196, v132, v133, v196
    v_max3_u32 v196, v134, v135, v196
    v_cmp_eq_u32 vcc, -1, v196
    s_nop 0
    s_cbranch_vccnz KF_S3_L
    s_branch KF_S3_OK
KF_FALLBACK:
    s_waitcnt vmcnt(0) lgkmcnt(0)
    s_nop 15
    s_nop 3
    v_and_b32 v108, 31, v240
    v_lshrrev_b32 v109, 5, v240
    v_lshlrev_b32 v110, 4, v109
    v_lshl_add_u32 v248, v108, 5, v110
    v_and_b32 v114, 16, v240
    v_mad_u32_u24 v248, v114, 48, v248
    v_and_b32 v114, 48, v240
    v_mul_u32_u24 v114, 72, v114
    v_lshl_add_u32 v223, v240, 3, v114
    v_and_b32 v116, 1, v108
    v_cmp_eq_u32 vcc, 1, v116
    v_bfe_u32 v115, v108, 2, 1
    v_add_u32 v115, 16, v115
    v_cndmask_b32 v115, v115, 18, vcc
    v_cmp_gt_u32 vcc, 16, v108
    v_and_b32 v117, 26, v108
    v_mov_b32 v116, 1073741824
    v_cndmask_b32 v114, v115, v108, vcc
    v_cmp_lt_u32 vcc, 16, v117
    v_lshl_add_u32 v114, v114, 5, v110
    v_add_u32 v114, 640, v114
    v_bfe_u32 v111, v240, 2, 3
    v_cndmask_b32 v249, v114, v116, vcc
    v_and_b32 v112, 3, v240
    v_mul_u32_u24 v247, 1152, v111
    v_mad_u32_u24 v247, v112, 36, v247
    v_add_u32 v246, v247, v110
    v_mul_u32_u24 v113, 36, v112
    s_mul_i32 s53, s32, 1280
    s_add_u32 s53, s53, 157696
    v_lshl_add_u32 v114, v111, 5, s53
    v_and_b32 v115, 48, v240
    v_lshl_add_u32 v213, v115, 4, v241
    v_add3_u32 v115, v113, v110, 0
    v_lshrrev_b32 v116, 5, v115
    v_and_or_b32 v115, v115, 31, v114
    v_lshl_add_u32 v206, v116, 8, v115
    v_add3_u32 v115, v113, v110, 4
    v_lshrrev_b32 v116, 5, v115
    v_and_or_b32 v115, v115, 31, v114
    v_lshl_add_u32 v207, v116, 8, v115
    v_add3_u32 v115, v113, v110, 8
    v_lshrrev_b32 v116, 5, v115
    v_and_or_b32 v115, v115, 31, v114
    v_lshl_add_u32 v208, v116, 8, v115
    v_add3_u32 v115, v113, v110, 12
    v_lshrrev_b32 v116, 5, v115
    v_and_or_b32 v115, v115, 31, v114
    v_lshl_add_u32 v209, v116, 8, v115
    v_add_u32 v115, 32, v113
    v_lshrrev_b32 v116, 5, v115
    v_and_or_b32 v115, v115, 31, v114
    v_lshl_add_u32 v210, v116, 8, v115
    s_and_b32 s53, s31, 3
    s_lshr_b32 s54, s31, 2
    s_lshl3_add_u32 s53, s53, s54
    v_and_b32 v108, 7, v240
    v_lshl_add_u32 v108, v108, 5, s53
    s_lshr_b32 s54, s48, 1
    s_lshl_b32 s54, s54, 7
    s_add_u32 s54, s54, 46440448
    v_lshl_add_u32 v212, v108, 9, s54
    v_bfe_u32 v109, v240, 2, 1
    v_lshl_add_u32 v109, v112, 3, v109
    v_and_b32 v110, 24, v240
    v_lshl_add_u32 v109, v110, 2, v109
    s_lshl1_add_u32 s53, s32, 160
    v_cmp_gt_u32 vcc, 24, v240
    v_add_u32 v109, s53, v109
    s_mov_b32 s53, 46403584
    v_cndmask_b32 v108, v108, v109, vcc
    v_lshl_add_u32 v211, v108, 7, s53
    v_lshrrev_b32 v109, 5, v240
    v_bfe_u32 v111, v240, 2, 3
    v_and_b32 v112, 3, v240
    v_and_b32 v113, 6, v111
    v_add_u32 v113, v111, v113
    v_lshl_add_u32 v113, v109, 1, v113
    v_lshlrev_b32 v113, 4, v113
    s_lshl_b32 s56, s32, 10
    v_lshl_add_u32 v114, v112, 8, v113
    v_add_u32 v214, s56, v114
    s_lshr_b32 s56, s32, 1
    s_lshl_b32 s56, s56, 8
    s_and_b32 s57, s32, 1
    s_lshl3_add_u32 s56, s57, s56
    v_lshl_add_u32 v114, v112, 1, v113
    v_add_u32 v215, s56, v114
    v_min_u32 v109, 53, v240
    v_mul_u32_u24 v110, 43, v109
    v_lshrrev_b32 v110, 7, v110
    v_mad_u32_u24 v109, v110, 6, v109
    s_lshl_b32 s54, s32, 8
    s_add_u32 s53, s54, 46403584
    v_lshl_add_u32 v253, v109, 7, s53
    v_and_b32 v108, 1, v240
    v_lshlrev_b32 v108, 4, v108
    v_mov_b32 v109, 0x3f80
    v_lshlrev_b32 v108, v108, v109
    v_bfe_u32 v109, v240, 1, 3
    v_lshrrev_b32 v110, 4, v240
    v_lshlrev_b32 v110, 2, v110
    v_sub_u32 v109, v109, v110
    v_cmp_eq_u32 s[52:53], 0, v109
    v_cmp_eq_u32 s[54:55], 1, v109
    v_cmp_eq_u32 s[56:57], 2, v109
    v_cmp_eq_u32 s[58:59], 3, v109
    v_cndmask_b32 v184, 0, v108, s[52:53]
    v_cndmask_b32 v185, 0, v108, s[54:55]
    v_cndmask_b32 v186, 0, v108, s[56:57]
    v_cndmask_b32 v187, 0, v108, s[58:59]
    v_cmp_eq_u32 s[52:53], -8, v109
    v_cmp_eq_u32 s[54:55], -7, v109
    v_cmp_eq_u32 s[56:57], -6, v109
    v_cmp_eq_u32 s[58:59], -5, v109
    v_cndmask_b32 v192, 0, v108, s[52:53]
    v_cndmask_b32 v193, 0, v108, s[54:55]
    v_cndmask_b32 v194, 0, v108, s[56:57]
    v_cndmask_b32 v195, 0, v108, s[58:59]
    s_mov_b32 s80, 1073741824
    s_mov_b32 s92, 1073741824
    s_mov_b32 s81, 1073741824
    s_mov_b32 s93, 1073741824
    s_mov_b32 s82, 1073741824
    s_mov_b32 s94, 1073741824
    s_mov_b32 s83, 1073741824
    s_mov_b32 s95, 1073741824
    s_add_u32 s40, s37, 0
    buffer_load_dwordx2 a[192:193], v223, s[20:23], s40 offen offset:512
    buffer_load_dwordx4 a[0:3], v248, s[20:23], s40 offen offset:0
    buffer_load_dwordx4 a[4:7], v248, s[20:23], s40 offen offset:2560
    s_add_u32 s41, s37, 5120
    buffer_load_dwordx2 a[194:195], v223, s[20:23], s41 offen offset:512
    buffer_load_dwordx4 a[8:11], v248, s[20:23], s41 offen offset:0
    buffer_load_dwordx4 a[12:15], v248, s[20:23], s41 offen offset:2560
    s_add_u32 s40, s37, 10240
    buffer_load_dwordx2 a[196:197], v223, s[20:23], s40 offen offset:512
    buffer_load_dwordx4 a[16:19], v248, s[20:23], s40 offen offset:0
    buffer_load_dwordx4 a[20:23], v248, s[20:23], s40 offen offset:2560
    s_add_u32 s41, s37, 15360
    buffer_load_dwordx2 a[198:199], v223, s[20:23], s41 offen offset:512
    buffer_load_dwordx4 a[24:27], v248, s[20:23], s41 offen offset:0
    buffer_load_dwordx4 a[28:31], v248, s[20:23], s41 offen offset:2560
    s_add_u32 s40, s37, 20480
    buffer_load_dwordx2 a[200:201], v223, s[20:23], s40 offen offset:512
    buffer_load_dwordx4 a[32:35], v248, s[20:23], s40 offen offset:0
    buffer_load_dwordx4 a[36:39], v248, s[20:23], s40 offen offset:2560
    s_add_u32 s41, s37, 25600
    buffer_load_dwordx2 a[202:203], v223, s[20:23], s41 offen offset:512
    buffer_load_dwordx4 a[40:43], v248, s[20:23], s41 offen offset:0
    buffer_load_dwordx4 a[44:47], v248, s[20:23], s41 offen offset:2560
    s_add_u32 s40, s37, 30720
    buffer_load_dwordx2 a[204:205], v223, s[20:23], s40 offen offset:512
    buffer_load_dwordx4 a[48:51], v248, s[20:23], s40 offen offset:0
    buffer_load_dwordx4 a[52:55], v248, s[20:23], s40 offen offset:2560
    s_add_u32 s41, s37, 35840
    buffer_load_dwordx2 a[206:207], v223, s[20:23], s41 offen offset:512
    buffer_load_dwordx4 a[56:59], v248, s[20:23], s41 offen offset:0
    buffer_load_dwordx4 a[60:63], v248, s[20:23], s41 offen offset:2560
    s_lshl_b32 s53, s32, 8
    v_lshl_add_u32 v118, v240, 2, s53
    s_mov_b32 s54, s36
    s_mov_b32 s55, 0
    s_mul_i32 s3, s32, 1280
    s_add_u32 m0, s3, 157696
    s_add_u32 s3, s39, 1024
    buffer_load_dwordx4 v213, s[20:23], s39 offen lds
    s_mov_b64 exec, 0xffff
    buffer_load_dwordx4 v213, s[20:23], s3 offen offset:1024 lds
    s_mov_b64 exec, -1
    s_waitcnt vmcnt(0)
    ds_read_b32 v128, v206
    ds_read_b32 v129, v207
    ds_read_b32 v130, v208
    ds_read_b32 v131, v209
    ds_read_b32 v132, v210
    s_waitcnt vmcnt(0) lgkmcnt(0)
KF_FB_LOOP:
    v_mov_b32 v133, 0
    v_mov_b32 v108, 0xff800000
    s_nop 0
    v_mfma_f32_32x32x4bf16_1k v[0:31], a[192:193], v[132:133], 0
    s_nop 15
    s_nop 1
    v_mfma_f32_32x32x16_bf16 v[0:15], a[0:3], v[128:131], v[0:15]
    v_mfma_f32_32x32x16_bf16 v[16:31], a[4:7], v[128:131], v[16:31]
    s_nop 10
    v_max3_f32 v108, v0, v1, v108
    v_max3_f32 v108, v2, v3, v108
    v_max3_f32 v108, v4, v5, v108
    v_max3_f32 v108, v6, v7, v108
    v_max3_f32 v108, v8, v9, v108
    v_max3_f32 v108, v10, v11, v108
    v_max3_f32 v108, v12, v13, v108
    v_max3_f32 v108, v14, v15, v108
    v_max3_f32 v108, v16, v17, v108
    v_max3_f32 v108, v18, v19, v108
    v_max3_f32 v108, v20, v21, v108
    v_max3_f32 v108, v22, v23, v108
    v_max3_f32 v108, v24, v25, v108
    v_max3_f32 v108, v26, v27, v108
    v_max3_f32 v108, v28, v29, v108
    v_max3_f32 v108, v30, v31, v108
    v_mfma_f32_32x32x4bf16_1k v[0:31], a[194:195], v[132:133], 0
    s_nop 15
    s_nop 1
    v_mfma_f32_32x32x16_bf16 v[0:15], a[8:11], v[128:131], v[0:15]
    v_mfma_f32_32x32x16_bf16 v[16:31], a[12:15], v[128:131], v[16:31]
    s_nop 10
    v_max3_f32 v108, v0, v1, v108
    v_max3_f32 v108, v2, v3, v108
    v_max3_f32 v108, v4, v5, v108
    v_max3_f32 v108, v6, v7, v108
    v_max3_f32 v108, v8, v9, v108
    v_max3_f32 v108, v10, v11, v108
    v_max3_f32 v108, v12, v13, v108
    v_max3_f32 v108, v14, v15, v108
    v_max3_f32 v108, v16, v17, v108
    v_max3_f32 v108, v18, v19, v108
    v_max3_f32 v108, v20, v21, v108
    v_max3_f32 v108, v22, v23, v108
    v_max3_f32 v108, v24, v25, v108
    v_max3_f32 v108, v26, v27, v108
    v_max3_f32 v108, v28, v29, v108
    v_max3_f32 v108, v30, v31, v108
    v_mfma_f32_32x32x4bf16_1k v[0:31], a[196:197], v[132:133], 0
    s_nop 15
    s_nop 1
    v_mfma_f32_32x32x16_bf16 v[0:15], a[16:19], v[128:131], v[0:15]
    v_mfma_f32_32x32x16_bf16 v[16:31], a[20:23], v[128:131], v[16:31]
    s_nop 10
    v_max3_f32 v108, v0, v1, v108
    v_max3_f32 v108, v2, v3, v108
    v_max3_f32 v108, v4, v5, v108
    v_max3_f32 v108, v6, v7, v108
    v_max3_f32 v108, v8, v9, v108
    v_max3_f32 v108, v10, v11, v108
    v_max3_f32 v108, v12, v13, v108
    v_max3_f32 v108, v14, v15, v108
    v_max3_f32 v108, v16, v17, v108
    v_max3_f32 v108, v18, v19, v108
    v_max3_f32 v108, v20, v21, v108
    v_max3_f32 v108, v22, v23, v108
    v_max3_f32 v108, v24, v25, v108
    v_max3_f32 v108, v26, v27, v108
    v_max3_f32 v108, v28, v29, v108
    v_max3_f32 v108, v30, v31, v108
    v_mfma_f32_32x32x4bf16_1k v[0:31], a[198:199], v[132:133], 0
    s_nop 15
    s_nop 1
    v_mfma_f32_32x32x16_bf16 v[0:15], a[24:27], v[128:131], v[0:15]
    v_mfma_f32_32x32x16_bf16 v[16:31], a[28:31], v[128:131], v[16:31]
    s_nop 10
    v_max3_f32 v108, v0, v1, v108
    v_max3_f32 v108, v2, v3, v108
    v_max3_f32 v108, v4, v5, v108
    v_max3_f32 v108, v6, v7, v108
    v_max3_f32 v108, v8, v9, v108
    v_max3_f32 v108, v10, v11, v108
    v_max3_f32 v108, v12, v13, v108
    v_max3_f32 v108, v14, v15, v108
    v_max3_f32 v108, v16, v17, v108
    v_max3_f32 v108, v18, v19, v108
    v_max3_f32 v108, v20, v21, v108
    v_max3_f32 v108, v22, v23, v108
    v_max3_f32 v108, v24, v25, v108
    v_max3_f32 v108, v26, v27, v108
    v_max3_f32 v108, v28, v29, v108
    v_max3_f32 v108, v30, v31, v108
    v_mfma_f32_32x32x4bf16_1k v[0:31], a[200:201], v[132:133], 0
    s_nop 15
    s_nop 1
    v_mfma_f32_32x32x16_bf16 v[0:15], a[32:35], v[128:131], v[0:15]
    v_mfma_f32_32x32x16_bf16 v[16:31], a[36:39], v[128:131], v[16:31]
    s_nop 10
    v_max3_f32 v108, v0, v1, v108
    v_max3_f32 v108, v2, v3, v108
    v_max3_f32 v108, v4, v5, v108
    v_max3_f32 v108, v6, v7, v108
    v_max3_f32 v108, v8, v9, v108
    v_max3_f32 v108, v10, v11, v108
    v_max3_f32 v108, v12, v13, v108
    v_max3_f32 v108, v14, v15, v108
    v_max3_f32 v108, v16, v17, v108
    v_max3_f32 v108, v18, v19, v108
    v_max3_f32 v108, v20, v21, v108
    v_max3_f32 v108, v22, v23, v108
    v_max3_f32 v108, v24, v25, v108
    v_max3_f32 v108, v26, v27, v108
    v_max3_f32 v108, v28, v29, v108
    v_max3_f32 v108, v30, v31, v108
    v_mfma_f32_32x32x4bf16_1k v[0:31], a[202:203], v[132:133], 0
    s_nop 15
    s_nop 1
    v_mfma_f32_32x32x16_bf16 v[0:15], a[40:43], v[128:131], v[0:15]
    v_mfma_f32_32x32x16_bf16 v[16:31], a[44:47], v[128:131], v[16:31]
    s_nop 10
    v_max3_f32 v108, v0, v1, v108
    v_max3_f32 v108, v2, v3, v108
    v_max3_f32 v108, v4, v5, v108
    v_max3_f32 v108, v6, v7, v108
    v_max3_f32 v108, v8, v9, v108
    v_max3_f32 v108, v10, v11, v108
    v_max3_f32 v108, v12, v13, v108
    v_max3_f32 v108, v14, v15, v108
    v_max3_f32 v108, v16, v17, v108
    v_max3_f32 v108, v18, v19, v108
    v_max3_f32 v108, v20, v21, v108
    v_max3_f32 v108, v22, v23, v108
    v_max3_f32 v108, v24, v25, v108
    v_max3_f32 v108, v26, v27, v108
    v_max3_f32 v108, v28, v29, v108
    v_max3_f32 v108, v30, v31, v108
    v_mfma_f32_32x32x4bf16_1k v[0:31], a[204:205], v[132:133], 0
    s_nop 15
    s_nop 1
    v_mfma_f32_32x32x16_bf16 v[0:15], a[48:51], v[128:131], v[0:15]
    v_mfma_f32_32x32x16_bf16 v[16:31], a[52:55], v[128:131], v[16:31]
    s_nop 10
    v_max3_f32 v108, v0, v1, v108
    v_max3_f32 v108, v2, v3, v108
    v_max3_f32 v108, v4, v5, v108
    v_max3_f32 v108, v6, v7, v108
    v_max3_f32 v108, v8, v9, v108
    v_max3_f32 v108, v10, v11, v108
    v_max3_f32 v108, v12, v13, v108
    v_max3_f32 v108, v14, v15, v108
    v_max3_f32 v108, v16, v17, v108
    v_max3_f32 v108, v18, v19, v108
    v_max3_f32 v108, v20, v21, v108
    v_max3_f32 v108, v22, v23, v108
    v_max3_f32 v108, v24, v25, v108
    v_max3_f32 v108, v26, v27, v108
    v_max3_f32 v108, v28, v29, v108
    v_max3_f32 v108, v30, v31, v108
    v_mfma_f32_32x32x4bf16_1k v[0:31], a[206:207], v[132:133], 0
    s_nop 15
    s_nop 1
    v_mfma_f32_32x32x16_bf16 v[0:15], a[56:59], v[128:131], v[0:15]
    v_mfma_f32_32x32x16_bf16 v[16:31], a[60:63], v[128:131], v[16:31]
    s_nop 10
    v_max3_f32 v108, v0, v1, v108
    v_max3_f32 v108, v2, v3, v108
    v_max3_f32 v108, v4, v5, v108
    v_max3_f32 v108, v6, v7, v108
    v_max3_f32 v108, v8, v9, v108
    v_max3_f32 v108, v10, v11, v108
    v_max3_f32 v108, v12, v13, v108
    v_max3_f32 v108, v14, v15, v108
    v_max3_f32 v108, v16, v17, v108
    v_max3_f32 v108, v18, v19, v108
    v_max3_f32 v108, v20, v21, v108
    v_max3_f32 v108, v22, v23, v108
    v_max3_f32 v108, v24, v25, v108
    v_max3_f32 v108, v26, v27, v108
    v_max3_f32 v108, v28, v29, v108
    v_max3_f32 v108, v30, v31, v108
    v_mov_b32 v109, v108
    s_nop 1
    v_permlane32_swap_b32 v109, v108
    v_max_f32 v108, v108, v109
    ds_write_b32 v118, v108 offset:50240
    v_add_u32 v118, 1024, v118
    s_add_u32 s54, s54, 144
    s_add_u32 s55, s55, 1
    buffer_load_dwordx4 v[128:131], v246, s[20:23], s54 offen
    buffer_load_dword v132, v247, s[20:23], s54 offen offset:32
    s_waitcnt vmcnt(0) lgkmcnt(0)
    s_cmp_lt_u32 s55, 8
    s_cbranch_scc1 KF_FB_LOOP
    s_barrier
    v_lshlrev_b32 v118, 2, v240
    ds_read_b32 v108, v118 offset:50240
    ds_read_b32 v109, v118 offset:50496
    ds_read_b32 v110, v118 offset:50752
    ds_read_b32 v111, v118 offset:51008
    s_waitcnt lgkmcnt(1)
    v_max3_f32 v108, v108, v109, v110
    s_waitcnt lgkmcnt(0)
    v_max_f32 v108, v108, v111
    v_and_b32 v109, 0xffff0000, v108
    v_sub_f32 v110, v108, v109
    v_cvt_pk_bf16_f32 v109, -v109, -v110
    v_accvgpr_write_b32 a241, v109
    ds_read_b32 v108, v118 offset:51264
    ds_read_b32 v109, v118 offset:51520
    ds_read_b32 v110, v118 offset:51776
    ds_read_b32 v111, v118 offset:52032
    s_waitcnt lgkmcnt(1)
    v_max3_f32 v108, v108, v109, v110
    s_waitcnt lgkmcnt(0)
    v_max_f32 v108, v108, v111
    v_and_b32 v109, 0xffff0000, v108
    v_sub_f32 v110, v108, v109
    v_cvt_pk_bf16_f32 v109, -v109, -v110
    v_accvgpr_write_b32 a243, v109
    ds_read_b32 v108, v118 offset:52288
    ds_read_b32 v109, v118 offset:52544
    ds_read_b32 v110, v118 offset:52800
    ds_read_b32 v111, v118 offset:53056
    s_waitcnt lgkmcnt(1)
    v_max3_f32 v108, v108, v109, v110
    s_waitcnt lgkmcnt(0)
    v_max_f32 v108, v108, v111
    v_and_b32 v109, 0xffff0000, v108
    v_sub_f32 v110, v108, v109
    v_cvt_pk_bf16_f32 v109, -v109, -v110
    v_accvgpr_write_b32 a245, v109
    ds_read_b32 v108, v118 offset:53312
    ds_read_b32 v109, v118 offset:53568
    ds_read_b32 v110, v118 offset:53824
    ds_read_b32 v111, v118 offset:54080
    s_waitcnt lgkmcnt(1)
    v_max3_f32 v108, v108, v109, v110
    s_waitcnt lgkmcnt(0)
    v_max_f32 v108, v108, v111
    v_and_b32 v109, 0xffff0000, v108
    v_sub_f32 v110, v108, v109
    v_cvt_pk_bf16_f32 v109, -v109, -v110
    v_accvgpr_write_b32 a247, v109
    ds_read_b32 v108, v118 offset:54336
    ds_read_b32 v109, v118 offset:54592
    ds_read_b32 v110, v118 offset:54848
    ds_read_b32 v111, v118 offset:55104
    s_waitcnt lgkmcnt(1)
    v_max3_f32 v108, v108, v109, v110
    s_waitcnt lgkmcnt(0)
    v_max_f32 v108, v108, v111
    v_and_b32 v109, 0xffff0000, v108
    v_sub_f32 v110, v108, v109
    v_cvt_pk_bf16_f32 v109, -v109, -v110
    v_accvgpr_write_b32 a249, v109
    ds_read_b32 v108, v118 offset:55360
    ds_read_b32 v109, v118 offset:55616
    ds_read_b32 v110, v118 offset:55872
    ds_read_b32 v111, v118 offset:56128
    s_waitcnt lgkmcnt(1)
    v_max3_f32 v108, v108, v109, v110
    s_waitcnt lgkmcnt(0)
    v_max_f32 v108, v108, v111
    v_and_b32 v109, 0xffff0000, v108
    v_sub_f32 v110, v108, v109
    v_cvt_pk_bf16_f32 v109, -v109, -v110
    v_accvgpr_write_b32 a251, v109
    ds_read_b32 v108, v118 offset:56384
    ds_read_b32 v109, v118 offset:56640
    ds_read_b32 v110, v118 offset:56896
    ds_read_b32 v111, v118 offset:57152
    s_waitcnt lgkmcnt(1)
    v_max3_f32 v108, v108, v109, v110
    s_waitcnt lgkmcnt(0)
    v_max_f32 v108, v108, v111
    v_and_b32 v109, 0xffff0000, v108
    v_sub_f32 v110, v108, v109
    v_cvt_pk_bf16_f32 v109, -v109, -v110
    v_accvgpr_write_b32 a253, v109
    ds_read_b32 v108, v118 offset:57408
    ds_read_b32 v109, v118 offset:57664
    ds_read_b32 v110, v118 offset:57920
    ds_read_b32 v111, v118 offset:58176
    s_waitcnt lgkmcnt(1)
    v_max3_f32 v108, v108, v109, v110
    s_waitcnt lgkmcnt(0)
    v_max_f32 v108, v108, v111
    v_and_b32 v109, 0xffff0000, v108
    v_sub_f32 v110, v108, v109
    v_cvt_pk_bf16_f32 v109, -v109, -v110
    v_accvgpr_write_b32 a255, v109
    s_mov_b32 s33, 1
    s_add_u32 s40, s37, 0
    buffer_load_dwordx2 a[192:193], v223, s[20:23], s40 offen offset:512
    buffer_load_dwordx4 a[0:3], v248, s[20:23], s40 offen offset:0
    buffer_load_dwordx4 a[4:7], v248, s[20:23], s40 offen offset:2560
    s_add_u32 s41, s37, 5120
    buffer_load_dwordx2 a[194:195], v223, s[20:23], s41 offen offset:512
    buffer_load_dwordx4 a[8:11], v248, s[20:23], s41 offen offset:0
    buffer_load_dwordx4 a[12:15], v248, s[20:23], s41 offen offset:2560
    buffer_load_dwordx4 a[64:67], v249, s[20:23], s40 offen offset:0
    buffer_load_dwordx4 a[68:71], v249, s[20:23], s40 offen offset:1280
    buffer_load_dwordx4 a[72:75], v249, s[20:23], s40 offen offset:2560
    buffer_load_dwordx4 a[76:79], v249, s[20:23], s40 offen offset:3840
    s_add_u32 s40, s37, 10240
    buffer_load_dwordx2 a[196:197], v223, s[20:23], s40 offen offset:512
    buffer_load_dwordx4 a[16:19], v248, s[20:23], s40 offen offset:0
    buffer_load_dwordx4 a[20:23], v248, s[20:23], s40 offen offset:2560
    buffer_load_dwordx4 a[80:83], v249, s[20:23], s41 offen offset:0
    buffer_load_dwordx4 a[84:87], v249, s[20:23], s41 offen offset:1280
    buffer_load_dwordx4 a[88:91], v249, s[20:23], s41 offen offset:2560
    buffer_load_dwordx4 a[92:95], v249, s[20:23], s41 offen offset:3840
    s_add_u32 s41, s37, 15360
    buffer_load_dwordx2 a[198:199], v223, s[20:23], s41 offen offset:512
    buffer_load_dwordx4 a[24:27], v248, s[20:23], s41 offen offset:0
    buffer_load_dwordx4 a[28:31], v248, s[20:23], s41 offen offset:2560
    buffer_load_dwordx4 a[96:99], v249, s[20:23], s40 offen offset:0
    buffer_load_dwordx4 a[100:103], v249, s[20:23], s40 offen offset:1280
    buffer_load_dwordx4 a[104:107], v249, s[20:23], s40 offen offset:2560
    buffer_load_dwordx4 a[108:111], v249, s[20:23], s40 offen offset:3840
    s_add_u32 s40, s37, 20480
    buffer_load_dwordx2 a[200:201], v223, s[20:23], s40 offen offset:512
    buffer_load_dwordx4 a[32:35], v248, s[20:23], s40 offen offset:0
    buffer_load_dwordx4 a[36:39], v248, s[20:23], s40 offen offset:2560
    buffer_load_dwordx4 a[112:115], v249, s[20:23], s41 offen offset:0
    s_waitcnt vmcnt(0) lgkmcnt(0)
    s_nop 15
    s_nop 3
    s_barrier
    s_branch KF_START
CODE_END:
.section .rodata,"a"
.p2align 6
.amdhsa_kernel sequential_preLN__grouped_kv_mqa__glu_gated_geglu__prompt_kernel
  .amdhsa_next_free_vgpr 512
  .amdhsa_next_free_sgpr 102
  .amdhsa_accum_offset 256
  .amdhsa_group_segment_fixed_size 0
  .amdhsa_kernarg_size 96
  .amdhsa_user_sgpr_count 2
  .amdhsa_user_sgpr_kernarg_segment_ptr 1
  .amdhsa_system_sgpr_workgroup_id_x 1
.end_amdhsa_kernel
```
